```python
import torch

def _softmax(x, axis=-1):
    return torch.softmax(x, dim=axis)
def _gelu(x):
    return torch.nn.functional.gelu(x, approximate="tanh")
def _silu(x):
    return torch.nn.functional.silu(x)
def _sigmoid(x):
    return torch.sigmoid(x)
def _layernorm(x, axis=-1, eps=1e-5):
    m = x.mean(dim=axis, keepdim=True)
    v = x.var(dim=axis, keepdim=True, unbiased=False)
    return (x - m) / torch.sqrt(v + eps)
def _scatter_add(tgt, idx, src, axis=0):
    return tgt.clone().index_add_(axis, idx, src)
def _segment_sum(src, seg, n):
    out = torch.zeros((n,) + src.shape[1:], dtype=src.dtype)
    return out.index_add_(0, seg, src)
def _pad(x, pw):
    flat = tuple(v for pair in reversed(pw) for v in pair)
    return torch.nn.functional.pad(x, flat)

kernel_name = 'gated_mix__compressed_kv_cla__linear_attn_block__prompt'

def setup_inputs():

    _w = (lambda a: (lambda t: t.to(torch.bfloat16) if t.is_floating_point() else t)(torch.as_tensor(a)))
    def _A_setup():
        B, H, Sq, Sk, D, M = 1, 32, 2048, 2048, 128, 512
        Dc = 4 * D
        return {
            "x": _w((lambda *s: torch.randn(*s, dtype=torch.bfloat16) * 0.05)(B, Sq, M)),
            "c_kv": _w((lambda *s: torch.randn(*s, dtype=torch.bfloat16) * 1.6)(B, Sk, Dc)),
            "w_q": _w((lambda *s: torch.randn(*s, dtype=torch.bfloat16) * 3.2)(M, H, D) * (M ** -0.5)),
            "w_uk": _w((lambda *s: torch.randn(*s, dtype=torch.bfloat16) * 3.2)(Dc, H, D) * (Dc ** -0.5)),
            "w_uv": _w((lambda *s: torch.randn(*s, dtype=torch.bfloat16) * 1.6)(Dc, H, D) * (Dc ** -0.5)),
            "w_o": _w((lambda *s: torch.randn(*s, dtype=torch.bfloat16) * 1.6)(H, D, M) * ((H * D) ** -0.5)),
        }
    _A_in = _A_setup()

    def _B_setup():
        B, S, D = 1, 2048, 512
        return {
            "x": _w((lambda *s: torch.randn(*s, dtype=torch.bfloat16) * 0.05)(B, S, D)),
            "wqkv": _w((lambda *s: torch.randn(*s, dtype=torch.bfloat16) * 3.2)(D, 3 * D)),
            "wo": _w((lambda *s: torch.randn(*s, dtype=torch.bfloat16) * 0.4)(D, D)),
        }
    _B_in = _B_setup()

    return {
        "A_x": _A_in["x"],
        "A_c_kv": _A_in["c_kv"],
        "A_w_q": _A_in["w_q"],
        "A_w_uk": _A_in["w_uk"],
        "A_w_uv": _A_in["w_uv"],
        "A_w_o": _A_in["w_o"],
        "B_x": _B_in["x"],
        "B_wqkv": _B_in["wqkv"],
        "B_wo": _B_in["wo"],
        "gate_w": _w((lambda *s: torch.randn(*s, dtype=torch.bfloat16) * 0.05)(512) * 16.0),
    }

def reference(A_x, A_c_kv, A_w_q, A_w_uk, A_w_uv, A_w_o, B_x, B_wqkv, B_wo, gate_w):
    def _A_ref(x, c_kv, w_q, w_uk, w_uv, w_o):
        B, Sq, M = x.shape[0], x.shape[1], x.shape[2]
        Sk = c_kv.shape[1]
        H, D = w_q.shape[1], w_q.shape[2]
        q = torch.einsum("bqm,mhd->bhqd", x, w_q)
        k = torch.einsum("bkc,chd->bhkd", c_kv, w_uk)
        v = torch.einsum("bkc,chd->bhkd", c_kv, w_uv)
        scores = torch.einsum("bhqd,bhkd->bhqk", q, k) * (D ** -0.5)
        off = Sk - Sq
        qi = torch.arange(Sq)[:, None]
        kj = torch.arange(Sk)[None, :]
        cmask = kj <= (qi + off)
        scores = torch.where(cmask[None, None], scores, -1e9)
        p = _softmax(scores, axis=-1)
        ctx = torch.einsum("bhqk,bhkd->bhqd", p, v)
        return torch.einsum("bhqd,hdm->bqm", ctx, w_o)

    def _B_ref(x, wqkv, wo):
        B, S, D = x.shape
        H = 32; Dh = D // H
        qkv = (lambda x, *d: x.permute(*d))((x @ wqkv).reshape(B, S, 3, H, Dh), 2, 0, 3, 1, 4)
        q, k, v = qkv[0], qkv[1], qkv[2]
        phi = lambda t: torch.where(t > 0, t + 1, torch.exp(t)) + 1e-6
        pq, pk = phi(q), phi(k)
        kv = torch.einsum("bhsd,bhse->bhde", pk, v)
        z = torch.einsum("bhsd->bhd", pk)
        num = torch.einsum("bhqd,bhde->bhqe", pq, kv)
        den = torch.einsum("bhqd,bhd->bhq", pq, z)[..., None] + 1e-6
        o = num / den
        return (lambda x, *d: x.permute(*d))(o, 0, 2, 1, 3).reshape(B, S, D) @ wo

    x = A_x
    g = _sigmoid((x * gate_w).sum(-1, keepdims=True))
    a = _A_ref(x, A_c_kv, A_w_q, A_w_uk, A_w_uv, A_w_o)
    b = _B_ref(x, B_wqkv, B_wo)
    return g * a + (1 - g) * b
```

```asm
; @launch kernel=fused_kernel grid=(256,1,1) block=(512,1,1) lds=163840
.amdgcn_target "amdgcn-amd-amdhsa--gfx950"
.text
.globl fused_kernel
.p2align 8
.type fused_kernel,@function
fused_kernel:
  s_cmp_ge_u32 s2, 256
  s_cbranch_scc1 L_end
  s_load_dwordx16 s[64:79], s[0:1], 0
  s_load_dwordx8 s[80:87], s[0:1], 64
  s_load_dwordx2 s[88:89], s[0:1], 96
  v_and_b32 v254, 63, v0
  v_lshrrev_b32 v184, 6, v0
  s_and_b32 s52, s2, 7
  s_lshr_b32 s53, s2, 3
  v_readfirstlane_b32 s92, v184
  s_lshl_b32 s90, s52, 2
  s_and_b32 s54, s53, 3
  s_add_u32 s90, s90, s54
  s_lshr_b32 s91, s53, 2
  s_lshr_b32 s93, s92, 2
  s_and_b32 s94, s92, 3
  s_lshr_b32 s95, s90, 1
  s_lshl_b32 s96, s90, 3
  s_add_u32 s96, s96, s91
  s_sub_u32 s97, 16, s91
  s_sub_u32 s55, 15, s91
  s_and_b32 s56, s90, 1
  s_cmp_eq_u32 s56, 0
  s_cselect_b32 s98, s91, s55
  s_mov_b32 s99, 262144
  s_sub_u32 s62, 3, s94
  s_cmp_eq_u32 s93, 0
  s_cselect_b32 s62, s94, s62
  v_lshlrev_b32 v253, 4, v254
  v_lshrrev_b32 v185, 4, v254
  v_lshrrev_b32 v186, 5, v254
  v_bfe_u32 v187, v254, 2, 2
  v_lshrrev_b32 v184, 3, v254
  v_lshlrev_b32 v184, 10, v184
  v_and_b32 v189, 7, v254
  v_xor_b32 v189, v189, v185
  v_lshlrev_b32 v189, 4, v189
  v_xor_b32 v190, 64, v189
  v_add_u32 v208, v184, v189
  v_add_u32 v209, v184, v190
  v_add_u32 v209, 7168, v209
  v_add_u32 v210, 14336, v208
  v_add_u32 v211, 14336, v209
  s_lshl_b32 s57, s90, 8
  v_lshlrev_b32 v184, 13, v185
  v_add_u32 v184, s57, v184
  v_and_b32 v189, 15, v254
  v_lshlrev_b32 v190, 2, v185
  v_xor_b32 v189, v189, v190
  s_and_b32 s57, s94, 1
  s_lshl_b32 s57, s57, 1
  v_xor_b32 v190, s57, v189
  v_lshl_add_u32 v212, v190, 4, v184
  v_add_u32 v213, 31744, v212
  v_mul_u32_u24 v184, 3072, v185
  v_lshrrev_b32 v190, 2, v189
  v_min_u32 v190, 2, v190
  v_lshl_add_u32 v184, v190, 10, v184
  v_and_b32 v190, 3, v189
  v_lshl_add_u32 v184, v190, 4, v184
  s_lshl_b32 s57, s95, 6
  v_add_u32 v214, s57, v184
  v_add_u32 v215, 11264, v214
  v_bfe_u32 v184, v254, 2, 2
  v_xor_b32 v184, v184, v185
  v_cmp_ne_u32 s[2:3], 3, v184
  s_waitcnt lgkmcnt(0)
  s_mov_b32 s16, s64
  s_and_b32 s17, s65, 0xffff
  s_mov_b32 s18, 2097152
  s_mov_b32 s19, 0x20000
  s_mov_b32 s20, s68
  s_and_b32 s21, s69, 0xffff
  s_mov_b32 s22, 4194304
  s_mov_b32 s23, 0x20000
  s_mov_b32 s24, s78
  s_and_b32 s25, s79, 0xffff
  s_mov_b32 s26, 1572864
  s_mov_b32 s27, 0x20000
  s_mov_b32 s4, s66
  s_and_b32 s5, s67, 0xffff
  s_mov_b32 s6, 2097152
  s_mov_b32 s7, 0x20000
  s_mov_b32 s8, s70
  s_and_b32 s9, s71, 0xffff
  s_mov_b32 s10, 4194304
  s_mov_b32 s11, 0x20000
  s_mov_b32 s12, s72
  s_and_b32 s13, s73, 0xffff
  s_mov_b32 s14, 4194304
  s_mov_b32 s15, 0x20000
  s_mov_b32 s28, s88
  s_and_b32 s29, s89, 0xffff
  s_mov_b32 s30, 100663296
  s_mov_b32 s31, 0x20000
  s_mov_b32 s32, s74
  s_and_b32 s33, s75, 0xffff
  s_mov_b32 s34, 4194304
  s_mov_b32 s35, 0x20000
  s_mov_b32 s36, s80
  s_and_b32 s37, s81, 0xffff
  s_mov_b32 s38, 524288
  s_mov_b32 s39, 0x20000
  s_mov_b32 s40, s84
  s_and_b32 s41, s85, 0xffff
  s_mov_b32 s42, 2097152
  s_mov_b32 s43, 0x20000
  s_mov_b32 s44, s82
  s_and_b32 s45, s83, 0xffff
  s_mov_b32 s46, 1024
  s_mov_b32 s47, 0x20000
  s_mov_b32 s48, s86
  s_and_b32 s49, s87, 0xffff
  s_mov_b32 s50, 256
  s_mov_b32 s51, 0x20000
  s_mov_b32 s80, s62
  s_lshl_b32 s57, s94, 15
  s_lshl_b32 s64, s91, 17
  s_add_u32 s64, s64, s57
  s_lshl_b32 s65, s55, 17
  s_add_u32 s65, s65, s57
  s_lshl_b32 s66, s94, 16
  s_mul_i32 s67, s94, 24576
  s_lshl_b32 s68, s94, 12
  s_and_b32 s0, s90, 3
  s_lshl_b32 s0, s0, 1
  s_mov_b32 s0, 0
  s_and_b32 s1, s0, 7
  s_sub_u32 s52, s1, 6
  s_cmp_ge_u32 s1, 6
  s_cselect_b32 s1, s52, s1
  s_cmp_lg_u32 s93, 0
  s_cbranch_scc1 L_g1
  s_mov_b32 s53, 0
  s_lshl_b32 s53, s53, 7
  s_add_u32 m0, s68, 0
  s_add_u32 s52, s64, s53
  buffer_load_dwordx4 v208, s[4:7], s52 offen offset:0 lds
  buffer_load_dwordx4 v209, s[4:7], s52 offen offset:1024 lds
  buffer_load_dwordx4 v210, s[4:7], s52 offen offset:2048 lds
  buffer_load_dwordx4 v211, s[4:7], s52 offen offset:3072 lds
  s_add_u32 m0, s68, 16384
  s_add_u32 s52, s65, s53
  buffer_load_dwordx4 v208, s[4:7], s52 offen offset:0 lds
  buffer_load_dwordx4 v209, s[4:7], s52 offen offset:1024 lds
  buffer_load_dwordx4 v210, s[4:7], s52 offen offset:2048 lds
  buffer_load_dwordx4 v211, s[4:7], s52 offen offset:3072 lds
  s_mov_b32 s56, 0
  s_lshl_b32 s56, s56, 19
  s_add_u32 s56, s56, s66
  s_add_u32 m0, s68, 65536
  s_add_u32 s58, s56, 0
  buffer_load_dwordx4 v212, s[8:11], s58 offen offset:0 lds
  buffer_load_dwordx4 v213, s[8:11], s58 offen offset:1024 lds
  s_add_u32 m0, m0, 2048
  s_nop 0
  buffer_load_dwordx4 v212, s[12:15], s58 offen offset:0 lds
  buffer_load_dwordx4 v213, s[12:15], s58 offen offset:1024 lds
  s_add_u32 m0, s68, 81920
  s_add_u32 s58, s56, 262144
  buffer_load_dwordx4 v212, s[8:11], s58 offen offset:0 lds
  buffer_load_dwordx4 v213, s[8:11], s58 offen offset:1024 lds
  s_add_u32 m0, m0, 2048
  s_nop 0
  buffer_load_dwordx4 v212, s[12:15], s58 offen offset:0 lds
  buffer_load_dwordx4 v213, s[12:15], s58 offen offset:1024 lds
  s_sub_u32 s55, 15, s91
  s_and_b32 s56, s90, 1
  s_lshr_b32 s57, s92, 1
  s_and_b32 s57, s57, 1
  s_lshl_b32 s58, s57, 13
  s_lshl_b32 s59, s93, 2
  s_add_u32 s59, s59, s80
  s_lshl_b32 s59, s59, 12
  s_sub_u32 s86, s59, s58
  s_lshl_b32 s60, s56, 2
  s_add_u32 s60, s60, s94
  s_lshl_b32 s60, s60, 12
  v_bfe_u32 v188, v254, 1, 3
  v_and_b32 v184, 15, v254
  v_lshlrev_b32 v184, 7, v184
  v_xor_b32 v189, v188, v185
  v_lshl_add_u32 v184, v189, 4, v184
  v_add_u32 v160, s58, v184
  v_xor_b32 v161, 64, v160
  v_and_b32 v184, 31, v254
  v_lshlrev_b32 v184, 7, v184
  v_xor_b32 v189, v188, v186
  v_lshl_add_u32 v184, v189, 4, v184
  v_add_u32 v164, s60, v184
  v_xor_b32 v165, 32, v164
  v_xor_b32 v166, 64, v164
  v_xor_b32 v167, 96, v164
  v_mul_u32_u24 v184, 320, v187
  v_and_b32 v189, 1, v185
  v_lshl_add_u32 v184, v189, 5, v184
  v_and_b32 v189, 3, v254
  v_lshl_add_u32 v184, v189, 3, v184
  v_add_u32 v184, 0x10000, v184
  v_lshl_add_u32 v189, v186, 12, v184
  s_lshl_b32 s59, s93, 6
  v_xor_b32 v162, s59, v189
  v_xor_b32 v163, 128, v189
  s_and_b32 s58, s92, 1
  s_lshl_b32 s59, s58, 7
  v_lshl_add_u32 v189, v185, 12, v184
  v_xor_b32 v168, s59, v189
  v_xor_b32 v169, 32, v168
  v_xor_b32 v170, 64, v168
  v_xor_b32 v171, 96, v168
  v_xor_b32 v172, 128, v168
  v_xor_b32 v173, 160, v168
  v_xor_b32 v174, 192, v168
  v_xor_b32 v175, 224, v168
  s_lshl_b32 s61, s90, 19
  s_lshl_b32 s59, s57, 14
  s_add_u32 s61, s61, s59
  s_lshl_b32 s59, s58, 12
  s_add_u32 s61, s61, s59
  s_lshl_b32 s59, s93, 24
  s_add_u32 s61, s61, s59
  s_lshl_b32 s59, s91, 15
  s_add_u32 s69, s61, s59
  s_lshl_b32 s59, s55, 15
  s_add_u32 s70, s61, s59
  s_lshr_b32 s71, s90, 3
  s_and_b32 s72, s90, 3
  v_and_b32 v184, 7, v254
  v_lshlrev_b32 v249, 5, v184
  v_lshrrev_b32 v189, 3, v254
  v_lshlrev_b32 v189, 7, v189
  v_lshl_add_u32 v189, v184, 2, v189
  s_lshl_b32 s52, s90, 10
  s_add_u32 s52, s52, 60850176
  v_add_u32 v248, s52, v189
  s_lshl_b32 s52, s94, 13
  s_lshl_b32 s53, s90, 19
  s_sub_u32 s73, 24576, s52
  s_add_u32 s73, s73, s53
  s_sub_u32 s74, 32768, s52
  s_and_b32 s74, s74, 0x7fff
  s_add_u32 s74, s74, s53
  s_add_u32 s74, s74, 16777216
  s_add_u32 s75, s52, 0
  s_add_u32 s76, s52, 98304
  s_cmp_eq_u32 s93, 0
  s_cselect_b32 s79, s91, s55
  s_add_u32 s53, s91, 1
  s_cselect_b32 s78, s53, s55
  s_cmp_eq_u32 s93, 0
  s_cselect_b32 s78, s53, s55
  s_cmp_eq_u32 s78, 1
  s_cselect_b32 s78, 0, s78
  s_mov_b32 s77, 0
  s_mov_b32 s81, 0
  s_mov_b32 s85, 0
  s_mov_b32 s84, 1
  s_mov_b32 s82, 0
  s_mov_b32 s83, 0x47800000
  s_waitcnt vmcnt(0)
  s_barrier
  ds_read_b64_tr_b16 v[216:217], v168 offset:0
  ds_read_b64_tr_b16 v[218:219], v168 offset:1024
  ds_read_b128 v[220:223], v160 offset:0
  ds_read_b64_tr_b16 v[176:177], v168 offset:16384
  ds_read_b64_tr_b16 v[178:179], v168 offset:17408
  ds_read_b128 v[180:183], v161 offset:0
  ds_read_b64_tr_b16 v[184:185], v169 offset:0
  ds_read_b64_tr_b16 v[186:187], v169 offset:1024
  s_waitcnt lgkmcnt(5)
  v_mfma_f32_16x16x32_bf16 v[0:3], v[216:219], v[220:223], 0
  ds_read_b64_tr_b16 v[188:189], v169 offset:16384
  ds_read_b64_tr_b16 v[190:191], v169 offset:17408
  s_waitcnt lgkmcnt(4)
  v_mfma_f32_16x16x32_bf16 v[0:3], v[176:179], v[180:183], v[0:3]
  ds_read_b64_tr_b16 v[192:193], v170 offset:0
  ds_read_b64_tr_b16 v[194:195], v170 offset:1024
  s_waitcnt lgkmcnt(4)
  v_mfma_f32_16x16x32_bf16 v[4:7], v[184:187], v[220:223], 0
  ds_read_b64_tr_b16 v[196:197], v170 offset:16384
  ds_read_b64_tr_b16 v[198:199], v170 offset:17408
  s_waitcnt lgkmcnt(4)
  v_mfma_f32_16x16x32_bf16 v[4:7], v[188:191], v[180:183], v[4:7]
  ds_read_b64_tr_b16 v[200:201], v171 offset:0
  ds_read_b64_tr_b16 v[202:203], v171 offset:1024
  s_waitcnt lgkmcnt(4)
  v_mfma_f32_16x16x32_bf16 v[8:11], v[192:195], v[220:223], 0
  ds_read_b64_tr_b16 v[204:205], v171 offset:16384
  ds_read_b64_tr_b16 v[206:207], v171 offset:17408
  s_waitcnt lgkmcnt(4)
  v_mfma_f32_16x16x32_bf16 v[8:11], v[196:199], v[180:183], v[8:11]
  ds_read_b128 v[128:131], v160 offset:2048
  ds_read_b128 v[132:135], v161 offset:2048
  s_waitcnt lgkmcnt(4)
  v_mfma_f32_16x16x32_bf16 v[12:15], v[200:203], v[220:223], 0
  ds_read_b128 v[220:223], v160 offset:4096
  ds_read_b128 v[136:139], v161 offset:4096
  s_waitcnt lgkmcnt(4)
  v_mfma_f32_16x16x32_bf16 v[12:15], v[204:207], v[180:183], v[12:15]
  s_waitcnt lgkmcnt(3)
  v_mfma_f32_16x16x32_bf16 v[16:19], v[216:219], v[128:131], 0
  ds_read_b128 v[180:183], v160 offset:6144
  s_waitcnt lgkmcnt(3)
  v_mfma_f32_16x16x32_bf16 v[16:19], v[176:179], v[132:135], v[16:19]
  ds_read_b128 v[140:143], v161 offset:6144
  v_mfma_f32_16x16x32_bf16 v[20:23], v[184:187], v[128:131], 0
  v_mfma_f32_16x16x32_bf16 v[20:23], v[188:191], v[132:135], v[20:23]
  v_mfma_f32_16x16x32_bf16 v[24:27], v[192:195], v[128:131], 0
  v_mfma_f32_16x16x32_bf16 v[24:27], v[196:199], v[132:135], v[24:27]
  v_mfma_f32_16x16x32_bf16 v[28:31], v[200:203], v[128:131], 0
  v_mfma_f32_16x16x32_bf16 v[28:31], v[204:207], v[132:135], v[28:31]
  s_waitcnt lgkmcnt(2)
  v_mfma_f32_16x16x32_bf16 v[32:35], v[216:219], v[220:223], 0
  ds_read_b128 v[128:131], v160 offset:16384
  v_mfma_f32_16x16x32_bf16 v[32:35], v[176:179], v[136:139], v[32:35]
  ds_read_b128 v[132:135], v161 offset:16384
  v_mfma_f32_16x16x32_bf16 v[36:39], v[184:187], v[220:223], 0
  v_mfma_f32_16x16x32_bf16 v[36:39], v[188:191], v[136:139], v[36:39]
  v_mfma_f32_16x16x32_bf16 v[40:43], v[192:195], v[220:223], 0
  v_mfma_f32_16x16x32_bf16 v[40:43], v[196:199], v[136:139], v[40:43]
  v_mfma_f32_16x16x32_bf16 v[44:47], v[200:203], v[220:223], 0
  v_mfma_f32_16x16x32_bf16 v[44:47], v[204:207], v[136:139], v[44:47]
  s_waitcnt lgkmcnt(2)
  v_mfma_f32_16x16x32_bf16 v[48:51], v[216:219], v[180:183], 0
  ds_read_b128 v[220:223], v160 offset:18432
  v_mfma_f32_16x16x32_bf16 v[48:51], v[176:179], v[140:143], v[48:51]
  ds_read_b128 v[136:139], v161 offset:18432
  v_mfma_f32_16x16x32_bf16 v[52:55], v[184:187], v[180:183], 0
  v_mfma_f32_16x16x32_bf16 v[52:55], v[188:191], v[140:143], v[52:55]
  v_mfma_f32_16x16x32_bf16 v[56:59], v[192:195], v[180:183], 0
  v_mfma_f32_16x16x32_bf16 v[56:59], v[196:199], v[140:143], v[56:59]
  v_mfma_f32_16x16x32_bf16 v[60:63], v[200:203], v[180:183], 0
  v_mfma_f32_16x16x32_bf16 v[60:63], v[204:207], v[140:143], v[60:63]
  s_waitcnt lgkmcnt(2)
  v_mfma_f32_16x16x32_bf16 v[64:67], v[216:219], v[128:131], 0
  ds_read_b128 v[180:183], v160 offset:20480
  v_mfma_f32_16x16x32_bf16 v[64:67], v[176:179], v[132:135], v[64:67]
  ds_read_b128 v[140:143], v161 offset:20480
  v_mfma_f32_16x16x32_bf16 v[68:71], v[184:187], v[128:131], 0
  v_mfma_f32_16x16x32_bf16 v[68:71], v[188:191], v[132:135], v[68:71]
  v_mfma_f32_16x16x32_bf16 v[72:75], v[192:195], v[128:131], 0
  v_mfma_f32_16x16x32_bf16 v[72:75], v[196:199], v[132:135], v[72:75]
  v_mfma_f32_16x16x32_bf16 v[76:79], v[200:203], v[128:131], 0
  v_mfma_f32_16x16x32_bf16 v[76:79], v[204:207], v[132:135], v[76:79]
  s_waitcnt lgkmcnt(2)
  v_mfma_f32_16x16x32_bf16 v[80:83], v[216:219], v[220:223], 0
  ds_read_b128 v[128:131], v160 offset:22528
  v_mfma_f32_16x16x32_bf16 v[80:83], v[176:179], v[136:139], v[80:83]
  ds_read_b128 v[132:135], v161 offset:22528
  v_mfma_f32_16x16x32_bf16 v[84:87], v[184:187], v[220:223], 0
  v_mfma_f32_16x16x32_bf16 v[84:87], v[188:191], v[136:139], v[84:87]
  v_mfma_f32_16x16x32_bf16 v[88:91], v[192:195], v[220:223], 0
  v_mfma_f32_16x16x32_bf16 v[88:91], v[196:199], v[136:139], v[88:91]
  v_mfma_f32_16x16x32_bf16 v[92:95], v[200:203], v[220:223], 0
  v_mfma_f32_16x16x32_bf16 v[92:95], v[204:207], v[136:139], v[92:95]
  s_waitcnt lgkmcnt(0)
  s_barrier
  ds_read_b64_tr_b16 v[220:221], v168 offset:32768
  ds_read_b64_tr_b16 v[222:223], v168 offset:33792
  ds_read_b128 v[136:139], v160 offset:32768
  ds_read_b64_tr_b16 v[144:145], v168 offset:49152
  ds_read_b64_tr_b16 v[146:147], v168 offset:50176
  ds_read_b128 v[148:151], v161 offset:32768
  s_add_u32 s53, s1, 2
  s_sub_u32 s52, s53, 6
  s_cmp_ge_u32 s53, 8
  s_cselect_b32 s53, s52, s53
  s_lshl_b32 s53, s53, 7
  s_add_u32 m0, s68, 0
  s_add_u32 s52, s64, s53
  buffer_load_dwordx4 v208, s[4:7], s52 offen offset:0 lds
  buffer_load_dwordx4 v209, s[4:7], s52 offen offset:1024 lds
  buffer_load_dwordx4 v210, s[4:7], s52 offen offset:2048 lds
  buffer_load_dwordx4 v211, s[4:7], s52 offen offset:3072 lds
  s_add_u32 m0, s68, 16384
  s_add_u32 s52, s65, s53
  buffer_load_dwordx4 v208, s[4:7], s52 offen offset:0 lds
  buffer_load_dwordx4 v209, s[4:7], s52 offen offset:1024 lds
  buffer_load_dwordx4 v210, s[4:7], s52 offen offset:2048 lds
  buffer_load_dwordx4 v211, s[4:7], s52 offen offset:3072 lds
  s_add_u32 s56, s1, 3
  s_sub_u32 s52, s56, 6
  s_cmp_ge_u32 s56, 8
  s_cselect_b32 s56, s52, s56
  s_lshl_b32 s56, s56, 19
  s_add_u32 s56, s56, s66
  s_add_u32 m0, s68, 65536
  s_add_u32 s58, s56, 0
  buffer_load_dwordx4 v212, s[8:11], s58 offen offset:0 lds
  buffer_load_dwordx4 v213, s[8:11], s58 offen offset:1024 lds
  s_add_u32 m0, m0, 2048
  s_nop 0
  buffer_load_dwordx4 v212, s[12:15], s58 offen offset:0 lds
  buffer_load_dwordx4 v213, s[12:15], s58 offen offset:1024 lds
  s_add_u32 m0, s68, 81920
  s_add_u32 s58, s56, 262144
  buffer_load_dwordx4 v212, s[8:11], s58 offen offset:0 lds
  buffer_load_dwordx4 v213, s[8:11], s58 offen offset:1024 lds
  s_add_u32 m0, m0, 2048
  s_nop 0
  buffer_load_dwordx4 v212, s[12:15], s58 offen offset:0 lds
  buffer_load_dwordx4 v213, s[12:15], s58 offen offset:1024 lds
  v_mfma_f32_16x16x32_bf16 v[96:99], v[216:219], v[180:183], 0
  ds_read_b64_tr_b16 v[152:153], v169 offset:32768
  ds_read_b64_tr_b16 v[154:155], v169 offset:33792
  v_mfma_f32_16x16x32_bf16 v[96:99], v[176:179], v[140:143], v[96:99]
  ds_read_b64_tr_b16 v[156:157], v169 offset:49152
  ds_read_b64_tr_b16 v[158:159], v169 offset:50176
  v_mfma_f32_16x16x32_bf16 v[100:103], v[184:187], v[180:183], 0
  v_mfma_f32_16x16x32_bf16 v[100:103], v[188:191], v[140:143], v[100:103]
  v_mfma_f32_16x16x32_bf16 v[104:107], v[192:195], v[180:183], 0
  v_mfma_f32_16x16x32_bf16 v[104:107], v[196:199], v[140:143], v[104:107]
  v_mfma_f32_16x16x32_bf16 v[108:111], v[200:203], v[180:183], 0
  ds_read_b64_tr_b16 v[180:181], v170 offset:32768
  ds_read_b64_tr_b16 v[182:183], v170 offset:33792
  v_mfma_f32_16x16x32_bf16 v[108:111], v[204:207], v[140:143], v[108:111]
  ds_read_b64_tr_b16 v[140:141], v170 offset:49152
  ds_read_b64_tr_b16 v[142:143], v170 offset:50176
  v_mfma_f32_16x16x32_bf16 v[112:115], v[216:219], v[128:131], 0
  ds_read_b64_tr_b16 v[216:217], v171 offset:32768
  v_mfma_f32_16x16x32_bf16 v[112:115], v[176:179], v[132:135], v[112:115]
  v_mfma_f32_16x16x32_bf16 v[116:119], v[184:187], v[128:131], 0
  v_mfma_f32_16x16x32_bf16 v[116:119], v[188:191], v[132:135], v[116:119]
  v_mfma_f32_16x16x32_bf16 v[120:123], v[192:195], v[128:131], 0
  v_mfma_f32_16x16x32_bf16 v[120:123], v[196:199], v[132:135], v[120:123]
  v_mfma_f32_16x16x32_bf16 v[124:127], v[200:203], v[128:131], 0
  v_mfma_f32_16x16x32_bf16 v[124:127], v[204:207], v[132:135], v[124:127]
  s_waitcnt lgkmcnt(3)
  v_mfma_f32_16x16x32_bf16 v[0:3], v[220:223], v[136:139], v[0:3]
  ds_read_b64_tr_b16 v[218:219], v171 offset:33792
  ds_read_b64_tr_b16 v[176:177], v171 offset:49152
  v_mfma_f32_16x16x32_bf16 v[0:3], v[144:147], v[148:151], v[0:3]
  ds_read_b64_tr_b16 v[178:179], v171 offset:50176
  ds_read_b128 v[184:187], v160 offset:34816
  v_mfma_f32_16x16x32_bf16 v[4:7], v[152:155], v[136:139], v[4:7]
  ds_read_b128 v[188:191], v161 offset:34816
  ds_read_b128 v[192:195], v160 offset:36864
  v_mfma_f32_16x16x32_bf16 v[4:7], v[156:159], v[148:151], v[4:7]
  ds_read_b128 v[196:199], v161 offset:36864
  v_mfma_f32_16x16x32_bf16 v[8:11], v[180:183], v[136:139], v[8:11]
  s_waitcnt lgkmcnt(7)
  v_mfma_f32_16x16x32_bf16 v[8:11], v[140:143], v[148:151], v[8:11]
  s_waitcnt lgkmcnt(6)
  v_mfma_f32_16x16x32_bf16 v[12:15], v[216:219], v[136:139], v[12:15]
  s_waitcnt lgkmcnt(4)
  v_mfma_f32_16x16x32_bf16 v[12:15], v[176:179], v[148:151], v[12:15]
  s_waitcnt lgkmcnt(3)
  v_mfma_f32_16x16x32_bf16 v[16:19], v[220:223], v[184:187], v[16:19]
  ds_read_b128 v[200:203], v160 offset:38912
  s_waitcnt lgkmcnt(3)
  v_mfma_f32_16x16x32_bf16 v[16:19], v[144:147], v[188:191], v[16:19]
  ds_read_b128 v[204:207], v161 offset:38912
  v_mfma_f32_16x16x32_bf16 v[20:23], v[152:155], v[184:187], v[20:23]
  v_mfma_f32_16x16x32_bf16 v[20:23], v[156:159], v[188:191], v[20:23]
  v_mfma_f32_16x16x32_bf16 v[24:27], v[180:183], v[184:187], v[24:27]
  v_mfma_f32_16x16x32_bf16 v[24:27], v[140:143], v[188:191], v[24:27]
  v_mfma_f32_16x16x32_bf16 v[28:31], v[216:219], v[184:187], v[28:31]
  v_mfma_f32_16x16x32_bf16 v[28:31], v[176:179], v[188:191], v[28:31]
  s_waitcnt lgkmcnt(2)
  v_mfma_f32_16x16x32_bf16 v[32:35], v[220:223], v[192:195], v[32:35]
  ds_read_b128 v[184:187], v160 offset:49152
  v_mfma_f32_16x16x32_bf16 v[32:35], v[144:147], v[196:199], v[32:35]
  ds_read_b128 v[188:191], v161 offset:49152
  v_mfma_f32_16x16x32_bf16 v[36:39], v[152:155], v[192:195], v[36:39]
  v_mfma_f32_16x16x32_bf16 v[36:39], v[156:159], v[196:199], v[36:39]
  v_mfma_f32_16x16x32_bf16 v[40:43], v[180:183], v[192:195], v[40:43]
  v_mfma_f32_16x16x32_bf16 v[40:43], v[140:143], v[196:199], v[40:43]
  v_mfma_f32_16x16x32_bf16 v[44:47], v[216:219], v[192:195], v[44:47]
  v_mfma_f32_16x16x32_bf16 v[44:47], v[176:179], v[196:199], v[44:47]
  s_waitcnt lgkmcnt(2)
  v_mfma_f32_16x16x32_bf16 v[48:51], v[220:223], v[200:203], v[48:51]
  ds_read_b128 v[192:195], v160 offset:51200
  v_mfma_f32_16x16x32_bf16 v[48:51], v[144:147], v[204:207], v[48:51]
  ds_read_b128 v[196:199], v161 offset:51200
  v_mfma_f32_16x16x32_bf16 v[52:55], v[152:155], v[200:203], v[52:55]
  v_mfma_f32_16x16x32_bf16 v[52:55], v[156:159], v[204:207], v[52:55]
  v_mfma_f32_16x16x32_bf16 v[56:59], v[180:183], v[200:203], v[56:59]
  v_mfma_f32_16x16x32_bf16 v[56:59], v[140:143], v[204:207], v[56:59]
  v_mfma_f32_16x16x32_bf16 v[60:63], v[216:219], v[200:203], v[60:63]
  v_mfma_f32_16x16x32_bf16 v[60:63], v[176:179], v[204:207], v[60:63]
  s_waitcnt lgkmcnt(2)
  v_mfma_f32_16x16x32_bf16 v[64:67], v[220:223], v[184:187], v[64:67]
  ds_read_b128 v[200:203], v160 offset:53248
  v_mfma_f32_16x16x32_bf16 v[64:67], v[144:147], v[188:191], v[64:67]
  ds_read_b128 v[204:207], v161 offset:53248
  v_mfma_f32_16x16x32_bf16 v[68:71], v[152:155], v[184:187], v[68:71]
  v_mfma_f32_16x16x32_bf16 v[68:71], v[156:159], v[188:191], v[68:71]
  v_mfma_f32_16x16x32_bf16 v[72:75], v[180:183], v[184:187], v[72:75]
  v_mfma_f32_16x16x32_bf16 v[72:75], v[140:143], v[188:191], v[72:75]
  v_mfma_f32_16x16x32_bf16 v[76:79], v[216:219], v[184:187], v[76:79]
  v_mfma_f32_16x16x32_bf16 v[76:79], v[176:179], v[188:191], v[76:79]
  s_waitcnt lgkmcnt(2)
  v_mfma_f32_16x16x32_bf16 v[80:83], v[220:223], v[192:195], v[80:83]
  ds_read_b128 v[184:187], v160 offset:55296
  v_mfma_f32_16x16x32_bf16 v[80:83], v[144:147], v[196:199], v[80:83]
  ds_read_b128 v[188:191], v161 offset:55296
  v_add_u32 v168, 65536, v168
  v_mfma_f32_16x16x32_bf16 v[84:87], v[152:155], v[192:195], v[84:87]
  v_add_u32 v169, 65536, v169
  v_add_u32 v170, 65536, v170
  v_mfma_f32_16x16x32_bf16 v[84:87], v[156:159], v[196:199], v[84:87]
  v_add_u32 v171, 65536, v171
  v_mfma_f32_16x16x32_bf16 v[88:91], v[180:183], v[192:195], v[88:91]
  v_mfma_f32_16x16x32_bf16 v[88:91], v[140:143], v[196:199], v[88:91]
  v_mfma_f32_16x16x32_bf16 v[92:95], v[216:219], v[192:195], v[92:95]
  v_mfma_f32_16x16x32_bf16 v[92:95], v[176:179], v[196:199], v[92:95]
  s_waitcnt vmcnt(8) lgkmcnt(0)
  s_barrier
  ds_read_b64_tr_b16 v[192:193], v168 offset:0
  ds_read_b64_tr_b16 v[194:195], v168 offset:1024
  ds_read_b128 v[196:199], v160 offset:0
  ds_read_b64_tr_b16 v[128:129], v168 offset:16384
  ds_read_b64_tr_b16 v[130:131], v168 offset:17408
  ds_read_b128 v[132:135], v161 offset:0
  s_add_u32 s53, s1, 3
  s_sub_u32 s52, s53, 6
  s_cmp_ge_u32 s53, 8
  s_cselect_b32 s53, s52, s53
  s_lshl_b32 s53, s53, 7
  s_add_u32 m0, s68, 32768
  s_add_u32 s52, s64, s53
  buffer_load_dwordx4 v208, s[4:7], s52 offen offset:0 lds
  buffer_load_dwordx4 v209, s[4:7], s52 offen offset:1024 lds
  buffer_load_dwordx4 v210, s[4:7], s52 offen offset:2048 lds
  buffer_load_dwordx4 v211, s[4:7], s52 offen offset:3072 lds
  s_add_u32 m0, s68, 49152
  s_add_u32 s52, s65, s53
  buffer_load_dwordx4 v208, s[4:7], s52 offen offset:0 lds
  buffer_load_dwordx4 v209, s[4:7], s52 offen offset:1024 lds
  buffer_load_dwordx4 v210, s[4:7], s52 offen offset:2048 lds
  buffer_load_dwordx4 v211, s[4:7], s52 offen offset:3072 lds
  s_add_u32 s56, s1, 4
  s_sub_u32 s52, s56, 6
  s_cmp_ge_u32 s56, 8
  s_cselect_b32 s56, s52, s56
  s_lshl_b32 s56, s56, 19
  s_add_u32 s56, s56, s66
  s_add_u32 m0, s68, 98304
  s_add_u32 s58, s56, 0
  buffer_load_dwordx4 v212, s[8:11], s58 offen offset:0 lds
  buffer_load_dwordx4 v213, s[8:11], s58 offen offset:1024 lds
  s_add_u32 m0, m0, 2048
  s_nop 0
  buffer_load_dwordx4 v212, s[12:15], s58 offen offset:0 lds
  buffer_load_dwordx4 v213, s[12:15], s58 offen offset:1024 lds
  s_add_u32 m0, s68, 114688
  s_add_u32 s58, s56, 262144
  buffer_load_dwordx4 v212, s[8:11], s58 offen offset:0 lds
  buffer_load_dwordx4 v213, s[8:11], s58 offen offset:1024 lds
  s_add_u32 m0, m0, 2048
  s_nop 0
  buffer_load_dwordx4 v212, s[12:15], s58 offen offset:0 lds
  buffer_load_dwordx4 v213, s[12:15], s58 offen offset:1024 lds
  v_mfma_f32_16x16x32_bf16 v[96:99], v[220:223], v[200:203], v[96:99]
  ds_read_b64_tr_b16 v[136:137], v169 offset:0
  ds_read_b64_tr_b16 v[138:139], v169 offset:1024
  v_mfma_f32_16x16x32_bf16 v[96:99], v[144:147], v[204:207], v[96:99]
  ds_read_b64_tr_b16 v[148:149], v169 offset:16384
  ds_read_b64_tr_b16 v[150:151], v169 offset:17408
  v_mfma_f32_16x16x32_bf16 v[100:103], v[152:155], v[200:203], v[100:103]
  v_mfma_f32_16x16x32_bf16 v[100:103], v[156:159], v[204:207], v[100:103]
  v_mfma_f32_16x16x32_bf16 v[104:107], v[180:183], v[200:203], v[104:107]
  v_mfma_f32_16x16x32_bf16 v[104:107], v[140:143], v[204:207], v[104:107]
  v_mfma_f32_16x16x32_bf16 v[108:111], v[216:219], v[200:203], v[108:111]
  ds_read_b64_tr_b16 v[200:201], v170 offset:0
  ds_read_b64_tr_b16 v[202:203], v170 offset:1024
  v_mfma_f32_16x16x32_bf16 v[108:111], v[176:179], v[204:207], v[108:111]
  ds_read_b64_tr_b16 v[204:205], v170 offset:16384
  ds_read_b64_tr_b16 v[206:207], v170 offset:17408
  v_mfma_f32_16x16x32_bf16 v[112:115], v[220:223], v[184:187], v[112:115]
  ds_read_b64_tr_b16 v[220:221], v171 offset:0
  v_mfma_f32_16x16x32_bf16 v[112:115], v[144:147], v[188:191], v[112:115]
  v_mfma_f32_16x16x32_bf16 v[116:119], v[152:155], v[184:187], v[116:119]
  v_mfma_f32_16x16x32_bf16 v[116:119], v[156:159], v[188:191], v[116:119]
  v_mfma_f32_16x16x32_bf16 v[120:123], v[180:183], v[184:187], v[120:123]
  v_mfma_f32_16x16x32_bf16 v[120:123], v[140:143], v[188:191], v[120:123]
  v_mfma_f32_16x16x32_bf16 v[124:127], v[216:219], v[184:187], v[124:127]
  v_mfma_f32_16x16x32_bf16 v[124:127], v[176:179], v[188:191], v[124:127]
  s_waitcnt lgkmcnt(3)
  v_mfma_f32_16x16x32_bf16 v[0:3], v[192:195], v[196:199], v[0:3]
  ds_read_b64_tr_b16 v[222:223], v171 offset:1024
  ds_read_b64_tr_b16 v[216:217], v171 offset:16384
  v_mfma_f32_16x16x32_bf16 v[0:3], v[128:131], v[132:135], v[0:3]
  ds_read_b64_tr_b16 v[218:219], v171 offset:17408
  ds_read_b128 v[176:179], v160 offset:2048
  v_mfma_f32_16x16x32_bf16 v[4:7], v[136:139], v[196:199], v[4:7]
  ds_read_b128 v[180:183], v161 offset:2048
  ds_read_b128 v[184:187], v160 offset:4096
  v_mfma_f32_16x16x32_bf16 v[4:7], v[148:151], v[132:135], v[4:7]
  ds_read_b128 v[188:191], v161 offset:4096
  v_mfma_f32_16x16x32_bf16 v[8:11], v[200:203], v[196:199], v[8:11]
  s_waitcnt lgkmcnt(7)
  v_mfma_f32_16x16x32_bf16 v[8:11], v[204:207], v[132:135], v[8:11]
  s_waitcnt lgkmcnt(6)
  v_mfma_f32_16x16x32_bf16 v[12:15], v[220:223], v[196:199], v[12:15]
  s_waitcnt lgkmcnt(4)
  v_mfma_f32_16x16x32_bf16 v[12:15], v[216:219], v[132:135], v[12:15]
  s_waitcnt lgkmcnt(3)
  v_mfma_f32_16x16x32_bf16 v[16:19], v[192:195], v[176:179], v[16:19]
  ds_read_b128 v[196:199], v160 offset:6144
  s_waitcnt lgkmcnt(3)
  v_mfma_f32_16x16x32_bf16 v[16:19], v[128:131], v[180:183], v[16:19]
  ds_read_b128 v[132:135], v161 offset:6144
  v_mfma_f32_16x16x32_bf16 v[20:23], v[136:139], v[176:179], v[20:23]
  v_mfma_f32_16x16x32_bf16 v[20:23], v[148:151], v[180:183], v[20:23]
  v_mfma_f32_16x16x32_bf16 v[24:27], v[200:203], v[176:179], v[24:27]
  v_mfma_f32_16x16x32_bf16 v[24:27], v[204:207], v[180:183], v[24:27]
  v_mfma_f32_16x16x32_bf16 v[28:31], v[220:223], v[176:179], v[28:31]
  v_mfma_f32_16x16x32_bf16 v[28:31], v[216:219], v[180:183], v[28:31]
  s_waitcnt lgkmcnt(2)
  v_mfma_f32_16x16x32_bf16 v[32:35], v[192:195], v[184:187], v[32:35]
  ds_read_b128 v[176:179], v160 offset:16384
  v_mfma_f32_16x16x32_bf16 v[32:35], v[128:131], v[188:191], v[32:35]
  ds_read_b128 v[180:183], v161 offset:16384
  v_mfma_f32_16x16x32_bf16 v[36:39], v[136:139], v[184:187], v[36:39]
  v_mfma_f32_16x16x32_bf16 v[36:39], v[148:151], v[188:191], v[36:39]
  v_mfma_f32_16x16x32_bf16 v[40:43], v[200:203], v[184:187], v[40:43]
  v_mfma_f32_16x16x32_bf16 v[40:43], v[204:207], v[188:191], v[40:43]
  v_mfma_f32_16x16x32_bf16 v[44:47], v[220:223], v[184:187], v[44:47]
  v_mfma_f32_16x16x32_bf16 v[44:47], v[216:219], v[188:191], v[44:47]
  s_waitcnt lgkmcnt(2)
  v_mfma_f32_16x16x32_bf16 v[48:51], v[192:195], v[196:199], v[48:51]
  ds_read_b128 v[184:187], v160 offset:18432
  v_mfma_f32_16x16x32_bf16 v[48:51], v[128:131], v[132:135], v[48:51]
  ds_read_b128 v[188:191], v161 offset:18432
  v_mfma_f32_16x16x32_bf16 v[52:55], v[136:139], v[196:199], v[52:55]
  v_mfma_f32_16x16x32_bf16 v[52:55], v[148:151], v[132:135], v[52:55]
  v_mfma_f32_16x16x32_bf16 v[56:59], v[200:203], v[196:199], v[56:59]
  v_mfma_f32_16x16x32_bf16 v[56:59], v[204:207], v[132:135], v[56:59]
  v_mfma_f32_16x16x32_bf16 v[60:63], v[220:223], v[196:199], v[60:63]
  v_mfma_f32_16x16x32_bf16 v[60:63], v[216:219], v[132:135], v[60:63]
  s_waitcnt lgkmcnt(2)
  v_mfma_f32_16x16x32_bf16 v[64:67], v[192:195], v[176:179], v[64:67]
  ds_read_b128 v[196:199], v160 offset:20480
  v_mfma_f32_16x16x32_bf16 v[64:67], v[128:131], v[180:183], v[64:67]
  ds_read_b128 v[132:135], v161 offset:20480
  v_mfma_f32_16x16x32_bf16 v[68:71], v[136:139], v[176:179], v[68:71]
  v_mfma_f32_16x16x32_bf16 v[68:71], v[148:151], v[180:183], v[68:71]
  v_mfma_f32_16x16x32_bf16 v[72:75], v[200:203], v[176:179], v[72:75]
  v_mfma_f32_16x16x32_bf16 v[72:75], v[204:207], v[180:183], v[72:75]
  v_mfma_f32_16x16x32_bf16 v[76:79], v[220:223], v[176:179], v[76:79]
  v_mfma_f32_16x16x32_bf16 v[76:79], v[216:219], v[180:183], v[76:79]
  s_waitcnt lgkmcnt(2)
  v_mfma_f32_16x16x32_bf16 v[80:83], v[192:195], v[184:187], v[80:83]
  ds_read_b128 v[176:179], v160 offset:22528
  v_mfma_f32_16x16x32_bf16 v[80:83], v[128:131], v[188:191], v[80:83]
  ds_read_b128 v[180:183], v161 offset:22528
  v_add_u32 v168, -65536, v168
  v_mfma_f32_16x16x32_bf16 v[84:87], v[136:139], v[184:187], v[84:87]
  v_add_u32 v169, -65536, v169
  v_add_u32 v170, -65536, v170
  v_mfma_f32_16x16x32_bf16 v[84:87], v[148:151], v[188:191], v[84:87]
  v_add_u32 v171, -65536, v171
  v_mfma_f32_16x16x32_bf16 v[88:91], v[200:203], v[184:187], v[88:91]
  v_mfma_f32_16x16x32_bf16 v[88:91], v[204:207], v[188:191], v[88:91]
  v_mfma_f32_16x16x32_bf16 v[92:95], v[220:223], v[184:187], v[92:95]
  v_mfma_f32_16x16x32_bf16 v[92:95], v[216:219], v[188:191], v[92:95]
  s_waitcnt vmcnt(8) lgkmcnt(0)
  s_barrier
  ds_read_b64_tr_b16 v[184:185], v168 offset:0
  ds_read_b64_tr_b16 v[186:187], v168 offset:1024
  ds_read_b128 v[188:191], v160 offset:32768
  ds_read_b64_tr_b16 v[140:141], v168 offset:16384
  ds_read_b64_tr_b16 v[142:143], v168 offset:17408
  ds_read_b128 v[144:147], v161 offset:32768
  s_add_u32 s53, s1, 4
  s_sub_u32 s52, s53, 6
  s_cmp_ge_u32 s53, 8
  s_cselect_b32 s53, s52, s53
  s_lshl_b32 s53, s53, 7
  s_add_u32 m0, s68, 0
  s_add_u32 s52, s64, s53
  buffer_load_dwordx4 v208, s[4:7], s52 offen offset:0 lds
  buffer_load_dwordx4 v209, s[4:7], s52 offen offset:1024 lds
  buffer_load_dwordx4 v210, s[4:7], s52 offen offset:2048 lds
  buffer_load_dwordx4 v211, s[4:7], s52 offen offset:3072 lds
  s_add_u32 m0, s68, 16384
  s_add_u32 s52, s65, s53
  buffer_load_dwordx4 v208, s[4:7], s52 offen offset:0 lds
  buffer_load_dwordx4 v209, s[4:7], s52 offen offset:1024 lds
  buffer_load_dwordx4 v210, s[4:7], s52 offen offset:2048 lds
  buffer_load_dwordx4 v211, s[4:7], s52 offen offset:3072 lds
  s_add_u32 s56, s1, 5
  s_sub_u32 s52, s56, 6
  s_cmp_ge_u32 s56, 8
  s_cselect_b32 s56, s52, s56
  s_lshl_b32 s56, s56, 19
  s_add_u32 s56, s56, s66
  s_add_u32 m0, s68, 131072
  s_add_u32 s58, s56, 0
  buffer_load_dwordx4 v212, s[8:11], s58 offen offset:0 lds
  buffer_load_dwordx4 v213, s[8:11], s58 offen offset:1024 lds
  s_add_u32 m0, m0, 2048
  s_nop 0
  buffer_load_dwordx4 v212, s[12:15], s58 offen offset:0 lds
  buffer_load_dwordx4 v213, s[12:15], s58 offen offset:1024 lds
  s_add_u32 m0, s68, 147456
  s_add_u32 s58, s56, 262144
  buffer_load_dwordx4 v212, s[8:11], s58 offen offset:0 lds
  buffer_load_dwordx4 v213, s[8:11], s58 offen offset:1024 lds
  s_add_u32 m0, m0, 2048
  s_nop 0
  buffer_load_dwordx4 v212, s[12:15], s58 offen offset:0 lds
  buffer_load_dwordx4 v213, s[12:15], s58 offen offset:1024 lds
  v_mfma_f32_16x16x32_bf16 v[96:99], v[192:195], v[196:199], v[96:99]
  ds_read_b64_tr_b16 v[152:153], v169 offset:0
  ds_read_b64_tr_b16 v[154:155], v169 offset:1024
  v_mfma_f32_16x16x32_bf16 v[96:99], v[128:131], v[132:135], v[96:99]
  ds_read_b64_tr_b16 v[156:157], v169 offset:16384
  ds_read_b64_tr_b16 v[158:159], v169 offset:17408
  v_mfma_f32_16x16x32_bf16 v[100:103], v[136:139], v[196:199], v[100:103]
  v_mfma_f32_16x16x32_bf16 v[100:103], v[148:151], v[132:135], v[100:103]
  v_mfma_f32_16x16x32_bf16 v[104:107], v[200:203], v[196:199], v[104:107]
  v_mfma_f32_16x16x32_bf16 v[104:107], v[204:207], v[132:135], v[104:107]
  v_mfma_f32_16x16x32_bf16 v[108:111], v[220:223], v[196:199], v[108:111]
  ds_read_b64_tr_b16 v[196:197], v170 offset:0
  ds_read_b64_tr_b16 v[198:199], v170 offset:1024
  v_mfma_f32_16x16x32_bf16 v[108:111], v[216:219], v[132:135], v[108:111]
  ds_read_b64_tr_b16 v[132:133], v170 offset:16384
  ds_read_b64_tr_b16 v[134:135], v170 offset:17408
  v_mfma_f32_16x16x32_bf16 v[112:115], v[192:195], v[176:179], v[112:115]
  ds_read_b64_tr_b16 v[192:193], v171 offset:0
  v_mfma_f32_16x16x32_bf16 v[112:115], v[128:131], v[180:183], v[112:115]
  v_mfma_f32_16x16x32_bf16 v[116:119], v[136:139], v[176:179], v[116:119]
  v_mfma_f32_16x16x32_bf16 v[116:119], v[148:151], v[180:183], v[116:119]
  v_mfma_f32_16x16x32_bf16 v[120:123], v[200:203], v[176:179], v[120:123]
  v_mfma_f32_16x16x32_bf16 v[120:123], v[204:207], v[180:183], v[120:123]
  v_mfma_f32_16x16x32_bf16 v[124:127], v[220:223], v[176:179], v[124:127]
  v_mfma_f32_16x16x32_bf16 v[124:127], v[216:219], v[180:183], v[124:127]
  s_waitcnt lgkmcnt(3)
  v_mfma_f32_16x16x32_bf16 v[0:3], v[184:187], v[188:191], v[0:3]
  ds_read_b64_tr_b16 v[194:195], v171 offset:1024
  ds_read_b64_tr_b16 v[216:217], v171 offset:16384
  v_mfma_f32_16x16x32_bf16 v[0:3], v[140:143], v[144:147], v[0:3]
  ds_read_b64_tr_b16 v[218:219], v171 offset:17408
  ds_read_b128 v[220:223], v160 offset:34816
  v_mfma_f32_16x16x32_bf16 v[4:7], v[152:155], v[188:191], v[4:7]
  ds_read_b128 v[176:179], v161 offset:34816
  ds_read_b128 v[180:183], v160 offset:36864
  v_mfma_f32_16x16x32_bf16 v[4:7], v[156:159], v[144:147], v[4:7]
  ds_read_b128 v[200:203], v161 offset:36864
  v_mfma_f32_16x16x32_bf16 v[8:11], v[196:199], v[188:191], v[8:11]
  s_waitcnt lgkmcnt(7)
  v_mfma_f32_16x16x32_bf16 v[8:11], v[132:135], v[144:147], v[8:11]
  s_waitcnt lgkmcnt(6)
  v_mfma_f32_16x16x32_bf16 v[12:15], v[192:195], v[188:191], v[12:15]
  s_waitcnt lgkmcnt(4)
  v_mfma_f32_16x16x32_bf16 v[12:15], v[216:219], v[144:147], v[12:15]
  s_waitcnt lgkmcnt(3)
  v_mfma_f32_16x16x32_bf16 v[16:19], v[184:187], v[220:223], v[16:19]
  ds_read_b128 v[188:191], v160 offset:38912
  s_waitcnt lgkmcnt(3)
  v_mfma_f32_16x16x32_bf16 v[16:19], v[140:143], v[176:179], v[16:19]
  ds_read_b128 v[204:207], v161 offset:38912
  v_mfma_f32_16x16x32_bf16 v[20:23], v[152:155], v[220:223], v[20:23]
  v_mfma_f32_16x16x32_bf16 v[20:23], v[156:159], v[176:179], v[20:23]
  v_mfma_f32_16x16x32_bf16 v[24:27], v[196:199], v[220:223], v[24:27]
  v_mfma_f32_16x16x32_bf16 v[24:27], v[132:135], v[176:179], v[24:27]
  v_mfma_f32_16x16x32_bf16 v[28:31], v[192:195], v[220:223], v[28:31]
  v_mfma_f32_16x16x32_bf16 v[28:31], v[216:219], v[176:179], v[28:31]
  s_waitcnt lgkmcnt(2)
  v_mfma_f32_16x16x32_bf16 v[32:35], v[184:187], v[180:183], v[32:35]
  ds_read_b128 v[220:223], v160 offset:49152
  v_mfma_f32_16x16x32_bf16 v[32:35], v[140:143], v[200:203], v[32:35]
  ds_read_b128 v[176:179], v161 offset:49152
  v_mfma_f32_16x16x32_bf16 v[36:39], v[152:155], v[180:183], v[36:39]
  v_mfma_f32_16x16x32_bf16 v[36:39], v[156:159], v[200:203], v[36:39]
  v_mfma_f32_16x16x32_bf16 v[40:43], v[196:199], v[180:183], v[40:43]
  v_mfma_f32_16x16x32_bf16 v[40:43], v[132:135], v[200:203], v[40:43]
  v_mfma_f32_16x16x32_bf16 v[44:47], v[192:195], v[180:183], v[44:47]
  v_mfma_f32_16x16x32_bf16 v[44:47], v[216:219], v[200:203], v[44:47]
  s_waitcnt lgkmcnt(2)
  v_mfma_f32_16x16x32_bf16 v[48:51], v[184:187], v[188:191], v[48:51]
  ds_read_b128 v[180:183], v160 offset:51200
  v_mfma_f32_16x16x32_bf16 v[48:51], v[140:143], v[204:207], v[48:51]
  ds_read_b128 v[200:203], v161 offset:51200
  v_mfma_f32_16x16x32_bf16 v[52:55], v[152:155], v[188:191], v[52:55]
  v_mfma_f32_16x16x32_bf16 v[52:55], v[156:159], v[204:207], v[52:55]
  v_mfma_f32_16x16x32_bf16 v[56:59], v[196:199], v[188:191], v[56:59]
  v_mfma_f32_16x16x32_bf16 v[56:59], v[132:135], v[204:207], v[56:59]
  v_mfma_f32_16x16x32_bf16 v[60:63], v[192:195], v[188:191], v[60:63]
  v_mfma_f32_16x16x32_bf16 v[60:63], v[216:219], v[204:207], v[60:63]
  s_waitcnt lgkmcnt(2)
  v_mfma_f32_16x16x32_bf16 v[64:67], v[184:187], v[220:223], v[64:67]
  ds_read_b128 v[188:191], v160 offset:53248
  v_mfma_f32_16x16x32_bf16 v[64:67], v[140:143], v[176:179], v[64:67]
  ds_read_b128 v[204:207], v161 offset:53248
  v_mfma_f32_16x16x32_bf16 v[68:71], v[152:155], v[220:223], v[68:71]
  v_mfma_f32_16x16x32_bf16 v[68:71], v[156:159], v[176:179], v[68:71]
  v_mfma_f32_16x16x32_bf16 v[72:75], v[196:199], v[220:223], v[72:75]
  v_mfma_f32_16x16x32_bf16 v[72:75], v[132:135], v[176:179], v[72:75]
  v_mfma_f32_16x16x32_bf16 v[76:79], v[192:195], v[220:223], v[76:79]
  v_mfma_f32_16x16x32_bf16 v[76:79], v[216:219], v[176:179], v[76:79]
  s_waitcnt lgkmcnt(2)
  v_mfma_f32_16x16x32_bf16 v[80:83], v[184:187], v[180:183], v[80:83]
  ds_read_b128 v[220:223], v160 offset:55296
  v_mfma_f32_16x16x32_bf16 v[80:83], v[140:143], v[200:203], v[80:83]
  ds_read_b128 v[176:179], v161 offset:55296
  v_mfma_f32_16x16x32_bf16 v[84:87], v[152:155], v[180:183], v[84:87]
  v_mfma_f32_16x16x32_bf16 v[84:87], v[156:159], v[200:203], v[84:87]
  v_mfma_f32_16x16x32_bf16 v[88:91], v[196:199], v[180:183], v[88:91]
  v_mfma_f32_16x16x32_bf16 v[88:91], v[132:135], v[200:203], v[88:91]
  v_mfma_f32_16x16x32_bf16 v[92:95], v[192:195], v[180:183], v[92:95]
  v_mfma_f32_16x16x32_bf16 v[92:95], v[216:219], v[200:203], v[92:95]
  s_waitcnt vmcnt(8) lgkmcnt(0)
  s_barrier
  ds_read_b64_tr_b16 v[180:181], v168 offset:32768
  ds_read_b64_tr_b16 v[182:183], v168 offset:33792
  ds_read_b128 v[200:203], v160 offset:0
  ds_read_b64_tr_b16 v[128:129], v168 offset:49152
  ds_read_b64_tr_b16 v[130:131], v168 offset:50176
  ds_read_b128 v[136:139], v161 offset:0
  s_add_u32 s53, s1, 5
  s_sub_u32 s52, s53, 6
  s_cmp_ge_u32 s53, 8
  s_cselect_b32 s53, s52, s53
  s_lshl_b32 s53, s53, 7
  s_add_u32 m0, s68, 32768
  s_add_u32 s52, s64, s53
  buffer_load_dwordx4 v208, s[4:7], s52 offen offset:0 lds
  buffer_load_dwordx4 v209, s[4:7], s52 offen offset:1024 lds
  buffer_load_dwordx4 v210, s[4:7], s52 offen offset:2048 lds
  buffer_load_dwordx4 v211, s[4:7], s52 offen offset:3072 lds
  s_add_u32 m0, s68, 49152
  s_add_u32 s52, s65, s53
  buffer_load_dwordx4 v208, s[4:7], s52 offen offset:0 lds
  buffer_load_dwordx4 v209, s[4:7], s52 offen offset:1024 lds
  buffer_load_dwordx4 v210, s[4:7], s52 offen offset:2048 lds
  buffer_load_dwordx4 v211, s[4:7], s52 offen offset:3072 lds
  s_add_u32 s56, s1, 6
  s_sub_u32 s52, s56, 6
  s_cmp_ge_u32 s56, 8
  s_cselect_b32 s56, s52, s56
  s_lshl_b32 s56, s56, 19
  s_add_u32 s56, s56, s66
  s_add_u32 m0, s68, 65536
  s_add_u32 s58, s56, 0
  buffer_load_dwordx4 v212, s[8:11], s58 offen offset:0 lds
  buffer_load_dwordx4 v213, s[8:11], s58 offen offset:1024 lds
  s_add_u32 m0, m0, 2048
  s_nop 0
  buffer_load_dwordx4 v212, s[12:15], s58 offen offset:0 lds
  buffer_load_dwordx4 v213, s[12:15], s58 offen offset:1024 lds
  s_add_u32 m0, s68, 81920
  s_add_u32 s58, s56, 262144
  buffer_load_dwordx4 v212, s[8:11], s58 offen offset:0 lds
  buffer_load_dwordx4 v213, s[8:11], s58 offen offset:1024 lds
  s_add_u32 m0, m0, 2048
  s_nop 0
  buffer_load_dwordx4 v212, s[12:15], s58 offen offset:0 lds
  buffer_load_dwordx4 v213, s[12:15], s58 offen offset:1024 lds
  v_mfma_f32_16x16x32_bf16 v[96:99], v[184:187], v[188:191], v[96:99]
  ds_read_b64_tr_b16 v[144:145], v169 offset:32768
  ds_read_b64_tr_b16 v[146:147], v169 offset:33792
  v_mfma_f32_16x16x32_bf16 v[96:99], v[140:143], v[204:207], v[96:99]
  ds_read_b64_tr_b16 v[148:149], v169 offset:49152
  ds_read_b64_tr_b16 v[150:151], v169 offset:50176
  v_mfma_f32_16x16x32_bf16 v[100:103], v[152:155], v[188:191], v[100:103]
  v_mfma_f32_16x16x32_bf16 v[100:103], v[156:159], v[204:207], v[100:103]
  v_mfma_f32_16x16x32_bf16 v[104:107], v[196:199], v[188:191], v[104:107]
  v_mfma_f32_16x16x32_bf16 v[104:107], v[132:135], v[204:207], v[104:107]
  v_mfma_f32_16x16x32_bf16 v[108:111], v[192:195], v[188:191], v[108:111]
  ds_read_b64_tr_b16 v[188:189], v170 offset:32768
  ds_read_b64_tr_b16 v[190:191], v170 offset:33792
  v_mfma_f32_16x16x32_bf16 v[108:111], v[216:219], v[204:207], v[108:111]
  ds_read_b64_tr_b16 v[204:205], v170 offset:49152
  ds_read_b64_tr_b16 v[206:207], v170 offset:50176
  v_mfma_f32_16x16x32_bf16 v[112:115], v[184:187], v[220:223], v[112:115]
  ds_read_b64_tr_b16 v[184:185], v171 offset:32768
  v_mfma_f32_16x16x32_bf16 v[112:115], v[140:143], v[176:179], v[112:115]
  v_mfma_f32_16x16x32_bf16 v[116:119], v[152:155], v[220:223], v[116:119]
  v_mfma_f32_16x16x32_bf16 v[116:119], v[156:159], v[176:179], v[116:119]
  v_mfma_f32_16x16x32_bf16 v[120:123], v[196:199], v[220:223], v[120:123]
  v_mfma_f32_16x16x32_bf16 v[120:123], v[132:135], v[176:179], v[120:123]
  v_mfma_f32_16x16x32_bf16 v[124:127], v[192:195], v[220:223], v[124:127]
  v_mfma_f32_16x16x32_bf16 v[124:127], v[216:219], v[176:179], v[124:127]
  s_waitcnt lgkmcnt(3)
  v_mfma_f32_16x16x32_bf16 v[0:3], v[180:183], v[200:203], v[0:3]
  ds_read_b64_tr_b16 v[186:187], v171 offset:33792
  ds_read_b64_tr_b16 v[216:217], v171 offset:49152
  v_mfma_f32_16x16x32_bf16 v[0:3], v[128:131], v[136:139], v[0:3]
  ds_read_b64_tr_b16 v[218:219], v171 offset:50176
  ds_read_b128 v[220:223], v160 offset:2048
  v_mfma_f32_16x16x32_bf16 v[4:7], v[144:147], v[200:203], v[4:7]
  ds_read_b128 v[176:179], v161 offset:2048
  ds_read_b128 v[192:195], v160 offset:4096
  v_mfma_f32_16x16x32_bf16 v[4:7], v[148:151], v[136:139], v[4:7]
  ds_read_b128 v[196:199], v161 offset:4096
  v_mfma_f32_16x16x32_bf16 v[8:11], v[188:191], v[200:203], v[8:11]
  s_waitcnt lgkmcnt(7)
  v_mfma_f32_16x16x32_bf16 v[8:11], v[204:207], v[136:139], v[8:11]
  s_waitcnt lgkmcnt(6)
  v_mfma_f32_16x16x32_bf16 v[12:15], v[184:187], v[200:203], v[12:15]
  s_waitcnt lgkmcnt(4)
  v_mfma_f32_16x16x32_bf16 v[12:15], v[216:219], v[136:139], v[12:15]
  s_waitcnt lgkmcnt(3)
  v_mfma_f32_16x16x32_bf16 v[16:19], v[180:183], v[220:223], v[16:19]
  ds_read_b128 v[200:203], v160 offset:6144
  s_waitcnt lgkmcnt(3)
  v_mfma_f32_16x16x32_bf16 v[16:19], v[128:131], v[176:179], v[16:19]
  ds_read_b128 v[132:135], v161 offset:6144
  v_mfma_f32_16x16x32_bf16 v[20:23], v[144:147], v[220:223], v[20:23]
  v_mfma_f32_16x16x32_bf16 v[20:23], v[148:151], v[176:179], v[20:23]
  v_mfma_f32_16x16x32_bf16 v[24:27], v[188:191], v[220:223], v[24:27]
  v_mfma_f32_16x16x32_bf16 v[24:27], v[204:207], v[176:179], v[24:27]
  v_mfma_f32_16x16x32_bf16 v[28:31], v[184:187], v[220:223], v[28:31]
  v_mfma_f32_16x16x32_bf16 v[28:31], v[216:219], v[176:179], v[28:31]
  s_waitcnt lgkmcnt(2)
  v_mfma_f32_16x16x32_bf16 v[32:35], v[180:183], v[192:195], v[32:35]
  ds_read_b128 v[220:223], v160 offset:16384
  v_mfma_f32_16x16x32_bf16 v[32:35], v[128:131], v[196:199], v[32:35]
  ds_read_b128 v[176:179], v161 offset:16384
  v_mfma_f32_16x16x32_bf16 v[36:39], v[144:147], v[192:195], v[36:39]
  v_mfma_f32_16x16x32_bf16 v[36:39], v[148:151], v[196:199], v[36:39]
  v_mfma_f32_16x16x32_bf16 v[40:43], v[188:191], v[192:195], v[40:43]
  v_mfma_f32_16x16x32_bf16 v[40:43], v[204:207], v[196:199], v[40:43]
  v_mfma_f32_16x16x32_bf16 v[44:47], v[184:187], v[192:195], v[44:47]
  v_mfma_f32_16x16x32_bf16 v[44:47], v[216:219], v[196:199], v[44:47]
  s_waitcnt lgkmcnt(2)
  v_mfma_f32_16x16x32_bf16 v[48:51], v[180:183], v[200:203], v[48:51]
  ds_read_b128 v[192:195], v160 offset:18432
  v_mfma_f32_16x16x32_bf16 v[48:51], v[128:131], v[132:135], v[48:51]
  ds_read_b128 v[196:199], v161 offset:18432
  v_mfma_f32_16x16x32_bf16 v[52:55], v[144:147], v[200:203], v[52:55]
  v_mfma_f32_16x16x32_bf16 v[52:55], v[148:151], v[132:135], v[52:55]
  v_mfma_f32_16x16x32_bf16 v[56:59], v[188:191], v[200:203], v[56:59]
  v_mfma_f32_16x16x32_bf16 v[56:59], v[204:207], v[132:135], v[56:59]
  v_mfma_f32_16x16x32_bf16 v[60:63], v[184:187], v[200:203], v[60:63]
  v_mfma_f32_16x16x32_bf16 v[60:63], v[216:219], v[132:135], v[60:63]
  s_waitcnt lgkmcnt(2)
  v_mfma_f32_16x16x32_bf16 v[64:67], v[180:183], v[220:223], v[64:67]
  ds_read_b128 v[200:203], v160 offset:20480
  v_mfma_f32_16x16x32_bf16 v[64:67], v[128:131], v[176:179], v[64:67]
  ds_read_b128 v[132:135], v161 offset:20480
  v_mfma_f32_16x16x32_bf16 v[68:71], v[144:147], v[220:223], v[68:71]
  v_mfma_f32_16x16x32_bf16 v[68:71], v[148:151], v[176:179], v[68:71]
  v_mfma_f32_16x16x32_bf16 v[72:75], v[188:191], v[220:223], v[72:75]
  v_mfma_f32_16x16x32_bf16 v[72:75], v[204:207], v[176:179], v[72:75]
  v_mfma_f32_16x16x32_bf16 v[76:79], v[184:187], v[220:223], v[76:79]
  v_mfma_f32_16x16x32_bf16 v[76:79], v[216:219], v[176:179], v[76:79]
  s_waitcnt lgkmcnt(2)
  v_mfma_f32_16x16x32_bf16 v[80:83], v[180:183], v[192:195], v[80:83]
  ds_read_b128 v[220:223], v160 offset:22528
  v_mfma_f32_16x16x32_bf16 v[80:83], v[128:131], v[196:199], v[80:83]
  ds_read_b128 v[176:179], v161 offset:22528
  v_add_u32 v168, 65536, v168
  v_mfma_f32_16x16x32_bf16 v[84:87], v[144:147], v[192:195], v[84:87]
  v_add_u32 v169, 65536, v169
  v_add_u32 v170, 65536, v170
  v_mfma_f32_16x16x32_bf16 v[84:87], v[148:151], v[196:199], v[84:87]
  v_add_u32 v171, 65536, v171
  v_mfma_f32_16x16x32_bf16 v[88:91], v[188:191], v[192:195], v[88:91]
  v_mfma_f32_16x16x32_bf16 v[88:91], v[204:207], v[196:199], v[88:91]
  v_mfma_f32_16x16x32_bf16 v[92:95], v[184:187], v[192:195], v[92:95]
  v_mfma_f32_16x16x32_bf16 v[92:95], v[216:219], v[196:199], v[92:95]
  s_waitcnt vmcnt(8) lgkmcnt(0)
  s_barrier
  ds_read_b64_tr_b16 v[192:193], v168 offset:0
  ds_read_b64_tr_b16 v[194:195], v168 offset:1024
  ds_read_b128 v[196:199], v160 offset:32768
  ds_read_b64_tr_b16 v[136:137], v168 offset:16384
  ds_read_b64_tr_b16 v[138:139], v168 offset:17408
  ds_read_b128 v[140:143], v161 offset:32768
  s_add_u32 s53, s1, 6
  s_sub_u32 s52, s53, 6
  s_cmp_ge_u32 s53, 8
  s_cselect_b32 s53, s52, s53
  s_lshl_b32 s53, s53, 7
  s_add_u32 m0, s68, 0
  s_add_u32 s52, s64, s53
  buffer_load_dwordx4 v208, s[4:7], s52 offen offset:0 lds
  buffer_load_dwordx4 v209, s[4:7], s52 offen offset:1024 lds
  buffer_load_dwordx4 v210, s[4:7], s52 offen offset:2048 lds
  buffer_load_dwordx4 v211, s[4:7], s52 offen offset:3072 lds
  s_add_u32 m0, s68, 16384
  s_add_u32 s52, s65, s53
  buffer_load_dwordx4 v208, s[4:7], s52 offen offset:0 lds
  buffer_load_dwordx4 v209, s[4:7], s52 offen offset:1024 lds
  buffer_load_dwordx4 v210, s[4:7], s52 offen offset:2048 lds
  buffer_load_dwordx4 v211, s[4:7], s52 offen offset:3072 lds
  s_add_u32 s56, s1, 7
  s_sub_u32 s52, s56, 6
  s_cmp_ge_u32 s56, 8
  s_cselect_b32 s56, s52, s56
  s_lshl_b32 s56, s56, 19
  s_add_u32 s56, s56, s66
  s_add_u32 m0, s68, 98304
  s_add_u32 s58, s56, 0
  buffer_load_dwordx4 v212, s[8:11], s58 offen offset:0 lds
  buffer_load_dwordx4 v213, s[8:11], s58 offen offset:1024 lds
  s_add_u32 m0, m0, 2048
  s_nop 0
  buffer_load_dwordx4 v212, s[12:15], s58 offen offset:0 lds
  buffer_load_dwordx4 v213, s[12:15], s58 offen offset:1024 lds
  s_add_u32 m0, s68, 114688
  s_add_u32 s58, s56, 262144
  buffer_load_dwordx4 v212, s[8:11], s58 offen offset:0 lds
  buffer_load_dwordx4 v213, s[8:11], s58 offen offset:1024 lds
  s_add_u32 m0, m0, 2048
  s_nop 0
  buffer_load_dwordx4 v212, s[12:15], s58 offen offset:0 lds
  buffer_load_dwordx4 v213, s[12:15], s58 offen offset:1024 lds
  v_mfma_f32_16x16x32_bf16 v[96:99], v[180:183], v[200:203], v[96:99]
  ds_read_b64_tr_b16 v[152:153], v169 offset:0
  ds_read_b64_tr_b16 v[154:155], v169 offset:1024
  v_mfma_f32_16x16x32_bf16 v[96:99], v[128:131], v[132:135], v[96:99]
  ds_read_b64_tr_b16 v[156:157], v169 offset:16384
  ds_read_b64_tr_b16 v[158:159], v169 offset:17408
  v_mfma_f32_16x16x32_bf16 v[100:103], v[144:147], v[200:203], v[100:103]
  v_mfma_f32_16x16x32_bf16 v[100:103], v[148:151], v[132:135], v[100:103]
  v_mfma_f32_16x16x32_bf16 v[104:107], v[188:191], v[200:203], v[104:107]
  v_mfma_f32_16x16x32_bf16 v[104:107], v[204:207], v[132:135], v[104:107]
  v_mfma_f32_16x16x32_bf16 v[108:111], v[184:187], v[200:203], v[108:111]
  ds_read_b64_tr_b16 v[200:201], v170 offset:0
  ds_read_b64_tr_b16 v[202:203], v170 offset:1024
  v_mfma_f32_16x16x32_bf16 v[108:111], v[216:219], v[132:135], v[108:111]
  ds_read_b64_tr_b16 v[132:133], v170 offset:16384
  ds_read_b64_tr_b16 v[134:135], v170 offset:17408
  v_mfma_f32_16x16x32_bf16 v[112:115], v[180:183], v[220:223], v[112:115]
  ds_read_b64_tr_b16 v[180:181], v171 offset:0
  v_mfma_f32_16x16x32_bf16 v[112:115], v[128:131], v[176:179], v[112:115]
  v_mfma_f32_16x16x32_bf16 v[116:119], v[144:147], v[220:223], v[116:119]
  v_mfma_f32_16x16x32_bf16 v[116:119], v[148:151], v[176:179], v[116:119]
  v_mfma_f32_16x16x32_bf16 v[120:123], v[188:191], v[220:223], v[120:123]
  v_mfma_f32_16x16x32_bf16 v[120:123], v[204:207], v[176:179], v[120:123]
  v_mfma_f32_16x16x32_bf16 v[124:127], v[184:187], v[220:223], v[124:127]
  v_mfma_f32_16x16x32_bf16 v[124:127], v[216:219], v[176:179], v[124:127]
  s_waitcnt lgkmcnt(3)
  v_mfma_f32_16x16x32_bf16 v[0:3], v[192:195], v[196:199], v[0:3]
  ds_read_b64_tr_b16 v[182:183], v171 offset:1024
  ds_read_b64_tr_b16 v[216:217], v171 offset:16384
  v_mfma_f32_16x16x32_bf16 v[0:3], v[136:139], v[140:143], v[0:3]
  ds_read_b64_tr_b16 v[218:219], v171 offset:17408
  ds_read_b128 v[220:223], v160 offset:34816
  v_mfma_f32_16x16x32_bf16 v[4:7], v[152:155], v[196:199], v[4:7]
  ds_read_b128 v[176:179], v161 offset:34816
  ds_read_b128 v[184:187], v160 offset:36864
  v_mfma_f32_16x16x32_bf16 v[4:7], v[156:159], v[140:143], v[4:7]
  ds_read_b128 v[188:191], v161 offset:36864
  v_mfma_f32_16x16x32_bf16 v[8:11], v[200:203], v[196:199], v[8:11]
  s_waitcnt lgkmcnt(7)
  v_mfma_f32_16x16x32_bf16 v[8:11], v[132:135], v[140:143], v[8:11]
  s_waitcnt lgkmcnt(6)
  v_mfma_f32_16x16x32_bf16 v[12:15], v[180:183], v[196:199], v[12:15]
  s_waitcnt lgkmcnt(4)
  v_mfma_f32_16x16x32_bf16 v[12:15], v[216:219], v[140:143], v[12:15]
  s_waitcnt lgkmcnt(3)
  v_mfma_f32_16x16x32_bf16 v[16:19], v[192:195], v[220:223], v[16:19]
  ds_read_b128 v[196:199], v160 offset:38912
  s_waitcnt lgkmcnt(3)
  v_mfma_f32_16x16x32_bf16 v[16:19], v[136:139], v[176:179], v[16:19]
  ds_read_b128 v[204:207], v161 offset:38912
  v_mfma_f32_16x16x32_bf16 v[20:23], v[152:155], v[220:223], v[20:23]
  v_mfma_f32_16x16x32_bf16 v[20:23], v[156:159], v[176:179], v[20:23]
  v_mfma_f32_16x16x32_bf16 v[24:27], v[200:203], v[220:223], v[24:27]
  v_mfma_f32_16x16x32_bf16 v[24:27], v[132:135], v[176:179], v[24:27]
  v_mfma_f32_16x16x32_bf16 v[28:31], v[180:183], v[220:223], v[28:31]
  v_mfma_f32_16x16x32_bf16 v[28:31], v[216:219], v[176:179], v[28:31]
  s_waitcnt lgkmcnt(2)
  v_mfma_f32_16x16x32_bf16 v[32:35], v[192:195], v[184:187], v[32:35]
  ds_read_b128 v[220:223], v160 offset:49152
  v_mfma_f32_16x16x32_bf16 v[32:35], v[136:139], v[188:191], v[32:35]
  ds_read_b128 v[176:179], v161 offset:49152
  v_mfma_f32_16x16x32_bf16 v[36:39], v[152:155], v[184:187], v[36:39]
  v_mfma_f32_16x16x32_bf16 v[36:39], v[156:159], v[188:191], v[36:39]
  v_mfma_f32_16x16x32_bf16 v[40:43], v[200:203], v[184:187], v[40:43]
  v_mfma_f32_16x16x32_bf16 v[40:43], v[132:135], v[188:191], v[40:43]
  v_mfma_f32_16x16x32_bf16 v[44:47], v[180:183], v[184:187], v[44:47]
  v_mfma_f32_16x16x32_bf16 v[44:47], v[216:219], v[188:191], v[44:47]
  s_waitcnt lgkmcnt(2)
  v_mfma_f32_16x16x32_bf16 v[48:51], v[192:195], v[196:199], v[48:51]
  ds_read_b128 v[184:187], v160 offset:51200
  v_mfma_f32_16x16x32_bf16 v[48:51], v[136:139], v[204:207], v[48:51]
  ds_read_b128 v[188:191], v161 offset:51200
  v_mfma_f32_16x16x32_bf16 v[52:55], v[152:155], v[196:199], v[52:55]
  v_mfma_f32_16x16x32_bf16 v[52:55], v[156:159], v[204:207], v[52:55]
  v_mfma_f32_16x16x32_bf16 v[56:59], v[200:203], v[196:199], v[56:59]
  v_mfma_f32_16x16x32_bf16 v[56:59], v[132:135], v[204:207], v[56:59]
  v_mfma_f32_16x16x32_bf16 v[60:63], v[180:183], v[196:199], v[60:63]
  v_mfma_f32_16x16x32_bf16 v[60:63], v[216:219], v[204:207], v[60:63]
  s_waitcnt lgkmcnt(2)
  v_mfma_f32_16x16x32_bf16 v[64:67], v[192:195], v[220:223], v[64:67]
  ds_read_b128 v[196:199], v160 offset:53248
  v_mfma_f32_16x16x32_bf16 v[64:67], v[136:139], v[176:179], v[64:67]
  ds_read_b128 v[204:207], v161 offset:53248
  v_mfma_f32_16x16x32_bf16 v[68:71], v[152:155], v[220:223], v[68:71]
  v_mfma_f32_16x16x32_bf16 v[68:71], v[156:159], v[176:179], v[68:71]
  v_mfma_f32_16x16x32_bf16 v[72:75], v[200:203], v[220:223], v[72:75]
  v_mfma_f32_16x16x32_bf16 v[72:75], v[132:135], v[176:179], v[72:75]
  v_mfma_f32_16x16x32_bf16 v[76:79], v[180:183], v[220:223], v[76:79]
  v_mfma_f32_16x16x32_bf16 v[76:79], v[216:219], v[176:179], v[76:79]
  s_waitcnt lgkmcnt(2)
  v_mfma_f32_16x16x32_bf16 v[80:83], v[192:195], v[184:187], v[80:83]
  ds_read_b128 v[220:223], v160 offset:55296
  v_mfma_f32_16x16x32_bf16 v[80:83], v[136:139], v[188:191], v[80:83]
  ds_read_b128 v[176:179], v161 offset:55296
  v_add_u32 v168, -65536, v168
  v_mfma_f32_16x16x32_bf16 v[84:87], v[152:155], v[184:187], v[84:87]
  v_add_u32 v169, -65536, v169
  v_add_u32 v170, -65536, v170
  v_mfma_f32_16x16x32_bf16 v[84:87], v[156:159], v[188:191], v[84:87]
  v_add_u32 v171, -65536, v171
  v_mfma_f32_16x16x32_bf16 v[88:91], v[200:203], v[184:187], v[88:91]
  v_mfma_f32_16x16x32_bf16 v[88:91], v[132:135], v[188:191], v[88:91]
  v_mfma_f32_16x16x32_bf16 v[92:95], v[180:183], v[184:187], v[92:95]
  v_mfma_f32_16x16x32_bf16 v[92:95], v[216:219], v[188:191], v[92:95]
  s_waitcnt vmcnt(8) lgkmcnt(0)
  s_barrier
  ds_read_b64_tr_b16 v[184:185], v168 offset:0
  ds_read_b64_tr_b16 v[186:187], v168 offset:1024
  ds_read_b128 v[188:191], v160 offset:0
  ds_read_b64_tr_b16 v[128:129], v168 offset:16384
  ds_read_b64_tr_b16 v[130:131], v168 offset:17408
  ds_read_b128 v[140:143], v161 offset:0
  s_add_u32 s53, s1, 7
  s_sub_u32 s52, s53, 6
  s_cmp_ge_u32 s53, 8
  s_cselect_b32 s53, s52, s53
  s_lshl_b32 s53, s53, 7
  s_add_u32 m0, s68, 32768
  s_add_u32 s52, s64, s53
  buffer_load_dwordx4 v208, s[4:7], s52 offen offset:0 lds
  buffer_load_dwordx4 v209, s[4:7], s52 offen offset:1024 lds
  buffer_load_dwordx4 v210, s[4:7], s52 offen offset:2048 lds
  buffer_load_dwordx4 v211, s[4:7], s52 offen offset:3072 lds
  s_add_u32 m0, s68, 49152
  s_add_u32 s52, s65, s53
  buffer_load_dwordx4 v208, s[4:7], s52 offen offset:0 lds
  buffer_load_dwordx4 v209, s[4:7], s52 offen offset:1024 lds
  buffer_load_dwordx4 v210, s[4:7], s52 offen offset:2048 lds
  buffer_load_dwordx4 v211, s[4:7], s52 offen offset:3072 lds
  s_add_u32 s56, s0, 8
  s_and_b32 s56, s56, 7
  s_mul_i32 s57, s56, 196608
  s_add_u32 s57, s57, s67
  s_lshl_b32 s56, s56, 19
  s_add_u32 s56, s56, s66
  s_add_u32 m0, s68, 131072
  s_add_u32 s58, s56, 0
  buffer_load_dwordx4 v212, s[20:23], s58 offen offset:0 lds
  buffer_load_dwordx4 v213, s[20:23], s58 offen offset:1024 lds
  s_add_u32 m0, m0, 2048
  s_add_u32 s58, s57, 0
  s_mov_b64 exec, s[2:3]
  buffer_load_dwordx4 v214, s[24:27], s58 offen offset:0 lds
  buffer_load_dwordx4 v215, s[24:27], s58 offen offset:1024 lds
  s_mov_b64 exec, -1
  s_add_u32 m0, s68, 147456
  s_add_u32 s58, s56, 262144
  buffer_load_dwordx4 v212, s[20:23], s58 offen offset:0 lds
  buffer_load_dwordx4 v213, s[20:23], s58 offen offset:1024 lds
  s_add_u32 m0, m0, 2048
  s_add_u32 s58, s57, 98304
  s_mov_b64 exec, s[2:3]
  buffer_load_dwordx4 v214, s[24:27], s58 offen offset:0 lds
  buffer_load_dwordx4 v215, s[24:27], s58 offen offset:1024 lds
  s_mov_b64 exec, -1
  v_mfma_f32_16x16x32_bf16 v[96:99], v[192:195], v[196:199], v[96:99]
  ds_read_b64_tr_b16 v[144:145], v169 offset:0
  ds_read_b64_tr_b16 v[146:147], v169 offset:1024
  v_mfma_f32_16x16x32_bf16 v[96:99], v[136:139], v[204:207], v[96:99]
  ds_read_b64_tr_b16 v[148:149], v169 offset:16384
  ds_read_b64_tr_b16 v[150:151], v169 offset:17408
  v_mfma_f32_16x16x32_bf16 v[100:103], v[152:155], v[196:199], v[100:103]
  v_mfma_f32_16x16x32_bf16 v[100:103], v[156:159], v[204:207], v[100:103]
  v_mfma_f32_16x16x32_bf16 v[104:107], v[200:203], v[196:199], v[104:107]
  v_mfma_f32_16x16x32_bf16 v[104:107], v[132:135], v[204:207], v[104:107]
  v_mfma_f32_16x16x32_bf16 v[108:111], v[180:183], v[196:199], v[108:111]
  ds_read_b64_tr_b16 v[196:197], v170 offset:0
  ds_read_b64_tr_b16 v[198:199], v170 offset:1024
  v_mfma_f32_16x16x32_bf16 v[108:111], v[216:219], v[204:207], v[108:111]
  ds_read_b64_tr_b16 v[204:205], v170 offset:16384
  ds_read_b64_tr_b16 v[206:207], v170 offset:17408
  v_mfma_f32_16x16x32_bf16 v[112:115], v[192:195], v[220:223], v[112:115]
  ds_read_b64_tr_b16 v[192:193], v171 offset:0
  v_mfma_f32_16x16x32_bf16 v[112:115], v[136:139], v[176:179], v[112:115]
  v_mfma_f32_16x16x32_bf16 v[116:119], v[152:155], v[220:223], v[116:119]
  v_mfma_f32_16x16x32_bf16 v[116:119], v[156:159], v[176:179], v[116:119]
  v_mfma_f32_16x16x32_bf16 v[120:123], v[200:203], v[220:223], v[120:123]
  v_mfma_f32_16x16x32_bf16 v[120:123], v[132:135], v[176:179], v[120:123]
  v_mfma_f32_16x16x32_bf16 v[124:127], v[180:183], v[220:223], v[124:127]
  v_mfma_f32_16x16x32_bf16 v[124:127], v[216:219], v[176:179], v[124:127]
  s_waitcnt lgkmcnt(3)
  v_mfma_f32_16x16x32_bf16 v[0:3], v[184:187], v[188:191], v[0:3]
  ds_read_b64_tr_b16 v[194:195], v171 offset:1024
  ds_read_b64_tr_b16 v[216:217], v171 offset:16384
  v_mfma_f32_16x16x32_bf16 v[0:3], v[128:131], v[140:143], v[0:3]
  ds_read_b64_tr_b16 v[218:219], v171 offset:17408
  ds_read_b128 v[220:223], v160 offset:2048
  v_mfma_f32_16x16x32_bf16 v[4:7], v[144:147], v[188:191], v[4:7]
  ds_read_b128 v[176:179], v161 offset:2048
  ds_read_b128 v[180:183], v160 offset:4096
  v_mfma_f32_16x16x32_bf16 v[4:7], v[148:151], v[140:143], v[4:7]
  ds_read_b128 v[200:203], v161 offset:4096
  v_mfma_f32_16x16x32_bf16 v[8:11], v[196:199], v[188:191], v[8:11]
  s_waitcnt lgkmcnt(7)
  v_mfma_f32_16x16x32_bf16 v[8:11], v[204:207], v[140:143], v[8:11]
  s_waitcnt lgkmcnt(6)
  v_mfma_f32_16x16x32_bf16 v[12:15], v[192:195], v[188:191], v[12:15]
  s_waitcnt lgkmcnt(4)
  v_mfma_f32_16x16x32_bf16 v[12:15], v[216:219], v[140:143], v[12:15]
  s_waitcnt lgkmcnt(3)
  v_mfma_f32_16x16x32_bf16 v[16:19], v[184:187], v[220:223], v[16:19]
  ds_read_b128 v[188:191], v160 offset:6144
  s_waitcnt lgkmcnt(3)
  v_mfma_f32_16x16x32_bf16 v[16:19], v[128:131], v[176:179], v[16:19]
  ds_read_b128 v[132:135], v161 offset:6144
  v_mfma_f32_16x16x32_bf16 v[20:23], v[144:147], v[220:223], v[20:23]
  v_mfma_f32_16x16x32_bf16 v[20:23], v[148:151], v[176:179], v[20:23]
  v_mfma_f32_16x16x32_bf16 v[24:27], v[196:199], v[220:223], v[24:27]
  v_mfma_f32_16x16x32_bf16 v[24:27], v[204:207], v[176:179], v[24:27]
  v_mfma_f32_16x16x32_bf16 v[28:31], v[192:195], v[220:223], v[28:31]
  v_mfma_f32_16x16x32_bf16 v[28:31], v[216:219], v[176:179], v[28:31]
  s_waitcnt lgkmcnt(2)
  v_mfma_f32_16x16x32_bf16 v[32:35], v[184:187], v[180:183], v[32:35]
  ds_read_b128 v[220:223], v160 offset:16384
  v_mfma_f32_16x16x32_bf16 v[32:35], v[128:131], v[200:203], v[32:35]
  ds_read_b128 v[176:179], v161 offset:16384
  v_mfma_f32_16x16x32_bf16 v[36:39], v[144:147], v[180:183], v[36:39]
  v_mfma_f32_16x16x32_bf16 v[36:39], v[148:151], v[200:203], v[36:39]
  v_mfma_f32_16x16x32_bf16 v[40:43], v[196:199], v[180:183], v[40:43]
  v_mfma_f32_16x16x32_bf16 v[40:43], v[204:207], v[200:203], v[40:43]
  v_mfma_f32_16x16x32_bf16 v[44:47], v[192:195], v[180:183], v[44:47]
  v_mfma_f32_16x16x32_bf16 v[44:47], v[216:219], v[200:203], v[44:47]
  s_waitcnt lgkmcnt(2)
  v_mfma_f32_16x16x32_bf16 v[48:51], v[184:187], v[188:191], v[48:51]
  ds_read_b128 v[180:183], v160 offset:18432
  v_mfma_f32_16x16x32_bf16 v[48:51], v[128:131], v[132:135], v[48:51]
  ds_read_b128 v[200:203], v161 offset:18432
  v_mfma_f32_16x16x32_bf16 v[52:55], v[144:147], v[188:191], v[52:55]
  v_mfma_f32_16x16x32_bf16 v[52:55], v[148:151], v[132:135], v[52:55]
  v_mfma_f32_16x16x32_bf16 v[56:59], v[196:199], v[188:191], v[56:59]
  v_mfma_f32_16x16x32_bf16 v[56:59], v[204:207], v[132:135], v[56:59]
  v_mfma_f32_16x16x32_bf16 v[60:63], v[192:195], v[188:191], v[60:63]
  v_mfma_f32_16x16x32_bf16 v[60:63], v[216:219], v[132:135], v[60:63]
  s_waitcnt lgkmcnt(2)
  v_mfma_f32_16x16x32_bf16 v[64:67], v[184:187], v[220:223], v[64:67]
  ds_read_b128 v[188:191], v160 offset:20480
  v_mfma_f32_16x16x32_bf16 v[64:67], v[128:131], v[176:179], v[64:67]
  ds_read_b128 v[132:135], v161 offset:20480
  v_mfma_f32_16x16x32_bf16 v[68:71], v[144:147], v[220:223], v[68:71]
  v_mfma_f32_16x16x32_bf16 v[68:71], v[148:151], v[176:179], v[68:71]
  v_mfma_f32_16x16x32_bf16 v[72:75], v[196:199], v[220:223], v[72:75]
  v_mfma_f32_16x16x32_bf16 v[72:75], v[204:207], v[176:179], v[72:75]
  v_mfma_f32_16x16x32_bf16 v[76:79], v[192:195], v[220:223], v[76:79]
  v_mfma_f32_16x16x32_bf16 v[76:79], v[216:219], v[176:179], v[76:79]
  s_waitcnt lgkmcnt(2)
  v_mfma_f32_16x16x32_bf16 v[80:83], v[184:187], v[180:183], v[80:83]
  ds_read_b128 v[220:223], v160 offset:22528
  v_mfma_f32_16x16x32_bf16 v[80:83], v[128:131], v[200:203], v[80:83]
  ds_read_b128 v[176:179], v161 offset:22528
  v_mfma_f32_16x16x32_bf16 v[84:87], v[144:147], v[180:183], v[84:87]
  v_mfma_f32_16x16x32_bf16 v[84:87], v[148:151], v[200:203], v[84:87]
  v_mfma_f32_16x16x32_bf16 v[88:91], v[196:199], v[180:183], v[88:91]
  v_mfma_f32_16x16x32_bf16 v[88:91], v[204:207], v[200:203], v[88:91]
  v_mfma_f32_16x16x32_bf16 v[92:95], v[192:195], v[180:183], v[92:95]
  v_mfma_f32_16x16x32_bf16 v[92:95], v[216:219], v[200:203], v[92:95]
  s_waitcnt vmcnt(8) lgkmcnt(0)
  s_barrier
  ds_read_b64_tr_b16 v[200:201], v168 offset:32768
  ds_read_b64_tr_b16 v[202:203], v168 offset:33792
  ds_read_b128 v[180:183], v160 offset:53248
  ds_read_b64_tr_b16 v[136:137], v168 offset:49152
  ds_read_b64_tr_b16 v[138:139], v168 offset:50176
  ds_read_b128 v[140:143], v161 offset:53248
  s_add_u32 s53, s0, 8
  s_and_b32 s53, s53, 7
  s_lshl_b32 s53, s53, 7
  s_add_u32 m0, s68, 0
  s_add_u32 s52, s64, s53
  buffer_load_dwordx4 v208, s[16:19], s52 offen offset:0 lds
  buffer_load_dwordx4 v209, s[16:19], s52 offen offset:1024 lds
  buffer_load_dwordx4 v210, s[16:19], s52 offen offset:2048 lds
  buffer_load_dwordx4 v211, s[16:19], s52 offen offset:3072 lds
  s_add_u32 m0, s68, 16384
  s_add_u32 s52, s65, s53
  buffer_load_dwordx4 v208, s[16:19], s52 offen offset:0 lds
  buffer_load_dwordx4 v209, s[16:19], s52 offen offset:1024 lds
  buffer_load_dwordx4 v210, s[16:19], s52 offen offset:2048 lds
  buffer_load_dwordx4 v211, s[16:19], s52 offen offset:3072 lds
  s_add_u32 s56, s0, 9
  s_and_b32 s56, s56, 7
  s_mul_i32 s57, s56, 196608
  s_add_u32 s57, s57, s67
  s_lshl_b32 s56, s56, 19
  s_add_u32 s56, s56, s66
  s_add_u32 m0, s68, 65536
  s_add_u32 s58, s56, 0
  buffer_load_dwordx4 v212, s[20:23], s58 offen offset:0 lds
  buffer_load_dwordx4 v213, s[20:23], s58 offen offset:1024 lds
  s_add_u32 m0, m0, 2048
  s_add_u32 s58, s57, 0
  s_mov_b64 exec, s[2:3]
  buffer_load_dwordx4 v214, s[24:27], s58 offen offset:0 lds
  buffer_load_dwordx4 v215, s[24:27], s58 offen offset:1024 lds
  s_mov_b64 exec, -1
  s_add_u32 m0, s68, 81920
  s_add_u32 s58, s56, 262144
  buffer_load_dwordx4 v212, s[20:23], s58 offen offset:0 lds
  buffer_load_dwordx4 v213, s[20:23], s58 offen offset:1024 lds
  s_add_u32 m0, m0, 2048
  s_add_u32 s58, s57, 98304
  s_mov_b64 exec, s[2:3]
  buffer_load_dwordx4 v214, s[24:27], s58 offen offset:0 lds
  buffer_load_dwordx4 v215, s[24:27], s58 offen offset:1024 lds
  s_mov_b64 exec, -1
  v_mfma_f32_16x16x32_bf16 v[96:99], v[184:187], v[188:191], v[96:99]
  ds_read_b64_tr_b16 v[152:153], v169 offset:32768
  ds_read_b64_tr_b16 v[154:155], v169 offset:33792
  v_mfma_f32_16x16x32_bf16 v[96:99], v[128:131], v[132:135], v[96:99]
  ds_read_b64_tr_b16 v[156:157], v169 offset:49152
  ds_read_b64_tr_b16 v[158:159], v169 offset:50176
  v_mfma_f32_16x16x32_bf16 v[100:103], v[144:147], v[188:191], v[100:103]
  v_mfma_f32_16x16x32_bf16 v[100:103], v[148:151], v[132:135], v[100:103]
  v_mfma_f32_16x16x32_bf16 v[104:107], v[196:199], v[188:191], v[104:107]
  v_mfma_f32_16x16x32_bf16 v[104:107], v[204:207], v[132:135], v[104:107]
  v_mfma_f32_16x16x32_bf16 v[108:111], v[192:195], v[188:191], v[108:111]
  v_mfma_f32_16x16x32_bf16 v[108:111], v[216:219], v[132:135], v[108:111]
  ds_read_b64_tr_b16 v[132:133], v170 offset:32768
  ds_read_b64_tr_b16 v[134:135], v170 offset:33792
  v_mfma_f32_16x16x32_bf16 v[112:115], v[184:187], v[220:223], v[112:115]
  v_mfma_f32_16x16x32_bf16 v[112:115], v[128:131], v[176:179], v[112:115]
  ds_read_b64_tr_b16 v[128:129], v170 offset:49152
  ds_read_b64_tr_b16 v[130:131], v170 offset:50176
  v_mfma_f32_16x16x32_bf16 v[116:119], v[144:147], v[220:223], v[116:119]
  ds_read_b64_tr_b16 v[144:145], v171 offset:32768
  v_mfma_f32_16x16x32_bf16 v[116:119], v[148:151], v[176:179], v[116:119]
  v_mfma_f32_16x16x32_bf16 v[120:123], v[196:199], v[220:223], v[120:123]
  v_mfma_f32_16x16x32_bf16 v[120:123], v[204:207], v[176:179], v[120:123]
  v_mfma_f32_16x16x32_bf16 v[124:127], v[192:195], v[220:223], v[124:127]
  v_mfma_f32_16x16x32_bf16 v[124:127], v[216:219], v[176:179], v[124:127]
  s_waitcnt lgkmcnt(5)
  v_mfma_f32_16x16x32_bf16 v[96:99], v[200:203], v[180:183], v[96:99]
  ds_read_b64_tr_b16 v[146:147], v171 offset:33792
  ds_read_b64_tr_b16 v[204:205], v171 offset:49152
  v_mfma_f32_16x16x32_bf16 v[96:99], v[136:139], v[140:143], v[96:99]
  ds_read_b64_tr_b16 v[206:207], v171 offset:50176
  ds_read_b128 v[216:219], v160 offset:55296
  v_mfma_f32_16x16x32_bf16 v[100:103], v[152:155], v[180:183], v[100:103]
  ds_read_b128 v[220:223], v161 offset:55296
  ds_read_b128 v[176:179], v160 offset:49152
  v_mfma_f32_16x16x32_bf16 v[100:103], v[156:159], v[140:143], v[100:103]
  ds_read_b128 v[184:187], v161 offset:49152
  s_waitcnt lgkmcnt(7)
  v_mfma_f32_16x16x32_bf16 v[104:107], v[132:135], v[180:183], v[104:107]
  v_mfma_f32_16x16x32_bf16 v[104:107], v[128:131], v[140:143], v[104:107]
  s_waitcnt lgkmcnt(6)
  v_mfma_f32_16x16x32_bf16 v[108:111], v[144:147], v[180:183], v[108:111]
  s_waitcnt lgkmcnt(4)
  v_mfma_f32_16x16x32_bf16 v[108:111], v[204:207], v[140:143], v[108:111]
  s_waitcnt lgkmcnt(3)
  v_mfma_f32_16x16x32_bf16 v[112:115], v[200:203], v[216:219], v[112:115]
  ds_read_b128 v[180:183], v160 offset:51200
  s_waitcnt lgkmcnt(3)
  v_mfma_f32_16x16x32_bf16 v[112:115], v[136:139], v[220:223], v[112:115]
  ds_read_b128 v[188:191], v161 offset:51200
  v_mfma_f32_16x16x32_bf16 v[116:119], v[152:155], v[216:219], v[116:119]
  v_mfma_f32_16x16x32_bf16 v[116:119], v[156:159], v[220:223], v[116:119]
  v_cvt_pk_bf16_f32 v232, v96, v97
  v_cvt_pk_bf16_f32 v233, v98, v99
  v_mfma_f32_16x16x32_bf16 v[120:123], v[132:135], v[216:219], v[120:123]
  v_cvt_pk_bf16_f32 v234, v100, v101
  v_cvt_pk_bf16_f32 v235, v102, v103
  v_mfma_f32_16x16x32_bf16 v[120:123], v[128:131], v[220:223], v[120:123]
  v_cvt_pk_bf16_f32 v236, v104, v105
  v_cvt_pk_bf16_f32 v237, v106, v107
  v_mfma_f32_16x16x32_bf16 v[124:127], v[144:147], v[216:219], v[124:127]
  v_cvt_pk_bf16_f32 v238, v108, v109
  v_cvt_pk_bf16_f32 v239, v110, v111
  v_mfma_f32_16x16x32_bf16 v[124:127], v[204:207], v[220:223], v[124:127]
  s_waitcnt lgkmcnt(2)
  v_mfma_f32_16x16x32_bf16 v[64:67], v[200:203], v[176:179], v[64:67]
  ds_read_b128 v[192:195], v160 offset:32768
  v_mfma_f32_16x16x32_bf16 v[64:67], v[136:139], v[184:187], v[64:67]
  ds_read_b128 v[196:199], v161 offset:32768
  v_mfma_f32_16x16x32_bf16 v[68:71], v[152:155], v[176:179], v[68:71]
  v_mfma_f32_16x16x32_bf16 v[68:71], v[156:159], v[184:187], v[68:71]
  v_cvt_pk_bf16_f32 v240, v112, v113
  v_cvt_pk_bf16_f32 v241, v114, v115
  v_mfma_f32_16x16x32_bf16 v[72:75], v[132:135], v[176:179], v[72:75]
  v_cvt_pk_bf16_f32 v242, v116, v117
  v_cvt_pk_bf16_f32 v243, v118, v119
  v_mfma_f32_16x16x32_bf16 v[72:75], v[128:131], v[184:187], v[72:75]
  v_cvt_pk_bf16_f32 v244, v120, v121
  v_cvt_pk_bf16_f32 v245, v122, v123
  v_mfma_f32_16x16x32_bf16 v[76:79], v[144:147], v[176:179], v[76:79]
  v_cvt_pk_bf16_f32 v246, v124, v125
  v_cvt_pk_bf16_f32 v247, v126, v127
  v_mfma_f32_16x16x32_bf16 v[76:79], v[204:207], v[184:187], v[76:79]
  s_waitcnt lgkmcnt(2)
  v_mfma_f32_16x16x32_bf16 v[80:83], v[200:203], v[180:183], v[80:83]
  ds_read_b128 v[184:187], v160 offset:34816
  v_mfma_f32_16x16x32_bf16 v[80:83], v[136:139], v[188:191], v[80:83]
  ds_read_b128 v[96:99], v161 offset:34816
  v_mfma_f32_16x16x32_bf16 v[84:87], v[152:155], v[180:183], v[84:87]
  v_mfma_f32_16x16x32_bf16 v[84:87], v[156:159], v[188:191], v[84:87]
  v_cvt_pk_bf16_f32 v216, v64, v65
  v_cvt_pk_bf16_f32 v217, v66, v67
  v_mfma_f32_16x16x32_bf16 v[88:91], v[132:135], v[180:183], v[88:91]
  v_cvt_pk_bf16_f32 v218, v68, v69
  v_cvt_pk_bf16_f32 v219, v70, v71
  v_mfma_f32_16x16x32_bf16 v[88:91], v[128:131], v[188:191], v[88:91]
  v_cvt_pk_bf16_f32 v220, v72, v73
  v_cvt_pk_bf16_f32 v221, v74, v75
  v_mfma_f32_16x16x32_bf16 v[92:95], v[144:147], v[180:183], v[92:95]
  v_cvt_pk_bf16_f32 v222, v76, v77
  v_cvt_pk_bf16_f32 v223, v78, v79
  v_mfma_f32_16x16x32_bf16 v[92:95], v[204:207], v[188:191], v[92:95]
  s_waitcnt lgkmcnt(2)
  v_mfma_f32_16x16x32_bf16 v[0:3], v[200:203], v[192:195], v[0:3]
  ds_read_b128 v[100:103], v160 offset:36864
  v_mfma_f32_16x16x32_bf16 v[0:3], v[136:139], v[196:199], v[0:3]
  ds_read_b128 v[104:107], v161 offset:36864
  v_mfma_f32_16x16x32_bf16 v[4:7], v[152:155], v[192:195], v[4:7]
  v_mfma_f32_16x16x32_bf16 v[4:7], v[156:159], v[196:199], v[4:7]
  v_cvt_pk_bf16_f32 v224, v80, v81
  v_cvt_pk_bf16_f32 v225, v82, v83
  v_mfma_f32_16x16x32_bf16 v[8:11], v[132:135], v[192:195], v[8:11]
  v_cvt_pk_bf16_f32 v226, v84, v85
  v_cvt_pk_bf16_f32 v227, v86, v87
  v_mfma_f32_16x16x32_bf16 v[8:11], v[128:131], v[196:199], v[8:11]
  v_cvt_pk_bf16_f32 v228, v88, v89
  v_cvt_pk_bf16_f32 v229, v90, v91
  v_mfma_f32_16x16x32_bf16 v[12:15], v[144:147], v[192:195], v[12:15]
  v_cvt_pk_bf16_f32 v230, v92, v93
  v_cvt_pk_bf16_f32 v231, v94, v95
  v_mfma_f32_16x16x32_bf16 v[12:15], v[204:207], v[196:199], v[12:15]
  s_waitcnt lgkmcnt(2)
  v_mfma_f32_16x16x32_bf16 v[16:19], v[200:203], v[184:187], v[16:19]
  ds_read_b128 v[80:83], v160 offset:38912
  v_mfma_f32_16x16x32_bf16 v[16:19], v[136:139], v[96:99], v[16:19]
  ds_read_b128 v[84:87], v161 offset:38912
  v_add_u32 v160, s86, v160
  v_mfma_f32_16x16x32_bf16 v[20:23], v[152:155], v[184:187], v[20:23]
  v_add_u32 v161, s86, v161
  s_and_b32 s55, s92, 1
  v_mfma_f32_16x16x32_bf16 v[20:23], v[156:159], v[96:99], v[20:23]
  s_lshl_b32 s55, s55, 7
  v_xor_b32 v168, s55, v168
  v_cvt_pk_bf16_f32 v176, v0, v1
  v_cvt_pk_bf16_f32 v177, v2, v3
  v_mfma_f32_16x16x32_bf16 v[24:27], v[132:135], v[184:187], v[24:27]
  v_xor_b32 v169, s55, v169
  v_xor_b32 v170, s55, v170
  v_cvt_pk_bf16_f32 v178, v4, v5
  v_cvt_pk_bf16_f32 v179, v6, v7
  v_mfma_f32_16x16x32_bf16 v[24:27], v[128:131], v[96:99], v[24:27]
  v_xor_b32 v171, s55, v171
  v_xor_b32 v172, s55, v172
  v_cvt_pk_bf16_f32 v180, v8, v9
  v_cvt_pk_bf16_f32 v181, v10, v11
  v_mfma_f32_16x16x32_bf16 v[28:31], v[144:147], v[184:187], v[28:31]
  v_xor_b32 v173, s55, v173
  v_xor_b32 v174, s55, v174
  v_cvt_pk_bf16_f32 v182, v12, v13
  v_cvt_pk_bf16_f32 v183, v14, v15
  v_mfma_f32_16x16x32_bf16 v[28:31], v[204:207], v[96:99], v[28:31]
  v_xor_b32 v175, s55, v175
  v_add_u32 v168, 65536, v168
  s_waitcnt vmcnt(8) lgkmcnt(0)
  s_barrier
  v_add_u32 v169, 65536, v169
  v_add_u32 v170, 65536, v170
  v_add_u32 v171, 65536, v171
  v_add_u32 v172, 65536, v172
  v_add_u32 v173, 65536, v173
  v_add_u32 v174, 65536, v174
  s_add_u32 s53, s0, 9
  s_and_b32 s53, s53, 7
  s_lshl_b32 s53, s53, 7
  s_add_u32 m0, s68, 32768
  s_add_u32 s52, s64, s53
  buffer_load_dwordx4 v208, s[16:19], s52 offen offset:0 lds
  buffer_load_dwordx4 v209, s[16:19], s52 offen offset:1024 lds
  buffer_load_dwordx4 v210, s[16:19], s52 offen offset:2048 lds
  buffer_load_dwordx4 v211, s[16:19], s52 offen offset:3072 lds
  s_add_u32 m0, s68, 49152
  s_add_u32 s52, s65, s53
  buffer_load_dwordx4 v208, s[16:19], s52 offen offset:0 lds
  buffer_load_dwordx4 v209, s[16:19], s52 offen offset:1024 lds
  buffer_load_dwordx4 v210, s[16:19], s52 offen offset:2048 lds
  buffer_load_dwordx4 v211, s[16:19], s52 offen offset:3072 lds
  s_add_u32 s56, s0, 10
  s_and_b32 s56, s56, 7
  s_mul_i32 s57, s56, 196608
  s_add_u32 s57, s57, s67
  s_lshl_b32 s56, s56, 19
  s_add_u32 s56, s56, s66
  s_add_u32 m0, s68, 98304
  s_add_u32 s58, s56, 0
  buffer_load_dwordx4 v212, s[20:23], s58 offen offset:0 lds
  buffer_load_dwordx4 v213, s[20:23], s58 offen offset:1024 lds
  s_add_u32 m0, m0, 2048
  s_add_u32 s58, s57, 0
  s_mov_b64 exec, s[2:3]
  buffer_load_dwordx4 v214, s[24:27], s58 offen offset:0 lds
  buffer_load_dwordx4 v215, s[24:27], s58 offen offset:1024 lds
  s_mov_b64 exec, -1
  s_add_u32 m0, s68, 114688
  s_add_u32 s58, s56, 262144
  buffer_load_dwordx4 v212, s[20:23], s58 offen offset:0 lds
  buffer_load_dwordx4 v213, s[20:23], s58 offen offset:1024 lds
  s_add_u32 m0, m0, 2048
  s_add_u32 s58, s57, 98304
  s_mov_b64 exec, s[2:3]
  buffer_load_dwordx4 v214, s[24:27], s58 offen offset:0 lds
  buffer_load_dwordx4 v215, s[24:27], s58 offen offset:1024 lds
  s_mov_b64 exec, -1
  v_mfma_f32_16x16x32_bf16 v[32:35], v[200:203], v[100:103], v[32:35]
  v_add_u32 v175, 65536, v175
  v_add_u32 v162, 65536, v162
  v_mfma_f32_16x16x32_bf16 v[32:35], v[136:139], v[104:107], v[32:35]
  ds_read_b128 v[88:91], v160 offset:0
  ds_read_b64_tr_b16 v[92:93], v168 offset:0
  v_mfma_f32_16x16x32_bf16 v[36:39], v[152:155], v[100:103], v[36:39]
  ds_read_b64_tr_b16 v[94:95], v168 offset:1024
  ds_read_b128 v[96:99], v161 offset:0
  v_mfma_f32_16x16x32_bf16 v[36:39], v[156:159], v[104:107], v[36:39]
  ds_read_b64_tr_b16 v[108:109], v168 offset:16384
  ds_read_b64_tr_b16 v[110:111], v168 offset:17408
  v_cvt_pk_bf16_f32 v184, v16, v17
  v_cvt_pk_bf16_f32 v185, v18, v19
  v_mfma_f32_16x16x32_bf16 v[40:43], v[132:135], v[100:103], v[40:43]
  ds_read_b128 v[112:115], v160 offset:2048
  ds_read_b128 v[116:119], v161 offset:2048
  v_cvt_pk_bf16_f32 v186, v20, v21
  v_cvt_pk_bf16_f32 v187, v22, v23
  v_mfma_f32_16x16x32_bf16 v[40:43], v[128:131], v[104:107], v[40:43]
  ds_read_b64_tr_b16 v[120:121], v169 offset:0
  ds_read_b64_tr_b16 v[122:123], v169 offset:1024
  v_cvt_pk_bf16_f32 v188, v24, v25
  v_cvt_pk_bf16_f32 v189, v26, v27
  v_mfma_f32_16x16x32_bf16 v[44:47], v[144:147], v[100:103], v[44:47]
  ds_read_b64_tr_b16 v[100:101], v169 offset:16384
  ds_read_b64_tr_b16 v[102:103], v169 offset:17408
  v_cvt_pk_bf16_f32 v190, v28, v29
  v_cvt_pk_bf16_f32 v191, v30, v31
  v_mfma_f32_16x16x32_bf16 v[44:47], v[204:207], v[104:107], v[44:47]
  ds_read_b128 v[104:107], v164 offset:0
  ds_read_b64_tr_b16 v[124:125], v162 offset:2048
  v_mfma_f32_16x16x32_bf16 v[48:51], v[200:203], v[80:83], v[48:51]
  ds_read_b64_tr_b16 v[126:127], v162 offset:3072
  v_mfma_f32_16x16x32_bf16 v[48:51], v[136:139], v[84:87], v[48:51]
  v_mfma_f32_16x16x32_bf16 v[52:55], v[152:155], v[80:83], v[52:55]
  v_mfma_f32_16x16x32_bf16 v[52:55], v[156:159], v[84:87], v[52:55]
  v_cvt_pk_bf16_f32 v192, v32, v33
  v_cvt_pk_bf16_f32 v193, v34, v35
  v_mfma_f32_16x16x32_bf16 v[56:59], v[132:135], v[80:83], v[56:59]
  v_cvt_pk_bf16_f32 v194, v36, v37
  v_cvt_pk_bf16_f32 v195, v38, v39
  v_mfma_f32_16x16x32_bf16 v[56:59], v[128:131], v[84:87], v[56:59]
  v_cvt_pk_bf16_f32 v196, v40, v41
  v_cvt_pk_bf16_f32 v197, v42, v43
  v_mfma_f32_16x16x32_bf16 v[60:63], v[144:147], v[80:83], v[60:63]
  v_cvt_pk_bf16_f32 v198, v44, v45
  v_cvt_pk_bf16_f32 v199, v46, v47
  v_mfma_f32_16x16x32_bf16 v[60:63], v[204:207], v[84:87], v[60:63]
  s_waitcnt lgkmcnt(3)
  v_mfma_f32_16x16x32_bf16 v[0:3], v[92:95], v[88:91], 0
  ds_read_b64_tr_b16 v[80:81], v170 offset:0
  ds_read_b64_tr_b16 v[82:83], v170 offset:1024
  v_mfma_f32_16x16x32_bf16 v[0:3], v[108:111], v[96:99], v[0:3]
  ds_read_b64_tr_b16 v[84:85], v170 offset:16384
  ds_read_b64_tr_b16 v[86:87], v170 offset:17408
  v_mfma_f32_16x16x32_bf16 v[32:35], v[92:95], v[112:115], 0
  ds_read_b64_tr_b16 v[92:93], v171 offset:0
  ds_read_b64_tr_b16 v[94:95], v171 offset:1024
  v_mfma_f32_16x16x32_bf16 v[32:35], v[108:111], v[116:119], v[32:35]
  ds_read_b64_tr_b16 v[108:109], v171 offset:16384
  ds_read_b64_tr_b16 v[110:111], v171 offset:17408
  v_cvt_pk_bf16_f32 v200, v48, v49
  v_cvt_pk_bf16_f32 v201, v50, v51
  v_cvt_pk_bf16_f32 v202, v52, v53
  v_cvt_pk_bf16_f32 v203, v54, v55
  v_mfma_f32_16x16x32_bf16 v[4:7], v[120:123], v[88:91], 0
  ds_read_b128 v[128:131], v165 offset:0
  ds_read_b64_tr_b16 v[132:133], v162 offset:10240
  v_cvt_pk_bf16_f32 v204, v56, v57
  v_cvt_pk_bf16_f32 v205, v58, v59
  v_cvt_pk_bf16_f32 v206, v60, v61
  v_cvt_pk_bf16_f32 v207, v62, v63
  v_mfma_f32_16x16x32_bf16 v[4:7], v[100:103], v[96:99], v[4:7]
  ds_read_b64_tr_b16 v[134:135], v162 offset:11264
  ds_read_b64_tr_b16 v[136:137], v172 offset:0
  v_mfma_f32_16x16x32_bf16 v[36:39], v[120:123], v[112:115], 0
  v_mfma_f32_16x16x32_bf16 v[36:39], v[100:103], v[116:119], v[36:39]
  s_waitcnt lgkmcnt(12)
  v_mfma_f32_32x32x16_bf16 v[64:79], v[124:127], v[104:107], 0
  ds_read_b64_tr_b16 v[138:139], v172 offset:1024
  ds_read_b64_tr_b16 v[100:101], v172 offset:16384
  ds_read_b64_tr_b16 v[102:103], v172 offset:17408
  buffer_store_dwordx4 v[176:179], v253, s[28:31], s69 offen offset:0 sc1
  buffer_store_dwordx4 v[180:183], v253, s[28:31], s69 offen offset:1024 sc1
  buffer_store_dwordx4 v[184:187], v253, s[28:31], s69 offen offset:2048 sc1
  buffer_store_dwordx4 v[188:191], v253, s[28:31], s69 offen offset:3072 sc1
  s_add_u32 s61, s69, 8192
  buffer_store_dwordx4 v[192:195], v253, s[28:31], s61 offen offset:0 sc1
  s_add_u32 s61, s69, 8192
  buffer_store_dwordx4 v[196:199], v253, s[28:31], s61 offen offset:1024 sc1
  s_add_u32 s61, s69, 8192
  buffer_store_dwordx4 v[200:203], v253, s[28:31], s61 offen offset:2048 sc1
  s_add_u32 s61, s69, 8192
  buffer_store_dwordx4 v[204:207], v253, s[28:31], s61 offen offset:3072 sc1
  s_waitcnt lgkmcnt(13)
  v_mfma_f32_16x16x32_bf16 v[8:11], v[80:83], v[88:91], 0
  ds_read_b64_tr_b16 v[104:105], v173 offset:0
  ds_read_b64_tr_b16 v[106:107], v173 offset:1024
  s_waitcnt lgkmcnt(13)
  v_mfma_f32_16x16x32_bf16 v[8:11], v[84:87], v[96:99], v[8:11]
  ds_read_b64_tr_b16 v[120:121], v173 offset:16384
  ds_read_b64_tr_b16 v[122:123], v173 offset:17408
  v_mfma_f32_16x16x32_bf16 v[40:43], v[80:83], v[112:115], 0
  v_mfma_f32_16x16x32_bf16 v[40:43], v[84:87], v[116:119], v[40:43]
  s_waitcnt lgkmcnt(11)
  v_mfma_f32_16x16x32_bf16 v[12:15], v[92:95], v[88:91], 0
  ds_read_b128 v[80:83], v166 offset:0
  ds_read_b64_tr_b16 v[84:85], v162 offset:18432
  v_mfma_f32_16x16x32_bf16 v[12:15], v[108:111], v[96:99], v[12:15]
  ds_read_b64_tr_b16 v[86:87], v162 offset:19456
  ds_read_b64_tr_b16 v[124:125], v174 offset:0
  v_mfma_f32_16x16x32_bf16 v[44:47], v[92:95], v[112:115], 0
  v_mfma_f32_16x16x32_bf16 v[44:47], v[108:111], v[116:119], v[44:47]
  s_waitcnt lgkmcnt(11)
  v_mfma_f32_32x32x16_bf16 v[64:79], v[132:135], v[128:131], v[64:79]
  ds_read_b64_tr_b16 v[126:127], v174 offset:1024
  ds_read_b64_tr_b16 v[92:93], v174 offset:16384
  ds_read_b64_tr_b16 v[94:95], v174 offset:17408
  s_waitcnt lgkmcnt(11)
  v_mfma_f32_16x16x32_bf16 v[16:19], v[136:139], v[88:91], 0
  ds_read_b64_tr_b16 v[108:109], v175 offset:0
  ds_read_b64_tr_b16 v[110:111], v175 offset:1024
  v_mfma_f32_16x16x32_bf16 v[16:19], v[100:103], v[96:99], v[16:19]
  ds_read_b64_tr_b16 v[128:129], v175 offset:16384
  ds_read_b64_tr_b16 v[130:131], v175 offset:17408
  v_mfma_f32_16x16x32_bf16 v[48:51], v[136:139], v[112:115], 0
  v_mfma_f32_16x16x32_bf16 v[48:51], v[100:103], v[116:119], v[48:51]
  s_waitcnt lgkmcnt(11)
  v_mfma_f32_16x16x32_bf16 v[20:23], v[104:107], v[88:91], 0
  ds_read_b128 v[100:103], v167 offset:0
  ds_read_b64_tr_b16 v[132:133], v162 offset:26624
  v_mfma_f32_16x16x32_bf16 v[20:23], v[120:123], v[96:99], v[20:23]
  ds_read_b64_tr_b16 v[134:135], v162 offset:27648
  v_add_u32 v168, -65536, v168
  v_mfma_f32_16x16x32_bf16 v[52:55], v[104:107], v[112:115], 0
  v_add_u32 v169, -65536, v169
  v_add_u32 v170, -65536, v170
  v_mfma_f32_16x16x32_bf16 v[52:55], v[120:123], v[116:119], v[52:55]
  v_add_u32 v171, -65536, v171
  v_add_u32 v172, -65536, v172
  s_waitcnt lgkmcnt(10)
  v_mfma_f32_32x32x16_bf16 v[64:79], v[84:87], v[80:83], v[64:79]
  v_add_u32 v173, -65536, v173
  v_add_u32 v174, -65536, v174
  v_add_u32 v175, -65536, v175
  s_waitcnt vmcnt(16) lgkmcnt(0)
  s_barrier
  v_add_u32 v162, -65536, v162
  ds_read_b128 v[80:83], v160 offset:32768
  ds_read_b64_tr_b16 v[84:85], v168 offset:0
  ds_read_b64_tr_b16 v[86:87], v168 offset:1024
  ds_read_b128 v[104:107], v161 offset:32768
  ds_read_b64_tr_b16 v[120:121], v168 offset:16384
  s_add_u32 s53, s0, 10
  s_and_b32 s53, s53, 7
  s_lshl_b32 s53, s53, 7
  s_add_u32 m0, s68, 0
  s_add_u32 s52, s64, s53
  buffer_load_dwordx4 v208, s[16:19], s52 offen offset:0 lds
  buffer_load_dwordx4 v209, s[16:19], s52 offen offset:1024 lds
  buffer_load_dwordx4 v210, s[16:19], s52 offen offset:2048 lds
  buffer_load_dwordx4 v211, s[16:19], s52 offen offset:3072 lds
  s_add_u32 m0, s68, 16384
  s_add_u32 s52, s65, s53
  buffer_load_dwordx4 v208, s[16:19], s52 offen offset:0 lds
  buffer_load_dwordx4 v209, s[16:19], s52 offen offset:1024 lds
  buffer_load_dwordx4 v210, s[16:19], s52 offen offset:2048 lds
  buffer_load_dwordx4 v211, s[16:19], s52 offen offset:3072 lds
  s_add_u32 s56, s0, 11
  s_and_b32 s56, s56, 7
  s_mul_i32 s57, s56, 196608
  s_add_u32 s57, s57, s67
  s_lshl_b32 s56, s56, 19
  s_add_u32 s56, s56, s66
  s_add_u32 m0, s68, 131072
  s_add_u32 s58, s56, 0
  buffer_load_dwordx4 v212, s[20:23], s58 offen offset:0 lds
  buffer_load_dwordx4 v213, s[20:23], s58 offen offset:1024 lds
  s_add_u32 m0, m0, 2048
  s_add_u32 s58, s57, 0
  s_mov_b64 exec, s[2:3]
  buffer_load_dwordx4 v214, s[24:27], s58 offen offset:0 lds
  buffer_load_dwordx4 v215, s[24:27], s58 offen offset:1024 lds
  s_mov_b64 exec, -1
  s_add_u32 m0, s68, 147456
  s_add_u32 s58, s56, 262144
  buffer_load_dwordx4 v212, s[20:23], s58 offen offset:0 lds
  buffer_load_dwordx4 v213, s[20:23], s58 offen offset:1024 lds
  s_add_u32 m0, m0, 2048
  s_add_u32 s58, s57, 98304
  s_mov_b64 exec, s[2:3]
  buffer_load_dwordx4 v214, s[24:27], s58 offen offset:0 lds
  buffer_load_dwordx4 v215, s[24:27], s58 offen offset:1024 lds
  s_mov_b64 exec, -1
  v_mfma_f32_16x16x32_bf16 v[24:27], v[124:127], v[88:91], 0
  ds_read_b64_tr_b16 v[122:123], v168 offset:17408
  ds_read_b128 v[136:139], v160 offset:34816
  v_mfma_f32_16x16x32_bf16 v[24:27], v[92:95], v[96:99], v[24:27]
  ds_read_b128 v[140:143], v161 offset:34816
  ds_read_b64_tr_b16 v[144:145], v169 offset:0
  v_mfma_f32_16x16x32_bf16 v[56:59], v[124:127], v[112:115], 0
  ds_read_b64_tr_b16 v[146:147], v169 offset:1024
  ds_read_b64_tr_b16 v[124:125], v169 offset:16384
  v_mfma_f32_16x16x32_bf16 v[56:59], v[92:95], v[116:119], v[56:59]
  ds_read_b64_tr_b16 v[126:127], v169 offset:17408
  ds_read_b128 v[92:95], v164 offset:32768
  v_mfma_f32_16x16x32_bf16 v[28:31], v[108:111], v[88:91], 0
  ds_read_b64_tr_b16 v[88:89], v162 offset:2048
  ds_read_b64_tr_b16 v[90:91], v162 offset:3072
  v_mfma_f32_16x16x32_bf16 v[28:31], v[128:131], v[96:99], v[28:31]
  v_mfma_f32_16x16x32_bf16 v[60:63], v[108:111], v[112:115], 0
  v_mfma_f32_16x16x32_bf16 v[60:63], v[128:131], v[116:119], v[60:63]
  v_mfma_f32_32x32x16_bf16 v[64:79], v[132:135], v[100:103], v[64:79]
  s_waitcnt lgkmcnt(10)
  v_mfma_f32_16x16x32_bf16 v[0:3], v[84:87], v[80:83], v[0:3]
  ds_read_b64_tr_b16 v[96:97], v170 offset:0
  ds_read_b64_tr_b16 v[98:99], v170 offset:1024
  s_waitcnt lgkmcnt(10)
  v_mfma_f32_16x16x32_bf16 v[0:3], v[120:123], v[104:107], v[0:3]
  ds_read_b64_tr_b16 v[100:101], v170 offset:16384
  ds_read_b64_tr_b16 v[102:103], v170 offset:17408
  v_mfma_f32_16x16x32_bf16 v[32:35], v[84:87], v[136:139], v[32:35]
  ds_read_b64_tr_b16 v[84:85], v171 offset:0
  ds_read_b64_tr_b16 v[86:87], v171 offset:1024
  s_waitcnt lgkmcnt(10)
  v_mfma_f32_16x16x32_bf16 v[32:35], v[120:123], v[140:143], v[32:35]
  ds_read_b64_tr_b16 v[108:109], v171 offset:16384
  ds_read_b64_tr_b16 v[110:111], v171 offset:17408
  v_mfma_f32_16x16x32_bf16 v[4:7], v[144:147], v[80:83], v[4:7]
  ds_read_b128 v[112:115], v165 offset:32768
  ds_read_b64_tr_b16 v[116:117], v162 offset:10240
  s_waitcnt lgkmcnt(10)
  v_mfma_f32_16x16x32_bf16 v[4:7], v[124:127], v[104:107], v[4:7]
  ds_read_b64_tr_b16 v[118:119], v162 offset:11264
  ds_read_b64_tr_b16 v[120:121], v172 offset:0
  v_mfma_f32_16x16x32_bf16 v[36:39], v[144:147], v[136:139], v[36:39]
  ds_read_b64_tr_b16 v[122:123], v172 offset:1024
  ds_read_b64_tr_b16 v[128:129], v172 offset:16384
  v_mfma_f32_16x16x32_bf16 v[36:39], v[124:127], v[140:143], v[36:39]
  ds_read_b64_tr_b16 v[130:131], v172 offset:17408
  v_mfma_f32_32x32x16_bf16 v[64:79], v[88:91], v[92:95], v[64:79]
  s_waitcnt lgkmcnt(13)
  v_mfma_f32_16x16x32_bf16 v[8:11], v[96:99], v[80:83], v[8:11]
  ds_read_b64_tr_b16 v[88:89], v173 offset:0
  ds_read_b64_tr_b16 v[90:91], v173 offset:1024
  s_waitcnt lgkmcnt(13)
  v_mfma_f32_16x16x32_bf16 v[8:11], v[100:103], v[104:107], v[8:11]
  ds_read_b64_tr_b16 v[92:93], v173 offset:16384
  ds_read_b64_tr_b16 v[94:95], v173 offset:17408
  v_mfma_f32_16x16x32_bf16 v[40:43], v[96:99], v[136:139], v[40:43]
  v_mfma_f32_16x16x32_bf16 v[40:43], v[100:103], v[140:143], v[40:43]
  s_waitcnt lgkmcnt(11)
  v_mfma_f32_16x16x32_bf16 v[12:15], v[84:87], v[80:83], v[12:15]
  ds_read_b128 v[96:99], v166 offset:32768
  ds_read_b64_tr_b16 v[100:101], v162 offset:18432
  v_mfma_f32_16x16x32_bf16 v[12:15], v[108:111], v[104:107], v[12:15]
  ds_read_b64_tr_b16 v[102:103], v162 offset:19456
  ds_read_b64_tr_b16 v[124:125], v174 offset:0
  v_mfma_f32_16x16x32_bf16 v[44:47], v[84:87], v[136:139], v[44:47]
  v_mfma_f32_16x16x32_bf16 v[44:47], v[108:111], v[140:143], v[44:47]
  s_waitcnt lgkmcnt(8)
  v_mfma_f32_32x32x16_bf16 v[64:79], v[116:119], v[112:115], v[64:79]
  ds_read_b64_tr_b16 v[126:127], v174 offset:1024
  ds_read_b64_tr_b16 v[84:85], v174 offset:16384
  ds_read_b64_tr_b16 v[86:87], v174 offset:17408
  v_mfma_f32_16x16x32_bf16 v[16:19], v[120:123], v[80:83], v[16:19]
  ds_read_b64_tr_b16 v[108:109], v175 offset:0
  ds_read_b64_tr_b16 v[110:111], v175 offset:1024
  v_mfma_f32_16x16x32_bf16 v[16:19], v[128:131], v[104:107], v[16:19]
  ds_read_b64_tr_b16 v[112:113], v175 offset:16384
  ds_read_b64_tr_b16 v[114:115], v175 offset:17408
  v_mfma_f32_16x16x32_bf16 v[48:51], v[120:123], v[136:139], v[48:51]
  v_mfma_f32_16x16x32_bf16 v[48:51], v[128:131], v[140:143], v[48:51]
  s_waitcnt lgkmcnt(11)
  v_mfma_f32_16x16x32_bf16 v[20:23], v[88:91], v[80:83], v[20:23]
  ds_read_b128 v[116:119], v167 offset:32768
  ds_read_b64_tr_b16 v[120:121], v162 offset:26624
  v_mfma_f32_16x16x32_bf16 v[20:23], v[92:95], v[104:107], v[20:23]
  ds_read_b64_tr_b16 v[122:123], v162 offset:27648
  v_mfma_f32_16x16x32_bf16 v[52:55], v[88:91], v[136:139], v[52:55]
  v_mfma_f32_16x16x32_bf16 v[52:55], v[92:95], v[140:143], v[52:55]
  s_waitcnt lgkmcnt(10)
  v_mfma_f32_32x32x16_bf16 v[64:79], v[100:103], v[96:99], v[64:79]
  s_waitcnt vmcnt(8) lgkmcnt(0)
  s_barrier
  ds_read_b128 v[88:91], v160 offset:0
  ds_read_b64_tr_b16 v[92:93], v168 offset:32768
  ds_read_b64_tr_b16 v[94:95], v168 offset:33792
  ds_read_b128 v[96:99], v161 offset:0
  ds_read_b64_tr_b16 v[100:101], v168 offset:49152
  ds_read_b64_tr_b16 v[102:103], v168 offset:50176
  s_add_u32 s53, s0, 11
  s_and_b32 s53, s53, 7
  s_lshl_b32 s53, s53, 7
  s_add_u32 m0, s68, 32768
  s_add_u32 s52, s64, s53
  buffer_load_dwordx4 v208, s[16:19], s52 offen offset:0 lds
  buffer_load_dwordx4 v209, s[16:19], s52 offen offset:1024 lds
  buffer_load_dwordx4 v210, s[16:19], s52 offen offset:2048 lds
  buffer_load_dwordx4 v211, s[16:19], s52 offen offset:3072 lds
  s_add_u32 m0, s68, 49152
  s_add_u32 s52, s65, s53
  buffer_load_dwordx4 v208, s[16:19], s52 offen offset:0 lds
  buffer_load_dwordx4 v209, s[16:19], s52 offen offset:1024 lds
  buffer_load_dwordx4 v210, s[16:19], s52 offen offset:2048 lds
  buffer_load_dwordx4 v211, s[16:19], s52 offen offset:3072 lds
  s_add_u32 s56, s0, 12
  s_and_b32 s56, s56, 7
  s_mul_i32 s57, s56, 196608
  s_add_u32 s57, s57, s67
  s_lshl_b32 s56, s56, 19
  s_add_u32 s56, s56, s66
  s_add_u32 m0, s68, 65536
  s_add_u32 s58, s56, 0
  buffer_load_dwordx4 v212, s[20:23], s58 offen offset:0 lds
  buffer_load_dwordx4 v213, s[20:23], s58 offen offset:1024 lds
  s_add_u32 m0, m0, 2048
  s_add_u32 s58, s57, 0
  s_mov_b64 exec, s[2:3]
  buffer_load_dwordx4 v214, s[24:27], s58 offen offset:0 lds
  buffer_load_dwordx4 v215, s[24:27], s58 offen offset:1024 lds
  s_mov_b64 exec, -1
  s_add_u32 m0, s68, 81920
  s_add_u32 s58, s56, 262144
  buffer_load_dwordx4 v212, s[20:23], s58 offen offset:0 lds
  buffer_load_dwordx4 v213, s[20:23], s58 offen offset:1024 lds
  s_add_u32 m0, m0, 2048
  s_add_u32 s58, s57, 98304
  s_mov_b64 exec, s[2:3]
  buffer_load_dwordx4 v214, s[24:27], s58 offen offset:0 lds
  buffer_load_dwordx4 v215, s[24:27], s58 offen offset:1024 lds
  s_mov_b64 exec, -1
  v_mfma_f32_16x16x32_bf16 v[24:27], v[124:127], v[80:83], v[24:27]
  ds_read_b128 v[128:131], v160 offset:2048
  ds_read_b128 v[132:135], v161 offset:2048
  v_mfma_f32_16x16x32_bf16 v[24:27], v[84:87], v[104:107], v[24:27]
  ds_read_b64_tr_b16 v[144:145], v169 offset:32768
  ds_read_b64_tr_b16 v[146:147], v169 offset:33792
  v_mfma_f32_16x16x32_bf16 v[56:59], v[124:127], v[136:139], v[56:59]
  ds_read_b64_tr_b16 v[124:125], v169 offset:49152
  ds_read_b64_tr_b16 v[126:127], v169 offset:50176
  v_mfma_f32_16x16x32_bf16 v[56:59], v[84:87], v[140:143], v[56:59]
  ds_read_b128 v[84:87], v164 offset:0
  ds_read_b64_tr_b16 v[148:149], v162 offset:34816
  v_mfma_f32_16x16x32_bf16 v[28:31], v[108:111], v[80:83], v[28:31]
  ds_read_b64_tr_b16 v[150:151], v162 offset:35840
  v_mfma_f32_16x16x32_bf16 v[28:31], v[112:115], v[104:107], v[28:31]
  v_mfma_f32_16x16x32_bf16 v[60:63], v[108:111], v[136:139], v[60:63]
  v_mfma_f32_16x16x32_bf16 v[60:63], v[112:115], v[140:143], v[60:63]
  v_mfma_f32_32x32x16_bf16 v[64:79], v[120:123], v[116:119], v[64:79]
  s_waitcnt lgkmcnt(9)
  v_mfma_f32_16x16x32_bf16 v[0:3], v[92:95], v[88:91], v[0:3]
  ds_read_b64_tr_b16 v[80:81], v170 offset:32768
  ds_read_b64_tr_b16 v[82:83], v170 offset:33792
  v_mfma_f32_16x16x32_bf16 v[0:3], v[100:103], v[96:99], v[0:3]
  ds_read_b64_tr_b16 v[104:105], v170 offset:49152
  ds_read_b64_tr_b16 v[106:107], v170 offset:50176
  s_waitcnt lgkmcnt(9)
  v_mfma_f32_16x16x32_bf16 v[32:35], v[92:95], v[128:131], v[32:35]
  ds_read_b64_tr_b16 v[92:93], v171 offset:32768
  ds_read_b64_tr_b16 v[94:95], v171 offset:33792
  v_mfma_f32_16x16x32_bf16 v[32:35], v[100:103], v[132:135], v[32:35]
  ds_read_b64_tr_b16 v[100:101], v171 offset:49152
  ds_read_b64_tr_b16 v[102:103], v171 offset:50176
  v_mfma_f32_16x16x32_bf16 v[4:7], v[144:147], v[88:91], v[4:7]
  ds_read_b128 v[108:111], v165 offset:0
  ds_read_b64_tr_b16 v[112:113], v162 offset:43008
  s_waitcnt lgkmcnt(10)
  v_mfma_f32_16x16x32_bf16 v[4:7], v[124:127], v[96:99], v[4:7]
  ds_read_b64_tr_b16 v[114:115], v162 offset:44032
  ds_read_b64_tr_b16 v[116:117], v172 offset:32768
  v_mfma_f32_16x16x32_bf16 v[36:39], v[144:147], v[128:131], v[36:39]
  ds_read_b64_tr_b16 v[118:119], v172 offset:33792
  ds_read_b64_tr_b16 v[120:121], v172 offset:49152
  v_mfma_f32_16x16x32_bf16 v[36:39], v[124:127], v[132:135], v[36:39]
  ds_read_b64_tr_b16 v[122:123], v172 offset:50176
  v_mfma_f32_32x32x16_bf16 v[64:79], v[148:151], v[84:87], v[64:79]
  s_waitcnt lgkmcnt(13)
  v_mfma_f32_16x16x32_bf16 v[8:11], v[80:83], v[88:91], v[8:11]
  ds_read_b64_tr_b16 v[84:85], v173 offset:32768
  ds_read_b64_tr_b16 v[86:87], v173 offset:33792
  s_waitcnt lgkmcnt(13)
  v_mfma_f32_16x16x32_bf16 v[8:11], v[104:107], v[96:99], v[8:11]
  ds_read_b64_tr_b16 v[124:125], v173 offset:49152
  ds_read_b64_tr_b16 v[126:127], v173 offset:50176
  v_mfma_f32_16x16x32_bf16 v[40:43], v[80:83], v[128:131], v[40:43]
  v_mfma_f32_16x16x32_bf16 v[40:43], v[104:107], v[132:135], v[40:43]
  s_waitcnt lgkmcnt(11)
  v_mfma_f32_16x16x32_bf16 v[12:15], v[92:95], v[88:91], v[12:15]
  ds_read_b128 v[80:83], v166 offset:0
  ds_read_b64_tr_b16 v[104:105], v162 offset:51200
  v_mfma_f32_16x16x32_bf16 v[12:15], v[100:103], v[96:99], v[12:15]
  ds_read_b64_tr_b16 v[106:107], v162 offset:52224
  ds_read_b64_tr_b16 v[136:137], v174 offset:32768
  v_mfma_f32_16x16x32_bf16 v[44:47], v[92:95], v[128:131], v[44:47]
  v_mfma_f32_16x16x32_bf16 v[44:47], v[100:103], v[132:135], v[44:47]
  s_waitcnt lgkmcnt(8)
  v_mfma_f32_32x32x16_bf16 v[64:79], v[112:115], v[108:111], v[64:79]
  ds_read_b64_tr_b16 v[138:139], v174 offset:33792
  ds_read_b64_tr_b16 v[92:93], v174 offset:49152
  ds_read_b64_tr_b16 v[94:95], v174 offset:50176
  v_mfma_f32_16x16x32_bf16 v[16:19], v[116:119], v[88:91], v[16:19]
  ds_read_b64_tr_b16 v[100:101], v175 offset:32768
  ds_read_b64_tr_b16 v[102:103], v175 offset:33792
  v_mfma_f32_16x16x32_bf16 v[16:19], v[120:123], v[96:99], v[16:19]
  ds_read_b64_tr_b16 v[108:109], v175 offset:49152
  ds_read_b64_tr_b16 v[110:111], v175 offset:50176
  v_mfma_f32_16x16x32_bf16 v[48:51], v[116:119], v[128:131], v[48:51]
  v_mfma_f32_16x16x32_bf16 v[48:51], v[120:123], v[132:135], v[48:51]
  s_waitcnt lgkmcnt(11)
  v_mfma_f32_16x16x32_bf16 v[20:23], v[84:87], v[88:91], v[20:23]
  ds_read_b128 v[112:115], v167 offset:0
  ds_read_b64_tr_b16 v[116:117], v162 offset:59392
  v_mfma_f32_16x16x32_bf16 v[20:23], v[124:127], v[96:99], v[20:23]
  ds_read_b64_tr_b16 v[118:119], v162 offset:60416
  v_add_u32 v168, 65536, v168
  v_mfma_f32_16x16x32_bf16 v[52:55], v[84:87], v[128:131], v[52:55]
  v_add_u32 v169, 65536, v169
  v_add_u32 v170, 65536, v170
  v_mfma_f32_16x16x32_bf16 v[52:55], v[124:127], v[132:135], v[52:55]
  v_add_u32 v171, 65536, v171
  v_add_u32 v172, 65536, v172
  s_waitcnt lgkmcnt(10)
  v_mfma_f32_32x32x16_bf16 v[64:79], v[104:107], v[80:83], v[64:79]
  v_add_u32 v173, 65536, v173
  v_add_u32 v174, 65536, v174
  v_add_u32 v175, 65536, v175
  s_waitcnt vmcnt(8) lgkmcnt(0)
  s_barrier
  v_add_u32 v162, 65536, v162
  ds_read_b128 v[80:83], v160 offset:32768
  ds_read_b64_tr_b16 v[84:85], v168 offset:0
  ds_read_b64_tr_b16 v[86:87], v168 offset:1024
  ds_read_b128 v[104:107], v161 offset:32768
  ds_read_b64_tr_b16 v[120:121], v168 offset:16384
  s_add_u32 s53, s0, 12
  s_and_b32 s53, s53, 7
  s_lshl_b32 s53, s53, 7
  s_add_u32 m0, s68, 0
  s_add_u32 s52, s64, s53
  buffer_load_dwordx4 v208, s[16:19], s52 offen offset:0 lds
  buffer_load_dwordx4 v209, s[16:19], s52 offen offset:1024 lds
  buffer_load_dwordx4 v210, s[16:19], s52 offen offset:2048 lds
  buffer_load_dwordx4 v211, s[16:19], s52 offen offset:3072 lds
  s_add_u32 m0, s68, 16384
  s_add_u32 s52, s65, s53
  buffer_load_dwordx4 v208, s[16:19], s52 offen offset:0 lds
  buffer_load_dwordx4 v209, s[16:19], s52 offen offset:1024 lds
  buffer_load_dwordx4 v210, s[16:19], s52 offen offset:2048 lds
  buffer_load_dwordx4 v211, s[16:19], s52 offen offset:3072 lds
  s_add_u32 s56, s0, 13
  s_and_b32 s56, s56, 7
  s_mul_i32 s57, s56, 196608
  s_add_u32 s57, s57, s67
  s_lshl_b32 s56, s56, 19
  s_add_u32 s56, s56, s66
  s_add_u32 m0, s68, 98304
  s_add_u32 s58, s56, 0
  buffer_load_dwordx4 v212, s[20:23], s58 offen offset:0 lds
  buffer_load_dwordx4 v213, s[20:23], s58 offen offset:1024 lds
  s_add_u32 m0, m0, 2048
  s_add_u32 s58, s57, 0
  s_mov_b64 exec, s[2:3]
  buffer_load_dwordx4 v214, s[24:27], s58 offen offset:0 lds
  buffer_load_dwordx4 v215, s[24:27], s58 offen offset:1024 lds
  s_mov_b64 exec, -1
  s_add_u32 m0, s68, 114688
  s_add_u32 s58, s56, 262144
  buffer_load_dwordx4 v212, s[20:23], s58 offen offset:0 lds
  buffer_load_dwordx4 v213, s[20:23], s58 offen offset:1024 lds
  s_add_u32 m0, m0, 2048
  s_add_u32 s58, s57, 98304
  s_mov_b64 exec, s[2:3]
  buffer_load_dwordx4 v214, s[24:27], s58 offen offset:0 lds
  buffer_load_dwordx4 v215, s[24:27], s58 offen offset:1024 lds
  s_mov_b64 exec, -1
  v_mfma_f32_16x16x32_bf16 v[24:27], v[136:139], v[88:91], v[24:27]
  ds_read_b64_tr_b16 v[122:123], v168 offset:17408
  ds_read_b128 v[124:127], v160 offset:34816
  v_mfma_f32_16x16x32_bf16 v[24:27], v[92:95], v[96:99], v[24:27]
  ds_read_b128 v[140:143], v161 offset:34816
  ds_read_b64_tr_b16 v[144:145], v169 offset:0
  v_mfma_f32_16x16x32_bf16 v[56:59], v[136:139], v[128:131], v[56:59]
  ds_read_b64_tr_b16 v[146:147], v169 offset:1024
  ds_read_b64_tr_b16 v[136:137], v169 offset:16384
  v_mfma_f32_16x16x32_bf16 v[56:59], v[92:95], v[132:135], v[56:59]
  ds_read_b64_tr_b16 v[138:139], v169 offset:17408
  ds_read_b128 v[92:95], v164 offset:32768
  v_mfma_f32_16x16x32_bf16 v[28:31], v[100:103], v[88:91], v[28:31]
  ds_read_b64_tr_b16 v[88:89], v162 offset:2048
  ds_read_b64_tr_b16 v[90:91], v162 offset:3072
  v_mfma_f32_16x16x32_bf16 v[28:31], v[108:111], v[96:99], v[28:31]
  v_mfma_f32_16x16x32_bf16 v[60:63], v[100:103], v[128:131], v[60:63]
  v_mfma_f32_16x16x32_bf16 v[60:63], v[108:111], v[132:135], v[60:63]
  v_mfma_f32_32x32x16_bf16 v[64:79], v[116:119], v[112:115], v[64:79]
  s_waitcnt lgkmcnt(10)
  v_mfma_f32_16x16x32_bf16 v[0:3], v[84:87], v[80:83], v[0:3]
  ds_read_b64_tr_b16 v[96:97], v170 offset:0
  ds_read_b64_tr_b16 v[98:99], v170 offset:1024
  s_waitcnt lgkmcnt(10)
  v_mfma_f32_16x16x32_bf16 v[0:3], v[120:123], v[104:107], v[0:3]
  ds_read_b64_tr_b16 v[100:101], v170 offset:16384
  ds_read_b64_tr_b16 v[102:103], v170 offset:17408
  v_mfma_f32_16x16x32_bf16 v[32:35], v[84:87], v[124:127], v[32:35]
  ds_read_b64_tr_b16 v[84:85], v171 offset:0
  ds_read_b64_tr_b16 v[86:87], v171 offset:1024
  s_waitcnt lgkmcnt(10)
  v_mfma_f32_16x16x32_bf16 v[32:35], v[120:123], v[140:143], v[32:35]
  ds_read_b64_tr_b16 v[108:109], v171 offset:16384
  ds_read_b64_tr_b16 v[110:111], v171 offset:17408
  v_mfma_f32_16x16x32_bf16 v[4:7], v[144:147], v[80:83], v[4:7]
  ds_read_b128 v[112:115], v165 offset:32768
  ds_read_b64_tr_b16 v[116:117], v162 offset:10240
  s_waitcnt lgkmcnt(10)
  v_mfma_f32_16x16x32_bf16 v[4:7], v[136:139], v[104:107], v[4:7]
  ds_read_b64_tr_b16 v[118:119], v162 offset:11264
  ds_read_b64_tr_b16 v[120:121], v172 offset:0
  v_mfma_f32_16x16x32_bf16 v[36:39], v[144:147], v[124:127], v[36:39]
  ds_read_b64_tr_b16 v[122:123], v172 offset:1024
  ds_read_b64_tr_b16 v[128:129], v172 offset:16384
  v_mfma_f32_16x16x32_bf16 v[36:39], v[136:139], v[140:143], v[36:39]
  ds_read_b64_tr_b16 v[130:131], v172 offset:17408
  v_mfma_f32_32x32x16_bf16 v[64:79], v[88:91], v[92:95], v[64:79]
  s_waitcnt lgkmcnt(13)
  v_mfma_f32_16x16x32_bf16 v[8:11], v[96:99], v[80:83], v[8:11]
  ds_read_b64_tr_b16 v[88:89], v173 offset:0
  ds_read_b64_tr_b16 v[90:91], v173 offset:1024
  s_waitcnt lgkmcnt(13)
  v_mfma_f32_16x16x32_bf16 v[8:11], v[100:103], v[104:107], v[8:11]
  ds_read_b64_tr_b16 v[92:93], v173 offset:16384
  ds_read_b64_tr_b16 v[94:95], v173 offset:17408
  v_mfma_f32_16x16x32_bf16 v[40:43], v[96:99], v[124:127], v[40:43]
  v_mfma_f32_16x16x32_bf16 v[40:43], v[100:103], v[140:143], v[40:43]
  s_waitcnt lgkmcnt(11)
  v_mfma_f32_16x16x32_bf16 v[12:15], v[84:87], v[80:83], v[12:15]
  ds_read_b128 v[96:99], v166 offset:32768
  ds_read_b64_tr_b16 v[100:101], v162 offset:18432
  v_mfma_f32_16x16x32_bf16 v[12:15], v[108:111], v[104:107], v[12:15]
  ds_read_b64_tr_b16 v[102:103], v162 offset:19456
  ds_read_b64_tr_b16 v[132:133], v174 offset:0
  v_mfma_f32_16x16x32_bf16 v[44:47], v[84:87], v[124:127], v[44:47]
  v_mfma_f32_16x16x32_bf16 v[44:47], v[108:111], v[140:143], v[44:47]
  s_waitcnt lgkmcnt(8)
  v_mfma_f32_32x32x16_bf16 v[64:79], v[116:119], v[112:115], v[64:79]
  ds_read_b64_tr_b16 v[134:135], v174 offset:1024
  ds_read_b64_tr_b16 v[84:85], v174 offset:16384
  ds_read_b64_tr_b16 v[86:87], v174 offset:17408
  v_mfma_f32_16x16x32_bf16 v[16:19], v[120:123], v[80:83], v[16:19]
  ds_read_b64_tr_b16 v[108:109], v175 offset:0
  ds_read_b64_tr_b16 v[110:111], v175 offset:1024
  v_mfma_f32_16x16x32_bf16 v[16:19], v[128:131], v[104:107], v[16:19]
  ds_read_b64_tr_b16 v[112:113], v175 offset:16384
  ds_read_b64_tr_b16 v[114:115], v175 offset:17408
  v_mfma_f32_16x16x32_bf16 v[48:51], v[120:123], v[124:127], v[48:51]
  v_mfma_f32_16x16x32_bf16 v[48:51], v[128:131], v[140:143], v[48:51]
  s_waitcnt lgkmcnt(11)
  v_mfma_f32_16x16x32_bf16 v[20:23], v[88:91], v[80:83], v[20:23]
  ds_read_b128 v[116:119], v167 offset:32768
  ds_read_b64_tr_b16 v[120:121], v162 offset:26624
  v_mfma_f32_16x16x32_bf16 v[20:23], v[92:95], v[104:107], v[20:23]
  ds_read_b64_tr_b16 v[122:123], v162 offset:27648
  v_add_u32 v168, -65536, v168
  v_mfma_f32_16x16x32_bf16 v[52:55], v[88:91], v[124:127], v[52:55]
  v_add_u32 v169, -65536, v169
  v_add_u32 v170, -65536, v170
  v_mfma_f32_16x16x32_bf16 v[52:55], v[92:95], v[140:143], v[52:55]
  v_add_u32 v171, -65536, v171
  v_add_u32 v172, -65536, v172
  s_waitcnt lgkmcnt(10)
  v_mfma_f32_32x32x16_bf16 v[64:79], v[100:103], v[96:99], v[64:79]
  v_add_u32 v173, -65536, v173
  v_add_u32 v174, -65536, v174
  v_add_u32 v175, -65536, v175
  s_waitcnt vmcnt(8) lgkmcnt(0)
  s_barrier
  v_add_u32 v162, -65536, v162
  ds_read_b128 v[88:91], v160 offset:0
  ds_read_b64_tr_b16 v[92:93], v168 offset:0
  ds_read_b64_tr_b16 v[94:95], v168 offset:1024
  ds_read_b128 v[96:99], v161 offset:0
  ds_read_b64_tr_b16 v[100:101], v168 offset:16384
  s_add_u32 s53, s0, 13
  s_and_b32 s53, s53, 7
  s_lshl_b32 s53, s53, 7
  s_add_u32 m0, s68, 32768
  s_add_u32 s52, s64, s53
  buffer_load_dwordx4 v208, s[16:19], s52 offen offset:0 lds
  buffer_load_dwordx4 v209, s[16:19], s52 offen offset:1024 lds
  buffer_load_dwordx4 v210, s[16:19], s52 offen offset:2048 lds
  buffer_load_dwordx4 v211, s[16:19], s52 offen offset:3072 lds
  s_add_u32 m0, s68, 49152
  s_add_u32 s52, s65, s53
  buffer_load_dwordx4 v208, s[16:19], s52 offen offset:0 lds
  buffer_load_dwordx4 v209, s[16:19], s52 offen offset:1024 lds
  buffer_load_dwordx4 v210, s[16:19], s52 offen offset:2048 lds
  buffer_load_dwordx4 v211, s[16:19], s52 offen offset:3072 lds
  s_add_u32 s56, s0, 14
  s_and_b32 s56, s56, 7
  s_mul_i32 s57, s56, 196608
  s_add_u32 s57, s57, s67
  s_lshl_b32 s56, s56, 19
  s_add_u32 s56, s56, s66
  s_add_u32 m0, s68, 131072
  s_add_u32 s58, s56, 0
  buffer_load_dwordx4 v212, s[20:23], s58 offen offset:0 lds
  buffer_load_dwordx4 v213, s[20:23], s58 offen offset:1024 lds
  s_add_u32 m0, m0, 2048
  s_add_u32 s58, s57, 0
  s_mov_b64 exec, s[2:3]
  buffer_load_dwordx4 v214, s[24:27], s58 offen offset:0 lds
  buffer_load_dwordx4 v215, s[24:27], s58 offen offset:1024 lds
  s_mov_b64 exec, -1
  s_add_u32 m0, s68, 147456
  s_add_u32 s58, s56, 262144
  buffer_load_dwordx4 v212, s[20:23], s58 offen offset:0 lds
  buffer_load_dwordx4 v213, s[20:23], s58 offen offset:1024 lds
  s_add_u32 m0, m0, 2048
  s_add_u32 s58, s57, 98304
  s_mov_b64 exec, s[2:3]
  buffer_load_dwordx4 v214, s[24:27], s58 offen offset:0 lds
  buffer_load_dwordx4 v215, s[24:27], s58 offen offset:1024 lds
  s_mov_b64 exec, -1
  v_mfma_f32_16x16x32_bf16 v[24:27], v[132:135], v[80:83], v[24:27]
  ds_read_b64_tr_b16 v[102:103], v168 offset:17408
  ds_read_b128 v[128:131], v160 offset:2048
  v_mfma_f32_16x16x32_bf16 v[24:27], v[84:87], v[104:107], v[24:27]
  ds_read_b128 v[136:139], v161 offset:2048
  ds_read_b64_tr_b16 v[144:145], v169 offset:0
  v_mfma_f32_16x16x32_bf16 v[56:59], v[132:135], v[124:127], v[56:59]
  ds_read_b64_tr_b16 v[146:147], v169 offset:1024
  ds_read_b64_tr_b16 v[132:133], v169 offset:16384
  v_mfma_f32_16x16x32_bf16 v[56:59], v[84:87], v[140:143], v[56:59]
  ds_read_b64_tr_b16 v[134:135], v169 offset:17408
  ds_read_b128 v[84:87], v164 offset:0
  v_mfma_f32_16x16x32_bf16 v[28:31], v[108:111], v[80:83], v[28:31]
  ds_read_b64_tr_b16 v[80:81], v162 offset:2048
  ds_read_b64_tr_b16 v[82:83], v162 offset:3072
  v_mfma_f32_16x16x32_bf16 v[28:31], v[112:115], v[104:107], v[28:31]
  v_mfma_f32_16x16x32_bf16 v[60:63], v[108:111], v[124:127], v[60:63]
  v_mfma_f32_16x16x32_bf16 v[60:63], v[112:115], v[140:143], v[60:63]
  v_mfma_f32_32x32x16_bf16 v[64:79], v[120:123], v[116:119], v[64:79]
  s_waitcnt lgkmcnt(10)
  v_mfma_f32_16x16x32_bf16 v[0:3], v[92:95], v[88:91], v[0:3]
  ds_read_b64_tr_b16 v[104:105], v170 offset:0
  ds_read_b64_tr_b16 v[106:107], v170 offset:1024
  s_waitcnt lgkmcnt(10)
  v_mfma_f32_16x16x32_bf16 v[0:3], v[100:103], v[96:99], v[0:3]
  ds_read_b64_tr_b16 v[108:109], v170 offset:16384
  ds_read_b64_tr_b16 v[110:111], v170 offset:17408
  v_mfma_f32_16x16x32_bf16 v[32:35], v[92:95], v[128:131], v[32:35]
  ds_read_b64_tr_b16 v[92:93], v171 offset:0
  ds_read_b64_tr_b16 v[94:95], v171 offset:1024
  s_waitcnt lgkmcnt(10)
  v_mfma_f32_16x16x32_bf16 v[32:35], v[100:103], v[136:139], v[32:35]
  ds_read_b64_tr_b16 v[100:101], v171 offset:16384
  ds_read_b64_tr_b16 v[102:103], v171 offset:17408
  v_mfma_f32_16x16x32_bf16 v[4:7], v[144:147], v[88:91], v[4:7]
  ds_read_b128 v[112:115], v165 offset:0
  ds_read_b64_tr_b16 v[116:117], v162 offset:10240
  s_waitcnt lgkmcnt(10)
  v_mfma_f32_16x16x32_bf16 v[4:7], v[132:135], v[96:99], v[4:7]
  ds_read_b64_tr_b16 v[118:119], v162 offset:11264
  ds_read_b64_tr_b16 v[120:121], v172 offset:0
  v_mfma_f32_16x16x32_bf16 v[36:39], v[144:147], v[128:131], v[36:39]
  ds_read_b64_tr_b16 v[122:123], v172 offset:1024
  ds_read_b64_tr_b16 v[124:125], v172 offset:16384
  v_mfma_f32_16x16x32_bf16 v[36:39], v[132:135], v[136:139], v[36:39]
  ds_read_b64_tr_b16 v[126:127], v172 offset:17408
  v_mfma_f32_32x32x16_bf16 v[64:79], v[80:83], v[84:87], v[64:79]
  s_waitcnt lgkmcnt(13)
  v_mfma_f32_16x16x32_bf16 v[8:11], v[104:107], v[88:91], v[8:11]
  ds_read_b64_tr_b16 v[80:81], v173 offset:0
  ds_read_b64_tr_b16 v[82:83], v173 offset:1024
  s_waitcnt lgkmcnt(13)
  v_mfma_f32_16x16x32_bf16 v[8:11], v[108:111], v[96:99], v[8:11]
  ds_read_b64_tr_b16 v[84:85], v173 offset:16384
  ds_read_b64_tr_b16 v[86:87], v173 offset:17408
  v_mfma_f32_16x16x32_bf16 v[40:43], v[104:107], v[128:131], v[40:43]
  v_mfma_f32_16x16x32_bf16 v[40:43], v[108:111], v[136:139], v[40:43]
  s_waitcnt lgkmcnt(11)
  v_mfma_f32_16x16x32_bf16 v[12:15], v[92:95], v[88:91], v[12:15]
  ds_read_b128 v[104:107], v166 offset:0
  ds_read_b64_tr_b16 v[108:109], v162 offset:18432
  v_mfma_f32_16x16x32_bf16 v[12:15], v[100:103], v[96:99], v[12:15]
  ds_read_b64_tr_b16 v[110:111], v162 offset:19456
  ds_read_b64_tr_b16 v[132:133], v174 offset:0
  v_mfma_f32_16x16x32_bf16 v[44:47], v[92:95], v[128:131], v[44:47]
  v_mfma_f32_16x16x32_bf16 v[44:47], v[100:103], v[136:139], v[44:47]
  s_waitcnt lgkmcnt(8)
  v_mfma_f32_32x32x16_bf16 v[64:79], v[116:119], v[112:115], v[64:79]
  ds_read_b64_tr_b16 v[134:135], v174 offset:1024
  ds_read_b64_tr_b16 v[92:93], v174 offset:16384
  ds_read_b64_tr_b16 v[94:95], v174 offset:17408
  v_mfma_f32_16x16x32_bf16 v[16:19], v[120:123], v[88:91], v[16:19]
  ds_read_b64_tr_b16 v[100:101], v175 offset:0
  ds_read_b64_tr_b16 v[102:103], v175 offset:1024
  v_mfma_f32_16x16x32_bf16 v[16:19], v[124:127], v[96:99], v[16:19]
  ds_read_b64_tr_b16 v[112:113], v175 offset:16384
  ds_read_b64_tr_b16 v[114:115], v175 offset:17408
  v_mfma_f32_16x16x32_bf16 v[48:51], v[120:123], v[128:131], v[48:51]
  v_mfma_f32_16x16x32_bf16 v[48:51], v[124:127], v[136:139], v[48:51]
  s_waitcnt lgkmcnt(11)
  v_mfma_f32_16x16x32_bf16 v[20:23], v[80:83], v[88:91], v[20:23]
  ds_read_b128 v[116:119], v167 offset:0
  ds_read_b64_tr_b16 v[120:121], v162 offset:26624
  v_mfma_f32_16x16x32_bf16 v[20:23], v[84:87], v[96:99], v[20:23]
  ds_read_b64_tr_b16 v[122:123], v162 offset:27648
  v_mfma_f32_16x16x32_bf16 v[52:55], v[80:83], v[128:131], v[52:55]
  v_mfma_f32_16x16x32_bf16 v[52:55], v[84:87], v[136:139], v[52:55]
  s_waitcnt lgkmcnt(10)
  v_mfma_f32_32x32x16_bf16 v[64:79], v[108:111], v[104:107], v[64:79]
  s_waitcnt vmcnt(8) lgkmcnt(0)
  s_barrier
  ds_read_b128 v[80:83], v160 offset:32768
  ds_read_b64_tr_b16 v[84:85], v168 offset:32768
  ds_read_b64_tr_b16 v[86:87], v168 offset:33792
  ds_read_b128 v[104:107], v161 offset:32768
  ds_read_b64_tr_b16 v[108:109], v168 offset:49152
  ds_read_b64_tr_b16 v[110:111], v168 offset:50176
  s_add_u32 s53, s0, 14
  s_and_b32 s53, s53, 7
  s_lshl_b32 s53, s53, 7
  s_add_u32 m0, s68, 0
  s_add_u32 s52, s64, s53
  buffer_load_dwordx4 v208, s[16:19], s52 offen offset:0 lds
  buffer_load_dwordx4 v209, s[16:19], s52 offen offset:1024 lds
  buffer_load_dwordx4 v210, s[16:19], s52 offen offset:2048 lds
  buffer_load_dwordx4 v211, s[16:19], s52 offen offset:3072 lds
  s_add_u32 m0, s68, 16384
  s_add_u32 s52, s65, s53
  buffer_load_dwordx4 v208, s[16:19], s52 offen offset:0 lds
  buffer_load_dwordx4 v209, s[16:19], s52 offen offset:1024 lds
  buffer_load_dwordx4 v210, s[16:19], s52 offen offset:2048 lds
  buffer_load_dwordx4 v211, s[16:19], s52 offen offset:3072 lds
  s_add_u32 s56, s0, 15
  s_and_b32 s56, s56, 7
  s_mul_i32 s57, s56, 196608
  s_add_u32 s57, s57, s67
  s_lshl_b32 s56, s56, 19
  s_add_u32 s56, s56, s66
  s_add_u32 m0, s68, 65536
  s_add_u32 s58, s56, 0
  buffer_load_dwordx4 v212, s[20:23], s58 offen offset:0 lds
  buffer_load_dwordx4 v213, s[20:23], s58 offen offset:1024 lds
  s_add_u32 m0, m0, 2048
  s_add_u32 s58, s57, 0
  s_mov_b64 exec, s[2:3]
  buffer_load_dwordx4 v214, s[24:27], s58 offen offset:0 lds
  buffer_load_dwordx4 v215, s[24:27], s58 offen offset:1024 lds
  s_mov_b64 exec, -1
  s_add_u32 m0, s68, 81920
  s_add_u32 s58, s56, 262144
  buffer_load_dwordx4 v212, s[20:23], s58 offen offset:0 lds
  buffer_load_dwordx4 v213, s[20:23], s58 offen offset:1024 lds
  s_add_u32 m0, m0, 2048
  s_add_u32 s58, s57, 98304
  s_mov_b64 exec, s[2:3]
  buffer_load_dwordx4 v214, s[24:27], s58 offen offset:0 lds
  buffer_load_dwordx4 v215, s[24:27], s58 offen offset:1024 lds
  s_mov_b64 exec, -1
  v_mfma_f32_16x16x32_bf16 v[24:27], v[132:135], v[88:91], v[24:27]
  ds_read_b128 v[124:127], v160 offset:34816
  ds_read_b128 v[140:143], v161 offset:34816
  v_mfma_f32_16x16x32_bf16 v[24:27], v[92:95], v[96:99], v[24:27]
  ds_read_b64_tr_b16 v[144:145], v169 offset:32768
  ds_read_b64_tr_b16 v[146:147], v169 offset:33792
  v_mfma_f32_16x16x32_bf16 v[56:59], v[132:135], v[128:131], v[56:59]
  ds_read_b64_tr_b16 v[132:133], v169 offset:49152
  ds_read_b64_tr_b16 v[134:135], v169 offset:50176
  v_mfma_f32_16x16x32_bf16 v[56:59], v[92:95], v[136:139], v[56:59]
  ds_read_b128 v[92:95], v164 offset:32768
  ds_read_b64_tr_b16 v[148:149], v162 offset:34816
  v_mfma_f32_16x16x32_bf16 v[28:31], v[100:103], v[88:91], v[28:31]
  ds_read_b64_tr_b16 v[150:151], v162 offset:35840
  v_mfma_f32_16x16x32_bf16 v[28:31], v[112:115], v[96:99], v[28:31]
  v_mfma_f32_16x16x32_bf16 v[60:63], v[100:103], v[128:131], v[60:63]
  v_mfma_f32_16x16x32_bf16 v[60:63], v[112:115], v[136:139], v[60:63]
  v_mfma_f32_32x32x16_bf16 v[64:79], v[120:123], v[116:119], v[64:79]
  s_waitcnt lgkmcnt(9)
  v_mfma_f32_16x16x32_bf16 v[0:3], v[84:87], v[80:83], v[0:3]
  ds_read_b64_tr_b16 v[88:89], v170 offset:32768
  ds_read_b64_tr_b16 v[90:91], v170 offset:33792
  v_mfma_f32_16x16x32_bf16 v[0:3], v[108:111], v[104:107], v[0:3]
  ds_read_b64_tr_b16 v[96:97], v170 offset:49152
  ds_read_b64_tr_b16 v[98:99], v170 offset:50176
  s_waitcnt lgkmcnt(9)
  v_mfma_f32_16x16x32_bf16 v[32:35], v[84:87], v[124:127], v[32:35]
  ds_read_b64_tr_b16 v[84:85], v171 offset:32768
  ds_read_b64_tr_b16 v[86:87], v171 offset:33792
  v_mfma_f32_16x16x32_bf16 v[32:35], v[108:111], v[140:143], v[32:35]
  ds_read_b64_tr_b16 v[100:101], v171 offset:49152
  ds_read_b64_tr_b16 v[102:103], v171 offset:50176
  v_mfma_f32_16x16x32_bf16 v[4:7], v[144:147], v[80:83], v[4:7]
  ds_read_b128 v[108:111], v165 offset:32768
  ds_read_b64_tr_b16 v[112:113], v162 offset:43008
  s_waitcnt lgkmcnt(10)
  v_mfma_f32_16x16x32_bf16 v[4:7], v[132:135], v[104:107], v[4:7]
  ds_read_b64_tr_b16 v[114:115], v162 offset:44032
  ds_read_b64_tr_b16 v[116:117], v172 offset:32768
  v_mfma_f32_16x16x32_bf16 v[36:39], v[144:147], v[124:127], v[36:39]
  ds_read_b64_tr_b16 v[118:119], v172 offset:33792
  ds_read_b64_tr_b16 v[120:121], v172 offset:49152
  v_mfma_f32_16x16x32_bf16 v[36:39], v[132:135], v[140:143], v[36:39]
  ds_read_b64_tr_b16 v[122:123], v172 offset:50176
  v_mfma_f32_32x32x16_bf16 v[64:79], v[148:151], v[92:95], v[64:79]
  s_waitcnt lgkmcnt(13)
  v_mfma_f32_16x16x32_bf16 v[8:11], v[88:91], v[80:83], v[8:11]
  ds_read_b64_tr_b16 v[92:93], v173 offset:32768
  ds_read_b64_tr_b16 v[94:95], v173 offset:33792
  s_waitcnt lgkmcnt(13)
  v_mfma_f32_16x16x32_bf16 v[8:11], v[96:99], v[104:107], v[8:11]
  ds_read_b64_tr_b16 v[128:129], v173 offset:49152
  ds_read_b64_tr_b16 v[130:131], v173 offset:50176
  v_mfma_f32_16x16x32_bf16 v[40:43], v[88:91], v[124:127], v[40:43]
  v_mfma_f32_16x16x32_bf16 v[40:43], v[96:99], v[140:143], v[40:43]
  s_waitcnt lgkmcnt(11)
  v_mfma_f32_16x16x32_bf16 v[12:15], v[84:87], v[80:83], v[12:15]
  ds_read_b128 v[88:91], v166 offset:32768
  ds_read_b64_tr_b16 v[96:97], v162 offset:51200
  v_mfma_f32_16x16x32_bf16 v[12:15], v[100:103], v[104:107], v[12:15]
  ds_read_b64_tr_b16 v[98:99], v162 offset:52224
  ds_read_b64_tr_b16 v[132:133], v174 offset:32768
  v_mfma_f32_16x16x32_bf16 v[44:47], v[84:87], v[124:127], v[44:47]
  v_mfma_f32_16x16x32_bf16 v[44:47], v[100:103], v[140:143], v[44:47]
  s_waitcnt lgkmcnt(8)
  v_mfma_f32_32x32x16_bf16 v[64:79], v[112:115], v[108:111], v[64:79]
  ds_read_b64_tr_b16 v[134:135], v174 offset:33792
  ds_read_b64_tr_b16 v[84:85], v174 offset:49152
  ds_read_b64_tr_b16 v[86:87], v174 offset:50176
  v_mfma_f32_16x16x32_bf16 v[16:19], v[116:119], v[80:83], v[16:19]
  ds_read_b64_tr_b16 v[100:101], v175 offset:32768
  ds_read_b64_tr_b16 v[102:103], v175 offset:33792
  v_mfma_f32_16x16x32_bf16 v[16:19], v[120:123], v[104:107], v[16:19]
  ds_read_b64_tr_b16 v[108:109], v175 offset:49152
  ds_read_b64_tr_b16 v[110:111], v175 offset:50176
  v_mfma_f32_16x16x32_bf16 v[48:51], v[116:119], v[124:127], v[48:51]
  v_mfma_f32_16x16x32_bf16 v[48:51], v[120:123], v[140:143], v[48:51]
  s_waitcnt lgkmcnt(11)
  v_mfma_f32_16x16x32_bf16 v[20:23], v[92:95], v[80:83], v[20:23]
  ds_read_b128 v[112:115], v167 offset:32768
  ds_read_b64_tr_b16 v[116:117], v162 offset:59392
  v_mfma_f32_16x16x32_bf16 v[20:23], v[128:131], v[104:107], v[20:23]
  ds_read_b64_tr_b16 v[118:119], v162 offset:60416
  v_add_u32 v168, 65536, v168
  v_mfma_f32_16x16x32_bf16 v[52:55], v[92:95], v[124:127], v[52:55]
  v_add_u32 v169, 65536, v169
  v_add_u32 v170, 65536, v170
  v_mfma_f32_16x16x32_bf16 v[52:55], v[128:131], v[140:143], v[52:55]
  v_add_u32 v171, 65536, v171
  v_add_u32 v172, 65536, v172
  s_waitcnt lgkmcnt(10)
  v_mfma_f32_32x32x16_bf16 v[64:79], v[96:99], v[88:91], v[64:79]
  v_add_u32 v173, 65536, v173
  v_add_u32 v174, 65536, v174
  v_add_u32 v175, 65536, v175
  s_waitcnt vmcnt(8) lgkmcnt(0)
  s_barrier
  v_add_u32 v162, 65536, v162
  ds_read_b128 v[88:91], v160 offset:0
  ds_read_b64_tr_b16 v[92:93], v168 offset:0
  ds_read_b64_tr_b16 v[94:95], v168 offset:1024
  ds_read_b128 v[96:99], v161 offset:0
  ds_read_b64_tr_b16 v[120:121], v168 offset:16384
  s_add_u32 s53, s0, 15
  s_and_b32 s53, s53, 7
  s_lshl_b32 s53, s53, 7
  s_add_u32 m0, s68, 32768
  s_add_u32 s52, s64, s53
  buffer_load_dwordx4 v208, s[16:19], s52 offen offset:0 lds
  buffer_load_dwordx4 v209, s[16:19], s52 offen offset:1024 lds
  buffer_load_dwordx4 v210, s[16:19], s52 offen offset:2048 lds
  buffer_load_dwordx4 v211, s[16:19], s52 offen offset:3072 lds
  s_add_u32 m0, s68, 49152
  s_add_u32 s52, s65, s53
  buffer_load_dwordx4 v208, s[16:19], s52 offen offset:0 lds
  buffer_load_dwordx4 v209, s[16:19], s52 offen offset:1024 lds
  buffer_load_dwordx4 v210, s[16:19], s52 offen offset:2048 lds
  buffer_load_dwordx4 v211, s[16:19], s52 offen offset:3072 lds
  v_mfma_f32_16x16x32_bf16 v[24:27], v[132:135], v[80:83], v[24:27]
  ds_read_b64_tr_b16 v[122:123], v168 offset:17408
  ds_read_b128 v[128:131], v160 offset:2048
  buffer_load_dword v251, v249, s[48:51], 0 offen sc1
  v_mfma_f32_16x16x32_bf16 v[24:27], v[84:87], v[104:107], v[24:27]
  ds_read_b128 v[136:139], v161 offset:2048
  ds_read_b64_tr_b16 v[144:145], v169 offset:0
  v_mfma_f32_16x16x32_bf16 v[56:59], v[132:135], v[124:127], v[56:59]
  ds_read_b64_tr_b16 v[146:147], v169 offset:1024
  ds_read_b64_tr_b16 v[132:133], v169 offset:16384
  v_mfma_f32_16x16x32_bf16 v[56:59], v[84:87], v[140:143], v[56:59]
  ds_read_b64_tr_b16 v[134:135], v169 offset:17408
  ds_read_b128 v[84:87], v164 offset:0
  v_mfma_f32_16x16x32_bf16 v[28:31], v[100:103], v[80:83], v[28:31]
  ds_read_b64_tr_b16 v[80:81], v162 offset:2048
  ds_read_b64_tr_b16 v[82:83], v162 offset:3072
  v_mfma_f32_16x16x32_bf16 v[28:31], v[108:111], v[104:107], v[28:31]
  v_mfma_f32_16x16x32_bf16 v[60:63], v[100:103], v[124:127], v[60:63]
  v_mfma_f32_16x16x32_bf16 v[60:63], v[108:111], v[140:143], v[60:63]
  v_mfma_f32_32x32x16_bf16 v[64:79], v[116:119], v[112:115], v[64:79]
  s_waitcnt lgkmcnt(10)
  v_mfma_f32_16x16x32_bf16 v[0:3], v[92:95], v[88:91], v[0:3]
  ds_read_b64_tr_b16 v[100:101], v170 offset:0
  ds_read_b64_tr_b16 v[102:103], v170 offset:1024
  s_waitcnt lgkmcnt(10)
  v_mfma_f32_16x16x32_bf16 v[0:3], v[120:123], v[96:99], v[0:3]
  ds_read_b64_tr_b16 v[104:105], v170 offset:16384
  ds_read_b64_tr_b16 v[106:107], v170 offset:17408
  v_mfma_f32_16x16x32_bf16 v[32:35], v[92:95], v[128:131], v[32:35]
  ds_read_b64_tr_b16 v[92:93], v171 offset:0
  ds_read_b64_tr_b16 v[94:95], v171 offset:1024
  s_waitcnt lgkmcnt(10)
  v_mfma_f32_16x16x32_bf16 v[32:35], v[120:123], v[136:139], v[32:35]
  ds_read_b64_tr_b16 v[108:109], v171 offset:16384
  ds_read_b64_tr_b16 v[110:111], v171 offset:17408
  v_mfma_f32_16x16x32_bf16 v[4:7], v[144:147], v[88:91], v[4:7]
  ds_read_b128 v[112:115], v165 offset:0
  ds_read_b64_tr_b16 v[116:117], v162 offset:10240
  s_waitcnt lgkmcnt(10)
  v_mfma_f32_16x16x32_bf16 v[4:7], v[132:135], v[96:99], v[4:7]
  ds_read_b64_tr_b16 v[118:119], v162 offset:11264
  ds_read_b64_tr_b16 v[120:121], v172 offset:0
  v_mfma_f32_16x16x32_bf16 v[36:39], v[144:147], v[128:131], v[36:39]
  ds_read_b64_tr_b16 v[122:123], v172 offset:1024
  ds_read_b64_tr_b16 v[124:125], v172 offset:16384
  v_mfma_f32_16x16x32_bf16 v[36:39], v[132:135], v[136:139], v[36:39]
  ds_read_b64_tr_b16 v[126:127], v172 offset:17408
  v_mfma_f32_32x32x16_bf16 v[64:79], v[80:83], v[84:87], v[64:79]
  s_waitcnt lgkmcnt(13)
  v_mfma_f32_16x16x32_bf16 v[8:11], v[100:103], v[88:91], v[8:11]
  ds_read_b64_tr_b16 v[80:81], v173 offset:0
  ds_read_b64_tr_b16 v[82:83], v173 offset:1024
  s_waitcnt lgkmcnt(13)
  v_mfma_f32_16x16x32_bf16 v[8:11], v[104:107], v[96:99], v[8:11]
  ds_read_b64_tr_b16 v[84:85], v173 offset:16384
  ds_read_b64_tr_b16 v[86:87], v173 offset:17408
  v_mfma_f32_16x16x32_bf16 v[40:43], v[100:103], v[128:131], v[40:43]
  v_mfma_f32_16x16x32_bf16 v[40:43], v[104:107], v[136:139], v[40:43]
  s_waitcnt lgkmcnt(11)
  v_mfma_f32_16x16x32_bf16 v[12:15], v[92:95], v[88:91], v[12:15]
  ds_read_b128 v[100:103], v166 offset:0
  ds_read_b64_tr_b16 v[104:105], v162 offset:18432
  v_mfma_f32_16x16x32_bf16 v[12:15], v[108:111], v[96:99], v[12:15]
  ds_read_b64_tr_b16 v[106:107], v162 offset:19456
  ds_read_b64_tr_b16 v[132:133], v174 offset:0
  v_mfma_f32_16x16x32_bf16 v[44:47], v[92:95], v[128:131], v[44:47]
  v_mfma_f32_16x16x32_bf16 v[44:47], v[108:111], v[136:139], v[44:47]
  s_waitcnt lgkmcnt(8)
  v_mfma_f32_32x32x16_bf16 v[64:79], v[116:119], v[112:115], v[64:79]
  ds_read_b64_tr_b16 v[134:135], v174 offset:1024
  ds_read_b64_tr_b16 v[92:93], v174 offset:16384
  ds_read_b64_tr_b16 v[94:95], v174 offset:17408
  v_mfma_f32_16x16x32_bf16 v[16:19], v[120:123], v[88:91], v[16:19]
  ds_read_b64_tr_b16 v[108:109], v175 offset:0
  ds_read_b64_tr_b16 v[110:111], v175 offset:1024
  v_mfma_f32_16x16x32_bf16 v[16:19], v[124:127], v[96:99], v[16:19]
  ds_read_b64_tr_b16 v[112:113], v175 offset:16384
  ds_read_b64_tr_b16 v[114:115], v175 offset:17408
  v_mfma_f32_16x16x32_bf16 v[48:51], v[120:123], v[128:131], v[48:51]
  v_mfma_f32_16x16x32_bf16 v[48:51], v[124:127], v[136:139], v[48:51]
  s_waitcnt lgkmcnt(11)
  v_mfma_f32_16x16x32_bf16 v[20:23], v[80:83], v[88:91], v[20:23]
  ds_read_b128 v[116:119], v167 offset:0
  ds_read_b64_tr_b16 v[120:121], v162 offset:26624
  v_mfma_f32_16x16x32_bf16 v[20:23], v[84:87], v[96:99], v[20:23]
  ds_read_b64_tr_b16 v[122:123], v162 offset:27648
  v_add_u32 v168, -65536, v168
  v_mfma_f32_16x16x32_bf16 v[52:55], v[80:83], v[128:131], v[52:55]
  v_add_u32 v169, -65536, v169
  v_add_u32 v170, -65536, v170
  v_mfma_f32_16x16x32_bf16 v[52:55], v[84:87], v[136:139], v[52:55]
  v_add_u32 v171, -65536, v171
  v_add_u32 v172, -65536, v172
  s_waitcnt lgkmcnt(10)
  v_mfma_f32_32x32x16_bf16 v[64:79], v[104:107], v[100:103], v[64:79]
  v_add_u32 v173, -65536, v173
  v_add_u32 v174, -65536, v174
  v_add_u32 v175, -65536, v175
  s_waitcnt vmcnt(0)
  v_cmp_ne_u32 vcc, 32, v251
  s_nop 1
  s_cbranch_vccz L_cntok_1
L_pollc0_2:
  buffer_load_dword v251, v249, s[48:51], 0 offen sc1
  s_waitcnt vmcnt(0)
  v_cmp_ne_u32 vcc, 32, v251
  s_nop 1
  s_cbranch_vccz L_pdonec0_3
  s_sleep 4
  s_sub_u32 s99, s99, 1
  s_cbranch_scc0 L_pollc0_2
  s_mov_b32 s99, 0
L_pdonec0_3:
L_cntok_1:
  s_waitcnt lgkmcnt(0)
  s_barrier
  v_add_u32 v162, -65536, v162
  ds_read_b128 v[80:83], v160 offset:32768
  ds_read_b64_tr_b16 v[84:85], v168 offset:0
  ds_read_b64_tr_b16 v[86:87], v168 offset:1024
  ds_read_b128 v[100:103], v161 offset:32768
  ds_read_b64_tr_b16 v[104:105], v168 offset:16384
  s_cmp_lg_u32 s92, 0
  s_cbranch_scc1 L_nolo
  v_mov_b32 v250, 1
  v_lshlrev_b32 v252, 2, v254
  s_lshl_b32 s52, s96, 7
  s_add_u32 s52, s52, 60850176
  s_mov_b64 exec, 255
  buffer_store_dword v250, v252, s[28:31], s52 offen offset:0 sc1
  s_mov_b64 exec, -1
L_nolo:
  v_mfma_f32_16x16x32_bf16 v[24:27], v[132:135], v[88:91], v[24:27]
  ds_read_b64_tr_b16 v[106:107], v168 offset:17408
  ds_read_b128 v[124:127], v160 offset:34816
  v_mfma_f32_16x16x32_bf16 v[24:27], v[92:95], v[96:99], v[24:27]
  ds_read_b128 v[140:143], v161 offset:34816
  ds_read_b64_tr_b16 v[144:145], v169 offset:0
  v_mfma_f32_16x16x32_bf16 v[56:59], v[132:135], v[128:131], v[56:59]
  ds_read_b64_tr_b16 v[146:147], v169 offset:1024
  ds_read_b64_tr_b16 v[132:133], v169 offset:16384
  v_mfma_f32_16x16x32_bf16 v[56:59], v[92:95], v[136:139], v[56:59]
  ds_read_b64_tr_b16 v[134:135], v169 offset:17408
  ds_read_b128 v[92:95], v164 offset:32768
  v_mfma_f32_16x16x32_bf16 v[28:31], v[108:111], v[88:91], v[28:31]
  ds_read_b64_tr_b16 v[88:89], v162 offset:2048
  ds_read_b64_tr_b16 v[90:91], v162 offset:3072
  v_mfma_f32_16x16x32_bf16 v[28:31], v[112:115], v[96:99], v[28:31]
  v_mfma_f32_16x16x32_bf16 v[60:63], v[108:111], v[128:131], v[60:63]
  v_mfma_f32_16x16x32_bf16 v[60:63], v[112:115], v[136:139], v[60:63]
  v_mfma_f32_32x32x16_bf16 v[64:79], v[120:123], v[116:119], v[64:79]
  s_waitcnt lgkmcnt(10)
  v_mfma_f32_16x16x32_bf16 v[0:3], v[84:87], v[80:83], v[0:3]
  ds_read_b64_tr_b16 v[96:97], v170 offset:0
  ds_read_b64_tr_b16 v[98:99], v170 offset:1024
  s_waitcnt lgkmcnt(10)
  v_mfma_f32_16x16x32_bf16 v[0:3], v[104:107], v[100:103], v[0:3]
  ds_read_b64_tr_b16 v[108:109], v170 offset:16384
  ds_read_b64_tr_b16 v[110:111], v170 offset:17408
  v_mfma_f32_16x16x32_bf16 v[32:35], v[84:87], v[124:127], v[32:35]
  ds_read_b64_tr_b16 v[84:85], v171 offset:0
  ds_read_b64_tr_b16 v[86:87], v171 offset:1024
  s_waitcnt lgkmcnt(10)
  v_mfma_f32_16x16x32_bf16 v[32:35], v[104:107], v[140:143], v[32:35]
  ds_read_b64_tr_b16 v[104:105], v171 offset:16384
  ds_read_b64_tr_b16 v[106:107], v171 offset:17408
  v_mfma_f32_16x16x32_bf16 v[4:7], v[144:147], v[80:83], v[4:7]
  ds_read_b128 v[112:115], v165 offset:32768
  ds_read_b64_tr_b16 v[116:117], v162 offset:10240
  s_waitcnt lgkmcnt(10)
  v_mfma_f32_16x16x32_bf16 v[4:7], v[132:135], v[100:103], v[4:7]
  ds_read_b64_tr_b16 v[118:119], v162 offset:11264
  ds_read_b64_tr_b16 v[120:121], v172 offset:0
  v_mfma_f32_16x16x32_bf16 v[36:39], v[144:147], v[124:127], v[36:39]
  ds_read_b64_tr_b16 v[122:123], v172 offset:1024
  ds_read_b64_tr_b16 v[128:129], v172 offset:16384
  v_mfma_f32_16x16x32_bf16 v[36:39], v[132:135], v[140:143], v[36:39]
  ds_read_b64_tr_b16 v[130:131], v172 offset:17408
  v_mfma_f32_32x32x16_bf16 v[64:79], v[88:91], v[92:95], v[64:79]
  s_waitcnt lgkmcnt(13)
  v_mfma_f32_16x16x32_bf16 v[8:11], v[96:99], v[80:83], v[8:11]
  ds_read_b64_tr_b16 v[88:89], v173 offset:0
  ds_read_b64_tr_b16 v[90:91], v173 offset:1024
  s_waitcnt lgkmcnt(13)
  v_mfma_f32_16x16x32_bf16 v[8:11], v[108:111], v[100:103], v[8:11]
  ds_read_b64_tr_b16 v[92:93], v173 offset:16384
  ds_read_b64_tr_b16 v[94:95], v173 offset:17408
  v_mfma_f32_16x16x32_bf16 v[40:43], v[96:99], v[124:127], v[40:43]
  v_mfma_f32_16x16x32_bf16 v[40:43], v[108:111], v[140:143], v[40:43]
  s_waitcnt lgkmcnt(11)
  v_mfma_f32_16x16x32_bf16 v[12:15], v[84:87], v[80:83], v[12:15]
  ds_read_b128 v[96:99], v166 offset:32768
  ds_read_b64_tr_b16 v[108:109], v162 offset:18432
  v_mfma_f32_16x16x32_bf16 v[12:15], v[104:107], v[100:103], v[12:15]
  ds_read_b64_tr_b16 v[110:111], v162 offset:19456
  ds_read_b64_tr_b16 v[132:133], v174 offset:0
  v_mfma_f32_16x16x32_bf16 v[44:47], v[84:87], v[124:127], v[44:47]
  v_mfma_f32_16x16x32_bf16 v[44:47], v[104:107], v[140:143], v[44:47]
  s_waitcnt lgkmcnt(8)
  v_mfma_f32_32x32x16_bf16 v[64:79], v[116:119], v[112:115], v[64:79]
  ds_read_b64_tr_b16 v[134:135], v174 offset:1024
  ds_read_b64_tr_b16 v[84:85], v174 offset:16384
  ds_read_b64_tr_b16 v[86:87], v174 offset:17408
  v_mfma_f32_16x16x32_bf16 v[16:19], v[120:123], v[80:83], v[16:19]
  ds_read_b64_tr_b16 v[104:105], v175 offset:0
  ds_read_b64_tr_b16 v[106:107], v175 offset:1024
  v_mfma_f32_16x16x32_bf16 v[16:19], v[128:131], v[100:103], v[16:19]
  ds_read_b64_tr_b16 v[112:113], v175 offset:16384
  ds_read_b64_tr_b16 v[114:115], v175 offset:17408
  v_mfma_f32_16x16x32_bf16 v[48:51], v[120:123], v[124:127], v[48:51]
  v_mfma_f32_16x16x32_bf16 v[48:51], v[128:131], v[140:143], v[48:51]
  s_waitcnt lgkmcnt(11)
  v_mfma_f32_16x16x32_bf16 v[20:23], v[88:91], v[80:83], v[20:23]
  ds_read_b128 v[116:119], v167 offset:32768
  ds_read_b64_tr_b16 v[120:121], v162 offset:26624
  v_mfma_f32_16x16x32_bf16 v[20:23], v[92:95], v[100:103], v[20:23]
  ds_read_b64_tr_b16 v[122:123], v162 offset:27648
  v_mfma_f32_16x16x32_bf16 v[52:55], v[88:91], v[124:127], v[52:55]
  v_mfma_f32_16x16x32_bf16 v[52:55], v[92:95], v[140:143], v[52:55]
  s_waitcnt lgkmcnt(10)
  v_mfma_f32_32x32x16_bf16 v[64:79], v[108:111], v[96:99], v[64:79]
  s_waitcnt lgkmcnt(0)
  s_barrier
  s_bfe_u32 s57, s92, 0x10001
  s_and_b32 s58, s92, 1
  s_lshl_b32 s58, s58, 12
  s_lshl_b32 s57, s57, 14
  s_sub_u32 s56, s58, s57
  s_add_u32 s52, s56, 57344
  s_add_u32 s53, s56, 49152
  s_add_u32 s54, s56, 24576
  s_add_u32 s55, s56, 16384
  s_lshl_b32 s56, s94, 11
  s_add_u32 s56, s56, 65536
  v_add_u32 v160, s52, v253
  v_add_u32 v161, s53, v253
  v_add_u32 v162, s54, v253
  v_add_u32 v163, s55, v253
  v_add_u32 v164, s56, v253
  v_mfma_f32_16x16x32_bf16 v[24:27], v[132:135], v[80:83], v[24:27]
  ds_write_b128 v160, v[176:179] offset:0
  ds_write_b128 v160, v[180:183] offset:1024
  v_mfma_f32_16x16x32_bf16 v[24:27], v[84:87], v[100:103], v[24:27]
  ds_write_b128 v160, v[184:187] offset:2048
  ds_write_b128 v160, v[188:191] offset:3072
  v_mfma_f32_16x16x32_bf16 v[56:59], v[132:135], v[124:127], v[56:59]
  ds_write_b128 v161, v[192:195] offset:0
  ds_write_b128 v161, v[196:199] offset:1024
  v_mfma_f32_16x16x32_bf16 v[56:59], v[84:87], v[140:143], v[56:59]
  ds_write_b128 v161, v[200:203] offset:2048
  ds_write_b128 v161, v[204:207] offset:3072
  v_mfma_f32_16x16x32_bf16 v[28:31], v[104:107], v[80:83], v[28:31]
  ds_write_b128 v162, v[216:219] offset:0
  v_mfma_f32_16x16x32_bf16 v[28:31], v[112:115], v[100:103], v[28:31]
  ds_write_b128 v162, v[220:223] offset:1024
  ds_write_b128 v162, v[224:227] offset:2048
  v_mfma_f32_16x16x32_bf16 v[60:63], v[104:107], v[124:127], v[60:63]
  ds_write_b128 v162, v[228:231] offset:3072
  ds_write_b128 v163, v[232:235] offset:0
  v_mfma_f32_16x16x32_bf16 v[60:63], v[112:115], v[140:143], v[60:63]
  ds_write_b128 v163, v[236:239] offset:1024
  ds_write_b128 v163, v[240:243] offset:2048
  v_mfma_f32_32x32x16_bf16 v[64:79], v[120:123], v[116:119], v[64:79]
  ds_write_b128 v163, v[244:247] offset:3072
  v_bfe_u32 v165, v254, 3, 1
  v_lshlrev_b32 v165, 10, v165
  v_and_b32 v166, 7, v254
  v_lshl_add_u32 v165, v166, 2, v165
  s_lshl_b32 s52, s93, 2
  s_add_u32 s52, s52, s80
  s_lshl_b32 s52, s52, 12
  s_lshl_b32 s53, s91, 7
  s_add_u32 s52, s52, s53
  s_add_u32 s52, s52, 60817504
  buffer_load_dword v168, v165, s[28:31], s52 offen sc1
  buffer_load_dword v171, v165, s[28:31], s52 offen offset:2048 sc1
  v_bfe_u32 v165, v254, 3, 2
  v_lshlrev_b32 v165, 10, v165
  v_and_b32 v166, 7, v254
  v_lshl_add_u32 v165, v166, 2, v165
  s_and_b32 s52, s90, 1
  s_lshl_b32 s52, s52, 2
  s_add_u32 s52, s52, s94
  s_lshl_b32 s52, s52, 12
  s_lshl_b32 s53, s91, 7
  s_add_u32 s52, s52, s53
  s_add_u32 s52, s52, 60817504
  buffer_load_dword v249, v165, s[28:31], s52 offen sc1
  buffer_load_dword v250, v248, s[28:31], 0 offen sc1
  s_mov_b32 s52, 0x3e0293ee
  s_mov_b32 s53, 0x3e0293ee
  v_pk_mul_f32 v[0:1], v[0:1], s[52:53]
  v_pk_mul_f32 v[2:3], v[2:3], s[52:53]
  v_pk_mul_f32 v[4:5], v[4:5], s[52:53]
  v_pk_mul_f32 v[6:7], v[6:7], s[52:53]
  v_pk_mul_f32 v[8:9], v[8:9], s[52:53]
  v_pk_mul_f32 v[10:11], v[10:11], s[52:53]
  v_pk_mul_f32 v[12:13], v[12:13], s[52:53]
  v_pk_mul_f32 v[14:15], v[14:15], s[52:53]
  v_pk_mul_f32 v[16:17], v[16:17], s[52:53]
  v_pk_mul_f32 v[18:19], v[18:19], s[52:53]
  v_pk_mul_f32 v[20:21], v[20:21], s[52:53]
  v_pk_mul_f32 v[22:23], v[22:23], s[52:53]
  v_pk_mul_f32 v[24:25], v[24:25], s[52:53]
  v_pk_mul_f32 v[26:27], v[26:27], s[52:53]
  v_pk_mul_f32 v[28:29], v[28:29], s[52:53]
  v_pk_mul_f32 v[30:31], v[30:31], s[52:53]
  v_pk_mul_f32 v[32:33], v[32:33], s[52:53]
  v_pk_mul_f32 v[34:35], v[34:35], s[52:53]
  v_pk_mul_f32 v[36:37], v[36:37], s[52:53]
  v_pk_mul_f32 v[38:39], v[38:39], s[52:53]
  v_pk_mul_f32 v[40:41], v[40:41], s[52:53]
  v_pk_mul_f32 v[42:43], v[42:43], s[52:53]
  v_pk_mul_f32 v[44:45], v[44:45], s[52:53]
  v_pk_mul_f32 v[46:47], v[46:47], s[52:53]
  v_pk_mul_f32 v[48:49], v[48:49], s[52:53]
  v_pk_mul_f32 v[50:51], v[50:51], s[52:53]
  v_pk_mul_f32 v[52:53], v[52:53], s[52:53]
  v_pk_mul_f32 v[54:55], v[54:55], s[52:53]
  v_pk_mul_f32 v[56:57], v[56:57], s[52:53]
  v_pk_mul_f32 v[58:59], v[58:59], s[52:53]
  v_pk_mul_f32 v[60:61], v[60:61], s[52:53]
  v_pk_mul_f32 v[62:63], v[62:63], s[52:53]
  v_cvt_pk_bf16_f32 v176, v0, v1
  v_cvt_pk_bf16_f32 v177, v2, v3
  v_cvt_pk_bf16_f32 v178, v4, v5
  v_cvt_pk_bf16_f32 v179, v6, v7
  v_cvt_pk_bf16_f32 v180, v8, v9
  v_cvt_pk_bf16_f32 v181, v10, v11
  v_cvt_pk_bf16_f32 v182, v12, v13
  v_cvt_pk_bf16_f32 v183, v14, v15
  v_cvt_pk_bf16_f32 v184, v16, v17
  v_cvt_pk_bf16_f32 v185, v18, v19
  v_cvt_pk_bf16_f32 v186, v20, v21
  v_cvt_pk_bf16_f32 v187, v22, v23
  v_cvt_pk_bf16_f32 v188, v24, v25
  v_cvt_pk_bf16_f32 v189, v26, v27
  v_cvt_pk_bf16_f32 v190, v28, v29
  v_cvt_pk_bf16_f32 v191, v30, v31
  v_cvt_pk_bf16_f32 v192, v32, v33
  v_cvt_pk_bf16_f32 v193, v34, v35
  v_cvt_pk_bf16_f32 v194, v36, v37
  v_cvt_pk_bf16_f32 v195, v38, v39
  v_cvt_pk_bf16_f32 v196, v40, v41
  v_cvt_pk_bf16_f32 v197, v42, v43
  v_cvt_pk_bf16_f32 v198, v44, v45
  v_cvt_pk_bf16_f32 v199, v46, v47
  v_cvt_pk_bf16_f32 v200, v48, v49
  v_cvt_pk_bf16_f32 v201, v50, v51
  v_cvt_pk_bf16_f32 v202, v52, v53
  v_cvt_pk_bf16_f32 v203, v54, v55
  v_cvt_pk_bf16_f32 v204, v56, v57
  v_cvt_pk_bf16_f32 v205, v58, v59
  v_cvt_pk_bf16_f32 v206, v60, v61
  v_cvt_pk_bf16_f32 v207, v62, v63
  v_cvt_pk_bf16_f32 v136, v64, v65
  v_cvt_pk_bf16_f32 v137, v66, v67
  v_cvt_pk_bf16_f32 v138, v68, v69
  v_cvt_pk_bf16_f32 v139, v70, v71
  v_cvt_pk_bf16_f32 v140, v72, v73
  v_cvt_pk_bf16_f32 v141, v74, v75
  v_cvt_pk_bf16_f32 v142, v76, v77
  v_cvt_pk_bf16_f32 v143, v78, v79
  ds_write_b128 v164, v[136:139] offset:0
  ds_write_b128 v164, v[140:143] offset:1024
  s_branch L_apro
L_g1:
  s_mov_b32 s53, 1
  s_lshl_b32 s53, s53, 7
  s_add_u32 m0, s68, 32768
  s_add_u32 s52, s64, s53
  buffer_load_dwordx4 v208, s[4:7], s52 offen offset:0 lds
  buffer_load_dwordx4 v209, s[4:7], s52 offen offset:1024 lds
  buffer_load_dwordx4 v210, s[4:7], s52 offen offset:2048 lds
  buffer_load_dwordx4 v211, s[4:7], s52 offen offset:3072 lds
  s_add_u32 m0, s68, 49152
  s_add_u32 s52, s65, s53
  buffer_load_dwordx4 v208, s[4:7], s52 offen offset:0 lds
  buffer_load_dwordx4 v209, s[4:7], s52 offen offset:1024 lds
  buffer_load_dwordx4 v210, s[4:7], s52 offen offset:2048 lds
  buffer_load_dwordx4 v211, s[4:7], s52 offen offset:3072 lds
  s_mov_b32 s56, 1
  s_lshl_b32 s56, s56, 19
  s_add_u32 s56, s56, s66
  s_add_u32 m0, s68, 98304
  s_add_u32 s58, s56, 0
  buffer_load_dwordx4 v212, s[8:11], s58 offen offset:0 lds
  buffer_load_dwordx4 v213, s[8:11], s58 offen offset:1024 lds
  s_add_u32 m0, m0, 2048
  s_nop 0
  buffer_load_dwordx4 v212, s[12:15], s58 offen offset:0 lds
  buffer_load_dwordx4 v213, s[12:15], s58 offen offset:1024 lds
  s_add_u32 m0, s68, 114688
  s_add_u32 s58, s56, 262144
  buffer_load_dwordx4 v212, s[8:11], s58 offen offset:0 lds
  buffer_load_dwordx4 v213, s[8:11], s58 offen offset:1024 lds
  s_add_u32 m0, m0, 2048
  s_nop 0
  buffer_load_dwordx4 v212, s[12:15], s58 offen offset:0 lds
  buffer_load_dwordx4 v213, s[12:15], s58 offen offset:1024 lds
  v_and_b32 v184, 31, v254
  v_lshlrev_b32 v184, 2, v184
  v_lshl_add_u32 v184, v186, 15, v184
  v_mov_b32 v189, 0
  s_lshl_b32 s52, s96, 7
  s_add_u32 s52, s52, 60817408
  s_cmp_lg_u32 s92, 7
  s_cbranch_scc1 L_noclr
  buffer_store_dword v189, v184, s[28:31], s52 offen sc1
  s_add_u32 s52, s52, 65536
  buffer_store_dword v189, v184, s[28:31], s52 offen sc1
  v_mov_b32 v192, 0
  v_mov_b32 v193, 0
  v_mov_b32 v194, 0
  v_mov_b32 v195, 0
  s_lshl_b32 s52, s96, 10
  s_add_u32 s52, s52, 61079552
  buffer_store_dwordx4 v[192:195], v253, s[28:31], s52 offen sc1
  s_nop 1
L_noclr:
  s_sub_u32 s55, 15, s91
  s_and_b32 s56, s90, 1
  s_lshr_b32 s57, s92, 1
  s_and_b32 s57, s57, 1
  s_lshl_b32 s58, s57, 13
  s_lshl_b32 s59, s93, 2
  s_add_u32 s59, s59, s80
  s_lshl_b32 s59, s59, 12
  s_sub_u32 s86, s59, s58
  s_lshl_b32 s60, s56, 2
  s_add_u32 s60, s60, s94
  s_lshl_b32 s60, s60, 12
  v_bfe_u32 v188, v254, 1, 3
  v_and_b32 v184, 15, v254
  v_lshlrev_b32 v184, 7, v184
  v_xor_b32 v189, v188, v185
  v_lshl_add_u32 v184, v189, 4, v184
  v_add_u32 v160, s58, v184
  v_xor_b32 v161, 64, v160
  v_and_b32 v184, 31, v254
  v_lshlrev_b32 v184, 7, v184
  v_xor_b32 v189, v188, v186
  v_lshl_add_u32 v184, v189, 4, v184
  v_add_u32 v164, s60, v184
  v_xor_b32 v165, 32, v164
  v_xor_b32 v166, 64, v164
  v_xor_b32 v167, 96, v164
  v_mul_u32_u24 v184, 320, v187
  v_and_b32 v189, 1, v185
  v_lshl_add_u32 v184, v189, 5, v184
  v_and_b32 v189, 3, v254
  v_lshl_add_u32 v184, v189, 3, v184
  v_add_u32 v184, 0x10000, v184
  v_lshl_add_u32 v189, v186, 12, v184
  s_lshl_b32 s59, s93, 6
  v_xor_b32 v162, s59, v189
  v_xor_b32 v163, 128, v189
  s_and_b32 s58, s92, 1
  s_lshl_b32 s59, s58, 7
  v_lshl_add_u32 v189, v185, 12, v184
  v_xor_b32 v168, s59, v189
  v_xor_b32 v169, 32, v168
  v_xor_b32 v170, 64, v168
  v_xor_b32 v171, 96, v168
  v_xor_b32 v172, 128, v168
  v_xor_b32 v173, 160, v168
  v_xor_b32 v174, 192, v168
  v_xor_b32 v175, 224, v168
  s_lshl_b32 s61, s90, 19
  s_lshl_b32 s59, s57, 14
  s_add_u32 s61, s61, s59
  s_lshl_b32 s59, s58, 12
  s_add_u32 s61, s61, s59
  s_lshl_b32 s59, s93, 24
  s_add_u32 s61, s61, s59
  s_lshl_b32 s59, s91, 15
  s_add_u32 s69, s61, s59
  s_lshl_b32 s59, s55, 15
  s_add_u32 s70, s61, s59
  s_lshr_b32 s71, s90, 3
  s_and_b32 s72, s90, 3
  v_and_b32 v184, 7, v254
  v_lshlrev_b32 v249, 5, v184
  v_lshrrev_b32 v189, 3, v254
  v_lshlrev_b32 v189, 7, v189
  v_lshl_add_u32 v189, v184, 2, v189
  s_lshl_b32 s52, s90, 10
  s_add_u32 s52, s52, 60850176
  v_add_u32 v248, s52, v189
  s_lshl_b32 s52, s94, 13
  s_lshl_b32 s53, s90, 19
  s_sub_u32 s73, 24576, s52
  s_add_u32 s73, s73, s53
  s_sub_u32 s74, 32768, s52
  s_and_b32 s74, s74, 0x7fff
  s_add_u32 s74, s74, s53
  s_add_u32 s74, s74, 16777216
  s_add_u32 s75, s52, 0
  s_add_u32 s76, s52, 98304
  s_cmp_eq_u32 s93, 0
  s_cselect_b32 s79, s91, s55
  s_add_u32 s53, s91, 1
  s_cselect_b32 s78, s53, s55
  s_cmp_eq_u32 s93, 0
  s_cselect_b32 s78, s53, s55
  s_cmp_eq_u32 s78, 1
  s_cselect_b32 s78, 0, s78
  s_mov_b32 s77, 0
  s_mov_b32 s81, 0
  s_mov_b32 s85, 0
  s_mov_b32 s84, 1
  s_mov_b32 s82, 0
  s_mov_b32 s83, 0x47800000
  s_barrier
  s_add_u32 s56, s1, 2
  s_sub_u32 s52, s56, 6
  s_cmp_ge_u32 s56, 8
  s_cselect_b32 s56, s52, s56
  s_lshl_b32 s56, s56, 19
  s_add_u32 s56, s56, s66
  s_add_u32 m0, s68, 131072
  s_add_u32 s58, s56, 0
  buffer_load_dwordx4 v212, s[8:11], s58 offen offset:0 lds
  buffer_load_dwordx4 v213, s[8:11], s58 offen offset:1024 lds
  s_add_u32 m0, m0, 2048
  s_nop 0
  buffer_load_dwordx4 v212, s[12:15], s58 offen offset:0 lds
  buffer_load_dwordx4 v213, s[12:15], s58 offen offset:1024 lds
  s_add_u32 m0, s68, 147456
  s_add_u32 s58, s56, 262144
  buffer_load_dwordx4 v212, s[8:11], s58 offen offset:0 lds
  buffer_load_dwordx4 v213, s[8:11], s58 offen offset:1024 lds
  s_add_u32 m0, m0, 2048
  s_nop 0
  buffer_load_dwordx4 v212, s[12:15], s58 offen offset:0 lds
  buffer_load_dwordx4 v213, s[12:15], s58 offen offset:1024 lds
  ds_read_b64_tr_b16 v[216:217], v168 offset:2048
  ds_read_b64_tr_b16 v[218:219], v168 offset:3072
  ds_read_b128 v[220:223], v160 offset:0
  ds_read_b64_tr_b16 v[176:177], v168 offset:18432
  ds_read_b64_tr_b16 v[178:179], v168 offset:19456
  ds_read_b128 v[180:183], v161 offset:0
  ds_read_b64_tr_b16 v[184:185], v169 offset:2048
  ds_read_b64_tr_b16 v[186:187], v169 offset:3072
  s_waitcnt lgkmcnt(5)
  v_mfma_f32_16x16x32_bf16 v[0:3], v[220:223], v[216:219], 0
  ds_read_b64_tr_b16 v[188:189], v169 offset:18432
  ds_read_b64_tr_b16 v[190:191], v169 offset:19456
  s_waitcnt lgkmcnt(4)
  v_mfma_f32_16x16x32_bf16 v[0:3], v[180:183], v[176:179], v[0:3]
  ds_read_b64_tr_b16 v[192:193], v170 offset:2048
  ds_read_b64_tr_b16 v[194:195], v170 offset:3072
  s_waitcnt lgkmcnt(4)
  v_mfma_f32_16x16x32_bf16 v[8:11], v[220:223], v[184:187], 0
  ds_read_b64_tr_b16 v[196:197], v170 offset:18432
  ds_read_b64_tr_b16 v[198:199], v170 offset:19456
  s_waitcnt lgkmcnt(4)
  v_mfma_f32_16x16x32_bf16 v[8:11], v[180:183], v[188:191], v[8:11]
  ds_read_b64_tr_b16 v[200:201], v171 offset:2048
  ds_read_b64_tr_b16 v[202:203], v171 offset:3072
  s_waitcnt lgkmcnt(4)
  v_mfma_f32_16x16x32_bf16 v[16:19], v[220:223], v[192:195], 0
  ds_read_b64_tr_b16 v[204:205], v171 offset:18432
  ds_read_b64_tr_b16 v[206:207], v171 offset:19456
  s_waitcnt lgkmcnt(4)
  v_mfma_f32_16x16x32_bf16 v[16:19], v[180:183], v[196:199], v[16:19]
  ds_read_b128 v[128:131], v160 offset:2048
  ds_read_b128 v[132:135], v161 offset:2048
  s_waitcnt lgkmcnt(4)
  v_mfma_f32_16x16x32_bf16 v[24:27], v[220:223], v[200:203], 0
  ds_read_b128 v[220:223], v160 offset:4096
  ds_read_b128 v[136:139], v161 offset:4096
  s_waitcnt lgkmcnt(4)
  v_mfma_f32_16x16x32_bf16 v[24:27], v[180:183], v[204:207], v[24:27]
  s_waitcnt lgkmcnt(3)
  v_mfma_f32_16x16x32_bf16 v[4:7], v[128:131], v[216:219], 0
  ds_read_b128 v[180:183], v160 offset:6144
  s_waitcnt lgkmcnt(3)
  v_mfma_f32_16x16x32_bf16 v[4:7], v[132:135], v[176:179], v[4:7]
  ds_read_b128 v[140:143], v161 offset:6144
  v_mfma_f32_16x16x32_bf16 v[12:15], v[128:131], v[184:187], 0
  v_mfma_f32_16x16x32_bf16 v[12:15], v[132:135], v[188:191], v[12:15]
  v_mfma_f32_16x16x32_bf16 v[20:23], v[128:131], v[192:195], 0
  v_mfma_f32_16x16x32_bf16 v[20:23], v[132:135], v[196:199], v[20:23]
  v_mfma_f32_16x16x32_bf16 v[28:31], v[128:131], v[200:203], 0
  v_mfma_f32_16x16x32_bf16 v[28:31], v[132:135], v[204:207], v[28:31]
  s_cmp_lg_u32 s94, 0
  s_cbranch_scc1 L_notch_4
  v_lshlrev_b32 v250, 10, v254
  s_and_b32 s52, s96, 31
  s_lshl_b32 s52, s52, 16
  buffer_load_dword v252, v250, s[4:7], s52 offen offset:256
L_notch_4:
  s_cmp_lg_u32 s94, 1
  s_cbranch_scc1 L_notch_5
  v_bfe_u32 v250, v254, 3, 2
  v_lshlrev_b32 v250, 13, v250
  v_and_b32 v251, 7, v254
  v_lshl_add_u32 v250, v251, 7, v250
  s_and_b32 s54, s96, 15
  s_lshl_b32 s52, s54, 15
  s_lshr_b32 s53, s90, 2
  s_lshl_b32 s53, s53, 10
  s_add_u32 s52, s52, s53
  s_add_u32 s52, s52, 1572864
  s_mov_b32 exec_hi, 0
  s_bitcmp1_b32 s96, 4
  s_cbranch_scc1 L_t2a_6
  buffer_load_dword v252, v250, s[8:11], s52 offen
  s_branch L_t2e_7
L_t2a_6:
  buffer_load_dword v252, v250, s[12:15], s52 offen
L_t2e_7:
  s_mov_b64 exec, -1
L_notch_5:
  s_cmp_lg_u32 s94, 2
  s_cbranch_scc1 L_notch_8
  v_lshlrev_b32 v250, 10, v254
  s_and_b32 s52, s96, 31
  s_lshl_b32 s52, s52, 16
  buffer_load_dword v252, v250, s[4:7], s52 offen offset:384
L_notch_8:
  s_waitcnt lgkmcnt(2)
  v_mfma_f32_16x16x32_bf16 v[32:35], v[220:223], v[216:219], 0
  ds_read_b128 v[128:131], v160 offset:16384
  v_mfma_f32_16x16x32_bf16 v[32:35], v[136:139], v[176:179], v[32:35]
  ds_read_b128 v[132:135], v161 offset:16384
  v_mfma_f32_16x16x32_bf16 v[40:43], v[220:223], v[184:187], 0
  v_mfma_f32_16x16x32_bf16 v[40:43], v[136:139], v[188:191], v[40:43]
  v_mfma_f32_16x16x32_bf16 v[48:51], v[220:223], v[192:195], 0
  v_mfma_f32_16x16x32_bf16 v[48:51], v[136:139], v[196:199], v[48:51]
  v_mfma_f32_16x16x32_bf16 v[56:59], v[220:223], v[200:203], 0
  v_mfma_f32_16x16x32_bf16 v[56:59], v[136:139], v[204:207], v[56:59]
  s_waitcnt lgkmcnt(2)
  v_mfma_f32_16x16x32_bf16 v[36:39], v[180:183], v[216:219], 0
  ds_read_b128 v[220:223], v160 offset:18432
  v_mfma_f32_16x16x32_bf16 v[36:39], v[140:143], v[176:179], v[36:39]
  ds_read_b128 v[136:139], v161 offset:18432
  v_mfma_f32_16x16x32_bf16 v[44:47], v[180:183], v[184:187], 0
  v_mfma_f32_16x16x32_bf16 v[44:47], v[140:143], v[188:191], v[44:47]
  v_mfma_f32_16x16x32_bf16 v[52:55], v[180:183], v[192:195], 0
  v_mfma_f32_16x16x32_bf16 v[52:55], v[140:143], v[196:199], v[52:55]
  v_mfma_f32_16x16x32_bf16 v[60:63], v[180:183], v[200:203], 0
  v_mfma_f32_16x16x32_bf16 v[60:63], v[140:143], v[204:207], v[60:63]
  s_waitcnt lgkmcnt(2)
  v_mfma_f32_16x16x32_bf16 v[64:67], v[128:131], v[216:219], 0
  ds_read_b128 v[180:183], v160 offset:20480
  v_mfma_f32_16x16x32_bf16 v[64:67], v[132:135], v[176:179], v[64:67]
  ds_read_b128 v[140:143], v161 offset:20480
  v_mfma_f32_16x16x32_bf16 v[72:75], v[128:131], v[184:187], 0
  v_mfma_f32_16x16x32_bf16 v[72:75], v[132:135], v[188:191], v[72:75]
  v_mfma_f32_16x16x32_bf16 v[80:83], v[128:131], v[192:195], 0
  v_mfma_f32_16x16x32_bf16 v[80:83], v[132:135], v[196:199], v[80:83]
  v_mfma_f32_16x16x32_bf16 v[88:91], v[128:131], v[200:203], 0
  v_mfma_f32_16x16x32_bf16 v[88:91], v[132:135], v[204:207], v[88:91]
  s_waitcnt lgkmcnt(2)
  v_mfma_f32_16x16x32_bf16 v[68:71], v[220:223], v[216:219], 0
  ds_read_b128 v[128:131], v160 offset:22528
  v_mfma_f32_16x16x32_bf16 v[68:71], v[136:139], v[176:179], v[68:71]
  ds_read_b128 v[132:135], v161 offset:22528
  v_mfma_f32_16x16x32_bf16 v[76:79], v[220:223], v[184:187], 0
  v_mfma_f32_16x16x32_bf16 v[76:79], v[136:139], v[188:191], v[76:79]
  v_mfma_f32_16x16x32_bf16 v[84:87], v[220:223], v[192:195], 0
  v_mfma_f32_16x16x32_bf16 v[84:87], v[136:139], v[196:199], v[84:87]
  v_mfma_f32_16x16x32_bf16 v[92:95], v[220:223], v[200:203], 0
  v_mfma_f32_16x16x32_bf16 v[92:95], v[136:139], v[204:207], v[92:95]
  s_waitcnt vmcnt(8) lgkmcnt(0)
  s_barrier
  ds_read_b64_tr_b16 v[220:221], v168 offset:34816
  ds_read_b64_tr_b16 v[222:223], v168 offset:35840
  ds_read_b128 v[136:139], v160 offset:32768
  ds_read_b64_tr_b16 v[144:145], v168 offset:51200
  ds_read_b64_tr_b16 v[146:147], v168 offset:52224
  ds_read_b128 v[148:151], v161 offset:32768
  v_mfma_f32_16x16x32_bf16 v[96:99], v[180:183], v[216:219], 0
  ds_read_b64_tr_b16 v[152:153], v169 offset:34816
  ds_read_b64_tr_b16 v[154:155], v169 offset:35840
  v_mfma_f32_16x16x32_bf16 v[96:99], v[140:143], v[176:179], v[96:99]
  ds_read_b64_tr_b16 v[156:157], v169 offset:51200
  ds_read_b64_tr_b16 v[158:159], v169 offset:52224
  v_mfma_f32_16x16x32_bf16 v[104:107], v[180:183], v[184:187], 0
  v_mfma_f32_16x16x32_bf16 v[104:107], v[140:143], v[188:191], v[104:107]
  v_mfma_f32_16x16x32_bf16 v[112:115], v[180:183], v[192:195], 0
  v_mfma_f32_16x16x32_bf16 v[112:115], v[140:143], v[196:199], v[112:115]
  v_mfma_f32_16x16x32_bf16 v[120:123], v[180:183], v[200:203], 0
  ds_read_b64_tr_b16 v[180:181], v170 offset:34816
  ds_read_b64_tr_b16 v[182:183], v170 offset:35840
  v_mfma_f32_16x16x32_bf16 v[120:123], v[140:143], v[204:207], v[120:123]
  ds_read_b64_tr_b16 v[140:141], v170 offset:51200
  ds_read_b64_tr_b16 v[142:143], v170 offset:52224
  v_mfma_f32_16x16x32_bf16 v[100:103], v[128:131], v[216:219], 0
  ds_read_b64_tr_b16 v[216:217], v171 offset:34816
  v_mfma_f32_16x16x32_bf16 v[100:103], v[132:135], v[176:179], v[100:103]
  v_mfma_f32_16x16x32_bf16 v[108:111], v[128:131], v[184:187], 0
  v_mfma_f32_16x16x32_bf16 v[108:111], v[132:135], v[188:191], v[108:111]
  v_mfma_f32_16x16x32_bf16 v[116:119], v[128:131], v[192:195], 0
  v_mfma_f32_16x16x32_bf16 v[116:119], v[132:135], v[196:199], v[116:119]
  v_mfma_f32_16x16x32_bf16 v[124:127], v[128:131], v[200:203], 0
  v_mfma_f32_16x16x32_bf16 v[124:127], v[132:135], v[204:207], v[124:127]
  s_waitcnt lgkmcnt(3)
  v_mfma_f32_16x16x32_bf16 v[0:3], v[136:139], v[220:223], v[0:3]
  ds_read_b64_tr_b16 v[218:219], v171 offset:35840
  ds_read_b64_tr_b16 v[176:177], v171 offset:51200
  v_mfma_f32_16x16x32_bf16 v[0:3], v[148:151], v[144:147], v[0:3]
  ds_read_b64_tr_b16 v[178:179], v171 offset:52224
  ds_read_b128 v[184:187], v160 offset:34816
  v_mfma_f32_16x16x32_bf16 v[8:11], v[136:139], v[152:155], v[8:11]
  ds_read_b128 v[188:191], v161 offset:34816
  ds_read_b128 v[192:195], v160 offset:36864
  v_mfma_f32_16x16x32_bf16 v[8:11], v[148:151], v[156:159], v[8:11]
  ds_read_b128 v[196:199], v161 offset:36864
  v_mfma_f32_16x16x32_bf16 v[16:19], v[136:139], v[180:183], v[16:19]
  s_waitcnt lgkmcnt(7)
  v_mfma_f32_16x16x32_bf16 v[16:19], v[148:151], v[140:143], v[16:19]
  s_waitcnt lgkmcnt(6)
  v_mfma_f32_16x16x32_bf16 v[24:27], v[136:139], v[216:219], v[24:27]
  s_waitcnt lgkmcnt(4)
  v_mfma_f32_16x16x32_bf16 v[24:27], v[148:151], v[176:179], v[24:27]
  s_waitcnt lgkmcnt(3)
  v_mfma_f32_16x16x32_bf16 v[4:7], v[184:187], v[220:223], v[4:7]
  ds_read_b128 v[200:203], v160 offset:38912
  s_waitcnt lgkmcnt(3)
  v_mfma_f32_16x16x32_bf16 v[4:7], v[188:191], v[144:147], v[4:7]
  ds_read_b128 v[204:207], v161 offset:38912
  v_mfma_f32_16x16x32_bf16 v[12:15], v[184:187], v[152:155], v[12:15]
  v_mfma_f32_16x16x32_bf16 v[12:15], v[188:191], v[156:159], v[12:15]
  v_mfma_f32_16x16x32_bf16 v[20:23], v[184:187], v[180:183], v[20:23]
  v_mfma_f32_16x16x32_bf16 v[20:23], v[188:191], v[140:143], v[20:23]
  v_mfma_f32_16x16x32_bf16 v[28:31], v[184:187], v[216:219], v[28:31]
  v_mfma_f32_16x16x32_bf16 v[28:31], v[188:191], v[176:179], v[28:31]
  s_cmp_lg_u32 s94, 1
  s_cbranch_scc1 L_notch_9
  v_bfe_u32 v250, v254, 3, 2
  v_lshlrev_b32 v250, 13, v250
  v_and_b32 v251, 7, v254
  v_lshl_add_u32 v250, v251, 7, v250
  s_and_b32 s54, s96, 15
  s_lshl_b32 s52, s54, 15
  s_lshr_b32 s53, s90, 2
  s_lshl_b32 s53, s53, 10
  s_add_u32 s52, s52, s53
  s_add_u32 s52, s52, 2097152
  s_mov_b32 exec_hi, 0
  s_bitcmp1_b32 s96, 4
  s_cbranch_scc1 L_t2a_10
  buffer_load_dword v252, v250, s[8:11], s52 offen
  s_branch L_t2e_11
L_t2a_10:
  buffer_load_dword v252, v250, s[12:15], s52 offen
L_t2e_11:
  s_mov_b64 exec, -1
L_notch_9:
  s_cmp_lg_u32 s94, 2
  s_cbranch_scc1 L_notch_12
  v_lshlrev_b32 v250, 10, v254
  s_and_b32 s52, s96, 31
  s_lshl_b32 s52, s52, 16
  buffer_load_dword v252, v250, s[4:7], s52 offen offset:512
L_notch_12:
  s_cmp_lg_u32 s94, 3
  s_cbranch_scc1 L_notch_13
  v_bfe_u32 v250, v254, 3, 2
  v_lshlrev_b32 v250, 13, v250
  v_and_b32 v251, 7, v254
  v_lshl_add_u32 v250, v251, 7, v250
  s_and_b32 s54, s96, 15
  s_lshl_b32 s52, s54, 15
  s_lshr_b32 s53, s90, 2
  s_lshl_b32 s53, s53, 10
  s_add_u32 s52, s52, s53
  s_add_u32 s52, s52, 2621440
  s_mov_b32 exec_hi, 0
  s_bitcmp1_b32 s96, 4
  s_cbranch_scc1 L_t2a_14
  buffer_load_dword v252, v250, s[8:11], s52 offen
  s_branch L_t2e_15
L_t2a_14:
  buffer_load_dword v252, v250, s[12:15], s52 offen
L_t2e_15:
  s_mov_b64 exec, -1
L_notch_13:
  s_waitcnt lgkmcnt(2)
  v_mfma_f32_16x16x32_bf16 v[32:35], v[192:195], v[220:223], v[32:35]
  ds_read_b128 v[184:187], v160 offset:49152
  v_mfma_f32_16x16x32_bf16 v[32:35], v[196:199], v[144:147], v[32:35]
  ds_read_b128 v[188:191], v161 offset:49152
  v_mfma_f32_16x16x32_bf16 v[40:43], v[192:195], v[152:155], v[40:43]
  v_mfma_f32_16x16x32_bf16 v[40:43], v[196:199], v[156:159], v[40:43]
  v_mfma_f32_16x16x32_bf16 v[48:51], v[192:195], v[180:183], v[48:51]
  v_mfma_f32_16x16x32_bf16 v[48:51], v[196:199], v[140:143], v[48:51]
  v_mfma_f32_16x16x32_bf16 v[56:59], v[192:195], v[216:219], v[56:59]
  v_mfma_f32_16x16x32_bf16 v[56:59], v[196:199], v[176:179], v[56:59]
  s_waitcnt lgkmcnt(2)
  v_mfma_f32_16x16x32_bf16 v[36:39], v[200:203], v[220:223], v[36:39]
  ds_read_b128 v[192:195], v160 offset:51200
  v_mfma_f32_16x16x32_bf16 v[36:39], v[204:207], v[144:147], v[36:39]
  ds_read_b128 v[196:199], v161 offset:51200
  v_mfma_f32_16x16x32_bf16 v[44:47], v[200:203], v[152:155], v[44:47]
  v_mfma_f32_16x16x32_bf16 v[44:47], v[204:207], v[156:159], v[44:47]
  v_mfma_f32_16x16x32_bf16 v[52:55], v[200:203], v[180:183], v[52:55]
  v_mfma_f32_16x16x32_bf16 v[52:55], v[204:207], v[140:143], v[52:55]
  v_mfma_f32_16x16x32_bf16 v[60:63], v[200:203], v[216:219], v[60:63]
  v_mfma_f32_16x16x32_bf16 v[60:63], v[204:207], v[176:179], v[60:63]
  s_waitcnt lgkmcnt(2)
  v_mfma_f32_16x16x32_bf16 v[64:67], v[184:187], v[220:223], v[64:67]
  ds_read_b128 v[200:203], v160 offset:53248
  v_mfma_f32_16x16x32_bf16 v[64:67], v[188:191], v[144:147], v[64:67]
  ds_read_b128 v[204:207], v161 offset:53248
  v_mfma_f32_16x16x32_bf16 v[72:75], v[184:187], v[152:155], v[72:75]
  v_mfma_f32_16x16x32_bf16 v[72:75], v[188:191], v[156:159], v[72:75]
  v_mfma_f32_16x16x32_bf16 v[80:83], v[184:187], v[180:183], v[80:83]
  v_mfma_f32_16x16x32_bf16 v[80:83], v[188:191], v[140:143], v[80:83]
  v_mfma_f32_16x16x32_bf16 v[88:91], v[184:187], v[216:219], v[88:91]
  v_mfma_f32_16x16x32_bf16 v[88:91], v[188:191], v[176:179], v[88:91]
  s_waitcnt lgkmcnt(2)
  v_mfma_f32_16x16x32_bf16 v[68:71], v[192:195], v[220:223], v[68:71]
  ds_read_b128 v[184:187], v160 offset:55296
  v_mfma_f32_16x16x32_bf16 v[68:71], v[196:199], v[144:147], v[68:71]
  ds_read_b128 v[188:191], v161 offset:55296
  v_add_u32 v168, 65536, v168
  v_mfma_f32_16x16x32_bf16 v[76:79], v[192:195], v[152:155], v[76:79]
  v_add_u32 v169, 65536, v169
  v_add_u32 v170, 65536, v170
  v_mfma_f32_16x16x32_bf16 v[76:79], v[196:199], v[156:159], v[76:79]
  v_add_u32 v171, 65536, v171
  v_mfma_f32_16x16x32_bf16 v[84:87], v[192:195], v[180:183], v[84:87]
  v_mfma_f32_16x16x32_bf16 v[84:87], v[196:199], v[140:143], v[84:87]
  v_mfma_f32_16x16x32_bf16 v[92:95], v[192:195], v[216:219], v[92:95]
  v_mfma_f32_16x16x32_bf16 v[92:95], v[196:199], v[176:179], v[92:95]
  s_waitcnt vmcnt(0) lgkmcnt(0)
  s_barrier
  ds_read_b64_tr_b16 v[192:193], v168 offset:2048
  ds_read_b64_tr_b16 v[194:195], v168 offset:3072
  ds_read_b128 v[196:199], v160 offset:0
  ds_read_b64_tr_b16 v[128:129], v168 offset:18432
  ds_read_b64_tr_b16 v[130:131], v168 offset:19456
  ds_read_b128 v[132:135], v161 offset:0
  v_mfma_f32_16x16x32_bf16 v[96:99], v[200:203], v[220:223], v[96:99]
  ds_read_b64_tr_b16 v[136:137], v169 offset:2048
  ds_read_b64_tr_b16 v[138:139], v169 offset:3072
  v_mfma_f32_16x16x32_bf16 v[96:99], v[204:207], v[144:147], v[96:99]
  ds_read_b64_tr_b16 v[148:149], v169 offset:18432
  ds_read_b64_tr_b16 v[150:151], v169 offset:19456
  v_mfma_f32_16x16x32_bf16 v[104:107], v[200:203], v[152:155], v[104:107]
  v_mfma_f32_16x16x32_bf16 v[104:107], v[204:207], v[156:159], v[104:107]
  v_mfma_f32_16x16x32_bf16 v[112:115], v[200:203], v[180:183], v[112:115]
  v_mfma_f32_16x16x32_bf16 v[112:115], v[204:207], v[140:143], v[112:115]
  v_mfma_f32_16x16x32_bf16 v[120:123], v[200:203], v[216:219], v[120:123]
  ds_read_b64_tr_b16 v[200:201], v170 offset:2048
  ds_read_b64_tr_b16 v[202:203], v170 offset:3072
  v_mfma_f32_16x16x32_bf16 v[120:123], v[204:207], v[176:179], v[120:123]
  ds_read_b64_tr_b16 v[204:205], v170 offset:18432
  ds_read_b64_tr_b16 v[206:207], v170 offset:19456
  v_mfma_f32_16x16x32_bf16 v[100:103], v[184:187], v[220:223], v[100:103]
  ds_read_b64_tr_b16 v[220:221], v171 offset:2048
  v_mfma_f32_16x16x32_bf16 v[100:103], v[188:191], v[144:147], v[100:103]
  v_mfma_f32_16x16x32_bf16 v[108:111], v[184:187], v[152:155], v[108:111]
  v_mfma_f32_16x16x32_bf16 v[108:111], v[188:191], v[156:159], v[108:111]
  v_mfma_f32_16x16x32_bf16 v[116:119], v[184:187], v[180:183], v[116:119]
  v_mfma_f32_16x16x32_bf16 v[116:119], v[188:191], v[140:143], v[116:119]
  v_mfma_f32_16x16x32_bf16 v[124:127], v[184:187], v[216:219], v[124:127]
  v_mfma_f32_16x16x32_bf16 v[124:127], v[188:191], v[176:179], v[124:127]
  s_waitcnt lgkmcnt(3)
  v_mfma_f32_16x16x32_bf16 v[0:3], v[196:199], v[192:195], v[0:3]
  ds_read_b64_tr_b16 v[222:223], v171 offset:3072
  ds_read_b64_tr_b16 v[216:217], v171 offset:18432
  v_mfma_f32_16x16x32_bf16 v[0:3], v[132:135], v[128:131], v[0:3]
  ds_read_b64_tr_b16 v[218:219], v171 offset:19456
  ds_read_b128 v[176:179], v160 offset:2048
  v_mfma_f32_16x16x32_bf16 v[8:11], v[196:199], v[136:139], v[8:11]
  ds_read_b128 v[180:183], v161 offset:2048
  ds_read_b128 v[184:187], v160 offset:4096
  v_mfma_f32_16x16x32_bf16 v[8:11], v[132:135], v[148:151], v[8:11]
  ds_read_b128 v[188:191], v161 offset:4096
  v_mfma_f32_16x16x32_bf16 v[16:19], v[196:199], v[200:203], v[16:19]
  s_waitcnt lgkmcnt(7)
  v_mfma_f32_16x16x32_bf16 v[16:19], v[132:135], v[204:207], v[16:19]
  s_waitcnt lgkmcnt(6)
  v_mfma_f32_16x16x32_bf16 v[24:27], v[196:199], v[220:223], v[24:27]
  s_waitcnt lgkmcnt(4)
  v_mfma_f32_16x16x32_bf16 v[24:27], v[132:135], v[216:219], v[24:27]
  s_waitcnt lgkmcnt(3)
  v_mfma_f32_16x16x32_bf16 v[4:7], v[176:179], v[192:195], v[4:7]
  ds_read_b128 v[196:199], v160 offset:6144
  s_waitcnt lgkmcnt(3)
  v_mfma_f32_16x16x32_bf16 v[4:7], v[180:183], v[128:131], v[4:7]
  ds_read_b128 v[132:135], v161 offset:6144
  v_mfma_f32_16x16x32_bf16 v[12:15], v[176:179], v[136:139], v[12:15]
  v_mfma_f32_16x16x32_bf16 v[12:15], v[180:183], v[148:151], v[12:15]
  v_mfma_f32_16x16x32_bf16 v[20:23], v[176:179], v[200:203], v[20:23]
  v_mfma_f32_16x16x32_bf16 v[20:23], v[180:183], v[204:207], v[20:23]
  v_mfma_f32_16x16x32_bf16 v[28:31], v[176:179], v[220:223], v[28:31]
  v_mfma_f32_16x16x32_bf16 v[28:31], v[180:183], v[216:219], v[28:31]
  s_cmp_lg_u32 s94, 2
  s_cbranch_scc1 L_notch_16
  v_lshlrev_b32 v250, 10, v254
  s_and_b32 s52, s96, 31
  s_lshl_b32 s52, s52, 16
  buffer_load_dword v252, v250, s[4:7], s52 offen offset:640
L_notch_16:
  s_cmp_lg_u32 s94, 3
  s_cbranch_scc1 L_notch_17
  v_bfe_u32 v250, v254, 3, 2
  v_lshlrev_b32 v250, 13, v250
  v_and_b32 v251, 7, v254
  v_lshl_add_u32 v250, v251, 7, v250
  s_and_b32 s54, s96, 15
  s_lshl_b32 s52, s54, 15
  s_lshr_b32 s53, s90, 2
  s_lshl_b32 s53, s53, 10
  s_add_u32 s52, s52, s53
  s_add_u32 s52, s52, 3145728
  s_mov_b32 exec_hi, 0
  s_bitcmp1_b32 s96, 4
  s_cbranch_scc1 L_t2a_18
  buffer_load_dword v252, v250, s[8:11], s52 offen
  s_branch L_t2e_19
L_t2a_18:
  buffer_load_dword v252, v250, s[12:15], s52 offen
L_t2e_19:
  s_mov_b64 exec, -1
L_notch_17:
  s_cmp_lg_u32 s94, 0
  s_cbranch_scc1 L_notch_20
  v_lshlrev_b32 v250, 10, v254
  s_and_b32 s52, s96, 31
  s_lshl_b32 s52, s52, 16
  buffer_load_dword v252, v250, s[4:7], s52 offen offset:768
L_notch_20:
  s_waitcnt lgkmcnt(2)
  v_mfma_f32_16x16x32_bf16 v[32:35], v[184:187], v[192:195], v[32:35]
  ds_read_b128 v[176:179], v160 offset:16384
  v_mfma_f32_16x16x32_bf16 v[32:35], v[188:191], v[128:131], v[32:35]
  ds_read_b128 v[180:183], v161 offset:16384
  v_mfma_f32_16x16x32_bf16 v[40:43], v[184:187], v[136:139], v[40:43]
  v_mfma_f32_16x16x32_bf16 v[40:43], v[188:191], v[148:151], v[40:43]
  v_mfma_f32_16x16x32_bf16 v[48:51], v[184:187], v[200:203], v[48:51]
  v_mfma_f32_16x16x32_bf16 v[48:51], v[188:191], v[204:207], v[48:51]
  v_mfma_f32_16x16x32_bf16 v[56:59], v[184:187], v[220:223], v[56:59]
  v_mfma_f32_16x16x32_bf16 v[56:59], v[188:191], v[216:219], v[56:59]
  s_waitcnt lgkmcnt(2)
  v_mfma_f32_16x16x32_bf16 v[36:39], v[196:199], v[192:195], v[36:39]
  ds_read_b128 v[184:187], v160 offset:18432
  v_mfma_f32_16x16x32_bf16 v[36:39], v[132:135], v[128:131], v[36:39]
  ds_read_b128 v[188:191], v161 offset:18432
  v_mfma_f32_16x16x32_bf16 v[44:47], v[196:199], v[136:139], v[44:47]
  v_mfma_f32_16x16x32_bf16 v[44:47], v[132:135], v[148:151], v[44:47]
  v_mfma_f32_16x16x32_bf16 v[52:55], v[196:199], v[200:203], v[52:55]
  v_mfma_f32_16x16x32_bf16 v[52:55], v[132:135], v[204:207], v[52:55]
  v_mfma_f32_16x16x32_bf16 v[60:63], v[196:199], v[220:223], v[60:63]
  v_mfma_f32_16x16x32_bf16 v[60:63], v[132:135], v[216:219], v[60:63]
  s_waitcnt lgkmcnt(2)
  v_mfma_f32_16x16x32_bf16 v[64:67], v[176:179], v[192:195], v[64:67]
  ds_read_b128 v[196:199], v160 offset:20480
  v_mfma_f32_16x16x32_bf16 v[64:67], v[180:183], v[128:131], v[64:67]
  ds_read_b128 v[132:135], v161 offset:20480
  v_mfma_f32_16x16x32_bf16 v[72:75], v[176:179], v[136:139], v[72:75]
  v_mfma_f32_16x16x32_bf16 v[72:75], v[180:183], v[148:151], v[72:75]
  v_mfma_f32_16x16x32_bf16 v[80:83], v[176:179], v[200:203], v[80:83]
  v_mfma_f32_16x16x32_bf16 v[80:83], v[180:183], v[204:207], v[80:83]
  v_mfma_f32_16x16x32_bf16 v[88:91], v[176:179], v[220:223], v[88:91]
  v_mfma_f32_16x16x32_bf16 v[88:91], v[180:183], v[216:219], v[88:91]
  s_waitcnt lgkmcnt(2)
  v_mfma_f32_16x16x32_bf16 v[68:71], v[184:187], v[192:195], v[68:71]
  ds_read_b128 v[176:179], v160 offset:22528
  v_mfma_f32_16x16x32_bf16 v[68:71], v[188:191], v[128:131], v[68:71]
  ds_read_b128 v[180:183], v161 offset:22528
  v_add_u32 v168, -65536, v168
  v_mfma_f32_16x16x32_bf16 v[76:79], v[184:187], v[136:139], v[76:79]
  v_add_u32 v169, -65536, v169
  v_add_u32 v170, -65536, v170
  v_mfma_f32_16x16x32_bf16 v[76:79], v[188:191], v[148:151], v[76:79]
  v_add_u32 v171, -65536, v171
  v_mfma_f32_16x16x32_bf16 v[84:87], v[184:187], v[200:203], v[84:87]
  v_mfma_f32_16x16x32_bf16 v[84:87], v[188:191], v[204:207], v[84:87]
  v_mfma_f32_16x16x32_bf16 v[92:95], v[184:187], v[220:223], v[92:95]
  v_mfma_f32_16x16x32_bf16 v[92:95], v[188:191], v[216:219], v[92:95]
  s_cmp_lg_u32 s92, 7
  s_cbranch_scc1 L_nofl_21
  v_mov_b32 v250, 1
  s_lshl_b32 s52, s91, 5
  v_mov_b32 v251, s52
  s_mov_b64 exec, 1
  buffer_atomic_add v250, v251, s[48:51], 0 offen sc1
  s_mov_b64 exec, -1
L_nofl_21:
  s_waitcnt lgkmcnt(0)
  s_barrier
  ds_read_b64_tr_b16 v[184:185], v168 offset:2048
  ds_read_b64_tr_b16 v[186:187], v168 offset:3072
  ds_read_b128 v[188:191], v160 offset:32768
  ds_read_b64_tr_b16 v[140:141], v168 offset:18432
  ds_read_b64_tr_b16 v[142:143], v168 offset:19456
  ds_read_b128 v[144:147], v161 offset:32768
  v_mfma_f32_16x16x32_bf16 v[96:99], v[196:199], v[192:195], v[96:99]
  ds_read_b64_tr_b16 v[152:153], v169 offset:2048
  ds_read_b64_tr_b16 v[154:155], v169 offset:3072
  v_mfma_f32_16x16x32_bf16 v[96:99], v[132:135], v[128:131], v[96:99]
  ds_read_b64_tr_b16 v[156:157], v169 offset:18432
  ds_read_b64_tr_b16 v[158:159], v169 offset:19456
  v_mfma_f32_16x16x32_bf16 v[104:107], v[196:199], v[136:139], v[104:107]
  v_mfma_f32_16x16x32_bf16 v[104:107], v[132:135], v[148:151], v[104:107]
  v_mfma_f32_16x16x32_bf16 v[112:115], v[196:199], v[200:203], v[112:115]
  v_mfma_f32_16x16x32_bf16 v[112:115], v[132:135], v[204:207], v[112:115]
  v_mfma_f32_16x16x32_bf16 v[120:123], v[196:199], v[220:223], v[120:123]
  ds_read_b64_tr_b16 v[196:197], v170 offset:2048
  ds_read_b64_tr_b16 v[198:199], v170 offset:3072
  v_mfma_f32_16x16x32_bf16 v[120:123], v[132:135], v[216:219], v[120:123]
  ds_read_b64_tr_b16 v[132:133], v170 offset:18432
  ds_read_b64_tr_b16 v[134:135], v170 offset:19456
  v_mfma_f32_16x16x32_bf16 v[100:103], v[176:179], v[192:195], v[100:103]
  ds_read_b64_tr_b16 v[192:193], v171 offset:2048
  v_mfma_f32_16x16x32_bf16 v[100:103], v[180:183], v[128:131], v[100:103]
  v_mfma_f32_16x16x32_bf16 v[108:111], v[176:179], v[136:139], v[108:111]
  v_mfma_f32_16x16x32_bf16 v[108:111], v[180:183], v[148:151], v[108:111]
  v_mfma_f32_16x16x32_bf16 v[116:119], v[176:179], v[200:203], v[116:119]
  v_mfma_f32_16x16x32_bf16 v[116:119], v[180:183], v[204:207], v[116:119]
  v_mfma_f32_16x16x32_bf16 v[124:127], v[176:179], v[220:223], v[124:127]
  v_mfma_f32_16x16x32_bf16 v[124:127], v[180:183], v[216:219], v[124:127]
  s_waitcnt lgkmcnt(3)
  v_mfma_f32_16x16x32_bf16 v[0:3], v[188:191], v[184:187], v[0:3]
  ds_read_b64_tr_b16 v[194:195], v171 offset:3072
  ds_read_b64_tr_b16 v[216:217], v171 offset:18432
  v_mfma_f32_16x16x32_bf16 v[0:3], v[144:147], v[140:143], v[0:3]
  ds_read_b64_tr_b16 v[218:219], v171 offset:19456
  ds_read_b128 v[220:223], v160 offset:34816
  v_mfma_f32_16x16x32_bf16 v[8:11], v[188:191], v[152:155], v[8:11]
  ds_read_b128 v[176:179], v161 offset:34816
  ds_read_b128 v[180:183], v160 offset:36864
  v_mfma_f32_16x16x32_bf16 v[8:11], v[144:147], v[156:159], v[8:11]
  ds_read_b128 v[200:203], v161 offset:36864
  v_mfma_f32_16x16x32_bf16 v[16:19], v[188:191], v[196:199], v[16:19]
  s_waitcnt lgkmcnt(7)
  v_mfma_f32_16x16x32_bf16 v[16:19], v[144:147], v[132:135], v[16:19]
  s_waitcnt lgkmcnt(6)
  v_mfma_f32_16x16x32_bf16 v[24:27], v[188:191], v[192:195], v[24:27]
  s_waitcnt lgkmcnt(4)
  v_mfma_f32_16x16x32_bf16 v[24:27], v[144:147], v[216:219], v[24:27]
  s_waitcnt lgkmcnt(3)
  v_mfma_f32_16x16x32_bf16 v[4:7], v[220:223], v[184:187], v[4:7]
  ds_read_b128 v[188:191], v160 offset:38912
  s_waitcnt lgkmcnt(3)
  v_mfma_f32_16x16x32_bf16 v[4:7], v[176:179], v[140:143], v[4:7]
  ds_read_b128 v[204:207], v161 offset:38912
  v_mfma_f32_16x16x32_bf16 v[12:15], v[220:223], v[152:155], v[12:15]
  v_mfma_f32_16x16x32_bf16 v[12:15], v[176:179], v[156:159], v[12:15]
  v_mfma_f32_16x16x32_bf16 v[20:23], v[220:223], v[196:199], v[20:23]
  v_mfma_f32_16x16x32_bf16 v[20:23], v[176:179], v[132:135], v[20:23]
  v_mfma_f32_16x16x32_bf16 v[28:31], v[220:223], v[192:195], v[28:31]
  v_mfma_f32_16x16x32_bf16 v[28:31], v[176:179], v[216:219], v[28:31]
  s_cmp_lg_u32 s94, 3
  s_cbranch_scc1 L_notch_22
  v_bfe_u32 v250, v254, 3, 2
  v_lshlrev_b32 v250, 13, v250
  v_and_b32 v251, 7, v254
  v_lshl_add_u32 v250, v251, 7, v250
  s_and_b32 s54, s96, 15
  s_lshl_b32 s52, s54, 15
  s_lshr_b32 s53, s90, 2
  s_lshl_b32 s53, s53, 10
  s_add_u32 s52, s52, s53
  s_add_u32 s52, s52, 3670016
  s_mov_b32 exec_hi, 0
  s_bitcmp1_b32 s96, 4
  s_cbranch_scc1 L_t2a_23
  buffer_load_dword v252, v250, s[8:11], s52 offen
  s_branch L_t2e_24
L_t2a_23:
  buffer_load_dword v252, v250, s[12:15], s52 offen
L_t2e_24:
  s_mov_b64 exec, -1
L_notch_22:
  s_cmp_lg_u32 s94, 0
  s_cbranch_scc1 L_notch_25
  v_lshlrev_b32 v250, 10, v254
  s_and_b32 s52, s96, 31
  s_lshl_b32 s52, s52, 16
  buffer_load_dword v252, v250, s[4:7], s52 offen offset:896
L_notch_25:
  s_cmp_lg_u32 s94, 1
  s_cbranch_scc1 L_notch_26
  v_bfe_u32 v250, v254, 3, 2
  v_lshlrev_b32 v250, 13, v250
  v_and_b32 v251, 7, v254
  v_lshl_add_u32 v250, v251, 7, v250
  s_and_b32 s54, s96, 15
  s_lshl_b32 s52, s54, 15
  s_lshr_b32 s53, s90, 2
  s_lshl_b32 s53, s53, 10
  s_add_u32 s52, s52, s53
  s_add_u32 s52, s52, 0
  s_mov_b32 exec_hi, 0
  s_bitcmp1_b32 s96, 4
  s_cbranch_scc1 L_t2a_27
  buffer_load_dword v252, v250, s[20:23], s52 offen
  s_branch L_t2e_28
L_t2a_27:
  v_and_b32 v250, 3, v254
  v_mul_u32_u24 v250, 3072, v250
  v_lshrrev_b32 v251, 2, v254
  v_min_u32 v251, 2, v251
  v_lshl_add_u32 v250, v251, 10, v250
  s_mul_i32 s52, s54, 12288
  s_lshr_b32 s53, s53, 3
  s_add_u32 s52, s52, s53
  s_add_u32 s52, s52, 0
  s_mov_b32 exec_lo, 0xfff
  buffer_load_dword v252, v250, s[24:27], s52 offen
L_t2e_28:
  s_mov_b64 exec, -1
L_notch_26:
  s_cmp_lg_u32 s94, 2
  s_cbranch_scc1 L_notch_29
  v_lshlrev_b32 v250, 10, v254
  s_and_b32 s52, s96, 31
  s_lshl_b32 s52, s52, 16
  buffer_load_dword v252, v250, s[16:19], s52 offen offset:0
L_notch_29:
  s_waitcnt lgkmcnt(2)
  v_mfma_f32_16x16x32_bf16 v[32:35], v[180:183], v[184:187], v[32:35]
  ds_read_b128 v[220:223], v160 offset:49152
  v_mfma_f32_16x16x32_bf16 v[32:35], v[200:203], v[140:143], v[32:35]
  ds_read_b128 v[176:179], v161 offset:49152
  v_mfma_f32_16x16x32_bf16 v[40:43], v[180:183], v[152:155], v[40:43]
  v_mfma_f32_16x16x32_bf16 v[40:43], v[200:203], v[156:159], v[40:43]
  v_mfma_f32_16x16x32_bf16 v[48:51], v[180:183], v[196:199], v[48:51]
  v_mfma_f32_16x16x32_bf16 v[48:51], v[200:203], v[132:135], v[48:51]
  v_mfma_f32_16x16x32_bf16 v[56:59], v[180:183], v[192:195], v[56:59]
  v_mfma_f32_16x16x32_bf16 v[56:59], v[200:203], v[216:219], v[56:59]
  s_waitcnt lgkmcnt(2)
  v_mfma_f32_16x16x32_bf16 v[36:39], v[188:191], v[184:187], v[36:39]
  ds_read_b128 v[180:183], v160 offset:51200
  v_mfma_f32_16x16x32_bf16 v[36:39], v[204:207], v[140:143], v[36:39]
  ds_read_b128 v[200:203], v161 offset:51200
  v_mfma_f32_16x16x32_bf16 v[44:47], v[188:191], v[152:155], v[44:47]
  v_mfma_f32_16x16x32_bf16 v[44:47], v[204:207], v[156:159], v[44:47]
  v_mfma_f32_16x16x32_bf16 v[52:55], v[188:191], v[196:199], v[52:55]
  v_mfma_f32_16x16x32_bf16 v[52:55], v[204:207], v[132:135], v[52:55]
  v_mfma_f32_16x16x32_bf16 v[60:63], v[188:191], v[192:195], v[60:63]
  v_mfma_f32_16x16x32_bf16 v[60:63], v[204:207], v[216:219], v[60:63]
  s_waitcnt lgkmcnt(2)
  v_mfma_f32_16x16x32_bf16 v[64:67], v[220:223], v[184:187], v[64:67]
  ds_read_b128 v[188:191], v160 offset:53248
  v_mfma_f32_16x16x32_bf16 v[64:67], v[176:179], v[140:143], v[64:67]
  ds_read_b128 v[204:207], v161 offset:53248
  v_mfma_f32_16x16x32_bf16 v[72:75], v[220:223], v[152:155], v[72:75]
  v_mfma_f32_16x16x32_bf16 v[72:75], v[176:179], v[156:159], v[72:75]
  v_mfma_f32_16x16x32_bf16 v[80:83], v[220:223], v[196:199], v[80:83]
  v_mfma_f32_16x16x32_bf16 v[80:83], v[176:179], v[132:135], v[80:83]
  v_mfma_f32_16x16x32_bf16 v[88:91], v[220:223], v[192:195], v[88:91]
  v_mfma_f32_16x16x32_bf16 v[88:91], v[176:179], v[216:219], v[88:91]
  s_waitcnt lgkmcnt(2)
  v_mfma_f32_16x16x32_bf16 v[68:71], v[180:183], v[184:187], v[68:71]
  ds_read_b128 v[220:223], v160 offset:55296
  v_mfma_f32_16x16x32_bf16 v[68:71], v[200:203], v[140:143], v[68:71]
  ds_read_b128 v[176:179], v161 offset:55296
  v_mfma_f32_16x16x32_bf16 v[76:79], v[180:183], v[152:155], v[76:79]
  v_mfma_f32_16x16x32_bf16 v[76:79], v[200:203], v[156:159], v[76:79]
  v_mfma_f32_16x16x32_bf16 v[84:87], v[180:183], v[196:199], v[84:87]
  v_mfma_f32_16x16x32_bf16 v[84:87], v[200:203], v[132:135], v[84:87]
  v_mfma_f32_16x16x32_bf16 v[92:95], v[180:183], v[192:195], v[92:95]
  v_mfma_f32_16x16x32_bf16 v[92:95], v[200:203], v[216:219], v[92:95]
  s_waitcnt lgkmcnt(0)
  s_barrier
  ds_read_b64_tr_b16 v[180:181], v168 offset:34816
  ds_read_b64_tr_b16 v[182:183], v168 offset:35840
  ds_read_b128 v[200:203], v160 offset:0
  ds_read_b64_tr_b16 v[128:129], v168 offset:51200
  ds_read_b64_tr_b16 v[130:131], v168 offset:52224
  ds_read_b128 v[136:139], v161 offset:0
  v_mfma_f32_16x16x32_bf16 v[96:99], v[188:191], v[184:187], v[96:99]
  ds_read_b64_tr_b16 v[144:145], v169 offset:34816
  ds_read_b64_tr_b16 v[146:147], v169 offset:35840
  v_mfma_f32_16x16x32_bf16 v[96:99], v[204:207], v[140:143], v[96:99]
  ds_read_b64_tr_b16 v[148:149], v169 offset:51200
  ds_read_b64_tr_b16 v[150:151], v169 offset:52224
  v_mfma_f32_16x16x32_bf16 v[104:107], v[188:191], v[152:155], v[104:107]
  v_mfma_f32_16x16x32_bf16 v[104:107], v[204:207], v[156:159], v[104:107]
  v_mfma_f32_16x16x32_bf16 v[112:115], v[188:191], v[196:199], v[112:115]
  v_mfma_f32_16x16x32_bf16 v[112:115], v[204:207], v[132:135], v[112:115]
  v_mfma_f32_16x16x32_bf16 v[120:123], v[188:191], v[192:195], v[120:123]
  ds_read_b64_tr_b16 v[188:189], v170 offset:34816
  ds_read_b64_tr_b16 v[190:191], v170 offset:35840
  v_mfma_f32_16x16x32_bf16 v[120:123], v[204:207], v[216:219], v[120:123]
  ds_read_b64_tr_b16 v[204:205], v170 offset:51200
  ds_read_b64_tr_b16 v[206:207], v170 offset:52224
  v_mfma_f32_16x16x32_bf16 v[100:103], v[220:223], v[184:187], v[100:103]
  ds_read_b64_tr_b16 v[184:185], v171 offset:34816
  v_mfma_f32_16x16x32_bf16 v[100:103], v[176:179], v[140:143], v[100:103]
  v_mfma_f32_16x16x32_bf16 v[108:111], v[220:223], v[152:155], v[108:111]
  v_mfma_f32_16x16x32_bf16 v[108:111], v[176:179], v[156:159], v[108:111]
  v_mfma_f32_16x16x32_bf16 v[116:119], v[220:223], v[196:199], v[116:119]
  v_mfma_f32_16x16x32_bf16 v[116:119], v[176:179], v[132:135], v[116:119]
  v_mfma_f32_16x16x32_bf16 v[124:127], v[220:223], v[192:195], v[124:127]
  v_mfma_f32_16x16x32_bf16 v[124:127], v[176:179], v[216:219], v[124:127]
  s_waitcnt lgkmcnt(3)
  v_mfma_f32_16x16x32_bf16 v[0:3], v[200:203], v[180:183], v[0:3]
  ds_read_b64_tr_b16 v[186:187], v171 offset:35840
  ds_read_b64_tr_b16 v[216:217], v171 offset:51200
  v_mfma_f32_16x16x32_bf16 v[0:3], v[136:139], v[128:131], v[0:3]
  ds_read_b64_tr_b16 v[218:219], v171 offset:52224
  ds_read_b128 v[220:223], v160 offset:2048
  v_mfma_f32_16x16x32_bf16 v[8:11], v[200:203], v[144:147], v[8:11]
  ds_read_b128 v[176:179], v161 offset:2048
  ds_read_b128 v[192:195], v160 offset:4096
  v_mfma_f32_16x16x32_bf16 v[8:11], v[136:139], v[148:151], v[8:11]
  ds_read_b128 v[196:199], v161 offset:4096
  v_mfma_f32_16x16x32_bf16 v[16:19], v[200:203], v[188:191], v[16:19]
  s_waitcnt lgkmcnt(7)
  v_mfma_f32_16x16x32_bf16 v[16:19], v[136:139], v[204:207], v[16:19]
  s_waitcnt lgkmcnt(6)
  v_mfma_f32_16x16x32_bf16 v[24:27], v[200:203], v[184:187], v[24:27]
  s_waitcnt lgkmcnt(4)
  v_mfma_f32_16x16x32_bf16 v[24:27], v[136:139], v[216:219], v[24:27]
  s_waitcnt lgkmcnt(3)
  v_mfma_f32_16x16x32_bf16 v[4:7], v[220:223], v[180:183], v[4:7]
  ds_read_b128 v[200:203], v160 offset:6144
  s_waitcnt lgkmcnt(3)
  v_mfma_f32_16x16x32_bf16 v[4:7], v[176:179], v[128:131], v[4:7]
  ds_read_b128 v[132:135], v161 offset:6144
  v_mfma_f32_16x16x32_bf16 v[12:15], v[220:223], v[144:147], v[12:15]
  v_mfma_f32_16x16x32_bf16 v[12:15], v[176:179], v[148:151], v[12:15]
  v_mfma_f32_16x16x32_bf16 v[20:23], v[220:223], v[188:191], v[20:23]
  v_mfma_f32_16x16x32_bf16 v[20:23], v[176:179], v[204:207], v[20:23]
  v_mfma_f32_16x16x32_bf16 v[28:31], v[220:223], v[184:187], v[28:31]
  v_mfma_f32_16x16x32_bf16 v[28:31], v[176:179], v[216:219], v[28:31]
  s_cmp_lg_u32 s94, 0
  s_cbranch_scc1 L_notch_30
  v_bfe_u32 v250, v254, 3, 2
  v_lshlrev_b32 v250, 13, v250
  v_and_b32 v251, 7, v254
  v_lshl_add_u32 v250, v251, 7, v250
  s_and_b32 s54, s96, 15
  s_lshl_b32 s52, s54, 15
  s_lshr_b32 s53, s90, 2
  s_lshl_b32 s53, s53, 10
  s_add_u32 s52, s52, s53
  s_add_u32 s52, s52, 524288
  s_mov_b32 exec_hi, 0
  s_bitcmp1_b32 s96, 4
  s_cbranch_scc1 L_t2a_31
  buffer_load_dword v252, v250, s[20:23], s52 offen
  s_branch L_t2e_32
L_t2a_31:
  v_and_b32 v250, 3, v254
  v_mul_u32_u24 v250, 3072, v250
  v_lshrrev_b32 v251, 2, v254
  v_min_u32 v251, 2, v251
  v_lshl_add_u32 v250, v251, 10, v250
  s_mul_i32 s52, s54, 12288
  s_lshr_b32 s53, s53, 3
  s_add_u32 s52, s52, s53
  s_add_u32 s52, s52, 196608
  s_mov_b32 exec_lo, 0xfff
  buffer_load_dword v252, v250, s[24:27], s52 offen
L_t2e_32:
  s_mov_b64 exec, -1
L_notch_30:
  s_cmp_lg_u32 s94, 1
  s_cbranch_scc1 L_notch_33
  v_lshlrev_b32 v250, 10, v254
  s_and_b32 s52, s96, 31
  s_lshl_b32 s52, s52, 16
  buffer_load_dword v252, v250, s[16:19], s52 offen offset:128
L_notch_33:
  s_cmp_lg_u32 s94, 2
  s_cbranch_scc1 L_notch_34
  v_bfe_u32 v250, v254, 3, 2
  v_lshlrev_b32 v250, 13, v250
  v_and_b32 v251, 7, v254
  v_lshl_add_u32 v250, v251, 7, v250
  s_and_b32 s54, s96, 15
  s_lshl_b32 s52, s54, 15
  s_lshr_b32 s53, s90, 2
  s_lshl_b32 s53, s53, 10
  s_add_u32 s52, s52, s53
  s_add_u32 s52, s52, 1048576
  s_mov_b32 exec_hi, 0
  s_bitcmp1_b32 s96, 4
  s_cbranch_scc1 L_t2a_35
  buffer_load_dword v252, v250, s[20:23], s52 offen
  s_branch L_t2e_36
L_t2a_35:
  v_and_b32 v250, 3, v254
  v_mul_u32_u24 v250, 3072, v250
  v_lshrrev_b32 v251, 2, v254
  v_min_u32 v251, 2, v251
  v_lshl_add_u32 v250, v251, 10, v250
  s_mul_i32 s52, s54, 12288
  s_lshr_b32 s53, s53, 3
  s_add_u32 s52, s52, s53
  s_add_u32 s52, s52, 393216
  s_mov_b32 exec_lo, 0xfff
  buffer_load_dword v252, v250, s[24:27], s52 offen
L_t2e_36:
  s_mov_b64 exec, -1
L_notch_34:
  s_cmp_lg_u32 s94, 3
  s_cbranch_scc1 L_notch_37
  v_lshlrev_b32 v250, 10, v254
  s_and_b32 s52, s96, 31
  s_lshl_b32 s52, s52, 16
  buffer_load_dword v252, v250, s[16:19], s52 offen offset:256
L_notch_37:
  s_waitcnt lgkmcnt(2)
  v_mfma_f32_16x16x32_bf16 v[32:35], v[192:195], v[180:183], v[32:35]
  ds_read_b128 v[220:223], v160 offset:16384
  v_mfma_f32_16x16x32_bf16 v[32:35], v[196:199], v[128:131], v[32:35]
  ds_read_b128 v[176:179], v161 offset:16384
  v_mfma_f32_16x16x32_bf16 v[40:43], v[192:195], v[144:147], v[40:43]
  v_mfma_f32_16x16x32_bf16 v[40:43], v[196:199], v[148:151], v[40:43]
  v_mfma_f32_16x16x32_bf16 v[48:51], v[192:195], v[188:191], v[48:51]
  v_mfma_f32_16x16x32_bf16 v[48:51], v[196:199], v[204:207], v[48:51]
  v_mfma_f32_16x16x32_bf16 v[56:59], v[192:195], v[184:187], v[56:59]
  v_mfma_f32_16x16x32_bf16 v[56:59], v[196:199], v[216:219], v[56:59]
  s_waitcnt lgkmcnt(2)
  v_mfma_f32_16x16x32_bf16 v[36:39], v[200:203], v[180:183], v[36:39]
  ds_read_b128 v[192:195], v160 offset:18432
  v_mfma_f32_16x16x32_bf16 v[36:39], v[132:135], v[128:131], v[36:39]
  ds_read_b128 v[196:199], v161 offset:18432
  v_mfma_f32_16x16x32_bf16 v[44:47], v[200:203], v[144:147], v[44:47]
  v_mfma_f32_16x16x32_bf16 v[44:47], v[132:135], v[148:151], v[44:47]
  v_mfma_f32_16x16x32_bf16 v[52:55], v[200:203], v[188:191], v[52:55]
  v_mfma_f32_16x16x32_bf16 v[52:55], v[132:135], v[204:207], v[52:55]
  v_mfma_f32_16x16x32_bf16 v[60:63], v[200:203], v[184:187], v[60:63]
  v_mfma_f32_16x16x32_bf16 v[60:63], v[132:135], v[216:219], v[60:63]
  s_lshl_b32 s52, s90, 3
  s_lshl_b32 s53, s94, 1
  s_add_u32 s52, s52, s53
  s_and_b32 s53, s52, 127
  s_lshl_b32 s53, s53, 10
  s_lshl_b32 s54, s94, 15
  s_cmp_lt_u32 s52, 128
  s_cselect_b32 s52, s64, s65
  s_sub_u32 s52, s52, s54
  s_add_u32 s52, s52, s53
  buffer_load_dwordx4 v[232:235], v253, s[44:47], 0 offen
  buffer_load_dwordx4 v[224:227], v253, s[16:19], s52 offen offset:0
  buffer_load_dwordx4 v[228:231], v253, s[16:19], s52 offen offset:1024
  s_waitcnt lgkmcnt(2)
  v_mfma_f32_16x16x32_bf16 v[64:67], v[220:223], v[180:183], v[64:67]
  ds_read_b128 v[200:203], v160 offset:20480
  v_mfma_f32_16x16x32_bf16 v[64:67], v[176:179], v[128:131], v[64:67]
  ds_read_b128 v[132:135], v161 offset:20480
  v_mfma_f32_16x16x32_bf16 v[72:75], v[220:223], v[144:147], v[72:75]
  v_mfma_f32_16x16x32_bf16 v[72:75], v[176:179], v[148:151], v[72:75]
  v_mfma_f32_16x16x32_bf16 v[80:83], v[220:223], v[188:191], v[80:83]
  v_mfma_f32_16x16x32_bf16 v[80:83], v[176:179], v[204:207], v[80:83]
  v_mfma_f32_16x16x32_bf16 v[88:91], v[220:223], v[184:187], v[88:91]
  v_mfma_f32_16x16x32_bf16 v[88:91], v[176:179], v[216:219], v[88:91]
  s_waitcnt lgkmcnt(2)
  v_mfma_f32_16x16x32_bf16 v[68:71], v[192:195], v[180:183], v[68:71]
  ds_read_b128 v[220:223], v160 offset:22528
  v_mfma_f32_16x16x32_bf16 v[68:71], v[196:199], v[128:131], v[68:71]
  ds_read_b128 v[176:179], v161 offset:22528
  v_add_u32 v168, 65536, v168
  v_mfma_f32_16x16x32_bf16 v[76:79], v[192:195], v[144:147], v[76:79]
  v_add_u32 v169, 65536, v169
  v_add_u32 v170, 65536, v170
  v_mfma_f32_16x16x32_bf16 v[76:79], v[196:199], v[148:151], v[76:79]
  v_add_u32 v171, 65536, v171
  v_mfma_f32_16x16x32_bf16 v[84:87], v[192:195], v[188:191], v[84:87]
  v_mfma_f32_16x16x32_bf16 v[84:87], v[196:199], v[204:207], v[84:87]
  v_mfma_f32_16x16x32_bf16 v[92:95], v[192:195], v[184:187], v[92:95]
  v_mfma_f32_16x16x32_bf16 v[92:95], v[196:199], v[216:219], v[92:95]
  s_waitcnt lgkmcnt(0)
  s_barrier
  ds_read_b64_tr_b16 v[192:193], v168 offset:2048
  ds_read_b64_tr_b16 v[194:195], v168 offset:3072
  ds_read_b128 v[196:199], v160 offset:32768
  ds_read_b64_tr_b16 v[136:137], v168 offset:18432
  ds_read_b64_tr_b16 v[138:139], v168 offset:19456
  ds_read_b128 v[140:143], v161 offset:32768
  v_mfma_f32_16x16x32_bf16 v[96:99], v[200:203], v[180:183], v[96:99]
  ds_read_b64_tr_b16 v[152:153], v169 offset:2048
  ds_read_b64_tr_b16 v[154:155], v169 offset:3072
  v_mfma_f32_16x16x32_bf16 v[96:99], v[132:135], v[128:131], v[96:99]
  ds_read_b64_tr_b16 v[156:157], v169 offset:18432
  ds_read_b64_tr_b16 v[158:159], v169 offset:19456
  v_mfma_f32_16x16x32_bf16 v[104:107], v[200:203], v[144:147], v[104:107]
  v_mfma_f32_16x16x32_bf16 v[104:107], v[132:135], v[148:151], v[104:107]
  v_mfma_f32_16x16x32_bf16 v[112:115], v[200:203], v[188:191], v[112:115]
  v_mfma_f32_16x16x32_bf16 v[112:115], v[132:135], v[204:207], v[112:115]
  v_mfma_f32_16x16x32_bf16 v[120:123], v[200:203], v[184:187], v[120:123]
  ds_read_b64_tr_b16 v[200:201], v170 offset:2048
  ds_read_b64_tr_b16 v[202:203], v170 offset:3072
  v_mfma_f32_16x16x32_bf16 v[120:123], v[132:135], v[216:219], v[120:123]
  ds_read_b64_tr_b16 v[132:133], v170 offset:18432
  ds_read_b64_tr_b16 v[134:135], v170 offset:19456
  v_mfma_f32_16x16x32_bf16 v[100:103], v[220:223], v[180:183], v[100:103]
  ds_read_b64_tr_b16 v[180:181], v171 offset:2048
  v_mfma_f32_16x16x32_bf16 v[100:103], v[176:179], v[128:131], v[100:103]
  v_mfma_f32_16x16x32_bf16 v[108:111], v[220:223], v[144:147], v[108:111]
  v_mfma_f32_16x16x32_bf16 v[108:111], v[176:179], v[148:151], v[108:111]
  v_mfma_f32_16x16x32_bf16 v[116:119], v[220:223], v[188:191], v[116:119]
  v_mfma_f32_16x16x32_bf16 v[116:119], v[176:179], v[204:207], v[116:119]
  v_mfma_f32_16x16x32_bf16 v[124:127], v[220:223], v[184:187], v[124:127]
  v_mfma_f32_16x16x32_bf16 v[124:127], v[176:179], v[216:219], v[124:127]
  s_waitcnt lgkmcnt(3)
  v_mfma_f32_16x16x32_bf16 v[0:3], v[196:199], v[192:195], v[0:3]
  ds_read_b64_tr_b16 v[182:183], v171 offset:3072
  ds_read_b64_tr_b16 v[216:217], v171 offset:18432
  v_mfma_f32_16x16x32_bf16 v[0:3], v[140:143], v[136:139], v[0:3]
  ds_read_b64_tr_b16 v[218:219], v171 offset:19456
  ds_read_b128 v[220:223], v160 offset:34816
  v_mfma_f32_16x16x32_bf16 v[8:11], v[196:199], v[152:155], v[8:11]
  ds_read_b128 v[176:179], v161 offset:34816
  ds_read_b128 v[184:187], v160 offset:36864
  v_mfma_f32_16x16x32_bf16 v[8:11], v[140:143], v[156:159], v[8:11]
  ds_read_b128 v[188:191], v161 offset:36864
  v_mfma_f32_16x16x32_bf16 v[16:19], v[196:199], v[200:203], v[16:19]
  s_waitcnt lgkmcnt(7)
  v_mfma_f32_16x16x32_bf16 v[16:19], v[140:143], v[132:135], v[16:19]
  s_waitcnt lgkmcnt(6)
  v_mfma_f32_16x16x32_bf16 v[24:27], v[196:199], v[180:183], v[24:27]
  s_waitcnt lgkmcnt(4)
  v_mfma_f32_16x16x32_bf16 v[24:27], v[140:143], v[216:219], v[24:27]
  s_waitcnt lgkmcnt(3)
  v_mfma_f32_16x16x32_bf16 v[4:7], v[220:223], v[192:195], v[4:7]
  ds_read_b128 v[196:199], v160 offset:38912
  s_waitcnt lgkmcnt(3)
  v_mfma_f32_16x16x32_bf16 v[4:7], v[176:179], v[136:139], v[4:7]
  ds_read_b128 v[204:207], v161 offset:38912
  v_mfma_f32_16x16x32_bf16 v[12:15], v[220:223], v[152:155], v[12:15]
  v_mfma_f32_16x16x32_bf16 v[12:15], v[176:179], v[156:159], v[12:15]
  v_mfma_f32_16x16x32_bf16 v[20:23], v[220:223], v[200:203], v[20:23]
  v_mfma_f32_16x16x32_bf16 v[20:23], v[176:179], v[132:135], v[20:23]
  v_mfma_f32_16x16x32_bf16 v[28:31], v[220:223], v[180:183], v[28:31]
  v_mfma_f32_16x16x32_bf16 v[28:31], v[176:179], v[216:219], v[28:31]
  s_waitcnt vmcnt(0)
  s_cmp_lg_u32 s94, 1
  s_cbranch_scc1 L_notch_38
  v_bfe_u32 v250, v254, 3, 2
  v_lshlrev_b32 v250, 13, v250
  v_and_b32 v251, 7, v254
  v_lshl_add_u32 v250, v251, 7, v250
  s_and_b32 s54, s96, 15
  s_lshl_b32 s52, s54, 15
  s_lshr_b32 s53, s90, 2
  s_lshl_b32 s53, s53, 10
  s_add_u32 s52, s52, s53
  s_add_u32 s52, s52, 1572864
  s_mov_b32 exec_hi, 0
  s_bitcmp1_b32 s96, 4
  s_cbranch_scc1 L_t2a_39
  buffer_load_dword v252, v250, s[20:23], s52 offen
  s_branch L_t2e_40
L_t2a_39:
  v_and_b32 v250, 3, v254
  v_mul_u32_u24 v250, 3072, v250
  v_lshrrev_b32 v251, 2, v254
  v_min_u32 v251, 2, v251
  v_lshl_add_u32 v250, v251, 10, v250
  s_mul_i32 s52, s54, 12288
  s_lshr_b32 s53, s53, 3
  s_add_u32 s52, s52, s53
  s_add_u32 s52, s52, 589824
  s_mov_b32 exec_lo, 0xfff
  buffer_load_dword v252, v250, s[24:27], s52 offen
L_t2e_40:
  s_mov_b64 exec, -1
L_notch_38:
  s_cmp_lg_u32 s94, 2
  s_cbranch_scc1 L_notch_41
  v_lshlrev_b32 v250, 10, v254
  s_and_b32 s52, s96, 31
  s_lshl_b32 s52, s52, 16
  buffer_load_dword v252, v250, s[16:19], s52 offen offset:384
L_notch_41:
  s_cmp_lg_u32 s94, 3
  s_cbranch_scc1 L_notch_42
  v_bfe_u32 v250, v254, 3, 2
  v_lshlrev_b32 v250, 13, v250
  v_and_b32 v251, 7, v254
  v_lshl_add_u32 v250, v251, 7, v250
  s_and_b32 s54, s96, 15
  s_lshl_b32 s52, s54, 15
  s_lshr_b32 s53, s90, 2
  s_lshl_b32 s53, s53, 10
  s_add_u32 s52, s52, s53
  s_add_u32 s52, s52, 2097152
  s_mov_b32 exec_hi, 0
  s_bitcmp1_b32 s96, 4
  s_cbranch_scc1 L_t2a_43
  buffer_load_dword v252, v250, s[20:23], s52 offen
  s_branch L_t2e_44
L_t2a_43:
  v_and_b32 v250, 3, v254
  v_mul_u32_u24 v250, 3072, v250
  v_lshrrev_b32 v251, 2, v254
  v_min_u32 v251, 2, v251
  v_lshl_add_u32 v250, v251, 10, v250
  s_mul_i32 s52, s54, 12288
  s_lshr_b32 s53, s53, 3
  s_add_u32 s52, s52, s53
  s_add_u32 s52, s52, 786432
  s_mov_b32 exec_lo, 0xfff
  buffer_load_dword v252, v250, s[24:27], s52 offen
L_t2e_44:
  s_mov_b64 exec, -1
L_notch_42:
  s_cmp_lg_u32 s94, 0
  s_cbranch_scc1 L_notch_45
  v_lshlrev_b32 v250, 10, v254
  s_and_b32 s52, s96, 31
  s_lshl_b32 s52, s52, 16
  buffer_load_dword v252, v250, s[16:19], s52 offen offset:512
L_notch_45:
  s_waitcnt lgkmcnt(2)
  v_mfma_f32_16x16x32_bf16 v[32:35], v[184:187], v[192:195], v[32:35]
  ds_read_b128 v[220:223], v160 offset:49152
  v_lshlrev_b32 v236, 16, v232
  v_and_b32 v237, 0xffff0000, v232
  v_lshlrev_b32 v238, 16, v233
  v_mfma_f32_16x16x32_bf16 v[32:35], v[188:191], v[136:139], v[32:35]
  ds_read_b128 v[176:179], v161 offset:49152
  v_and_b32 v239, 0xffff0000, v233
  v_lshlrev_b32 v240, 16, v234
  v_mfma_f32_16x16x32_bf16 v[40:43], v[184:187], v[152:155], v[40:43]
  v_and_b32 v241, 0xffff0000, v234
  v_lshlrev_b32 v242, 16, v235
  v_and_b32 v243, 0xffff0000, v235
  v_mfma_f32_16x16x32_bf16 v[40:43], v[188:191], v[156:159], v[40:43]
  v_lshlrev_b32 v244, 16, v224
  v_and_b32 v245, 0xffff0000, v224
  v_mfma_f32_16x16x32_bf16 v[48:51], v[184:187], v[200:203], v[48:51]
  v_lshlrev_b32 v246, 16, v228
  v_and_b32 v247, 0xffff0000, v228
  v_mul_f32 v208, v244, v236
  v_mfma_f32_16x16x32_bf16 v[48:51], v[188:191], v[132:135], v[48:51]
  v_mul_f32 v209, v246, v236
  v_fmac_f32 v208, v245, v237
  v_mfma_f32_16x16x32_bf16 v[56:59], v[184:187], v[180:183], v[56:59]
  v_fmac_f32 v209, v247, v237
  v_lshlrev_b32 v244, 16, v225
  v_and_b32 v245, 0xffff0000, v225
  v_mfma_f32_16x16x32_bf16 v[56:59], v[188:191], v[216:219], v[56:59]
  v_lshlrev_b32 v246, 16, v229
  v_and_b32 v247, 0xffff0000, v229
  s_waitcnt lgkmcnt(2)
  v_mfma_f32_16x16x32_bf16 v[36:39], v[196:199], v[192:195], v[36:39]
  ds_read_b128 v[184:187], v160 offset:51200
  v_fmac_f32 v208, v244, v238
  v_fmac_f32 v209, v246, v238
  v_fmac_f32 v208, v245, v239
  v_mfma_f32_16x16x32_bf16 v[36:39], v[204:207], v[136:139], v[36:39]
  ds_read_b128 v[188:191], v161 offset:51200
  v_fmac_f32 v209, v247, v239
  v_lshlrev_b32 v244, 16, v226
  v_mfma_f32_16x16x32_bf16 v[44:47], v[196:199], v[152:155], v[44:47]
  v_and_b32 v245, 0xffff0000, v226
  v_lshlrev_b32 v246, 16, v230
  v_and_b32 v247, 0xffff0000, v230
  v_mfma_f32_16x16x32_bf16 v[44:47], v[204:207], v[156:159], v[44:47]
  v_fmac_f32 v208, v244, v240
  v_fmac_f32 v209, v246, v240
  v_mfma_f32_16x16x32_bf16 v[52:55], v[196:199], v[200:203], v[52:55]
  v_fmac_f32 v208, v245, v241
  v_fmac_f32 v209, v247, v241
  v_lshlrev_b32 v244, 16, v227
  v_mfma_f32_16x16x32_bf16 v[52:55], v[204:207], v[132:135], v[52:55]
  v_and_b32 v245, 0xffff0000, v227
  v_lshlrev_b32 v246, 16, v231
  v_mfma_f32_16x16x32_bf16 v[60:63], v[196:199], v[180:183], v[60:63]
  v_and_b32 v247, 0xffff0000, v231
  v_fmac_f32 v208, v244, v242
  v_fmac_f32 v209, v246, v242
  v_mfma_f32_16x16x32_bf16 v[60:63], v[204:207], v[216:219], v[60:63]
  v_fmac_f32 v208, v245, v243
  v_fmac_f32 v209, v247, v243
  s_waitcnt lgkmcnt(2)
  v_mfma_f32_16x16x32_bf16 v[64:67], v[220:223], v[192:195], v[64:67]
  ds_read_b128 v[196:199], v160 offset:53248
  v_add_f32_dpp v208, v208, v208 row_shr:1 row_mask:0xf bank_mask:0xf bound_ctrl:0
  v_add_f32_dpp v209, v209, v209 row_shr:1 row_mask:0xf bank_mask:0xf bound_ctrl:0
  v_mfma_f32_16x16x32_bf16 v[64:67], v[176:179], v[136:139], v[64:67]
  ds_read_b128 v[204:207], v161 offset:53248
  s_nop 0
  v_add_f32_dpp v208, v208, v208 row_shr:2 row_mask:0xf bank_mask:0xf bound_ctrl:0
  v_mfma_f32_16x16x32_bf16 v[72:75], v[220:223], v[152:155], v[72:75]
  v_add_f32_dpp v209, v209, v209 row_shr:2 row_mask:0xf bank_mask:0xf bound_ctrl:0
  s_nop 0
  v_mfma_f32_16x16x32_bf16 v[72:75], v[176:179], v[156:159], v[72:75]
  v_add_f32_dpp v208, v208, v208 row_shr:4 row_mask:0xf bank_mask:0xf bound_ctrl:0
  v_mfma_f32_16x16x32_bf16 v[80:83], v[220:223], v[200:203], v[80:83]
  v_add_f32_dpp v209, v209, v209 row_shr:4 row_mask:0xf bank_mask:0xf bound_ctrl:0
  s_nop 0
  v_mfma_f32_16x16x32_bf16 v[80:83], v[176:179], v[132:135], v[80:83]
  v_add_f32_dpp v208, v208, v208 row_shr:8 row_mask:0xf bank_mask:0xf bound_ctrl:0
  v_add_f32_dpp v209, v209, v209 row_shr:8 row_mask:0xf bank_mask:0xf bound_ctrl:0
  v_mfma_f32_16x16x32_bf16 v[88:91], v[220:223], v[180:183], v[88:91]
  s_nop 0
  v_add_f32_dpp v208, v208, v208 row_bcast:15 row_mask:0xa bank_mask:0xf
  v_mfma_f32_16x16x32_bf16 v[88:91], v[176:179], v[216:219], v[88:91]
  v_add_f32_dpp v209, v209, v209 row_bcast:15 row_mask:0xa bank_mask:0xf
  s_waitcnt lgkmcnt(2)
  v_mfma_f32_16x16x32_bf16 v[68:71], v[184:187], v[192:195], v[68:71]
  ds_read_b128 v[220:223], v160 offset:55296
  s_nop 0
  v_add_f32_dpp v208, v208, v208 row_bcast:31 row_mask:0xc bank_mask:0xf
  v_mfma_f32_16x16x32_bf16 v[68:71], v[188:191], v[136:139], v[68:71]
  ds_read_b128 v[176:179], v161 offset:55296
  v_add_u32 v168, -65536, v168
  v_add_f32_dpp v209, v209, v209 row_bcast:31 row_mask:0xc bank_mask:0xf
  s_nop 0
  v_mfma_f32_16x16x32_bf16 v[76:79], v[184:187], v[152:155], v[76:79]
  v_add_u32 v169, -65536, v169
  v_add_u32 v170, -65536, v170
  v_mul_f32 v208, 0xbfb8aa3b, v208
  v_mul_f32 v209, 0xbfb8aa3b, v209
  v_mfma_f32_16x16x32_bf16 v[76:79], v[188:191], v[156:159], v[76:79]
  v_add_u32 v171, -65536, v171
  v_exp_f32 v208, v208
  v_mfma_f32_16x16x32_bf16 v[84:87], v[184:187], v[200:203], v[84:87]
  v_exp_f32 v209, v209
  v_add_f32 v208, 1.0, v208
  v_mfma_f32_16x16x32_bf16 v[84:87], v[188:191], v[132:135], v[84:87]
  v_add_f32 v209, 1.0, v209
  v_rcp_f32 v208, v208
  v_mfma_f32_16x16x32_bf16 v[92:95], v[184:187], v[180:183], v[92:95]
  v_rcp_f32 v209, v209
  v_add_f32 v208, 1.0, v208
  v_mfma_f32_16x16x32_bf16 v[92:95], v[188:191], v[216:219], v[92:95]
  v_add_f32 v209, 1.0, v209
  v_mov_b32 v244, 0
  s_lshl_b32 s52, s96, 7
  s_lshl_b32 s53, s94, 3
  s_add_u32 s52, s52, s53
  s_add_u32 s52, s52, 60817504
  s_mov_b32 exec_lo, 0
  s_mov_b32 exec_hi, 0x80000000
  buffer_store_dwordx2 v[208:209], v244, s[28:31], s52 offen sc1
  s_mov_b64 exec, -1
  s_waitcnt lgkmcnt(0)
  s_barrier
  ds_read_b64_tr_b16 v[184:185], v168 offset:2048
  ds_read_b64_tr_b16 v[186:187], v168 offset:3072
  ds_read_b128 v[188:191], v160 offset:0
  ds_read_b64_tr_b16 v[128:129], v168 offset:18432
  ds_read_b64_tr_b16 v[130:131], v168 offset:19456
  ds_read_b128 v[140:143], v161 offset:0
  v_mfma_f32_16x16x32_bf16 v[96:99], v[196:199], v[192:195], v[96:99]
  ds_read_b64_tr_b16 v[144:145], v169 offset:2048
  ds_read_b64_tr_b16 v[146:147], v169 offset:3072
  v_mfma_f32_16x16x32_bf16 v[96:99], v[204:207], v[136:139], v[96:99]
  ds_read_b64_tr_b16 v[148:149], v169 offset:18432
  ds_read_b64_tr_b16 v[150:151], v169 offset:19456
  v_mfma_f32_16x16x32_bf16 v[104:107], v[196:199], v[152:155], v[104:107]
  v_mfma_f32_16x16x32_bf16 v[104:107], v[204:207], v[156:159], v[104:107]
  v_mfma_f32_16x16x32_bf16 v[112:115], v[196:199], v[200:203], v[112:115]
  v_mfma_f32_16x16x32_bf16 v[112:115], v[204:207], v[132:135], v[112:115]
  v_mfma_f32_16x16x32_bf16 v[120:123], v[196:199], v[180:183], v[120:123]
  ds_read_b64_tr_b16 v[196:197], v170 offset:2048
  ds_read_b64_tr_b16 v[198:199], v170 offset:3072
  v_mfma_f32_16x16x32_bf16 v[120:123], v[204:207], v[216:219], v[120:123]
  ds_read_b64_tr_b16 v[204:205], v170 offset:18432
  ds_read_b64_tr_b16 v[206:207], v170 offset:19456
  v_mfma_f32_16x16x32_bf16 v[100:103], v[220:223], v[192:195], v[100:103]
  ds_read_b64_tr_b16 v[192:193], v171 offset:2048
  v_mfma_f32_16x16x32_bf16 v[100:103], v[176:179], v[136:139], v[100:103]
  v_mfma_f32_16x16x32_bf16 v[108:111], v[220:223], v[152:155], v[108:111]
  v_mfma_f32_16x16x32_bf16 v[108:111], v[176:179], v[156:159], v[108:111]
  v_mfma_f32_16x16x32_bf16 v[116:119], v[220:223], v[200:203], v[116:119]
  v_mfma_f32_16x16x32_bf16 v[116:119], v[176:179], v[132:135], v[116:119]
  v_mfma_f32_16x16x32_bf16 v[124:127], v[220:223], v[180:183], v[124:127]
  v_mfma_f32_16x16x32_bf16 v[124:127], v[176:179], v[216:219], v[124:127]
  s_waitcnt lgkmcnt(3)
  v_mfma_f32_16x16x32_bf16 v[0:3], v[188:191], v[184:187], v[0:3]
  ds_read_b64_tr_b16 v[194:195], v171 offset:3072
  ds_read_b64_tr_b16 v[216:217], v171 offset:18432
  v_mfma_f32_16x16x32_bf16 v[0:3], v[140:143], v[128:131], v[0:3]
  ds_read_b64_tr_b16 v[218:219], v171 offset:19456
  ds_read_b128 v[220:223], v160 offset:2048
  v_mfma_f32_16x16x32_bf16 v[8:11], v[188:191], v[144:147], v[8:11]
  ds_read_b128 v[176:179], v161 offset:2048
  ds_read_b128 v[180:183], v160 offset:4096
  v_mfma_f32_16x16x32_bf16 v[8:11], v[140:143], v[148:151], v[8:11]
  ds_read_b128 v[200:203], v161 offset:4096
  v_mfma_f32_16x16x32_bf16 v[16:19], v[188:191], v[196:199], v[16:19]
  s_waitcnt lgkmcnt(7)
  v_mfma_f32_16x16x32_bf16 v[16:19], v[140:143], v[204:207], v[16:19]
  s_waitcnt lgkmcnt(6)
  v_mfma_f32_16x16x32_bf16 v[24:27], v[188:191], v[192:195], v[24:27]
  s_waitcnt lgkmcnt(4)
  v_mfma_f32_16x16x32_bf16 v[24:27], v[140:143], v[216:219], v[24:27]
  s_waitcnt lgkmcnt(3)
  v_mfma_f32_16x16x32_bf16 v[4:7], v[220:223], v[184:187], v[4:7]
  ds_read_b128 v[188:191], v160 offset:6144
  s_waitcnt lgkmcnt(3)
  v_mfma_f32_16x16x32_bf16 v[4:7], v[176:179], v[128:131], v[4:7]
  ds_read_b128 v[132:135], v161 offset:6144
  v_mfma_f32_16x16x32_bf16 v[12:15], v[220:223], v[144:147], v[12:15]
  v_mfma_f32_16x16x32_bf16 v[12:15], v[176:179], v[148:151], v[12:15]
  v_mfma_f32_16x16x32_bf16 v[20:23], v[220:223], v[196:199], v[20:23]
  v_mfma_f32_16x16x32_bf16 v[20:23], v[176:179], v[204:207], v[20:23]
  v_mfma_f32_16x16x32_bf16 v[28:31], v[220:223], v[192:195], v[28:31]
  v_mfma_f32_16x16x32_bf16 v[28:31], v[176:179], v[216:219], v[28:31]
  s_cmp_lg_u32 s94, 2
  s_cbranch_scc1 L_notch_46
  v_bfe_u32 v250, v254, 3, 2
  v_lshlrev_b32 v250, 13, v250
  v_and_b32 v251, 7, v254
  v_lshl_add_u32 v250, v251, 7, v250
  s_and_b32 s54, s96, 15
  s_lshl_b32 s52, s54, 15
  s_lshr_b32 s53, s90, 2
  s_lshl_b32 s53, s53, 10
  s_add_u32 s52, s52, s53
  s_add_u32 s52, s52, 2621440
  s_mov_b32 exec_hi, 0
  s_bitcmp1_b32 s96, 4
  s_cbranch_scc1 L_t2a_47
  buffer_load_dword v252, v250, s[20:23], s52 offen
  s_branch L_t2e_48
L_t2a_47:
  v_and_b32 v250, 3, v254
  v_mul_u32_u24 v250, 3072, v250
  v_lshrrev_b32 v251, 2, v254
  v_min_u32 v251, 2, v251
  v_lshl_add_u32 v250, v251, 10, v250
  s_mul_i32 s52, s54, 12288
  s_lshr_b32 s53, s53, 3
  s_add_u32 s52, s52, s53
  s_add_u32 s52, s52, 983040
  s_mov_b32 exec_lo, 0xfff
  buffer_load_dword v252, v250, s[24:27], s52 offen
L_t2e_48:
  s_mov_b64 exec, -1
L_notch_46:
  s_cmp_lg_u32 s94, 3
  s_cbranch_scc1 L_notch_49
  v_lshlrev_b32 v250, 10, v254
  s_and_b32 s52, s96, 31
  s_lshl_b32 s52, s52, 16
  buffer_load_dword v252, v250, s[16:19], s52 offen offset:640
L_notch_49:
  s_cmp_lg_u32 s94, 0
  s_cbranch_scc1 L_notch_50
  v_bfe_u32 v250, v254, 3, 2
  v_lshlrev_b32 v250, 13, v250
  v_and_b32 v251, 7, v254
  v_lshl_add_u32 v250, v251, 7, v250
  s_and_b32 s54, s96, 15
  s_lshl_b32 s52, s54, 15
  s_lshr_b32 s53, s90, 2
  s_lshl_b32 s53, s53, 10
  s_add_u32 s52, s52, s53
  s_add_u32 s52, s52, 3145728
  s_mov_b32 exec_hi, 0
  s_bitcmp1_b32 s96, 4
  s_cbranch_scc1 L_t2a_51
  buffer_load_dword v252, v250, s[20:23], s52 offen
  s_branch L_t2e_52
L_t2a_51:
  v_and_b32 v250, 3, v254
  v_mul_u32_u24 v250, 3072, v250
  v_lshrrev_b32 v251, 2, v254
  v_min_u32 v251, 2, v251
  v_lshl_add_u32 v250, v251, 10, v250
  s_mul_i32 s52, s54, 12288
  s_lshr_b32 s53, s53, 3
  s_add_u32 s52, s52, s53
  s_add_u32 s52, s52, 1179648
  s_mov_b32 exec_lo, 0xfff
  buffer_load_dword v252, v250, s[24:27], s52 offen
L_t2e_52:
  s_mov_b64 exec, -1
L_notch_50:
  s_cmp_lg_u32 s94, 1
  s_cbranch_scc1 L_notch_53
  v_lshlrev_b32 v250, 10, v254
  s_and_b32 s52, s96, 31
  s_lshl_b32 s52, s52, 16
  buffer_load_dword v252, v250, s[16:19], s52 offen offset:768
L_notch_53:
  s_waitcnt lgkmcnt(2)
  v_mfma_f32_16x16x32_bf16 v[32:35], v[180:183], v[184:187], v[32:35]
  ds_read_b128 v[220:223], v160 offset:16384
  v_mfma_f32_16x16x32_bf16 v[32:35], v[200:203], v[128:131], v[32:35]
  ds_read_b128 v[176:179], v161 offset:16384
  v_mfma_f32_16x16x32_bf16 v[40:43], v[180:183], v[144:147], v[40:43]
  v_mfma_f32_16x16x32_bf16 v[40:43], v[200:203], v[148:151], v[40:43]
  v_mfma_f32_16x16x32_bf16 v[48:51], v[180:183], v[196:199], v[48:51]
  v_mfma_f32_16x16x32_bf16 v[48:51], v[200:203], v[204:207], v[48:51]
  v_mfma_f32_16x16x32_bf16 v[56:59], v[180:183], v[192:195], v[56:59]
  v_mfma_f32_16x16x32_bf16 v[56:59], v[200:203], v[216:219], v[56:59]
  s_waitcnt lgkmcnt(2)
  v_mfma_f32_16x16x32_bf16 v[36:39], v[188:191], v[184:187], v[36:39]
  ds_read_b128 v[180:183], v160 offset:18432
  v_mfma_f32_16x16x32_bf16 v[36:39], v[132:135], v[128:131], v[36:39]
  ds_read_b128 v[200:203], v161 offset:18432
  v_mfma_f32_16x16x32_bf16 v[44:47], v[188:191], v[144:147], v[44:47]
  v_mfma_f32_16x16x32_bf16 v[44:47], v[132:135], v[148:151], v[44:47]
  v_mfma_f32_16x16x32_bf16 v[52:55], v[188:191], v[196:199], v[52:55]
  v_mfma_f32_16x16x32_bf16 v[52:55], v[132:135], v[204:207], v[52:55]
  v_mfma_f32_16x16x32_bf16 v[60:63], v[188:191], v[192:195], v[60:63]
  v_mfma_f32_16x16x32_bf16 v[60:63], v[132:135], v[216:219], v[60:63]
  s_waitcnt lgkmcnt(2)
  v_mfma_f32_16x16x32_bf16 v[64:67], v[220:223], v[184:187], v[64:67]
  ds_read_b128 v[188:191], v160 offset:20480
  v_mfma_f32_16x16x32_bf16 v[64:67], v[176:179], v[128:131], v[64:67]
  ds_read_b128 v[132:135], v161 offset:20480
  v_mfma_f32_16x16x32_bf16 v[72:75], v[220:223], v[144:147], v[72:75]
  v_mfma_f32_16x16x32_bf16 v[72:75], v[176:179], v[148:151], v[72:75]
  v_mfma_f32_16x16x32_bf16 v[80:83], v[220:223], v[196:199], v[80:83]
  v_mfma_f32_16x16x32_bf16 v[80:83], v[176:179], v[204:207], v[80:83]
  v_mfma_f32_16x16x32_bf16 v[88:91], v[220:223], v[192:195], v[88:91]
  v_mfma_f32_16x16x32_bf16 v[88:91], v[176:179], v[216:219], v[88:91]
  s_waitcnt lgkmcnt(2)
  v_mfma_f32_16x16x32_bf16 v[68:71], v[180:183], v[184:187], v[68:71]
  ds_read_b128 v[220:223], v160 offset:22528
  v_mfma_f32_16x16x32_bf16 v[68:71], v[200:203], v[128:131], v[68:71]
  ds_read_b128 v[176:179], v161 offset:22528
  v_mfma_f32_16x16x32_bf16 v[76:79], v[180:183], v[144:147], v[76:79]
  v_mfma_f32_16x16x32_bf16 v[76:79], v[200:203], v[148:151], v[76:79]
  v_mfma_f32_16x16x32_bf16 v[84:87], v[180:183], v[196:199], v[84:87]
  v_mfma_f32_16x16x32_bf16 v[84:87], v[200:203], v[204:207], v[84:87]
  v_mfma_f32_16x16x32_bf16 v[92:95], v[180:183], v[192:195], v[92:95]
  v_mfma_f32_16x16x32_bf16 v[92:95], v[200:203], v[216:219], v[92:95]
  s_waitcnt lgkmcnt(0)
  s_barrier
  ds_read_b64_tr_b16 v[200:201], v168 offset:34816
  ds_read_b64_tr_b16 v[202:203], v168 offset:35840
  ds_read_b128 v[180:183], v160 offset:53248
  ds_read_b64_tr_b16 v[136:137], v168 offset:51200
  ds_read_b64_tr_b16 v[138:139], v168 offset:52224
  ds_read_b128 v[140:143], v161 offset:53248
  v_mfma_f32_16x16x32_bf16 v[96:99], v[188:191], v[184:187], v[96:99]
  ds_read_b64_tr_b16 v[152:153], v169 offset:34816
  ds_read_b64_tr_b16 v[154:155], v169 offset:35840
  v_mfma_f32_16x16x32_bf16 v[96:99], v[132:135], v[128:131], v[96:99]
  ds_read_b64_tr_b16 v[156:157], v169 offset:51200
  ds_read_b64_tr_b16 v[158:159], v169 offset:52224
  v_mfma_f32_16x16x32_bf16 v[104:107], v[188:191], v[144:147], v[104:107]
  ds_read_b64_tr_b16 v[208:209], v170 offset:34816
  ds_read_b64_tr_b16 v[210:211], v170 offset:35840
  v_mfma_f32_16x16x32_bf16 v[104:107], v[132:135], v[148:151], v[104:107]
  ds_read_b64_tr_b16 v[212:213], v170 offset:51200
  ds_read_b64_tr_b16 v[214:215], v170 offset:52224
  v_mfma_f32_16x16x32_bf16 v[112:115], v[188:191], v[196:199], v[112:115]
  v_mfma_f32_16x16x32_bf16 v[112:115], v[132:135], v[204:207], v[112:115]
  v_mfma_f32_16x16x32_bf16 v[120:123], v[188:191], v[192:195], v[120:123]
  v_mfma_f32_16x16x32_bf16 v[120:123], v[132:135], v[216:219], v[120:123]
  ds_read_b64_tr_b16 v[132:133], v171 offset:34816
  v_mfma_f32_16x16x32_bf16 v[100:103], v[220:223], v[184:187], v[100:103]
  v_mfma_f32_16x16x32_bf16 v[100:103], v[176:179], v[128:131], v[100:103]
  v_mfma_f32_16x16x32_bf16 v[108:111], v[220:223], v[144:147], v[108:111]
  v_mfma_f32_16x16x32_bf16 v[108:111], v[176:179], v[148:151], v[108:111]
  v_mfma_f32_16x16x32_bf16 v[116:119], v[220:223], v[196:199], v[116:119]
  v_mfma_f32_16x16x32_bf16 v[116:119], v[176:179], v[204:207], v[116:119]
  v_mfma_f32_16x16x32_bf16 v[124:127], v[220:223], v[192:195], v[124:127]
  v_mfma_f32_16x16x32_bf16 v[124:127], v[176:179], v[216:219], v[124:127]
  s_waitcnt lgkmcnt(1)
  v_mfma_f32_16x16x32_bf16 v[96:99], v[180:183], v[200:203], v[96:99]
  ds_read_b64_tr_b16 v[134:135], v171 offset:35840
  ds_read_b64_tr_b16 v[204:205], v171 offset:51200
  v_mfma_f32_16x16x32_bf16 v[96:99], v[140:143], v[136:139], v[96:99]
  ds_read_b64_tr_b16 v[206:207], v171 offset:52224
  ds_read_b128 v[216:219], v160 offset:55296
  v_mfma_f32_16x16x32_bf16 v[104:107], v[180:183], v[152:155], v[104:107]
  ds_read_b128 v[220:223], v161 offset:55296
  ds_read_b128 v[176:179], v160 offset:49152
  v_mfma_f32_16x16x32_bf16 v[104:107], v[140:143], v[156:159], v[104:107]
  ds_read_b128 v[184:187], v161 offset:49152
  v_mfma_f32_16x16x32_bf16 v[112:115], v[180:183], v[208:211], v[112:115]
  v_mfma_f32_16x16x32_bf16 v[112:115], v[140:143], v[212:215], v[112:115]
  s_waitcnt lgkmcnt(6)
  v_mfma_f32_16x16x32_bf16 v[120:123], v[180:183], v[132:135], v[120:123]
  s_waitcnt lgkmcnt(4)
  v_mfma_f32_16x16x32_bf16 v[120:123], v[140:143], v[204:207], v[120:123]
  s_waitcnt lgkmcnt(3)
  v_mfma_f32_16x16x32_bf16 v[100:103], v[216:219], v[200:203], v[100:103]
  ds_read_b128 v[180:183], v160 offset:51200
  s_waitcnt lgkmcnt(3)
  v_mfma_f32_16x16x32_bf16 v[100:103], v[220:223], v[136:139], v[100:103]
  ds_read_b128 v[188:191], v161 offset:51200
  v_mfma_f32_16x16x32_bf16 v[108:111], v[216:219], v[152:155], v[108:111]
  v_mfma_f32_16x16x32_bf16 v[108:111], v[220:223], v[156:159], v[108:111]
  v_mfma_f32_16x16x32_bf16 v[116:119], v[216:219], v[208:211], v[116:119]
  v_mfma_f32_16x16x32_bf16 v[116:119], v[220:223], v[212:215], v[116:119]
  v_mfma_f32_16x16x32_bf16 v[124:127], v[216:219], v[132:135], v[124:127]
  v_mfma_f32_16x16x32_bf16 v[124:127], v[220:223], v[204:207], v[124:127]
  v_cvt_pk_bf16_f32 v232, v96, v97
  v_cvt_pk_bf16_f32 v233, v98, v99
  s_cmp_lg_u32 s94, 3
  s_cbranch_scc1 L_notch_54
  v_bfe_u32 v250, v254, 3, 2
  v_lshlrev_b32 v250, 13, v250
  v_and_b32 v251, 7, v254
  v_lshl_add_u32 v250, v251, 7, v250
  s_and_b32 s54, s96, 15
  s_lshl_b32 s52, s54, 15
  s_lshr_b32 s53, s90, 2
  s_lshl_b32 s53, s53, 10
  s_add_u32 s52, s52, s53
  s_add_u32 s52, s52, 3670016
  s_mov_b32 exec_hi, 0
  s_bitcmp1_b32 s96, 4
  s_cbranch_scc1 L_t2a_55
  buffer_load_dword v252, v250, s[20:23], s52 offen
  s_branch L_t2e_56
L_t2a_55:
  v_and_b32 v250, 3, v254
  v_mul_u32_u24 v250, 3072, v250
  v_lshrrev_b32 v251, 2, v254
  v_min_u32 v251, 2, v251
  v_lshl_add_u32 v250, v251, 10, v250
  s_mul_i32 s52, s54, 12288
  s_lshr_b32 s53, s53, 3
  s_add_u32 s52, s52, s53
  s_add_u32 s52, s52, 1376256
  s_mov_b32 exec_lo, 0xfff
  buffer_load_dword v252, v250, s[24:27], s52 offen
L_t2e_56:
  s_mov_b64 exec, -1
L_notch_54:
  s_cmp_lg_u32 s94, 0
  s_cbranch_scc1 L_notch_57
  v_lshlrev_b32 v250, 10, v254
  s_and_b32 s52, s96, 31
  s_lshl_b32 s52, s52, 16
  buffer_load_dword v252, v250, s[16:19], s52 offen offset:896
L_notch_57:
  s_waitcnt lgkmcnt(2)
  v_mfma_f32_16x16x32_bf16 v[64:67], v[176:179], v[200:203], v[64:67]
  ds_read_b128 v[192:195], v160 offset:32768
  v_cvt_pk_bf16_f32 v234, v100, v101
  v_cvt_pk_bf16_f32 v235, v102, v103
  v_mfma_f32_16x16x32_bf16 v[64:67], v[184:187], v[136:139], v[64:67]
  ds_read_b128 v[196:199], v161 offset:32768
  v_cvt_pk_bf16_f32 v236, v104, v105
  v_cvt_pk_bf16_f32 v237, v106, v107
  v_mfma_f32_16x16x32_bf16 v[72:75], v[176:179], v[152:155], v[72:75]
  v_cvt_pk_bf16_f32 v238, v108, v109
  v_cvt_pk_bf16_f32 v239, v110, v111
  v_mfma_f32_16x16x32_bf16 v[72:75], v[184:187], v[156:159], v[72:75]
  v_cvt_pk_bf16_f32 v240, v112, v113
  v_cvt_pk_bf16_f32 v241, v114, v115
  v_mfma_f32_16x16x32_bf16 v[80:83], v[176:179], v[208:211], v[80:83]
  v_cvt_pk_bf16_f32 v242, v116, v117
  v_cvt_pk_bf16_f32 v243, v118, v119
  v_mfma_f32_16x16x32_bf16 v[80:83], v[184:187], v[212:215], v[80:83]
  v_cvt_pk_bf16_f32 v244, v120, v121
  v_cvt_pk_bf16_f32 v245, v122, v123
  v_mfma_f32_16x16x32_bf16 v[88:91], v[176:179], v[132:135], v[88:91]
  v_cvt_pk_bf16_f32 v246, v124, v125
  v_cvt_pk_bf16_f32 v247, v126, v127
  v_mfma_f32_16x16x32_bf16 v[88:91], v[184:187], v[204:207], v[88:91]
  s_waitcnt lgkmcnt(2)
  v_mfma_f32_16x16x32_bf16 v[68:71], v[180:183], v[200:203], v[68:71]
  ds_read_b128 v[176:179], v160 offset:34816
  v_mfma_f32_16x16x32_bf16 v[68:71], v[188:191], v[136:139], v[68:71]
  ds_read_b128 v[184:187], v161 offset:34816
  v_mfma_f32_16x16x32_bf16 v[76:79], v[180:183], v[152:155], v[76:79]
  v_mfma_f32_16x16x32_bf16 v[76:79], v[188:191], v[156:159], v[76:79]
  v_mfma_f32_16x16x32_bf16 v[84:87], v[180:183], v[208:211], v[84:87]
  v_mfma_f32_16x16x32_bf16 v[84:87], v[188:191], v[212:215], v[84:87]
  v_mfma_f32_16x16x32_bf16 v[92:95], v[180:183], v[132:135], v[92:95]
  v_mfma_f32_16x16x32_bf16 v[92:95], v[188:191], v[204:207], v[92:95]
  v_cvt_pk_bf16_f32 v216, v64, v65
  v_cvt_pk_bf16_f32 v217, v66, v67
  s_waitcnt lgkmcnt(2)
  v_mfma_f32_16x16x32_bf16 v[0:3], v[192:195], v[200:203], v[0:3]
  ds_read_b128 v[96:99], v160 offset:36864
  v_cvt_pk_bf16_f32 v218, v68, v69
  v_cvt_pk_bf16_f32 v219, v70, v71
  v_mfma_f32_16x16x32_bf16 v[0:3], v[196:199], v[136:139], v[0:3]
  ds_read_b128 v[100:103], v161 offset:36864
  v_cvt_pk_bf16_f32 v220, v72, v73
  v_cvt_pk_bf16_f32 v221, v74, v75
  v_mfma_f32_16x16x32_bf16 v[8:11], v[192:195], v[152:155], v[8:11]
  v_cvt_pk_bf16_f32 v222, v76, v77
  v_cvt_pk_bf16_f32 v223, v78, v79
  v_mfma_f32_16x16x32_bf16 v[8:11], v[196:199], v[156:159], v[8:11]
  v_cvt_pk_bf16_f32 v224, v80, v81
  v_cvt_pk_bf16_f32 v225, v82, v83
  v_mfma_f32_16x16x32_bf16 v[16:19], v[192:195], v[208:211], v[16:19]
  v_cvt_pk_bf16_f32 v226, v84, v85
  v_cvt_pk_bf16_f32 v227, v86, v87
  v_mfma_f32_16x16x32_bf16 v[16:19], v[196:199], v[212:215], v[16:19]
  v_cvt_pk_bf16_f32 v228, v88, v89
  v_cvt_pk_bf16_f32 v229, v90, v91
  v_mfma_f32_16x16x32_bf16 v[24:27], v[192:195], v[132:135], v[24:27]
  v_cvt_pk_bf16_f32 v230, v92, v93
  v_cvt_pk_bf16_f32 v231, v94, v95
  v_mfma_f32_16x16x32_bf16 v[24:27], v[196:199], v[204:207], v[24:27]
  s_waitcnt lgkmcnt(2)
  v_mfma_f32_16x16x32_bf16 v[4:7], v[176:179], v[200:203], v[4:7]
  ds_read_b128 v[192:195], v160 offset:38912
  v_mfma_f32_16x16x32_bf16 v[4:7], v[184:187], v[136:139], v[4:7]
  ds_read_b128 v[104:107], v161 offset:38912
  v_add_u32 v160, s86, v160
  v_mfma_f32_16x16x32_bf16 v[12:15], v[176:179], v[152:155], v[12:15]
  v_add_u32 v161, s86, v161
  s_and_b32 s55, s92, 1
  v_mfma_f32_16x16x32_bf16 v[12:15], v[184:187], v[156:159], v[12:15]
  s_lshl_b32 s55, s55, 7
  v_xor_b32 v168, s55, v168
  v_mfma_f32_16x16x32_bf16 v[20:23], v[176:179], v[208:211], v[20:23]
  v_xor_b32 v169, s55, v169
  v_xor_b32 v170, s55, v170
  v_mfma_f32_16x16x32_bf16 v[20:23], v[184:187], v[212:215], v[20:23]
  v_xor_b32 v171, s55, v171
  v_xor_b32 v172, s55, v172
  v_mfma_f32_16x16x32_bf16 v[28:31], v[176:179], v[132:135], v[28:31]
  v_xor_b32 v173, s55, v173
  v_xor_b32 v174, s55, v174
  v_mfma_f32_16x16x32_bf16 v[28:31], v[184:187], v[204:207], v[28:31]
  v_xor_b32 v175, s55, v175
  v_add_u32 v168, 65536, v168
  v_cvt_pk_bf16_f32 v176, v0, v1
  v_cvt_pk_bf16_f32 v177, v2, v3
  s_waitcnt lgkmcnt(0)
  s_barrier
  v_add_u32 v169, 65536, v169
  v_add_u32 v170, 65536, v170
  v_add_u32 v171, 65536, v171
  v_add_u32 v172, 65536, v172
  v_add_u32 v173, 65536, v173
  v_add_u32 v174, 65536, v174
  v_mfma_f32_16x16x32_bf16 v[32:35], v[96:99], v[200:203], v[32:35]
  v_add_u32 v175, 65536, v175
  v_add_u32 v162, 65536, v162
  v_cvt_pk_bf16_f32 v178, v4, v5
  v_cvt_pk_bf16_f32 v179, v6, v7
  v_mfma_f32_16x16x32_bf16 v[32:35], v[100:103], v[136:139], v[32:35]
  v_add_u32 v163, 65536, v163
  ds_read_b128 v[108:111], v160 offset:0
  v_cvt_pk_bf16_f32 v180, v8, v9
  v_cvt_pk_bf16_f32 v181, v10, v11
  v_mfma_f32_16x16x32_bf16 v[40:43], v[96:99], v[152:155], v[40:43]
  ds_read_b64_tr_b16 v[112:113], v168 offset:0
  ds_read_b64_tr_b16 v[114:115], v168 offset:1024
  v_cvt_pk_bf16_f32 v182, v12, v13
  v_cvt_pk_bf16_f32 v183, v14, v15
  v_mfma_f32_16x16x32_bf16 v[40:43], v[100:103], v[156:159], v[40:43]
  ds_read_b128 v[116:119], v161 offset:0
  ds_read_b64_tr_b16 v[120:121], v168 offset:16384
  v_cvt_pk_bf16_f32 v184, v16, v17
  v_cvt_pk_bf16_f32 v185, v18, v19
  v_mfma_f32_16x16x32_bf16 v[48:51], v[96:99], v[208:211], v[48:51]
  ds_read_b64_tr_b16 v[122:123], v168 offset:17408
  ds_read_b128 v[124:127], v160 offset:2048
  v_cvt_pk_bf16_f32 v186, v20, v21
  v_cvt_pk_bf16_f32 v187, v22, v23
  v_mfma_f32_16x16x32_bf16 v[48:51], v[100:103], v[212:215], v[48:51]
  ds_read_b128 v[128:131], v161 offset:2048
  ds_read_b64_tr_b16 v[140:141], v169 offset:0
  v_cvt_pk_bf16_f32 v188, v24, v25
  v_cvt_pk_bf16_f32 v189, v26, v27
  v_mfma_f32_16x16x32_bf16 v[56:59], v[96:99], v[132:135], v[56:59]
  ds_read_b64_tr_b16 v[142:143], v169 offset:1024
  ds_read_b64_tr_b16 v[96:97], v169 offset:16384
  v_cvt_pk_bf16_f32 v190, v28, v29
  v_cvt_pk_bf16_f32 v191, v30, v31
  v_mfma_f32_16x16x32_bf16 v[56:59], v[100:103], v[204:207], v[56:59]
  ds_read_b64_tr_b16 v[98:99], v169 offset:17408
  ds_read_b128 v[100:103], v164 offset:0
  v_mfma_f32_16x16x32_bf16 v[36:39], v[192:195], v[200:203], v[36:39]
  ds_read_b64_tr_b16 v[144:145], v162 offset:2048
  ds_read_b64_tr_b16 v[146:147], v162 offset:3072
  v_mfma_f32_16x16x32_bf16 v[36:39], v[104:107], v[136:139], v[36:39]
  v_mfma_f32_16x16x32_bf16 v[44:47], v[192:195], v[152:155], v[44:47]
  v_mfma_f32_16x16x32_bf16 v[44:47], v[104:107], v[156:159], v[44:47]
  v_mfma_f32_16x16x32_bf16 v[52:55], v[192:195], v[208:211], v[52:55]
  v_mfma_f32_16x16x32_bf16 v[52:55], v[104:107], v[212:215], v[52:55]
  v_mfma_f32_16x16x32_bf16 v[60:63], v[192:195], v[132:135], v[60:63]
  v_mfma_f32_16x16x32_bf16 v[60:63], v[104:107], v[204:207], v[60:63]
  v_cvt_pk_bf16_f32 v192, v32, v33
  v_cvt_pk_bf16_f32 v193, v34, v35
  v_cvt_pk_bf16_f32 v194, v36, v37
  v_cvt_pk_bf16_f32 v195, v38, v39
  s_waitcnt lgkmcnt(4)
  v_mfma_f32_16x16x32_bf16 v[0:3], v[112:115], v[108:111], 0
  ds_read_b64_tr_b16 v[104:105], v163 offset:2048
  ds_read_b64_tr_b16 v[106:107], v163 offset:3072
  v_cvt_pk_bf16_f32 v196, v40, v41
  v_cvt_pk_bf16_f32 v197, v42, v43
  v_cvt_pk_bf16_f32 v198, v44, v45
  v_cvt_pk_bf16_f32 v199, v46, v47
  v_mfma_f32_16x16x32_bf16 v[0:3], v[120:123], v[116:119], v[0:3]
  ds_read_b64_tr_b16 v[132:133], v170 offset:0
  ds_read_b64_tr_b16 v[134:135], v170 offset:1024
  v_mfma_f32_16x16x32_bf16 v[32:35], v[112:115], v[124:127], 0
  ds_read_b64_tr_b16 v[112:113], v170 offset:16384
  ds_read_b64_tr_b16 v[114:115], v170 offset:17408
  v_mfma_f32_16x16x32_bf16 v[32:35], v[120:123], v[128:131], v[32:35]
  ds_read_b64_tr_b16 v[120:121], v171 offset:0
  ds_read_b64_tr_b16 v[122:123], v171 offset:1024
  v_cvt_pk_bf16_f32 v200, v48, v49
  v_cvt_pk_bf16_f32 v201, v50, v51
  v_cvt_pk_bf16_f32 v202, v52, v53
  v_cvt_pk_bf16_f32 v203, v54, v55
  v_mfma_f32_16x16x32_bf16 v[4:7], v[140:143], v[108:111], 0
  ds_read_b64_tr_b16 v[136:137], v171 offset:16384
  ds_read_b64_tr_b16 v[138:139], v171 offset:17408
  v_cvt_pk_bf16_f32 v204, v56, v57
  v_cvt_pk_bf16_f32 v205, v58, v59
  v_cvt_pk_bf16_f32 v206, v60, v61
  v_cvt_pk_bf16_f32 v207, v62, v63
  s_waitcnt lgkmcnt(10)
  v_mfma_f32_16x16x32_bf16 v[4:7], v[96:99], v[116:119], v[4:7]
  ds_read_b128 v[148:151], v165 offset:0
  ds_read_b64_tr_b16 v[152:153], v162 offset:10240
  v_mfma_f32_16x16x32_bf16 v[36:39], v[140:143], v[124:127], 0
  ds_read_b64_tr_b16 v[154:155], v162 offset:11264
  ds_read_b64_tr_b16 v[140:141], v163 offset:10240
  v_mfma_f32_16x16x32_bf16 v[36:39], v[96:99], v[128:131], v[36:39]
  ds_read_b64_tr_b16 v[142:143], v163 offset:11264
  v_mfma_f32_32x32x16_bf16 v[64:79], v[100:103], v[144:147], 0
  s_waitcnt lgkmcnt(13)
  v_mfma_f32_32x32x16_bf16 v[80:95], v[100:103], v[104:107], 0
  ds_read_b64_tr_b16 v[96:97], v172 offset:0
  ds_read_b64_tr_b16 v[98:99], v172 offset:1024
  s_waitcnt lgkmcnt(13)
  v_mfma_f32_16x16x32_bf16 v[8:11], v[132:135], v[108:111], 0
  ds_read_b64_tr_b16 v[100:101], v172 offset:16384
  ds_read_b64_tr_b16 v[102:103], v172 offset:17408
  s_waitcnt lgkmcnt(13)
  v_mfma_f32_16x16x32_bf16 v[8:11], v[112:115], v[116:119], v[8:11]
  ds_read_b64_tr_b16 v[104:105], v173 offset:0
  ds_read_b64_tr_b16 v[106:107], v173 offset:1024
  v_mfma_f32_16x16x32_bf16 v[40:43], v[132:135], v[124:127], 0
  v_mfma_f32_16x16x32_bf16 v[40:43], v[112:115], v[128:131], v[40:43]
  s_waitcnt lgkmcnt(11)
  v_mfma_f32_16x16x32_bf16 v[12:15], v[120:123], v[108:111], 0
  ds_read_b64_tr_b16 v[112:113], v173 offset:16384
  ds_read_b64_tr_b16 v[114:115], v173 offset:17408
  v_mfma_f32_16x16x32_bf16 v[12:15], v[136:139], v[116:119], v[12:15]
  ds_read_b128 v[132:135], v166 offset:0
  ds_read_b64_tr_b16 v[144:145], v162 offset:18432
  v_mfma_f32_16x16x32_bf16 v[44:47], v[120:123], v[124:127], 0
  v_mfma_f32_16x16x32_bf16 v[44:47], v[136:139], v[128:131], v[44:47]
  s_waitcnt lgkmcnt(10)
  v_mfma_f32_32x32x16_bf16 v[64:79], v[148:151], v[152:155], v[64:79]
  ds_read_b64_tr_b16 v[146:147], v162 offset:19456
  ds_read_b64_tr_b16 v[120:121], v163 offset:18432
  ds_read_b64_tr_b16 v[122:123], v163 offset:19456
  v_mfma_f32_32x32x16_bf16 v[80:95], v[148:151], v[140:143], v[80:95]
  ds_read_b64_tr_b16 v[136:137], v174 offset:0
  ds_read_b64_tr_b16 v[138:139], v174 offset:1024
  s_waitcnt lgkmcnt(11)
  v_mfma_f32_16x16x32_bf16 v[16:19], v[96:99], v[108:111], 0
  ds_read_b64_tr_b16 v[140:141], v174 offset:16384
  ds_read_b64_tr_b16 v[142:143], v174 offset:17408
  v_mfma_f32_16x16x32_bf16 v[16:19], v[100:103], v[116:119], v[16:19]
  ds_read_b64_tr_b16 v[148:149], v175 offset:0
  ds_read_b64_tr_b16 v[150:151], v175 offset:1024
  v_mfma_f32_16x16x32_bf16 v[48:51], v[96:99], v[124:127], 0
  v_mfma_f32_16x16x32_bf16 v[48:51], v[100:103], v[128:131], v[48:51]
  s_waitcnt lgkmcnt(11)
  v_mfma_f32_16x16x32_bf16 v[20:23], v[104:107], v[108:111], 0
  ds_read_b64_tr_b16 v[96:97], v175 offset:16384
  ds_read_b64_tr_b16 v[98:99], v175 offset:17408
  v_mfma_f32_16x16x32_bf16 v[20:23], v[112:115], v[116:119], v[20:23]
  ds_read_b128 v[100:103], v167 offset:0
  ds_read_b64_tr_b16 v[152:153], v162 offset:26624
  v_mfma_f32_16x16x32_bf16 v[52:55], v[104:107], v[124:127], 0
  v_mfma_f32_16x16x32_bf16 v[52:55], v[112:115], v[128:131], v[52:55]
  s_waitcnt lgkmcnt(10)
  v_mfma_f32_32x32x16_bf16 v[64:79], v[132:135], v[144:147], v[64:79]
  ds_read_b64_tr_b16 v[154:155], v162 offset:27648
  ds_read_b64_tr_b16 v[104:105], v163 offset:26624
  ds_read_b64_tr_b16 v[106:107], v163 offset:27648
  v_mfma_f32_32x32x16_bf16 v[80:95], v[132:135], v[120:123], v[80:95]
  v_add_u32 v168, -65536, v168
  v_add_u32 v169, -65536, v169
  v_add_u32 v170, -65536, v170
  s_waitcnt lgkmcnt(9)
  v_mfma_f32_16x16x32_bf16 v[24:27], v[136:139], v[108:111], 0
  v_add_u32 v171, -65536, v171
  v_add_u32 v172, -65536, v172
  v_mfma_f32_16x16x32_bf16 v[24:27], v[140:143], v[116:119], v[24:27]
  v_add_u32 v173, -65536, v173
  v_add_u32 v174, -65536, v174
  s_waitcnt lgkmcnt(0)
  s_barrier
  v_add_u32 v175, -65536, v175
  v_add_u32 v162, -65536, v162
  v_add_u32 v163, -65536, v163
  ds_read_b128 v[112:115], v160 offset:32768
  ds_read_b64_tr_b16 v[120:121], v168 offset:0
  ds_read_b64_tr_b16 v[122:123], v168 offset:1024
  v_mfma_f32_16x16x32_bf16 v[56:59], v[136:139], v[124:127], 0
  ds_read_b128 v[132:135], v161 offset:32768
  ds_read_b64_tr_b16 v[136:137], v168 offset:16384
  v_mfma_f32_16x16x32_bf16 v[56:59], v[140:143], v[128:131], v[56:59]
  ds_read_b64_tr_b16 v[138:139], v168 offset:17408
  ds_read_b128 v[140:143], v160 offset:34816
  v_mfma_f32_16x16x32_bf16 v[28:31], v[148:151], v[108:111], 0
  ds_read_b128 v[108:111], v161 offset:34816
  ds_read_b64_tr_b16 v[144:145], v169 offset:0
  v_mfma_f32_16x16x32_bf16 v[28:31], v[96:99], v[116:119], v[28:31]
  ds_read_b64_tr_b16 v[146:147], v169 offset:1024
  ds_read_b64_tr_b16 v[116:117], v169 offset:16384
  v_mfma_f32_16x16x32_bf16 v[60:63], v[148:151], v[124:127], 0
  ds_read_b64_tr_b16 v[118:119], v169 offset:17408
  ds_read_b128 v[124:127], v164 offset:32768
  v_mfma_f32_16x16x32_bf16 v[60:63], v[96:99], v[128:131], v[60:63]
  ds_read_b64_tr_b16 v[96:97], v162 offset:2048
  ds_read_b64_tr_b16 v[98:99], v162 offset:3072
  v_mfma_f32_32x32x16_bf16 v[64:79], v[100:103], v[152:155], v[64:79]
  v_mfma_f32_32x32x16_bf16 v[80:95], v[100:103], v[104:107], v[80:95]
  s_waitcnt lgkmcnt(12)
  v_mfma_f32_16x16x32_bf16 v[0:3], v[120:123], v[112:115], v[0:3]
  ds_read_b64_tr_b16 v[100:101], v163 offset:2048
  ds_read_b64_tr_b16 v[102:103], v163 offset:3072
  s_waitcnt lgkmcnt(11)
  v_mfma_f32_16x16x32_bf16 v[0:3], v[136:139], v[132:135], v[0:3]
  ds_read_b64_tr_b16 v[104:105], v170 offset:0
  ds_read_b64_tr_b16 v[106:107], v170 offset:1024
  s_waitcnt lgkmcnt(12)
  v_mfma_f32_16x16x32_bf16 v[32:35], v[120:123], v[140:143], v[32:35]
  ds_read_b64_tr_b16 v[120:121], v170 offset:16384
  ds_read_b64_tr_b16 v[122:123], v170 offset:17408
  s_waitcnt lgkmcnt(13)
  v_mfma_f32_16x16x32_bf16 v[32:35], v[136:139], v[108:111], v[32:35]
  ds_read_b64_tr_b16 v[128:129], v171 offset:0
  ds_read_b64_tr_b16 v[130:131], v171 offset:1024
  s_waitcnt lgkmcnt(13)
  v_mfma_f32_16x16x32_bf16 v[4:7], v[144:147], v[112:115], v[4:7]
  ds_read_b64_tr_b16 v[136:137], v171 offset:16384
  ds_read_b64_tr_b16 v[138:139], v171 offset:17408
  s_waitcnt lgkmcnt(13)
  v_mfma_f32_16x16x32_bf16 v[4:7], v[116:119], v[132:135], v[4:7]
  ds_read_b128 v[148:151], v165 offset:32768
  ds_read_b64_tr_b16 v[152:153], v162 offset:10240
  v_mfma_f32_16x16x32_bf16 v[36:39], v[144:147], v[140:143], v[36:39]
  v_mfma_f32_16x16x32_bf16 v[36:39], v[116:119], v[108:111], v[36:39]
  s_waitcnt lgkmcnt(12)
  v_mfma_f32_32x32x16_bf16 v[64:79], v[124:127], v[96:99], v[64:79]
  ds_read_b64_tr_b16 v[154:155], v162 offset:11264
  ds_read_b64_tr_b16 v[96:97], v163 offset:10240
  ds_read_b64_tr_b16 v[98:99], v163 offset:11264
  s_waitcnt lgkmcnt(13)
  v_mfma_f32_32x32x16_bf16 v[80:95], v[124:127], v[100:103], v[80:95]
  ds_read_b64_tr_b16 v[100:101], v172 offset:0
  ds_read_b64_tr_b16 v[102:103], v172 offset:1024
  s_waitcnt lgkmcnt(13)
  v_mfma_f32_16x16x32_bf16 v[8:11], v[104:107], v[112:115], v[8:11]
  ds_read_b64_tr_b16 v[116:117], v172 offset:16384
  ds_read_b64_tr_b16 v[118:119], v172 offset:17408
  s_waitcnt lgkmcnt(13)
  v_mfma_f32_16x16x32_bf16 v[8:11], v[120:123], v[132:135], v[8:11]
  ds_read_b64_tr_b16 v[124:125], v173 offset:0
  ds_read_b64_tr_b16 v[126:127], v173 offset:1024
  v_mfma_f32_16x16x32_bf16 v[40:43], v[104:107], v[140:143], v[40:43]
  v_mfma_f32_16x16x32_bf16 v[40:43], v[120:123], v[108:111], v[40:43]
  s_waitcnt lgkmcnt(11)
  v_mfma_f32_16x16x32_bf16 v[12:15], v[128:131], v[112:115], v[12:15]
  ds_read_b64_tr_b16 v[104:105], v173 offset:16384
  ds_read_b64_tr_b16 v[106:107], v173 offset:17408
  v_mfma_f32_16x16x32_bf16 v[12:15], v[136:139], v[132:135], v[12:15]
  ds_read_b128 v[120:123], v166 offset:32768
  ds_read_b64_tr_b16 v[144:145], v162 offset:18432
  v_mfma_f32_16x16x32_bf16 v[44:47], v[128:131], v[140:143], v[44:47]
  v_mfma_f32_16x16x32_bf16 v[44:47], v[136:139], v[108:111], v[44:47]
  s_waitcnt lgkmcnt(10)
  v_mfma_f32_32x32x16_bf16 v[64:79], v[148:151], v[152:155], v[64:79]
  ds_read_b64_tr_b16 v[146:147], v162 offset:19456
  ds_read_b64_tr_b16 v[128:129], v163 offset:18432
  ds_read_b64_tr_b16 v[130:131], v163 offset:19456
  v_mfma_f32_32x32x16_bf16 v[80:95], v[148:151], v[96:99], v[80:95]
  ds_read_b64_tr_b16 v[96:97], v174 offset:0
  ds_read_b64_tr_b16 v[98:99], v174 offset:1024
  s_waitcnt lgkmcnt(11)
  v_mfma_f32_16x16x32_bf16 v[16:19], v[100:103], v[112:115], v[16:19]
  ds_read_b64_tr_b16 v[136:137], v174 offset:16384
  ds_read_b64_tr_b16 v[138:139], v174 offset:17408
  v_mfma_f32_16x16x32_bf16 v[16:19], v[116:119], v[132:135], v[16:19]
  ds_read_b64_tr_b16 v[148:149], v175 offset:0
  ds_read_b64_tr_b16 v[150:151], v175 offset:1024
  v_mfma_f32_16x16x32_bf16 v[48:51], v[100:103], v[140:143], v[48:51]
  v_mfma_f32_16x16x32_bf16 v[48:51], v[116:119], v[108:111], v[48:51]
  s_waitcnt lgkmcnt(11)
  v_mfma_f32_16x16x32_bf16 v[20:23], v[124:127], v[112:115], v[20:23]
  ds_read_b64_tr_b16 v[100:101], v175 offset:16384
  ds_read_b64_tr_b16 v[102:103], v175 offset:17408
  v_mfma_f32_16x16x32_bf16 v[20:23], v[104:107], v[132:135], v[20:23]
  ds_read_b128 v[116:119], v167 offset:32768
  ds_read_b64_tr_b16 v[152:153], v162 offset:26624
  v_mfma_f32_16x16x32_bf16 v[52:55], v[124:127], v[140:143], v[52:55]
  v_mfma_f32_16x16x32_bf16 v[52:55], v[104:107], v[108:111], v[52:55]
  s_waitcnt lgkmcnt(10)
  v_mfma_f32_32x32x16_bf16 v[64:79], v[120:123], v[144:147], v[64:79]
  ds_read_b64_tr_b16 v[154:155], v162 offset:27648
  ds_read_b64_tr_b16 v[104:105], v163 offset:26624
  ds_read_b64_tr_b16 v[106:107], v163 offset:27648
  v_mfma_f32_32x32x16_bf16 v[80:95], v[120:123], v[128:131], v[80:95]
  s_waitcnt lgkmcnt(9)
  v_mfma_f32_16x16x32_bf16 v[24:27], v[96:99], v[112:115], v[24:27]
  v_mfma_f32_16x16x32_bf16 v[24:27], v[136:139], v[132:135], v[24:27]
  s_waitcnt lgkmcnt(0)
  s_barrier
  ds_read_b128 v[120:123], v160 offset:0
  ds_read_b64_tr_b16 v[124:125], v168 offset:32768
  ds_read_b64_tr_b16 v[126:127], v168 offset:33792
  ds_read_b128 v[128:131], v161 offset:0
  ds_read_b64_tr_b16 v[144:145], v168 offset:49152
  ds_read_b64_tr_b16 v[146:147], v168 offset:50176
  v_mfma_f32_16x16x32_bf16 v[56:59], v[96:99], v[140:143], v[56:59]
  ds_read_b128 v[96:99], v160 offset:2048
  ds_read_b128 v[156:159], v161 offset:2048
  v_mfma_f32_16x16x32_bf16 v[56:59], v[136:139], v[108:111], v[56:59]
  ds_read_b64_tr_b16 v[136:137], v169 offset:32768
  ds_read_b64_tr_b16 v[138:139], v169 offset:33792
  v_mfma_f32_16x16x32_bf16 v[28:31], v[148:151], v[112:115], v[28:31]
  ds_read_b64_tr_b16 v[112:113], v169 offset:49152
  ds_read_b64_tr_b16 v[114:115], v169 offset:50176
  v_mfma_f32_16x16x32_bf16 v[28:31], v[100:103], v[132:135], v[28:31]
  ds_read_b128 v[132:135], v164 offset:0
  ds_read_b64_tr_b16 v[208:209], v162 offset:34816
  v_mfma_f32_16x16x32_bf16 v[60:63], v[148:151], v[140:143], v[60:63]
  ds_read_b64_tr_b16 v[210:211], v162 offset:35840
  v_mfma_f32_16x16x32_bf16 v[60:63], v[100:103], v[108:111], v[60:63]
  v_mfma_f32_32x32x16_bf16 v[64:79], v[116:119], v[152:155], v[64:79]
  v_mfma_f32_32x32x16_bf16 v[80:95], v[116:119], v[104:107], v[80:95]
  s_waitcnt lgkmcnt(12)
  v_mfma_f32_16x16x32_bf16 v[0:3], v[124:127], v[120:123], v[0:3]
  ds_read_b64_tr_b16 v[100:101], v163 offset:34816
  ds_read_b64_tr_b16 v[102:103], v163 offset:35840
  s_waitcnt lgkmcnt(11)
  v_mfma_f32_16x16x32_bf16 v[0:3], v[144:147], v[128:131], v[0:3]
  ds_read_b64_tr_b16 v[104:105], v170 offset:32768
  ds_read_b64_tr_b16 v[106:107], v170 offset:33792
  s_waitcnt lgkmcnt(11)
  v_mfma_f32_16x16x32_bf16 v[32:35], v[124:127], v[96:99], v[32:35]
  ds_read_b64_tr_b16 v[108:109], v170 offset:49152
  ds_read_b64_tr_b16 v[110:111], v170 offset:50176
  v_mfma_f32_16x16x32_bf16 v[32:35], v[144:147], v[156:159], v[32:35]
  ds_read_b64_tr_b16 v[116:117], v171 offset:32768
  ds_read_b64_tr_b16 v[118:119], v171 offset:33792
  s_waitcnt lgkmcnt(11)
  v_mfma_f32_16x16x32_bf16 v[4:7], v[136:139], v[120:123], v[4:7]
  ds_read_b64_tr_b16 v[124:125], v171 offset:49152
  ds_read_b64_tr_b16 v[126:127], v171 offset:50176
  v_mfma_f32_16x16x32_bf16 v[4:7], v[112:115], v[128:131], v[4:7]
  ds_read_b128 v[140:143], v165 offset:0
  ds_read_b64_tr_b16 v[144:145], v162 offset:43008
  v_mfma_f32_16x16x32_bf16 v[36:39], v[136:139], v[96:99], v[36:39]
  v_mfma_f32_16x16x32_bf16 v[36:39], v[112:115], v[156:159], v[36:39]
  s_waitcnt lgkmcnt(12)
  v_mfma_f32_32x32x16_bf16 v[64:79], v[132:135], v[208:211], v[64:79]
  ds_read_b64_tr_b16 v[146:147], v162 offset:44032
  ds_read_b64_tr_b16 v[112:113], v163 offset:43008
  ds_read_b64_tr_b16 v[114:115], v163 offset:44032
  s_waitcnt lgkmcnt(13)
  v_mfma_f32_32x32x16_bf16 v[80:95], v[132:135], v[100:103], v[80:95]
  ds_read_b64_tr_b16 v[100:101], v172 offset:32768
  ds_read_b64_tr_b16 v[102:103], v172 offset:33792
  buffer_store_dwordx4 v[176:179], v253, s[28:31], s69 offen offset:0 sc1
  buffer_store_dwordx4 v[180:183], v253, s[28:31], s69 offen offset:1024 sc1
  buffer_store_dwordx4 v[184:187], v253, s[28:31], s69 offen offset:2048 sc1
  buffer_store_dwordx4 v[188:191], v253, s[28:31], s69 offen offset:3072 sc1
  s_add_u32 s61, s69, 8192
  buffer_store_dwordx4 v[192:195], v253, s[28:31], s61 offen offset:0 sc1
  s_add_u32 s61, s69, 8192
  buffer_store_dwordx4 v[196:199], v253, s[28:31], s61 offen offset:1024 sc1
  s_add_u32 s61, s69, 8192
  buffer_store_dwordx4 v[200:203], v253, s[28:31], s61 offen offset:2048 sc1
  s_add_u32 s61, s69, 8192
  buffer_store_dwordx4 v[204:207], v253, s[28:31], s61 offen offset:3072 sc1
  s_waitcnt lgkmcnt(13)
  v_mfma_f32_16x16x32_bf16 v[8:11], v[104:107], v[120:123], v[8:11]
  ds_read_b64_tr_b16 v[132:133], v172 offset:49152
  ds_read_b64_tr_b16 v[134:135], v172 offset:50176
  s_waitcnt lgkmcnt(13)
  v_mfma_f32_16x16x32_bf16 v[8:11], v[108:111], v[128:131], v[8:11]
  ds_read_b64_tr_b16 v[136:137], v173 offset:32768
  ds_read_b64_tr_b16 v[138:139], v173 offset:33792
  v_mfma_f32_16x16x32_bf16 v[40:43], v[104:107], v[96:99], v[40:43]
  v_mfma_f32_16x16x32_bf16 v[40:43], v[108:111], v[156:159], v[40:43]
  s_waitcnt lgkmcnt(11)
  v_mfma_f32_16x16x32_bf16 v[12:15], v[116:119], v[120:123], v[12:15]
  ds_read_b64_tr_b16 v[104:105], v173 offset:49152
  ds_read_b64_tr_b16 v[106:107], v173 offset:50176
  v_mfma_f32_16x16x32_bf16 v[12:15], v[124:127], v[128:131], v[12:15]
  ds_read_b128 v[108:111], v166 offset:0
  ds_read_b64_tr_b16 v[148:149], v162 offset:51200
  v_mfma_f32_16x16x32_bf16 v[44:47], v[116:119], v[96:99], v[44:47]
  v_mfma_f32_16x16x32_bf16 v[44:47], v[124:127], v[156:159], v[44:47]
  s_waitcnt lgkmcnt(10)
  v_mfma_f32_32x32x16_bf16 v[64:79], v[140:143], v[144:147], v[64:79]
  ds_read_b64_tr_b16 v[150:151], v162 offset:52224
  ds_read_b64_tr_b16 v[116:117], v163 offset:51200
  ds_read_b64_tr_b16 v[118:119], v163 offset:52224
  v_mfma_f32_32x32x16_bf16 v[80:95], v[140:143], v[112:115], v[80:95]
  ds_read_b64_tr_b16 v[112:113], v174 offset:32768
  ds_read_b64_tr_b16 v[114:115], v174 offset:33792
  s_waitcnt lgkmcnt(11)
  v_mfma_f32_16x16x32_bf16 v[16:19], v[100:103], v[120:123], v[16:19]
  ds_read_b64_tr_b16 v[124:125], v174 offset:49152
  ds_read_b64_tr_b16 v[126:127], v174 offset:50176
  v_mfma_f32_16x16x32_bf16 v[16:19], v[132:135], v[128:131], v[16:19]
  ds_read_b64_tr_b16 v[140:141], v175 offset:32768
  ds_read_b64_tr_b16 v[142:143], v175 offset:33792
  v_mfma_f32_16x16x32_bf16 v[48:51], v[100:103], v[96:99], v[48:51]
  v_mfma_f32_16x16x32_bf16 v[48:51], v[132:135], v[156:159], v[48:51]
  s_waitcnt lgkmcnt(11)
  v_mfma_f32_16x16x32_bf16 v[20:23], v[136:139], v[120:123], v[20:23]
  ds_read_b64_tr_b16 v[100:101], v175 offset:49152
  ds_read_b64_tr_b16 v[102:103], v175 offset:50176
  v_mfma_f32_16x16x32_bf16 v[20:23], v[104:107], v[128:131], v[20:23]
  ds_read_b128 v[132:135], v167 offset:0
  ds_read_b64_tr_b16 v[144:145], v162 offset:59392
  v_mfma_f32_16x16x32_bf16 v[52:55], v[136:139], v[96:99], v[52:55]
  v_mfma_f32_16x16x32_bf16 v[52:55], v[104:107], v[156:159], v[52:55]
  s_waitcnt lgkmcnt(10)
  v_mfma_f32_32x32x16_bf16 v[64:79], v[108:111], v[148:151], v[64:79]
  ds_read_b64_tr_b16 v[146:147], v162 offset:60416
  ds_read_b64_tr_b16 v[104:105], v163 offset:59392
  ds_read_b64_tr_b16 v[106:107], v163 offset:60416
  v_mfma_f32_32x32x16_bf16 v[80:95], v[108:111], v[116:119], v[80:95]
  v_add_u32 v168, 65536, v168
  v_add_u32 v169, 65536, v169
  v_add_u32 v170, 65536, v170
  s_waitcnt lgkmcnt(9)
  v_mfma_f32_16x16x32_bf16 v[24:27], v[112:115], v[120:123], v[24:27]
  v_add_u32 v171, 65536, v171
  v_add_u32 v172, 65536, v172
  v_mfma_f32_16x16x32_bf16 v[24:27], v[124:127], v[128:131], v[24:27]
  v_add_u32 v173, 65536, v173
  v_add_u32 v174, 65536, v174
  s_waitcnt lgkmcnt(0)
  s_barrier
  v_add_u32 v175, 65536, v175
  v_add_u32 v162, 65536, v162
  v_add_u32 v163, 65536, v163
  ds_read_b128 v[108:111], v160 offset:32768
  ds_read_b64_tr_b16 v[116:117], v168 offset:0
  ds_read_b64_tr_b16 v[118:119], v168 offset:1024
  v_mfma_f32_16x16x32_bf16 v[56:59], v[112:115], v[96:99], v[56:59]
  ds_read_b128 v[112:115], v161 offset:32768
  ds_read_b64_tr_b16 v[136:137], v168 offset:16384
  v_mfma_f32_16x16x32_bf16 v[56:59], v[124:127], v[156:159], v[56:59]
  ds_read_b64_tr_b16 v[138:139], v168 offset:17408
  ds_read_b128 v[124:127], v160 offset:34816
  v_mfma_f32_16x16x32_bf16 v[28:31], v[140:143], v[120:123], v[28:31]
  ds_read_b128 v[120:123], v161 offset:34816
  ds_read_b64_tr_b16 v[148:149], v169 offset:0
  v_mfma_f32_16x16x32_bf16 v[28:31], v[100:103], v[128:131], v[28:31]
  ds_read_b64_tr_b16 v[150:151], v169 offset:1024
  ds_read_b64_tr_b16 v[128:129], v169 offset:16384
  v_mfma_f32_16x16x32_bf16 v[60:63], v[140:143], v[96:99], v[60:63]
  ds_read_b64_tr_b16 v[130:131], v169 offset:17408
  ds_read_b128 v[96:99], v164 offset:32768
  v_mfma_f32_16x16x32_bf16 v[60:63], v[100:103], v[156:159], v[60:63]
  ds_read_b64_tr_b16 v[100:101], v162 offset:2048
  ds_read_b64_tr_b16 v[102:103], v162 offset:3072
  v_mfma_f32_32x32x16_bf16 v[64:79], v[132:135], v[144:147], v[64:79]
  v_mfma_f32_32x32x16_bf16 v[80:95], v[132:135], v[104:107], v[80:95]
  s_waitcnt lgkmcnt(12)
  v_mfma_f32_16x16x32_bf16 v[0:3], v[116:119], v[108:111], v[0:3]
  ds_read_b64_tr_b16 v[104:105], v163 offset:2048
  ds_read_b64_tr_b16 v[106:107], v163 offset:3072
  s_waitcnt lgkmcnt(11)
  v_mfma_f32_16x16x32_bf16 v[0:3], v[136:139], v[112:115], v[0:3]
  ds_read_b64_tr_b16 v[132:133], v170 offset:0
  ds_read_b64_tr_b16 v[134:135], v170 offset:1024
  s_waitcnt lgkmcnt(12)
  v_mfma_f32_16x16x32_bf16 v[32:35], v[116:119], v[124:127], v[32:35]
  ds_read_b64_tr_b16 v[116:117], v170 offset:16384
  ds_read_b64_tr_b16 v[118:119], v170 offset:17408
  s_waitcnt lgkmcnt(13)
  v_mfma_f32_16x16x32_bf16 v[32:35], v[136:139], v[120:123], v[32:35]
  ds_read_b64_tr_b16 v[136:137], v171 offset:0
  ds_read_b64_tr_b16 v[138:139], v171 offset:1024
  s_waitcnt lgkmcnt(13)
  v_mfma_f32_16x16x32_bf16 v[4:7], v[148:151], v[108:111], v[4:7]
  ds_read_b64_tr_b16 v[140:141], v171 offset:16384
  ds_read_b64_tr_b16 v[142:143], v171 offset:17408
  s_waitcnt lgkmcnt(13)
  v_mfma_f32_16x16x32_bf16 v[4:7], v[128:131], v[112:115], v[4:7]
  ds_read_b128 v[144:147], v165 offset:32768
  ds_read_b64_tr_b16 v[152:153], v162 offset:10240
  v_mfma_f32_16x16x32_bf16 v[36:39], v[148:151], v[124:127], v[36:39]
  v_mfma_f32_16x16x32_bf16 v[36:39], v[128:131], v[120:123], v[36:39]
  s_waitcnt lgkmcnt(12)
  v_mfma_f32_32x32x16_bf16 v[64:79], v[96:99], v[100:103], v[64:79]
  ds_read_b64_tr_b16 v[154:155], v162 offset:11264
  ds_read_b64_tr_b16 v[100:101], v163 offset:10240
  ds_read_b64_tr_b16 v[102:103], v163 offset:11264
  s_waitcnt lgkmcnt(13)
  v_mfma_f32_32x32x16_bf16 v[80:95], v[96:99], v[104:107], v[80:95]
  ds_read_b64_tr_b16 v[96:97], v172 offset:0
  ds_read_b64_tr_b16 v[98:99], v172 offset:1024
  s_waitcnt lgkmcnt(13)
  v_mfma_f32_16x16x32_bf16 v[8:11], v[132:135], v[108:111], v[8:11]
  ds_read_b64_tr_b16 v[104:105], v172 offset:16384
  ds_read_b64_tr_b16 v[106:107], v172 offset:17408
  s_waitcnt lgkmcnt(13)
  v_mfma_f32_16x16x32_bf16 v[8:11], v[116:119], v[112:115], v[8:11]
  ds_read_b64_tr_b16 v[128:129], v173 offset:0
  ds_read_b64_tr_b16 v[130:131], v173 offset:1024
  v_mfma_f32_16x16x32_bf16 v[40:43], v[132:135], v[124:127], v[40:43]
  v_mfma_f32_16x16x32_bf16 v[40:43], v[116:119], v[120:123], v[40:43]
  s_waitcnt lgkmcnt(11)
  v_mfma_f32_16x16x32_bf16 v[12:15], v[136:139], v[108:111], v[12:15]
  ds_read_b64_tr_b16 v[116:117], v173 offset:16384
  ds_read_b64_tr_b16 v[118:119], v173 offset:17408
  v_mfma_f32_16x16x32_bf16 v[12:15], v[140:143], v[112:115], v[12:15]
  ds_read_b128 v[132:135], v166 offset:32768
  ds_read_b64_tr_b16 v[148:149], v162 offset:18432
  v_mfma_f32_16x16x32_bf16 v[44:47], v[136:139], v[124:127], v[44:47]
  v_mfma_f32_16x16x32_bf16 v[44:47], v[140:143], v[120:123], v[44:47]
  s_waitcnt lgkmcnt(10)
  v_mfma_f32_32x32x16_bf16 v[64:79], v[144:147], v[152:155], v[64:79]
  ds_read_b64_tr_b16 v[150:151], v162 offset:19456
  ds_read_b64_tr_b16 v[136:137], v163 offset:18432
  ds_read_b64_tr_b16 v[138:139], v163 offset:19456
  v_mfma_f32_32x32x16_bf16 v[80:95], v[144:147], v[100:103], v[80:95]
  ds_read_b64_tr_b16 v[100:101], v174 offset:0
  ds_read_b64_tr_b16 v[102:103], v174 offset:1024
  s_waitcnt lgkmcnt(11)
  v_mfma_f32_16x16x32_bf16 v[16:19], v[96:99], v[108:111], v[16:19]
  ds_read_b64_tr_b16 v[140:141], v174 offset:16384
  ds_read_b64_tr_b16 v[142:143], v174 offset:17408
  v_mfma_f32_16x16x32_bf16 v[16:19], v[104:107], v[112:115], v[16:19]
  ds_read_b64_tr_b16 v[144:145], v175 offset:0
  ds_read_b64_tr_b16 v[146:147], v175 offset:1024
  v_mfma_f32_16x16x32_bf16 v[48:51], v[96:99], v[124:127], v[48:51]
  v_mfma_f32_16x16x32_bf16 v[48:51], v[104:107], v[120:123], v[48:51]
  s_waitcnt lgkmcnt(11)
  v_mfma_f32_16x16x32_bf16 v[20:23], v[128:131], v[108:111], v[20:23]
  ds_read_b64_tr_b16 v[96:97], v175 offset:16384
  ds_read_b64_tr_b16 v[98:99], v175 offset:17408
  v_mfma_f32_16x16x32_bf16 v[20:23], v[116:119], v[112:115], v[20:23]
  ds_read_b128 v[104:107], v167 offset:32768
  ds_read_b64_tr_b16 v[152:153], v162 offset:26624
  v_mfma_f32_16x16x32_bf16 v[52:55], v[128:131], v[124:127], v[52:55]
  v_mfma_f32_16x16x32_bf16 v[52:55], v[116:119], v[120:123], v[52:55]
  s_waitcnt lgkmcnt(10)
  v_mfma_f32_32x32x16_bf16 v[64:79], v[132:135], v[148:151], v[64:79]
  ds_read_b64_tr_b16 v[154:155], v162 offset:27648
  ds_read_b64_tr_b16 v[116:117], v163 offset:26624
  ds_read_b64_tr_b16 v[118:119], v163 offset:27648
  v_mfma_f32_32x32x16_bf16 v[80:95], v[132:135], v[136:139], v[80:95]
  v_add_u32 v168, -65536, v168
  v_add_u32 v169, -65536, v169
  v_add_u32 v170, -65536, v170
  s_waitcnt lgkmcnt(9)
  v_mfma_f32_16x16x32_bf16 v[24:27], v[100:103], v[108:111], v[24:27]
  v_add_u32 v171, -65536, v171
  v_add_u32 v172, -65536, v172
  v_mfma_f32_16x16x32_bf16 v[24:27], v[140:143], v[112:115], v[24:27]
  v_add_u32 v173, -65536, v173
  v_add_u32 v174, -65536, v174
  s_waitcnt lgkmcnt(0)
  s_barrier
  v_add_u32 v175, -65536, v175
  v_add_u32 v162, -65536, v162
  v_add_u32 v163, -65536, v163
  ds_read_b128 v[128:131], v160 offset:0
  ds_read_b64_tr_b16 v[132:133], v168 offset:0
  ds_read_b64_tr_b16 v[134:135], v168 offset:1024
  v_mfma_f32_16x16x32_bf16 v[56:59], v[100:103], v[124:127], v[56:59]
  ds_read_b128 v[100:103], v161 offset:0
  ds_read_b64_tr_b16 v[136:137], v168 offset:16384
  v_mfma_f32_16x16x32_bf16 v[56:59], v[140:143], v[120:123], v[56:59]
  ds_read_b64_tr_b16 v[138:139], v168 offset:17408
  ds_read_b128 v[140:143], v160 offset:2048
  v_mfma_f32_16x16x32_bf16 v[28:31], v[144:147], v[108:111], v[28:31]
  ds_read_b128 v[108:111], v161 offset:2048
  ds_read_b64_tr_b16 v[148:149], v169 offset:0
  v_mfma_f32_16x16x32_bf16 v[28:31], v[96:99], v[112:115], v[28:31]
  ds_read_b64_tr_b16 v[150:151], v169 offset:1024
  ds_read_b64_tr_b16 v[112:113], v169 offset:16384
  v_mfma_f32_16x16x32_bf16 v[60:63], v[144:147], v[124:127], v[60:63]
  ds_read_b64_tr_b16 v[114:115], v169 offset:17408
  ds_read_b128 v[124:127], v164 offset:0
  v_mfma_f32_16x16x32_bf16 v[60:63], v[96:99], v[120:123], v[60:63]
  ds_read_b64_tr_b16 v[96:97], v162 offset:2048
  ds_read_b64_tr_b16 v[98:99], v162 offset:3072
  v_mfma_f32_32x32x16_bf16 v[64:79], v[104:107], v[152:155], v[64:79]
  v_mfma_f32_32x32x16_bf16 v[80:95], v[104:107], v[116:119], v[80:95]
  s_waitcnt lgkmcnt(12)
  v_mfma_f32_16x16x32_bf16 v[0:3], v[132:135], v[128:131], v[0:3]
  ds_read_b64_tr_b16 v[104:105], v163 offset:2048
  ds_read_b64_tr_b16 v[106:107], v163 offset:3072
  s_waitcnt lgkmcnt(11)
  v_mfma_f32_16x16x32_bf16 v[0:3], v[136:139], v[100:103], v[0:3]
  ds_read_b64_tr_b16 v[116:117], v170 offset:0
  ds_read_b64_tr_b16 v[118:119], v170 offset:1024
  s_waitcnt lgkmcnt(12)
  v_mfma_f32_16x16x32_bf16 v[32:35], v[132:135], v[140:143], v[32:35]
  ds_read_b64_tr_b16 v[120:121], v170 offset:16384
  ds_read_b64_tr_b16 v[122:123], v170 offset:17408
  s_waitcnt lgkmcnt(13)
  v_mfma_f32_16x16x32_bf16 v[32:35], v[136:139], v[108:111], v[32:35]
  ds_read_b64_tr_b16 v[132:133], v171 offset:0
  ds_read_b64_tr_b16 v[134:135], v171 offset:1024
  s_waitcnt lgkmcnt(13)
  v_mfma_f32_16x16x32_bf16 v[4:7], v[148:151], v[128:131], v[4:7]
  ds_read_b64_tr_b16 v[136:137], v171 offset:16384
  ds_read_b64_tr_b16 v[138:139], v171 offset:17408
  s_waitcnt lgkmcnt(13)
  v_mfma_f32_16x16x32_bf16 v[4:7], v[112:115], v[100:103], v[4:7]
  ds_read_b128 v[144:147], v165 offset:0
  ds_read_b64_tr_b16 v[152:153], v162 offset:10240
  v_mfma_f32_16x16x32_bf16 v[36:39], v[148:151], v[140:143], v[36:39]
  v_mfma_f32_16x16x32_bf16 v[36:39], v[112:115], v[108:111], v[36:39]
  s_waitcnt lgkmcnt(12)
  v_mfma_f32_32x32x16_bf16 v[64:79], v[124:127], v[96:99], v[64:79]
  ds_read_b64_tr_b16 v[154:155], v162 offset:11264
  ds_read_b64_tr_b16 v[96:97], v163 offset:10240
  ds_read_b64_tr_b16 v[98:99], v163 offset:11264
  s_waitcnt lgkmcnt(13)
  v_mfma_f32_32x32x16_bf16 v[80:95], v[124:127], v[104:107], v[80:95]
  ds_read_b64_tr_b16 v[104:105], v172 offset:0
  ds_read_b64_tr_b16 v[106:107], v172 offset:1024
  s_waitcnt lgkmcnt(13)
  v_mfma_f32_16x16x32_bf16 v[8:11], v[116:119], v[128:131], v[8:11]
  ds_read_b64_tr_b16 v[112:113], v172 offset:16384
  ds_read_b64_tr_b16 v[114:115], v172 offset:17408
  s_waitcnt lgkmcnt(13)
  v_mfma_f32_16x16x32_bf16 v[8:11], v[120:123], v[100:103], v[8:11]
  ds_read_b64_tr_b16 v[124:125], v173 offset:0
  ds_read_b64_tr_b16 v[126:127], v173 offset:1024
  v_mfma_f32_16x16x32_bf16 v[40:43], v[116:119], v[140:143], v[40:43]
  v_mfma_f32_16x16x32_bf16 v[40:43], v[120:123], v[108:111], v[40:43]
  s_waitcnt lgkmcnt(11)
  v_mfma_f32_16x16x32_bf16 v[12:15], v[132:135], v[128:131], v[12:15]
  ds_read_b64_tr_b16 v[116:117], v173 offset:16384
  ds_read_b64_tr_b16 v[118:119], v173 offset:17408
  v_mfma_f32_16x16x32_bf16 v[12:15], v[136:139], v[100:103], v[12:15]
  ds_read_b128 v[120:123], v166 offset:0
  ds_read_b64_tr_b16 v[148:149], v162 offset:18432
  v_mfma_f32_16x16x32_bf16 v[44:47], v[132:135], v[140:143], v[44:47]
  v_mfma_f32_16x16x32_bf16 v[44:47], v[136:139], v[108:111], v[44:47]
  s_waitcnt lgkmcnt(10)
  v_mfma_f32_32x32x16_bf16 v[64:79], v[144:147], v[152:155], v[64:79]
  ds_read_b64_tr_b16 v[150:151], v162 offset:19456
  ds_read_b64_tr_b16 v[132:133], v163 offset:18432
  ds_read_b64_tr_b16 v[134:135], v163 offset:19456
  v_mfma_f32_32x32x16_bf16 v[80:95], v[144:147], v[96:99], v[80:95]
  ds_read_b64_tr_b16 v[96:97], v174 offset:0
  ds_read_b64_tr_b16 v[98:99], v174 offset:1024
  s_waitcnt lgkmcnt(11)
  v_mfma_f32_16x16x32_bf16 v[16:19], v[104:107], v[128:131], v[16:19]
  ds_read_b64_tr_b16 v[136:137], v174 offset:16384
  ds_read_b64_tr_b16 v[138:139], v174 offset:17408
  v_mfma_f32_16x16x32_bf16 v[16:19], v[112:115], v[100:103], v[16:19]
  ds_read_b64_tr_b16 v[144:145], v175 offset:0
  ds_read_b64_tr_b16 v[146:147], v175 offset:1024
  v_mfma_f32_16x16x32_bf16 v[48:51], v[104:107], v[140:143], v[48:51]
  v_mfma_f32_16x16x32_bf16 v[48:51], v[112:115], v[108:111], v[48:51]
  s_waitcnt lgkmcnt(11)
  v_mfma_f32_16x16x32_bf16 v[20:23], v[124:127], v[128:131], v[20:23]
  ds_read_b64_tr_b16 v[104:105], v175 offset:16384
  ds_read_b64_tr_b16 v[106:107], v175 offset:17408
  v_mfma_f32_16x16x32_bf16 v[20:23], v[116:119], v[100:103], v[20:23]
  ds_read_b128 v[112:115], v167 offset:0
  ds_read_b64_tr_b16 v[152:153], v162 offset:26624
  v_mfma_f32_16x16x32_bf16 v[52:55], v[124:127], v[140:143], v[52:55]
  v_mfma_f32_16x16x32_bf16 v[52:55], v[116:119], v[108:111], v[52:55]
  s_waitcnt lgkmcnt(10)
  v_mfma_f32_32x32x16_bf16 v[64:79], v[120:123], v[148:151], v[64:79]
  ds_read_b64_tr_b16 v[154:155], v162 offset:27648
  ds_read_b64_tr_b16 v[116:117], v163 offset:26624
  ds_read_b64_tr_b16 v[118:119], v163 offset:27648
  v_mfma_f32_32x32x16_bf16 v[80:95], v[120:123], v[132:135], v[80:95]
  s_waitcnt lgkmcnt(9)
  v_mfma_f32_16x16x32_bf16 v[24:27], v[96:99], v[128:131], v[24:27]
  v_mfma_f32_16x16x32_bf16 v[24:27], v[136:139], v[100:103], v[24:27]
  s_waitcnt lgkmcnt(0)
  s_barrier
  ds_read_b128 v[120:123], v160 offset:32768
  ds_read_b64_tr_b16 v[124:125], v168 offset:32768
  ds_read_b64_tr_b16 v[126:127], v168 offset:33792
  ds_read_b128 v[132:135], v161 offset:32768
  ds_read_b64_tr_b16 v[148:149], v168 offset:49152
  ds_read_b64_tr_b16 v[150:151], v168 offset:50176
  v_mfma_f32_16x16x32_bf16 v[56:59], v[96:99], v[140:143], v[56:59]
  ds_read_b128 v[96:99], v160 offset:34816
  ds_read_b128 v[156:159], v161 offset:34816
  v_mfma_f32_16x16x32_bf16 v[56:59], v[136:139], v[108:111], v[56:59]
  ds_read_b64_tr_b16 v[136:137], v169 offset:32768
  ds_read_b64_tr_b16 v[138:139], v169 offset:33792
  v_mfma_f32_16x16x32_bf16 v[28:31], v[144:147], v[128:131], v[28:31]
  ds_read_b64_tr_b16 v[128:129], v169 offset:49152
  ds_read_b64_tr_b16 v[130:131], v169 offset:50176
  v_mfma_f32_16x16x32_bf16 v[28:31], v[104:107], v[100:103], v[28:31]
  ds_read_b128 v[100:103], v164 offset:32768
  ds_read_b64_tr_b16 v[208:209], v162 offset:34816
  v_mfma_f32_16x16x32_bf16 v[60:63], v[144:147], v[140:143], v[60:63]
  ds_read_b64_tr_b16 v[210:211], v162 offset:35840
  v_mfma_f32_16x16x32_bf16 v[60:63], v[104:107], v[108:111], v[60:63]
  v_mfma_f32_32x32x16_bf16 v[64:79], v[112:115], v[152:155], v[64:79]
  v_mfma_f32_32x32x16_bf16 v[80:95], v[112:115], v[116:119], v[80:95]
  s_waitcnt lgkmcnt(12)
  v_mfma_f32_16x16x32_bf16 v[0:3], v[124:127], v[120:123], v[0:3]
  ds_read_b64_tr_b16 v[104:105], v163 offset:34816
  ds_read_b64_tr_b16 v[106:107], v163 offset:35840
  s_waitcnt lgkmcnt(11)
  v_mfma_f32_16x16x32_bf16 v[0:3], v[148:151], v[132:135], v[0:3]
  ds_read_b64_tr_b16 v[108:109], v170 offset:32768
  ds_read_b64_tr_b16 v[110:111], v170 offset:33792
  s_waitcnt lgkmcnt(11)
  v_mfma_f32_16x16x32_bf16 v[32:35], v[124:127], v[96:99], v[32:35]
  ds_read_b64_tr_b16 v[112:113], v170 offset:49152
  ds_read_b64_tr_b16 v[114:115], v170 offset:50176
  v_mfma_f32_16x16x32_bf16 v[32:35], v[148:151], v[156:159], v[32:35]
  ds_read_b64_tr_b16 v[116:117], v171 offset:32768
  ds_read_b64_tr_b16 v[118:119], v171 offset:33792
  s_waitcnt lgkmcnt(11)
  v_mfma_f32_16x16x32_bf16 v[4:7], v[136:139], v[120:123], v[4:7]
  ds_read_b64_tr_b16 v[124:125], v171 offset:49152
  ds_read_b64_tr_b16 v[126:127], v171 offset:50176
  v_mfma_f32_16x16x32_bf16 v[4:7], v[128:131], v[132:135], v[4:7]
  ds_read_b128 v[140:143], v165 offset:32768
  ds_read_b64_tr_b16 v[144:145], v162 offset:43008
  v_mfma_f32_16x16x32_bf16 v[36:39], v[136:139], v[96:99], v[36:39]
  v_mfma_f32_16x16x32_bf16 v[36:39], v[128:131], v[156:159], v[36:39]
  s_waitcnt lgkmcnt(12)
  v_mfma_f32_32x32x16_bf16 v[64:79], v[100:103], v[208:211], v[64:79]
  ds_read_b64_tr_b16 v[146:147], v162 offset:44032
  ds_read_b64_tr_b16 v[128:129], v163 offset:43008
  ds_read_b64_tr_b16 v[130:131], v163 offset:44032
  s_waitcnt lgkmcnt(13)
  v_mfma_f32_32x32x16_bf16 v[80:95], v[100:103], v[104:107], v[80:95]
  ds_read_b64_tr_b16 v[100:101], v172 offset:32768
  ds_read_b64_tr_b16 v[102:103], v172 offset:33792
  s_waitcnt lgkmcnt(13)
  v_mfma_f32_16x16x32_bf16 v[8:11], v[108:111], v[120:123], v[8:11]
  ds_read_b64_tr_b16 v[104:105], v172 offset:49152
  ds_read_b64_tr_b16 v[106:107], v172 offset:50176
  s_waitcnt lgkmcnt(13)
  v_mfma_f32_16x16x32_bf16 v[8:11], v[112:115], v[132:135], v[8:11]
  ds_read_b64_tr_b16 v[136:137], v173 offset:32768
  ds_read_b64_tr_b16 v[138:139], v173 offset:33792
  v_mfma_f32_16x16x32_bf16 v[40:43], v[108:111], v[96:99], v[40:43]
  v_mfma_f32_16x16x32_bf16 v[40:43], v[112:115], v[156:159], v[40:43]
  s_waitcnt lgkmcnt(11)
  v_mfma_f32_16x16x32_bf16 v[12:15], v[116:119], v[120:123], v[12:15]
  ds_read_b64_tr_b16 v[108:109], v173 offset:49152
  ds_read_b64_tr_b16 v[110:111], v173 offset:50176
  v_mfma_f32_16x16x32_bf16 v[12:15], v[124:127], v[132:135], v[12:15]
  ds_read_b128 v[112:115], v166 offset:32768
  ds_read_b64_tr_b16 v[148:149], v162 offset:51200
  v_mfma_f32_16x16x32_bf16 v[44:47], v[116:119], v[96:99], v[44:47]
  v_mfma_f32_16x16x32_bf16 v[44:47], v[124:127], v[156:159], v[44:47]
  s_waitcnt lgkmcnt(10)
  v_mfma_f32_32x32x16_bf16 v[64:79], v[140:143], v[144:147], v[64:79]
  ds_read_b64_tr_b16 v[150:151], v162 offset:52224
  ds_read_b64_tr_b16 v[116:117], v163 offset:51200
  ds_read_b64_tr_b16 v[118:119], v163 offset:52224
  v_mfma_f32_32x32x16_bf16 v[80:95], v[140:143], v[128:131], v[80:95]
  ds_read_b64_tr_b16 v[124:125], v174 offset:32768
  ds_read_b64_tr_b16 v[126:127], v174 offset:33792
  s_waitcnt lgkmcnt(11)
  v_mfma_f32_16x16x32_bf16 v[16:19], v[100:103], v[120:123], v[16:19]
  ds_read_b64_tr_b16 v[128:129], v174 offset:49152
  ds_read_b64_tr_b16 v[130:131], v174 offset:50176
  v_mfma_f32_16x16x32_bf16 v[16:19], v[104:107], v[132:135], v[16:19]
  ds_read_b64_tr_b16 v[140:141], v175 offset:32768
  ds_read_b64_tr_b16 v[142:143], v175 offset:33792
  v_mfma_f32_16x16x32_bf16 v[48:51], v[100:103], v[96:99], v[48:51]
  v_mfma_f32_16x16x32_bf16 v[48:51], v[104:107], v[156:159], v[48:51]
  s_waitcnt lgkmcnt(11)
  v_mfma_f32_16x16x32_bf16 v[20:23], v[136:139], v[120:123], v[20:23]
  ds_read_b64_tr_b16 v[100:101], v175 offset:49152
  ds_read_b64_tr_b16 v[102:103], v175 offset:50176
  v_mfma_f32_16x16x32_bf16 v[20:23], v[108:111], v[132:135], v[20:23]
  ds_read_b128 v[104:107], v167 offset:32768
  ds_read_b64_tr_b16 v[144:145], v162 offset:59392
  v_mfma_f32_16x16x32_bf16 v[52:55], v[136:139], v[96:99], v[52:55]
  v_mfma_f32_16x16x32_bf16 v[52:55], v[108:111], v[156:159], v[52:55]
  s_waitcnt lgkmcnt(10)
  v_mfma_f32_32x32x16_bf16 v[64:79], v[112:115], v[148:151], v[64:79]
  ds_read_b64_tr_b16 v[146:147], v162 offset:60416
  ds_read_b64_tr_b16 v[108:109], v163 offset:59392
  ds_read_b64_tr_b16 v[110:111], v163 offset:60416
  v_mfma_f32_32x32x16_bf16 v[80:95], v[112:115], v[116:119], v[80:95]
  v_add_u32 v168, 65536, v168
  v_add_u32 v169, 65536, v169
  v_add_u32 v170, 65536, v170
  s_waitcnt lgkmcnt(9)
  v_mfma_f32_16x16x32_bf16 v[24:27], v[124:127], v[120:123], v[24:27]
  v_add_u32 v171, 65536, v171
  v_add_u32 v172, 65536, v172
  v_mfma_f32_16x16x32_bf16 v[24:27], v[128:131], v[132:135], v[24:27]
  v_add_u32 v173, 65536, v173
  v_add_u32 v174, 65536, v174
  s_waitcnt lgkmcnt(0)
  s_barrier
  v_add_u32 v175, 65536, v175
  v_add_u32 v162, 65536, v162
  v_add_u32 v163, 65536, v163
  ds_read_b128 v[112:115], v160 offset:0
  ds_read_b64_tr_b16 v[116:117], v168 offset:0
  ds_read_b64_tr_b16 v[118:119], v168 offset:1024
  v_mfma_f32_16x16x32_bf16 v[56:59], v[124:127], v[96:99], v[56:59]
  ds_read_b128 v[124:127], v161 offset:0
  ds_read_b64_tr_b16 v[136:137], v168 offset:16384
  v_mfma_f32_16x16x32_bf16 v[56:59], v[128:131], v[156:159], v[56:59]
  ds_read_b64_tr_b16 v[138:139], v168 offset:17408
  ds_read_b128 v[128:131], v160 offset:2048
  v_mfma_f32_16x16x32_bf16 v[28:31], v[140:143], v[120:123], v[28:31]
  ds_read_b128 v[120:123], v161 offset:2048
  ds_read_b64_tr_b16 v[148:149], v169 offset:0
  v_mfma_f32_16x16x32_bf16 v[28:31], v[100:103], v[132:135], v[28:31]
  ds_read_b64_tr_b16 v[150:151], v169 offset:1024
  ds_read_b64_tr_b16 v[132:133], v169 offset:16384
  v_mfma_f32_16x16x32_bf16 v[60:63], v[140:143], v[96:99], v[60:63]
  ds_read_b64_tr_b16 v[134:135], v169 offset:17408
  ds_read_b128 v[96:99], v164 offset:0
  v_mfma_f32_16x16x32_bf16 v[60:63], v[100:103], v[156:159], v[60:63]
  ds_read_b64_tr_b16 v[100:101], v162 offset:2048
  ds_read_b64_tr_b16 v[102:103], v162 offset:3072
  v_mfma_f32_32x32x16_bf16 v[64:79], v[104:107], v[144:147], v[64:79]
  v_mfma_f32_32x32x16_bf16 v[80:95], v[104:107], v[108:111], v[80:95]
  s_waitcnt lgkmcnt(12)
  v_mfma_f32_16x16x32_bf16 v[0:3], v[116:119], v[112:115], v[0:3]
  ds_read_b64_tr_b16 v[104:105], v163 offset:2048
  ds_read_b64_tr_b16 v[106:107], v163 offset:3072
  s_waitcnt lgkmcnt(11)
  v_mfma_f32_16x16x32_bf16 v[0:3], v[136:139], v[124:127], v[0:3]
  ds_read_b64_tr_b16 v[108:109], v170 offset:0
  ds_read_b64_tr_b16 v[110:111], v170 offset:1024
  s_waitcnt lgkmcnt(12)
  v_mfma_f32_16x16x32_bf16 v[32:35], v[116:119], v[128:131], v[32:35]
  ds_read_b64_tr_b16 v[116:117], v170 offset:16384
  ds_read_b64_tr_b16 v[118:119], v170 offset:17408
  s_waitcnt lgkmcnt(13)
  v_mfma_f32_16x16x32_bf16 v[32:35], v[136:139], v[120:123], v[32:35]
  ds_read_b64_tr_b16 v[136:137], v171 offset:0
  ds_read_b64_tr_b16 v[138:139], v171 offset:1024
  s_waitcnt lgkmcnt(13)
  v_mfma_f32_16x16x32_bf16 v[4:7], v[148:151], v[112:115], v[4:7]
  ds_read_b64_tr_b16 v[140:141], v171 offset:16384
  ds_read_b64_tr_b16 v[142:143], v171 offset:17408
  s_waitcnt lgkmcnt(13)
  v_mfma_f32_16x16x32_bf16 v[4:7], v[132:135], v[124:127], v[4:7]
  ds_read_b128 v[144:147], v165 offset:0
  ds_read_b64_tr_b16 v[152:153], v162 offset:10240
  v_mfma_f32_16x16x32_bf16 v[36:39], v[148:151], v[128:131], v[36:39]
  v_mfma_f32_16x16x32_bf16 v[36:39], v[132:135], v[120:123], v[36:39]
  s_waitcnt lgkmcnt(12)
  v_mfma_f32_32x32x16_bf16 v[64:79], v[96:99], v[100:103], v[64:79]
  ds_read_b64_tr_b16 v[154:155], v162 offset:11264
  ds_read_b64_tr_b16 v[100:101], v163 offset:10240
  ds_read_b64_tr_b16 v[102:103], v163 offset:11264
  s_waitcnt lgkmcnt(13)
  v_mfma_f32_32x32x16_bf16 v[80:95], v[96:99], v[104:107], v[80:95]
  ds_read_b64_tr_b16 v[96:97], v172 offset:0
  ds_read_b64_tr_b16 v[98:99], v172 offset:1024
  s_waitcnt lgkmcnt(13)
  v_mfma_f32_16x16x32_bf16 v[8:11], v[108:111], v[112:115], v[8:11]
  ds_read_b64_tr_b16 v[104:105], v172 offset:16384
  ds_read_b64_tr_b16 v[106:107], v172 offset:17408
  s_waitcnt lgkmcnt(13)
  v_mfma_f32_16x16x32_bf16 v[8:11], v[116:119], v[124:127], v[8:11]
  ds_read_b64_tr_b16 v[132:133], v173 offset:0
  ds_read_b64_tr_b16 v[134:135], v173 offset:1024
  v_mfma_f32_16x16x32_bf16 v[40:43], v[108:111], v[128:131], v[40:43]
  v_mfma_f32_16x16x32_bf16 v[40:43], v[116:119], v[120:123], v[40:43]
  s_waitcnt lgkmcnt(11)
  v_mfma_f32_16x16x32_bf16 v[12:15], v[136:139], v[112:115], v[12:15]
  ds_read_b64_tr_b16 v[108:109], v173 offset:16384
  ds_read_b64_tr_b16 v[110:111], v173 offset:17408
  v_mfma_f32_16x16x32_bf16 v[12:15], v[140:143], v[124:127], v[12:15]
  ds_read_b128 v[116:119], v166 offset:0
  ds_read_b64_tr_b16 v[148:149], v162 offset:18432
  v_mfma_f32_16x16x32_bf16 v[44:47], v[136:139], v[128:131], v[44:47]
  v_mfma_f32_16x16x32_bf16 v[44:47], v[140:143], v[120:123], v[44:47]
  s_waitcnt lgkmcnt(10)
  v_mfma_f32_32x32x16_bf16 v[64:79], v[144:147], v[152:155], v[64:79]
  ds_read_b64_tr_b16 v[150:151], v162 offset:19456
  ds_read_b64_tr_b16 v[136:137], v163 offset:18432
  ds_read_b64_tr_b16 v[138:139], v163 offset:19456
  v_mfma_f32_32x32x16_bf16 v[80:95], v[144:147], v[100:103], v[80:95]
  ds_read_b64_tr_b16 v[100:101], v174 offset:0
  ds_read_b64_tr_b16 v[102:103], v174 offset:1024
  s_waitcnt lgkmcnt(11)
  v_mfma_f32_16x16x32_bf16 v[16:19], v[96:99], v[112:115], v[16:19]
  ds_read_b64_tr_b16 v[140:141], v174 offset:16384
  ds_read_b64_tr_b16 v[142:143], v174 offset:17408
  v_mfma_f32_16x16x32_bf16 v[16:19], v[104:107], v[124:127], v[16:19]
  ds_read_b64_tr_b16 v[144:145], v175 offset:0
  ds_read_b64_tr_b16 v[146:147], v175 offset:1024
  v_mfma_f32_16x16x32_bf16 v[48:51], v[96:99], v[128:131], v[48:51]
  v_mfma_f32_16x16x32_bf16 v[48:51], v[104:107], v[120:123], v[48:51]
  s_waitcnt lgkmcnt(11)
  v_mfma_f32_16x16x32_bf16 v[20:23], v[132:135], v[112:115], v[20:23]
  ds_read_b64_tr_b16 v[96:97], v175 offset:16384
  ds_read_b64_tr_b16 v[98:99], v175 offset:17408
  v_mfma_f32_16x16x32_bf16 v[20:23], v[108:111], v[124:127], v[20:23]
  ds_read_b128 v[104:107], v167 offset:0
  ds_read_b64_tr_b16 v[152:153], v162 offset:26624
  v_mfma_f32_16x16x32_bf16 v[52:55], v[132:135], v[128:131], v[52:55]
  v_mfma_f32_16x16x32_bf16 v[52:55], v[108:111], v[120:123], v[52:55]
  s_waitcnt lgkmcnt(10)
  v_mfma_f32_32x32x16_bf16 v[64:79], v[116:119], v[148:151], v[64:79]
  ds_read_b64_tr_b16 v[154:155], v162 offset:27648
  ds_read_b64_tr_b16 v[108:109], v163 offset:26624
  ds_read_b64_tr_b16 v[110:111], v163 offset:27648
  v_mfma_f32_32x32x16_bf16 v[80:95], v[116:119], v[136:139], v[80:95]
  v_add_u32 v168, -65536, v168
  v_add_u32 v169, -65536, v169
  v_add_u32 v170, -65536, v170
  s_waitcnt lgkmcnt(9)
  v_mfma_f32_16x16x32_bf16 v[24:27], v[100:103], v[112:115], v[24:27]
  v_add_u32 v171, -65536, v171
  v_add_u32 v172, -65536, v172
  v_mfma_f32_16x16x32_bf16 v[24:27], v[140:143], v[124:127], v[24:27]
  v_add_u32 v173, -65536, v173
  v_add_u32 v174, -65536, v174
  s_waitcnt vmcnt(0)
  s_waitcnt lgkmcnt(0)
  s_barrier
  v_add_u32 v175, -65536, v175
  v_add_u32 v162, -65536, v162
  v_add_u32 v163, -65536, v163
  ds_read_b128 v[116:119], v160 offset:32768
  ds_read_b64_tr_b16 v[132:133], v168 offset:0
  ds_read_b64_tr_b16 v[134:135], v168 offset:1024
  v_mfma_f32_16x16x32_bf16 v[56:59], v[100:103], v[128:131], v[56:59]
  ds_read_b128 v[100:103], v161 offset:32768
  ds_read_b64_tr_b16 v[136:137], v168 offset:16384
  v_mfma_f32_16x16x32_bf16 v[56:59], v[140:143], v[120:123], v[56:59]
  ds_read_b64_tr_b16 v[138:139], v168 offset:17408
  ds_read_b128 v[140:143], v160 offset:34816
  v_mfma_f32_16x16x32_bf16 v[28:31], v[144:147], v[112:115], v[28:31]
  ds_read_b128 v[112:115], v161 offset:34816
  ds_read_b64_tr_b16 v[148:149], v169 offset:0
  v_mfma_f32_16x16x32_bf16 v[28:31], v[96:99], v[124:127], v[28:31]
  ds_read_b64_tr_b16 v[150:151], v169 offset:1024
  ds_read_b64_tr_b16 v[124:125], v169 offset:16384
  v_mfma_f32_16x16x32_bf16 v[60:63], v[144:147], v[128:131], v[60:63]
  ds_read_b64_tr_b16 v[126:127], v169 offset:17408
  ds_read_b128 v[128:131], v164 offset:32768
  v_mfma_f32_16x16x32_bf16 v[60:63], v[96:99], v[120:123], v[60:63]
  ds_read_b64_tr_b16 v[96:97], v162 offset:2048
  ds_read_b64_tr_b16 v[98:99], v162 offset:3072
  v_mfma_f32_32x32x16_bf16 v[64:79], v[104:107], v[152:155], v[64:79]
  v_mfma_f32_32x32x16_bf16 v[80:95], v[104:107], v[108:111], v[80:95]
  s_waitcnt lgkmcnt(12)
  v_mfma_f32_16x16x32_bf16 v[0:3], v[132:135], v[116:119], v[0:3]
  ds_read_b64_tr_b16 v[104:105], v163 offset:2048
  ds_read_b64_tr_b16 v[106:107], v163 offset:3072
  s_waitcnt lgkmcnt(11)
  v_mfma_f32_16x16x32_bf16 v[0:3], v[136:139], v[100:103], v[0:3]
  ds_read_b64_tr_b16 v[108:109], v170 offset:0
  ds_read_b64_tr_b16 v[110:111], v170 offset:1024
  s_waitcnt lgkmcnt(12)
  v_mfma_f32_16x16x32_bf16 v[32:35], v[132:135], v[140:143], v[32:35]
  ds_read_b64_tr_b16 v[120:121], v170 offset:16384
  ds_read_b64_tr_b16 v[122:123], v170 offset:17408
  s_waitcnt lgkmcnt(13)
  v_mfma_f32_16x16x32_bf16 v[32:35], v[136:139], v[112:115], v[32:35]
  ds_read_b64_tr_b16 v[132:133], v171 offset:0
  ds_read_b64_tr_b16 v[134:135], v171 offset:1024
  s_waitcnt lgkmcnt(13)
  v_mfma_f32_16x16x32_bf16 v[4:7], v[148:151], v[116:119], v[4:7]
  ds_read_b64_tr_b16 v[136:137], v171 offset:16384
  ds_read_b64_tr_b16 v[138:139], v171 offset:17408
  s_waitcnt lgkmcnt(13)
  v_mfma_f32_16x16x32_bf16 v[4:7], v[124:127], v[100:103], v[4:7]
  ds_read_b128 v[144:147], v165 offset:32768
  ds_read_b64_tr_b16 v[152:153], v162 offset:10240
  v_mfma_f32_16x16x32_bf16 v[36:39], v[148:151], v[140:143], v[36:39]
  v_mfma_f32_16x16x32_bf16 v[36:39], v[124:127], v[112:115], v[36:39]
  s_waitcnt lgkmcnt(12)
  v_mfma_f32_32x32x16_bf16 v[64:79], v[128:131], v[96:99], v[64:79]
  ds_read_b64_tr_b16 v[154:155], v162 offset:11264
  ds_read_b64_tr_b16 v[96:97], v163 offset:10240
  ds_read_b64_tr_b16 v[98:99], v163 offset:11264
  s_waitcnt lgkmcnt(13)
  v_mfma_f32_32x32x16_bf16 v[80:95], v[128:131], v[104:107], v[80:95]
  ds_read_b64_tr_b16 v[104:105], v172 offset:0
  ds_read_b64_tr_b16 v[106:107], v172 offset:1024
  s_waitcnt lgkmcnt(13)
  v_mfma_f32_16x16x32_bf16 v[8:11], v[108:111], v[116:119], v[8:11]
  ds_read_b64_tr_b16 v[124:125], v172 offset:16384
  ds_read_b64_tr_b16 v[126:127], v172 offset:17408
  s_waitcnt lgkmcnt(13)
  v_mfma_f32_16x16x32_bf16 v[8:11], v[120:123], v[100:103], v[8:11]
  ds_read_b64_tr_b16 v[128:129], v173 offset:0
  ds_read_b64_tr_b16 v[130:131], v173 offset:1024
  v_mfma_f32_16x16x32_bf16 v[40:43], v[108:111], v[140:143], v[40:43]
  v_mfma_f32_16x16x32_bf16 v[40:43], v[120:123], v[112:115], v[40:43]
  s_waitcnt lgkmcnt(11)
  v_mfma_f32_16x16x32_bf16 v[12:15], v[132:135], v[116:119], v[12:15]
  ds_read_b64_tr_b16 v[108:109], v173 offset:16384
  ds_read_b64_tr_b16 v[110:111], v173 offset:17408
  v_mfma_f32_16x16x32_bf16 v[12:15], v[136:139], v[100:103], v[12:15]
  ds_read_b128 v[120:123], v166 offset:32768
  ds_read_b64_tr_b16 v[148:149], v162 offset:18432
  v_mfma_f32_16x16x32_bf16 v[44:47], v[132:135], v[140:143], v[44:47]
  v_mfma_f32_16x16x32_bf16 v[44:47], v[136:139], v[112:115], v[44:47]
  s_waitcnt lgkmcnt(10)
  v_mfma_f32_32x32x16_bf16 v[64:79], v[144:147], v[152:155], v[64:79]
  ds_read_b64_tr_b16 v[150:151], v162 offset:19456
  ds_read_b64_tr_b16 v[132:133], v163 offset:18432
  ds_read_b64_tr_b16 v[134:135], v163 offset:19456
  v_mfma_f32_32x32x16_bf16 v[80:95], v[144:147], v[96:99], v[80:95]
  ds_read_b64_tr_b16 v[96:97], v174 offset:0
  ds_read_b64_tr_b16 v[98:99], v174 offset:1024
  s_waitcnt lgkmcnt(11)
  v_mfma_f32_16x16x32_bf16 v[16:19], v[104:107], v[116:119], v[16:19]
  ds_read_b64_tr_b16 v[136:137], v174 offset:16384
  ds_read_b64_tr_b16 v[138:139], v174 offset:17408
  v_mfma_f32_16x16x32_bf16 v[16:19], v[124:127], v[100:103], v[16:19]
  ds_read_b64_tr_b16 v[144:145], v175 offset:0
  ds_read_b64_tr_b16 v[146:147], v175 offset:1024
  v_mfma_f32_16x16x32_bf16 v[48:51], v[104:107], v[140:143], v[48:51]
  v_mfma_f32_16x16x32_bf16 v[48:51], v[124:127], v[112:115], v[48:51]
  s_waitcnt lgkmcnt(11)
  v_mfma_f32_16x16x32_bf16 v[20:23], v[128:131], v[116:119], v[20:23]
  ds_read_b64_tr_b16 v[104:105], v175 offset:16384
  ds_read_b64_tr_b16 v[106:107], v175 offset:17408
  v_mfma_f32_16x16x32_bf16 v[20:23], v[108:111], v[100:103], v[20:23]
  ds_read_b128 v[124:127], v167 offset:32768
  ds_read_b64_tr_b16 v[152:153], v162 offset:26624
  v_mfma_f32_16x16x32_bf16 v[52:55], v[128:131], v[140:143], v[52:55]
  v_mfma_f32_16x16x32_bf16 v[52:55], v[108:111], v[112:115], v[52:55]
  s_waitcnt lgkmcnt(10)
  v_mfma_f32_32x32x16_bf16 v[64:79], v[120:123], v[148:151], v[64:79]
  ds_read_b64_tr_b16 v[154:155], v162 offset:27648
  ds_read_b64_tr_b16 v[108:109], v163 offset:26624
  ds_read_b64_tr_b16 v[110:111], v163 offset:27648
  v_mfma_f32_32x32x16_bf16 v[80:95], v[120:123], v[132:135], v[80:95]
  s_waitcnt lgkmcnt(9)
  v_mfma_f32_16x16x32_bf16 v[24:27], v[96:99], v[116:119], v[24:27]
  v_mfma_f32_16x16x32_bf16 v[24:27], v[136:139], v[100:103], v[24:27]
  s_waitcnt lgkmcnt(0)
  s_barrier
  s_bfe_u32 s57, s92, 0x10001
  s_and_b32 s58, s92, 1
  s_lshl_b32 s58, s58, 12
  s_lshl_b32 s57, s57, 14
  s_sub_u32 s56, s58, s57
  s_add_u32 s52, s56, 163840
  s_add_u32 s53, s56, 155648
  s_add_u32 s54, s56, 131072
  s_add_u32 s55, s56, 122880
  s_add_u32 s59, s58, 98304
  s_add_u32 s60, s58, 131072
  s_cmp_eq_u32 s57, 0
  s_cselect_b32 s52, s59, s52
  s_cselect_b32 s54, s60, s54
  s_lshl_b32 s56, s94, 12
  s_add_u32 s56, s56, 73728
  v_add_u32 v160, s52, v253
  v_add_u32 v161, s53, v253
  v_add_u32 v162, s54, v253
  v_add_u32 v163, s55, v253
  v_add_u32 v164, s56, v253
  v_mfma_f32_16x16x32_bf16 v[56:59], v[96:99], v[140:143], v[56:59]
  ds_write_b128 v160, v[176:179] offset:0
  ds_write_b128 v160, v[180:183] offset:1024
  v_mfma_f32_16x16x32_bf16 v[56:59], v[136:139], v[112:115], v[56:59]
  ds_write_b128 v160, v[184:187] offset:2048
  ds_write_b128 v160, v[188:191] offset:3072
  v_mfma_f32_16x16x32_bf16 v[28:31], v[144:147], v[116:119], v[28:31]
  ds_write_b128 v161, v[192:195] offset:0
  ds_write_b128 v161, v[196:199] offset:1024
  v_mfma_f32_16x16x32_bf16 v[28:31], v[104:107], v[100:103], v[28:31]
  ds_write_b128 v161, v[200:203] offset:2048
  ds_write_b128 v161, v[204:207] offset:3072
  v_mfma_f32_16x16x32_bf16 v[60:63], v[144:147], v[140:143], v[60:63]
  ds_write_b128 v162, v[216:219] offset:0
  ds_write_b128 v162, v[220:223] offset:1024
  v_mfma_f32_16x16x32_bf16 v[60:63], v[104:107], v[112:115], v[60:63]
  ds_write_b128 v162, v[224:227] offset:2048
  ds_write_b128 v162, v[228:231] offset:3072
  v_mfma_f32_32x32x16_bf16 v[64:79], v[124:127], v[152:155], v[64:79]
  ds_write_b128 v163, v[232:235] offset:0
  ds_write_b128 v163, v[236:239] offset:1024
  v_mfma_f32_32x32x16_bf16 v[80:95], v[124:127], v[108:111], v[80:95]
  ds_write_b128 v163, v[240:243] offset:2048
  ds_write_b128 v163, v[244:247] offset:3072
  v_bfe_u32 v165, v254, 3, 1
  v_lshlrev_b32 v165, 10, v165
  v_and_b32 v166, 7, v254
  v_lshl_add_u32 v165, v166, 2, v165
  s_lshl_b32 s52, s93, 2
  s_add_u32 s52, s52, s80
  s_lshl_b32 s52, s52, 12
  s_lshl_b32 s53, s91, 7
  s_add_u32 s52, s52, s53
  s_add_u32 s52, s52, 60817504
  buffer_load_dword v168, v165, s[28:31], s52 offen sc1
  buffer_load_dword v171, v165, s[28:31], s52 offen offset:2048 sc1
  s_mov_b32 s52, 0x3e0293ee
  s_mov_b32 s53, 0x3e0293ee
  v_pk_mul_f32 v[0:1], v[0:1], s[52:53]
  v_pk_mul_f32 v[2:3], v[2:3], s[52:53]
  v_pk_mul_f32 v[4:5], v[4:5], s[52:53]
  v_pk_mul_f32 v[6:7], v[6:7], s[52:53]
  v_pk_mul_f32 v[8:9], v[8:9], s[52:53]
  v_pk_mul_f32 v[10:11], v[10:11], s[52:53]
  v_pk_mul_f32 v[12:13], v[12:13], s[52:53]
  v_pk_mul_f32 v[14:15], v[14:15], s[52:53]
  v_pk_mul_f32 v[16:17], v[16:17], s[52:53]
  v_pk_mul_f32 v[18:19], v[18:19], s[52:53]
  v_pk_mul_f32 v[20:21], v[20:21], s[52:53]
  v_pk_mul_f32 v[22:23], v[22:23], s[52:53]
  v_pk_mul_f32 v[24:25], v[24:25], s[52:53]
  v_pk_mul_f32 v[26:27], v[26:27], s[52:53]
  v_pk_mul_f32 v[28:29], v[28:29], s[52:53]
  v_pk_mul_f32 v[30:31], v[30:31], s[52:53]
  v_pk_mul_f32 v[32:33], v[32:33], s[52:53]
  v_pk_mul_f32 v[34:35], v[34:35], s[52:53]
  v_pk_mul_f32 v[36:37], v[36:37], s[52:53]
  v_pk_mul_f32 v[38:39], v[38:39], s[52:53]
  v_pk_mul_f32 v[40:41], v[40:41], s[52:53]
  v_pk_mul_f32 v[42:43], v[42:43], s[52:53]
  v_pk_mul_f32 v[44:45], v[44:45], s[52:53]
  v_pk_mul_f32 v[46:47], v[46:47], s[52:53]
  v_pk_mul_f32 v[48:49], v[48:49], s[52:53]
  v_pk_mul_f32 v[50:51], v[50:51], s[52:53]
  v_pk_mul_f32 v[52:53], v[52:53], s[52:53]
  v_pk_mul_f32 v[54:55], v[54:55], s[52:53]
  v_pk_mul_f32 v[56:57], v[56:57], s[52:53]
  v_pk_mul_f32 v[58:59], v[58:59], s[52:53]
  v_pk_mul_f32 v[60:61], v[60:61], s[52:53]
  v_pk_mul_f32 v[62:63], v[62:63], s[52:53]
  v_cvt_pk_bf16_f32 v176, v0, v1
  v_cvt_pk_bf16_f32 v177, v2, v3
  v_cvt_pk_bf16_f32 v178, v4, v5
  v_cvt_pk_bf16_f32 v179, v6, v7
  v_cvt_pk_bf16_f32 v180, v8, v9
  v_cvt_pk_bf16_f32 v181, v10, v11
  v_cvt_pk_bf16_f32 v182, v12, v13
  v_cvt_pk_bf16_f32 v183, v14, v15
  v_cvt_pk_bf16_f32 v184, v16, v17
  v_cvt_pk_bf16_f32 v185, v18, v19
  v_cvt_pk_bf16_f32 v186, v20, v21
  v_cvt_pk_bf16_f32 v187, v22, v23
  v_cvt_pk_bf16_f32 v188, v24, v25
  v_cvt_pk_bf16_f32 v189, v26, v27
  v_cvt_pk_bf16_f32 v190, v28, v29
  v_cvt_pk_bf16_f32 v191, v30, v31
  v_cvt_pk_bf16_f32 v192, v32, v33
  v_cvt_pk_bf16_f32 v193, v34, v35
  v_cvt_pk_bf16_f32 v194, v36, v37
  v_cvt_pk_bf16_f32 v195, v38, v39
  v_cvt_pk_bf16_f32 v196, v40, v41
  v_cvt_pk_bf16_f32 v197, v42, v43
  v_cvt_pk_bf16_f32 v198, v44, v45
  v_cvt_pk_bf16_f32 v199, v46, v47
  v_cvt_pk_bf16_f32 v200, v48, v49
  v_cvt_pk_bf16_f32 v201, v50, v51
  v_cvt_pk_bf16_f32 v202, v52, v53
  v_cvt_pk_bf16_f32 v203, v54, v55
  v_cvt_pk_bf16_f32 v204, v56, v57
  v_cvt_pk_bf16_f32 v205, v58, v59
  v_cvt_pk_bf16_f32 v206, v60, v61
  v_cvt_pk_bf16_f32 v207, v62, v63
  v_cvt_pk_bf16_f32 v136, v64, v65
  v_cvt_pk_bf16_f32 v137, v66, v67
  v_cvt_pk_bf16_f32 v138, v68, v69
  v_cvt_pk_bf16_f32 v139, v70, v71
  v_cvt_pk_bf16_f32 v140, v72, v73
  v_cvt_pk_bf16_f32 v141, v74, v75
  v_cvt_pk_bf16_f32 v142, v76, v77
  v_cvt_pk_bf16_f32 v143, v78, v79
  ds_write_b128 v164, v[136:139] offset:0
  ds_write_b128 v164, v[140:143] offset:1024
  v_cvt_pk_bf16_f32 v144, v80, v81
  v_cvt_pk_bf16_f32 v145, v82, v83
  v_cvt_pk_bf16_f32 v146, v84, v85
  v_cvt_pk_bf16_f32 v147, v86, v87
  v_cvt_pk_bf16_f32 v148, v88, v89
  v_cvt_pk_bf16_f32 v149, v90, v91
  v_cvt_pk_bf16_f32 v150, v92, v93
  v_cvt_pk_bf16_f32 v151, v94, v95
  ds_write_b128 v164, v[144:147] offset:2048
  ds_write_b128 v164, v[148:151] offset:3072
  s_branch L_apro
L_apro:
  s_cmp_eq_u32 s93, 0
  s_cselect_b32 s52, 32768, 0
  s_mov_b32 s3, 0
  s_add_u32 s53, s52, 98304
  v_add_u32 v169, s52, v253
  v_add_u32 v170, s53, v253
  v_and_b32 v208, 15, v254
  v_lshrrev_b32 v209, 4, v254
  v_lshlrev_b32 v209, 2, v209
  v_sub_u32 v214, v208, v209
  v_mov_b32 v215, 0xff800000
  v_mov_b32 v104, 0
  v_mov_b32 v105, 0
  v_mov_b32 v106, 0
  v_mov_b32 v107, 0
  v_mov_b32 v108, 0
  v_mov_b32 v109, 0
  v_mov_b32 v110, 0
  v_mov_b32 v111, 0
  s_mov_b32 s64, 0
  s_mov_b32 s69, 0
  s_mov_b32 s0, 0
  s_lshl_b32 s1, s71, 2
  s_add_u32 s1, s1, s72
  s_mul_i32 s1, s1, 294912
  s_add_u32 s1, s1, 67108864
  s_add_u32 s85, s93, 8
  s_add_u32 s48, s78, 1
  s_cmp_eq_u32 s48, s97
  s_cselect_b32 s48, s78, 99
  s_mov_b32 s20, 0x3fb8aa3b
  s_mov_b32 s22, 0x358637bd
  s_mov_b32 s7, s82
  s_cmp_ge_u32 s77, s91
  s_addc_u32 s82, s77, 0
  s_cmp_lg_u32 s94, 0
  s_cselect_b32 s15, s82, s7
  s_lshl_b32 s15, s15, 15
  s_sub_u32 s14, 15, s82
  s_min_u32 s14, s14, s82
  s_lshl_b32 s14, s14, 3
  s_lshl_b64 s[8:9], 0xff, s14
  s_lshr_b32 s14, s82, 3
  s_lshl_b32 s6, s14, 5
  s_lshl_b32 s14, s82, 15
  s_add_u32 s4, s73, s14
  s_add_u32 s5, s74, s15
  s_cmp_eq_u32 s93, 0
  s_cbranch_scc1 L_noprio
  s_setprio 1
L_noprio:
  s_waitcnt lgkmcnt(0)
  s_barrier
  s_cmp_eq_u32 s93, 0
  s_cbranch_scc1 L_nofc
  s_andn2_b32 s18, s90, 7
  s_lshr_b32 s56, s80, 1
  s_lshl_b32 s56, s56, 2
  s_add_u32 s18, s18, s56
  s_lshl_b32 s18, s18, 3
  s_add_u32 s18, s18, s91
  s_lshl_b32 s18, s18, 3
  s_and_b32 s56, s90, 7
  s_add_u32 s18, s18, s56
  s_lshl_b32 s18, s18, 4
  s_add_u32 s18, s18, s93
  s_lshl_b32 s18, s18, 1
  s_and_b32 s56, s80, 1
  s_add_u32 s18, s18, s56
  s_lshl_b32 s18, s18, 2
  s_add_u32 s18, s18, 61079552
  s_lshl_b32 s56, s79, 2
  s_add_u32 s56, s56, s80
  s_mul_i32 s56, s56, 288
  s_lshl_b32 s57, s90, 3
  s_add_u32 s56, s56, s57
  s_lshl_b32 s56, s56, 10
  s_add_u32 s65, s56, 33554432
  s_mul_i32 s56, s92, 36864
  s_add_u32 s2, s1, s56
  s_bfe_u32 s56, s90, 0x10002
  s_lshl_b32 s56, s56, 1
  s_add_u32 s56, s56, s93
  s_lshl_b32 s57, s91, 2
  s_sub_u32 s58, 60, s57
  s_add_u32 s57, s57, s56
  s_add_u32 s58, s58, s56
  s_cmp_eq_u32 s91, 7
  s_cselect_b32 s19, s58, s57
  s_cselect_b32 s21, s57, s58
  s_cselect_b32 s47, 0x33, 0xcc
  s_lshl_b32 s56, s71, 13
  s_lshl_b32 s57, s72, 8
  s_add_u32 s56, s56, s57
  s_lshl_b32 s66, s19, 15
  s_add_u32 s66, s66, s56
  s_lshl_b32 s67, s21, 15
  s_add_u32 s67, s67, s56
  s_lshl_b32 s56, s71, 3
  s_add_u32 s56, s56, s92
  s_lshl_b32 s57, s56, 13
  s_add_u32 s57, s57, 33554432
  s_mul_i32 s19, s19, 294912
  s_add_u32 s19, s19, s57
  s_mul_i32 s21, s21, 294912
  s_add_u32 s21, s21, s57
  s_mul_i32 s24, s56, 7168
  s_sub_u32 s24, 253952, s24
  s_mul_i32 s56, s94, 3072
  s_bitcmp1_b32 s97, 0
  s_cselect_b32 s57, 49152, 0
  s_cselect_b32 s58, 0, 49152
  s_cmp_eq_u32 s93, 0
  s_cselect_b32 s25, 73728, s57
  s_cselect_b32 s26, 24576, s58
  s_cselect_b32 s44, s57, 73728
  s_cselect_b32 s45, s58, 24576
  s_cselect_b32 s27, 0, 24
  s_cselect_b32 s23, 1, -1
  s_mul_i32 s68, s23, 327680
  s_add_u32 s68, s68, s19
  s_mul_i32 s23, s23, 294912
  s_lshl_b32 s27, s27, 10
  s_add_u32 s27, s27, 98304
  s_add_u32 s25, s25, s56
  s_add_u32 s26, s26, s56
  s_add_u32 s27, s27, s56
  s_add_u32 s44, s44, s56
  s_add_u32 s45, s45, s56
  s_mov_b32 s46, 0
L_nofc:
  s_cmp_eq_u32 s80, 2
  s_cbranch_scc1 L_pro1
  s_cmp_eq_u32 s80, 1
  s_cbranch_scc1 L_pro2
  s_cmp_eq_u32 s80, 0
  s_cbranch_scc1 L_pro3
L_pro0:
  ds_read_b128 v[128:131], v169 offset:0
  ds_read_b128 v[132:135], v169 offset:1024
  ds_read_b128 v[136:139], v169 offset:4096
  ds_read_b128 v[140:143], v169 offset:5120
  ds_read_b128 v[144:147], v169 offset:2048
  ds_read_b128 v[148:151], v169 offset:3072
  ds_read_b128 v[152:155], v169 offset:6144
  ds_read_b128 v[156:159], v169 offset:7168
  v_mov_b32 v164, 0x3f803f80
  v_mov_b32 v165, 0x3f803f80
  v_mov_b32 v166, 0x3f803f80
  v_mov_b32 v167, 0x3f803f80
  s_waitcnt lgkmcnt(6)
  v_mfma_f32_16x16x32_bf16 v[64:67], v[128:131], v[176:179], 0
  v_mov_b32 v0, 0
  v_mov_b32 v1, 0
  v_mov_b32 v2, 0
  v_mov_b32 v3, 0
  v_mov_b32 v4, 0
  v_mfma_f32_16x16x32_bf16 v[64:67], v[132:135], v[180:183], v[64:67]
  v_mov_b32 v5, 0
  v_mov_b32 v6, 0
  v_mov_b32 v7, 0
  v_mov_b32 v8, 0
  v_mov_b32 v9, 0
  v_mfma_f32_16x16x32_bf16 v[72:75], v[128:131], v[192:195], 0
  v_mov_b32 v10, 0
  v_mov_b32 v11, 0
  v_mov_b32 v12, 0
  v_mov_b32 v13, 0
  v_mov_b32 v14, 0
  v_mfma_f32_16x16x32_bf16 v[72:75], v[132:135], v[196:199], v[72:75]
  v_mov_b32 v15, 0
  v_mov_b32 v16, 0
  v_mov_b32 v17, 0
  v_mov_b32 v18, 0
  v_mov_b32 v19, 0
  s_waitcnt lgkmcnt(4)
  v_mfma_f32_16x16x32_bf16 v[64:67], v[136:139], v[184:187], v[64:67]
  v_mov_b32 v20, 0
  v_mov_b32 v21, 0
  v_mov_b32 v22, 0
  v_mov_b32 v23, 0
  v_mov_b32 v24, 0
  v_mfma_f32_16x16x32_bf16 v[64:67], v[140:143], v[188:191], v[64:67]
  v_mov_b32 v25, 0
  v_mov_b32 v26, 0
  v_mov_b32 v27, 0
  v_mov_b32 v28, 0
  v_mov_b32 v29, 0
  v_mfma_f32_16x16x32_bf16 v[72:75], v[136:139], v[200:203], v[72:75]
  v_mov_b32 v30, 0
  v_mov_b32 v31, 0
  v_mov_b32 v32, 0
  v_mov_b32 v33, 0
  v_mov_b32 v34, 0
  v_mfma_f32_16x16x32_bf16 v[72:75], v[140:143], v[204:207], v[72:75]
  v_mov_b32 v35, 0
  v_mov_b32 v36, 0
  v_mov_b32 v37, 0
  v_mov_b32 v38, 0
  v_mov_b32 v39, 0
  s_waitcnt lgkmcnt(2)
  v_mfma_f32_16x16x32_bf16 v[76:79], v[144:147], v[192:195], 0
  v_mov_b32 v40, 0
  v_mov_b32 v41, 0
  v_mov_b32 v42, 0
  v_mov_b32 v43, 0
  v_mov_b32 v44, 0
  v_mov_b32 v45, 0
  v_mfma_f32_16x16x32_bf16 v[76:79], v[148:151], v[196:199], v[76:79]
  v_mov_b32 v46, 0
  v_mov_b32 v47, 0
  v_mov_b32 v48, 0
  v_mov_b32 v49, 0
  v_mov_b32 v50, 0
  v_mov_b32 v51, 0
  s_waitcnt lgkmcnt(0)
  v_mfma_f32_16x16x32_bf16 v[76:79], v[152:155], v[200:203], v[76:79]
  v_mov_b32 v52, 0
  v_mov_b32 v53, 0
  v_mov_b32 v54, 0
  v_mov_b32 v55, 0
  v_mov_b32 v56, 0
  v_mov_b32 v57, 0
  v_mfma_f32_16x16x32_bf16 v[76:79], v[156:159], v[204:207], v[76:79]
  v_mov_b32 v58, 0
  v_mov_b32 v59, 0
  v_mov_b32 v60, 0
  v_mov_b32 v61, 0
  v_mov_b32 v62, 0
  v_mov_b32 v63, 0
  ds_read_b128 v[128:131], v169 offset:8192
  ds_read_b128 v[132:135], v169 offset:9216
  ds_read_b128 v[136:139], v169 offset:12288
  ds_read_b128 v[140:143], v169 offset:13312
  ds_read_b128 v[144:147], v169 offset:10240
  ds_read_b128 v[148:151], v169 offset:11264
  v_cmp_le_i32 s[52:53], 0, v214
  v_cmp_le_i32 s[54:55], 1, v214
  v_cmp_le_i32 s[56:57], 2, v214
  v_cmp_le_i32 s[58:59], 3, v214
  v_mov_b32 v68, v215
  v_mov_b32 v69, v215
  v_mov_b32 v70, v215
  v_mov_b32 v71, v215
  v_cndmask_b32 v64, v215, v64, s[52:53]
  v_cndmask_b32 v65, v215, v65, s[54:55]
  v_cndmask_b32 v66, v215, v66, s[56:57]
  v_cndmask_b32 v67, v215, v67, s[58:59]
  v_cndmask_b32 v76, v215, v76, s[52:53]
  v_cndmask_b32 v77, v215, v77, s[54:55]
  v_cndmask_b32 v78, v215, v78, s[56:57]
  v_cndmask_b32 v79, v215, v79, s[58:59]
  v_max3_f32 v208, v64, v65, v66
  v_max3_f32 v210, v67, v68, v69
  v_max3_f32 v209, v72, v73, v74
  v_max3_f32 v211, v75, v76, v77
  v_max3_f32 v208, v208, v70, v71
  v_max3_f32 v209, v209, v78, v79
  v_max_f32 v208, v208, v210
  v_max_f32 v209, v209, v211
  v_mov_b32 v210, v208
  v_mov_b32 v211, v209
  s_nop 0
  v_permlane16_swap_b32 v208, v210
  v_permlane16_swap_b32 v209, v211
  s_nop 0
  v_max_f32 v208, v208, v210
  v_max_f32 v209, v209, v211
  v_mov_b32 v210, v208
  v_mov_b32 v211, v209
  s_nop 0
  v_permlane32_swap_b32 v208, v210
  v_permlane32_swap_b32 v209, v211
  s_nop 0
  v_max_f32 v208, v208, v210
  v_max_f32 v209, v209, v211
  v_sub_f32 v64, v64, v208
  v_sub_f32 v65, v65, v208
  v_sub_f32 v66, v66, v208
  v_sub_f32 v67, v67, v208
  v_sub_f32 v68, v68, v208
  v_sub_f32 v69, v69, v208
  v_sub_f32 v70, v70, v208
  v_sub_f32 v71, v71, v208
  v_sub_f32 v72, v72, v209
  v_sub_f32 v73, v73, v209
  v_sub_f32 v74, v74, v209
  v_sub_f32 v75, v75, v209
  v_sub_f32 v76, v76, v209
  v_sub_f32 v77, v77, v209
  v_sub_f32 v78, v78, v209
  v_sub_f32 v79, v79, v209
  v_sub_f32 v96, 0, v208
  v_sub_f32 v97, 0, v208
  v_sub_f32 v98, 0, v208
  v_sub_f32 v99, 0, v208
  v_sub_f32 v100, 0, v209
  v_sub_f32 v101, 0, v209
  v_sub_f32 v102, 0, v209
  v_sub_f32 v103, 0, v209
  v_exp_f32 v160, v64
  v_exp_f32 v161, v65
  s_nop 0
  v_cvt_pk_bf16_f32 v112, v160, v161
  v_exp_f32 v162, v66
  v_exp_f32 v163, v67
  v_exp_f32 v160, v72
  s_nop 0
  v_cvt_pk_bf16_f32 v113, v162, v163
  v_exp_f32 v161, v73
  v_exp_f32 v162, v74
  s_nop 0
  v_cvt_pk_bf16_f32 v116, v160, v161
  v_exp_f32 v163, v75
  v_exp_f32 v160, v68
  s_nop 0
  v_cvt_pk_bf16_f32 v117, v162, v163
  v_exp_f32 v161, v69
  v_exp_f32 v162, v70
  s_nop 0
  v_cvt_pk_bf16_f32 v114, v160, v161
  v_exp_f32 v163, v71
  s_waitcnt lgkmcnt(4)
  s_branch L_it1
L_pro1:
  ds_read_b128 v[128:131], v169 offset:8192
  ds_read_b128 v[132:135], v169 offset:9216
  ds_read_b128 v[136:139], v169 offset:12288
  ds_read_b128 v[140:143], v169 offset:13312
  ds_read_b128 v[144:147], v169 offset:10240
  ds_read_b128 v[148:151], v169 offset:11264
  ds_read_b128 v[152:155], v169 offset:14336
  ds_read_b128 v[156:159], v169 offset:15360
  v_mov_b32 v164, 0x3f803f80
  v_mov_b32 v165, 0x3f803f80
  v_mov_b32 v166, 0x3f803f80
  v_mov_b32 v167, 0x3f803f80
  s_waitcnt lgkmcnt(6)
  v_mfma_f32_16x16x32_bf16 v[80:83], v[128:131], v[176:179], 0
  v_mov_b32 v0, 0
  v_mov_b32 v1, 0
  v_mov_b32 v2, 0
  v_mov_b32 v3, 0
  v_mov_b32 v4, 0
  v_mfma_f32_16x16x32_bf16 v[80:83], v[132:135], v[180:183], v[80:83]
  v_mov_b32 v5, 0
  v_mov_b32 v6, 0
  v_mov_b32 v7, 0
  v_mov_b32 v8, 0
  v_mov_b32 v9, 0
  v_mfma_f32_16x16x32_bf16 v[88:91], v[128:131], v[192:195], 0
  v_mov_b32 v10, 0
  v_mov_b32 v11, 0
  v_mov_b32 v12, 0
  v_mov_b32 v13, 0
  v_mov_b32 v14, 0
  v_mfma_f32_16x16x32_bf16 v[88:91], v[132:135], v[196:199], v[88:91]
  v_mov_b32 v15, 0
  v_mov_b32 v16, 0
  v_mov_b32 v17, 0
  v_mov_b32 v18, 0
  v_mov_b32 v19, 0
  s_waitcnt lgkmcnt(4)
  v_mfma_f32_16x16x32_bf16 v[80:83], v[136:139], v[184:187], v[80:83]
  v_mov_b32 v20, 0
  v_mov_b32 v21, 0
  v_mov_b32 v22, 0
  v_mov_b32 v23, 0
  v_mov_b32 v24, 0
  v_mfma_f32_16x16x32_bf16 v[80:83], v[140:143], v[188:191], v[80:83]
  v_mov_b32 v25, 0
  v_mov_b32 v26, 0
  v_mov_b32 v27, 0
  v_mov_b32 v28, 0
  v_mov_b32 v29, 0
  v_mfma_f32_16x16x32_bf16 v[88:91], v[136:139], v[200:203], v[88:91]
  v_mov_b32 v30, 0
  v_mov_b32 v31, 0
  v_mov_b32 v32, 0
  v_mov_b32 v33, 0
  v_mov_b32 v34, 0
  v_mfma_f32_16x16x32_bf16 v[88:91], v[140:143], v[204:207], v[88:91]
  v_mov_b32 v35, 0
  v_mov_b32 v36, 0
  v_mov_b32 v37, 0
  v_mov_b32 v38, 0
  v_mov_b32 v39, 0
  s_waitcnt lgkmcnt(2)
  v_mfma_f32_16x16x32_bf16 v[92:95], v[144:147], v[192:195], 0
  v_mov_b32 v40, 0
  v_mov_b32 v41, 0
  v_mov_b32 v42, 0
  v_mov_b32 v43, 0
  v_mov_b32 v44, 0
  v_mov_b32 v45, 0
  v_mfma_f32_16x16x32_bf16 v[92:95], v[148:151], v[196:199], v[92:95]
  v_mov_b32 v46, 0
  v_mov_b32 v47, 0
  v_mov_b32 v48, 0
  v_mov_b32 v49, 0
  v_mov_b32 v50, 0
  v_mov_b32 v51, 0
  s_waitcnt lgkmcnt(0)
  v_mfma_f32_16x16x32_bf16 v[92:95], v[152:155], v[200:203], v[92:95]
  v_mov_b32 v52, 0
  v_mov_b32 v53, 0
  v_mov_b32 v54, 0
  v_mov_b32 v55, 0
  v_mov_b32 v56, 0
  v_mov_b32 v57, 0
  v_mfma_f32_16x16x32_bf16 v[92:95], v[156:159], v[204:207], v[92:95]
  v_mov_b32 v58, 0
  v_mov_b32 v59, 0
  v_mov_b32 v60, 0
  v_mov_b32 v61, 0
  v_mov_b32 v62, 0
  v_mov_b32 v63, 0
  ds_read_b128 v[128:131], v169 offset:16384
  ds_read_b128 v[132:135], v169 offset:17408
  ds_read_b128 v[136:139], v169 offset:20480
  ds_read_b128 v[140:143], v169 offset:21504
  ds_read_b128 v[144:147], v169 offset:18432
  ds_read_b128 v[148:151], v169 offset:19456
  v_cmp_le_i32 s[52:53], 0, v214
  v_cmp_le_i32 s[54:55], 1, v214
  v_cmp_le_i32 s[56:57], 2, v214
  v_cmp_le_i32 s[58:59], 3, v214
  v_mov_b32 v84, v215
  v_mov_b32 v85, v215
  v_mov_b32 v86, v215
  v_mov_b32 v87, v215
  v_cndmask_b32 v80, v215, v80, s[52:53]
  v_cndmask_b32 v81, v215, v81, s[54:55]
  v_cndmask_b32 v82, v215, v82, s[56:57]
  v_cndmask_b32 v83, v215, v83, s[58:59]
  v_cndmask_b32 v92, v215, v92, s[52:53]
  v_cndmask_b32 v93, v215, v93, s[54:55]
  v_cndmask_b32 v94, v215, v94, s[56:57]
  v_cndmask_b32 v95, v215, v95, s[58:59]
  v_max3_f32 v208, v80, v81, v82
  v_max3_f32 v210, v83, v84, v85
  v_max3_f32 v209, v88, v89, v90
  v_max3_f32 v211, v91, v92, v93
  v_max3_f32 v208, v208, v86, v87
  v_max3_f32 v209, v209, v94, v95
  v_max_f32 v208, v208, v210
  v_max_f32 v209, v209, v211
  v_mov_b32 v210, v208
  v_mov_b32 v211, v209
  s_nop 0
  v_permlane16_swap_b32 v208, v210
  v_permlane16_swap_b32 v209, v211
  s_nop 0
  v_max_f32 v208, v208, v210
  v_max_f32 v209, v209, v211
  v_mov_b32 v210, v208
  v_mov_b32 v211, v209
  s_nop 0
  v_permlane32_swap_b32 v208, v210
  v_permlane32_swap_b32 v209, v211
  s_nop 0
  v_max_f32 v208, v208, v210
  v_max_f32 v209, v209, v211
  v_sub_f32 v80, v80, v208
  v_sub_f32 v81, v81, v208
  v_sub_f32 v82, v82, v208
  v_sub_f32 v83, v83, v208
  v_sub_f32 v84, v84, v208
  v_sub_f32 v85, v85, v208
  v_sub_f32 v86, v86, v208
  v_sub_f32 v87, v87, v208
  v_sub_f32 v88, v88, v209
  v_sub_f32 v89, v89, v209
  v_sub_f32 v90, v90, v209
  v_sub_f32 v91, v91, v209
  v_sub_f32 v92, v92, v209
  v_sub_f32 v93, v93, v209
  v_sub_f32 v94, v94, v209
  v_sub_f32 v95, v95, v209
  v_sub_f32 v96, 0, v208
  v_sub_f32 v97, 0, v208
  v_sub_f32 v98, 0, v208
  v_sub_f32 v99, 0, v208
  v_sub_f32 v100, 0, v209
  v_sub_f32 v101, 0, v209
  v_sub_f32 v102, 0, v209
  v_sub_f32 v103, 0, v209
  v_exp_f32 v160, v80
  v_exp_f32 v161, v81
  s_nop 0
  v_cvt_pk_bf16_f32 v120, v160, v161
  v_exp_f32 v162, v82
  v_exp_f32 v163, v83
  v_exp_f32 v160, v88
  s_nop 0
  v_cvt_pk_bf16_f32 v121, v162, v163
  v_exp_f32 v161, v89
  v_exp_f32 v162, v90
  s_nop 0
  v_cvt_pk_bf16_f32 v124, v160, v161
  v_exp_f32 v163, v91
  v_exp_f32 v160, v84
  s_nop 0
  v_cvt_pk_bf16_f32 v125, v162, v163
  v_exp_f32 v161, v85
  v_exp_f32 v162, v86
  s_nop 0
  v_cvt_pk_bf16_f32 v122, v160, v161
  v_exp_f32 v163, v87
  s_waitcnt lgkmcnt(4)
  s_branch L_it2
L_pro2:
  ds_read_b128 v[128:131], v169 offset:16384
  ds_read_b128 v[132:135], v169 offset:17408
  ds_read_b128 v[136:139], v169 offset:20480
  ds_read_b128 v[140:143], v169 offset:21504
  ds_read_b128 v[144:147], v169 offset:18432
  ds_read_b128 v[148:151], v169 offset:19456
  ds_read_b128 v[152:155], v169 offset:22528
  ds_read_b128 v[156:159], v169 offset:23552
  v_mov_b32 v164, 0x3f803f80
  v_mov_b32 v165, 0x3f803f80
  v_mov_b32 v166, 0x3f803f80
  v_mov_b32 v167, 0x3f803f80
  s_waitcnt lgkmcnt(6)
  v_mfma_f32_16x16x32_bf16 v[64:67], v[128:131], v[176:179], 0
  v_mov_b32 v0, 0
  v_mov_b32 v1, 0
  v_mov_b32 v2, 0
  v_mov_b32 v3, 0
  v_mov_b32 v4, 0
  v_mfma_f32_16x16x32_bf16 v[64:67], v[132:135], v[180:183], v[64:67]
  v_mov_b32 v5, 0
  v_mov_b32 v6, 0
  v_mov_b32 v7, 0
  v_mov_b32 v8, 0
  v_mov_b32 v9, 0
  v_mfma_f32_16x16x32_bf16 v[72:75], v[128:131], v[192:195], 0
  v_mov_b32 v10, 0
  v_mov_b32 v11, 0
  v_mov_b32 v12, 0
  v_mov_b32 v13, 0
  v_mov_b32 v14, 0
  v_mfma_f32_16x16x32_bf16 v[72:75], v[132:135], v[196:199], v[72:75]
  v_mov_b32 v15, 0
  v_mov_b32 v16, 0
  v_mov_b32 v17, 0
  v_mov_b32 v18, 0
  v_mov_b32 v19, 0
  s_waitcnt lgkmcnt(4)
  v_mfma_f32_16x16x32_bf16 v[64:67], v[136:139], v[184:187], v[64:67]
  v_mov_b32 v20, 0
  v_mov_b32 v21, 0
  v_mov_b32 v22, 0
  v_mov_b32 v23, 0
  v_mov_b32 v24, 0
  v_mfma_f32_16x16x32_bf16 v[64:67], v[140:143], v[188:191], v[64:67]
  v_mov_b32 v25, 0
  v_mov_b32 v26, 0
  v_mov_b32 v27, 0
  v_mov_b32 v28, 0
  v_mov_b32 v29, 0
  v_mfma_f32_16x16x32_bf16 v[72:75], v[136:139], v[200:203], v[72:75]
  v_mov_b32 v30, 0
  v_mov_b32 v31, 0
  v_mov_b32 v32, 0
  v_mov_b32 v33, 0
  v_mov_b32 v34, 0
  v_mfma_f32_16x16x32_bf16 v[72:75], v[140:143], v[204:207], v[72:75]
  v_mov_b32 v35, 0
  v_mov_b32 v36, 0
  v_mov_b32 v37, 0
  v_mov_b32 v38, 0
  v_mov_b32 v39, 0
  s_waitcnt lgkmcnt(2)
  v_mfma_f32_16x16x32_bf16 v[76:79], v[144:147], v[192:195], 0
  v_mov_b32 v40, 0
  v_mov_b32 v41, 0
  v_mov_b32 v42, 0
  v_mov_b32 v43, 0
  v_mov_b32 v44, 0
  v_mov_b32 v45, 0
  v_mfma_f32_16x16x32_bf16 v[76:79], v[148:151], v[196:199], v[76:79]
  v_mov_b32 v46, 0
  v_mov_b32 v47, 0
  v_mov_b32 v48, 0
  v_mov_b32 v49, 0
  v_mov_b32 v50, 0
  v_mov_b32 v51, 0
  s_waitcnt lgkmcnt(0)
  v_mfma_f32_16x16x32_bf16 v[76:79], v[152:155], v[200:203], v[76:79]
  v_mov_b32 v52, 0
  v_mov_b32 v53, 0
  v_mov_b32 v54, 0
  v_mov_b32 v55, 0
  v_mov_b32 v56, 0
  v_mov_b32 v57, 0
  v_mfma_f32_16x16x32_bf16 v[76:79], v[156:159], v[204:207], v[76:79]
  v_mov_b32 v58, 0
  v_mov_b32 v59, 0
  v_mov_b32 v60, 0
  v_mov_b32 v61, 0
  v_mov_b32 v62, 0
  v_mov_b32 v63, 0
  ds_read_b128 v[128:131], v169 offset:24576
  ds_read_b128 v[132:135], v169 offset:25600
  ds_read_b128 v[136:139], v169 offset:28672
  ds_read_b128 v[140:143], v169 offset:29696
  ds_read_b128 v[144:147], v169 offset:26624
  ds_read_b128 v[148:151], v169 offset:27648
  v_cmp_le_i32 s[52:53], 0, v214
  v_cmp_le_i32 s[54:55], 1, v214
  v_cmp_le_i32 s[56:57], 2, v214
  v_cmp_le_i32 s[58:59], 3, v214
  v_mov_b32 v68, v215
  v_mov_b32 v69, v215
  v_mov_b32 v70, v215
  v_mov_b32 v71, v215
  v_cndmask_b32 v64, v215, v64, s[52:53]
  v_cndmask_b32 v65, v215, v65, s[54:55]
  v_cndmask_b32 v66, v215, v66, s[56:57]
  v_cndmask_b32 v67, v215, v67, s[58:59]
  v_cndmask_b32 v76, v215, v76, s[52:53]
  v_cndmask_b32 v77, v215, v77, s[54:55]
  v_cndmask_b32 v78, v215, v78, s[56:57]
  v_cndmask_b32 v79, v215, v79, s[58:59]
  v_max3_f32 v208, v64, v65, v66
  v_max3_f32 v210, v67, v68, v69
  v_max3_f32 v209, v72, v73, v74
  v_max3_f32 v211, v75, v76, v77
  v_max3_f32 v208, v208, v70, v71
  v_max3_f32 v209, v209, v78, v79
  v_max_f32 v208, v208, v210
  v_max_f32 v209, v209, v211
  v_mov_b32 v210, v208
  v_mov_b32 v211, v209
  s_nop 0
  v_permlane16_swap_b32 v208, v210
  v_permlane16_swap_b32 v209, v211
  s_nop 0
  v_max_f32 v208, v208, v210
  v_max_f32 v209, v209, v211
  v_mov_b32 v210, v208
  v_mov_b32 v211, v209
  s_nop 0
  v_permlane32_swap_b32 v208, v210
  v_permlane32_swap_b32 v209, v211
  s_nop 0
  v_max_f32 v208, v208, v210
  v_max_f32 v209, v209, v211
  v_sub_f32 v64, v64, v208
  v_sub_f32 v65, v65, v208
  v_sub_f32 v66, v66, v208
  v_sub_f32 v67, v67, v208
  v_sub_f32 v68, v68, v208
  v_sub_f32 v69, v69, v208
  v_sub_f32 v70, v70, v208
  v_sub_f32 v71, v71, v208
  v_sub_f32 v72, v72, v209
  v_sub_f32 v73, v73, v209
  v_sub_f32 v74, v74, v209
  v_sub_f32 v75, v75, v209
  v_sub_f32 v76, v76, v209
  v_sub_f32 v77, v77, v209
  v_sub_f32 v78, v78, v209
  v_sub_f32 v79, v79, v209
  v_sub_f32 v96, 0, v208
  v_sub_f32 v97, 0, v208
  v_sub_f32 v98, 0, v208
  v_sub_f32 v99, 0, v208
  v_sub_f32 v100, 0, v209
  v_sub_f32 v101, 0, v209
  v_sub_f32 v102, 0, v209
  v_sub_f32 v103, 0, v209
  v_exp_f32 v160, v64
  v_exp_f32 v161, v65
  s_nop 0
  v_cvt_pk_bf16_f32 v112, v160, v161
  v_exp_f32 v162, v66
  v_exp_f32 v163, v67
  v_exp_f32 v160, v72
  s_nop 0
  v_cvt_pk_bf16_f32 v113, v162, v163
  v_exp_f32 v161, v73
  v_exp_f32 v162, v74
  s_nop 0
  v_cvt_pk_bf16_f32 v116, v160, v161
  v_exp_f32 v163, v75
  v_exp_f32 v160, v68
  s_nop 0
  v_cvt_pk_bf16_f32 v117, v162, v163
  v_exp_f32 v161, v69
  v_exp_f32 v162, v70
  s_nop 0
  v_cvt_pk_bf16_f32 v114, v160, v161
  v_exp_f32 v163, v71
  s_waitcnt lgkmcnt(4)
  s_branch L_it3
L_pro3:
  ds_read_b128 v[128:131], v169 offset:24576
  ds_read_b128 v[132:135], v169 offset:25600
  ds_read_b128 v[136:139], v169 offset:28672
  ds_read_b128 v[140:143], v169 offset:29696
  ds_read_b128 v[144:147], v169 offset:26624
  ds_read_b128 v[148:151], v169 offset:27648
  ds_read_b128 v[152:155], v169 offset:30720
  ds_read_b128 v[156:159], v169 offset:31744
  v_mov_b32 v164, 0x3f803f80
  v_mov_b32 v165, 0x3f803f80
  v_mov_b32 v166, 0x3f803f80
  v_mov_b32 v167, 0x3f803f80
  s_waitcnt lgkmcnt(6)
  v_mfma_f32_16x16x32_bf16 v[80:83], v[128:131], v[176:179], 0
  v_mov_b32 v0, 0
  v_mov_b32 v1, 0
  v_mov_b32 v2, 0
  v_mov_b32 v3, 0
  v_mov_b32 v4, 0
  v_mfma_f32_16x16x32_bf16 v[80:83], v[132:135], v[180:183], v[80:83]
  v_mov_b32 v5, 0
  v_mov_b32 v6, 0
  v_mov_b32 v7, 0
  v_mov_b32 v8, 0
  v_mov_b32 v9, 0
  v_mfma_f32_16x16x32_bf16 v[88:91], v[128:131], v[192:195], 0
  v_mov_b32 v10, 0
  v_mov_b32 v11, 0
  v_mov_b32 v12, 0
  v_mov_b32 v13, 0
  v_mov_b32 v14, 0
  v_mfma_f32_16x16x32_bf16 v[88:91], v[132:135], v[196:199], v[88:91]
  v_mov_b32 v15, 0
  v_mov_b32 v16, 0
  v_mov_b32 v17, 0
  v_mov_b32 v18, 0
  v_mov_b32 v19, 0
  s_waitcnt lgkmcnt(4)
  v_mfma_f32_16x16x32_bf16 v[80:83], v[136:139], v[184:187], v[80:83]
  v_mov_b32 v20, 0
  v_mov_b32 v21, 0
  v_mov_b32 v22, 0
  v_mov_b32 v23, 0
  v_mov_b32 v24, 0
  v_mfma_f32_16x16x32_bf16 v[80:83], v[140:143], v[188:191], v[80:83]
  v_mov_b32 v25, 0
  v_mov_b32 v26, 0
  v_mov_b32 v27, 0
  v_mov_b32 v28, 0
  v_mov_b32 v29, 0
  v_mfma_f32_16x16x32_bf16 v[88:91], v[136:139], v[200:203], v[88:91]
  v_mov_b32 v30, 0
  v_mov_b32 v31, 0
  v_mov_b32 v32, 0
  v_mov_b32 v33, 0
  v_mov_b32 v34, 0
  v_mfma_f32_16x16x32_bf16 v[88:91], v[140:143], v[204:207], v[88:91]
  v_mov_b32 v35, 0
  v_mov_b32 v36, 0
  v_mov_b32 v37, 0
  v_mov_b32 v38, 0
  v_mov_b32 v39, 0
  s_waitcnt lgkmcnt(2)
  v_mfma_f32_16x16x32_bf16 v[92:95], v[144:147], v[192:195], 0
  v_mov_b32 v40, 0
  v_mov_b32 v41, 0
  v_mov_b32 v42, 0
  v_mov_b32 v43, 0
  v_mov_b32 v44, 0
  v_mov_b32 v45, 0
  v_mfma_f32_16x16x32_bf16 v[92:95], v[148:151], v[196:199], v[92:95]
  v_mov_b32 v46, 0
  v_mov_b32 v47, 0
  v_mov_b32 v48, 0
  v_mov_b32 v49, 0
  v_mov_b32 v50, 0
  v_mov_b32 v51, 0
  s_waitcnt lgkmcnt(0)
  v_mfma_f32_16x16x32_bf16 v[92:95], v[152:155], v[200:203], v[92:95]
  v_mov_b32 v52, 0
  v_mov_b32 v53, 0
  v_mov_b32 v54, 0
  v_mov_b32 v55, 0
  v_mov_b32 v56, 0
  v_mov_b32 v57, 0
  v_mfma_f32_16x16x32_bf16 v[92:95], v[156:159], v[204:207], v[92:95]
  v_mov_b32 v58, 0
  v_mov_b32 v59, 0
  v_mov_b32 v60, 0
  v_mov_b32 v61, 0
  v_mov_b32 v62, 0
  v_mov_b32 v63, 0
  v_cmp_le_i32 s[52:53], 0, v214
  v_cmp_le_i32 s[54:55], 1, v214
  v_cmp_le_i32 s[56:57], 2, v214
  v_cmp_le_i32 s[58:59], 3, v214
  v_mov_b32 v84, v215
  v_mov_b32 v85, v215
  v_mov_b32 v86, v215
  v_mov_b32 v87, v215
  v_cndmask_b32 v80, v215, v80, s[52:53]
  v_cndmask_b32 v81, v215, v81, s[54:55]
  v_cndmask_b32 v82, v215, v82, s[56:57]
  v_cndmask_b32 v83, v215, v83, s[58:59]
  v_cndmask_b32 v92, v215, v92, s[52:53]
  v_cndmask_b32 v93, v215, v93, s[54:55]
  v_cndmask_b32 v94, v215, v94, s[56:57]
  v_cndmask_b32 v95, v215, v95, s[58:59]
  v_max3_f32 v208, v80, v81, v82
  v_max3_f32 v210, v83, v84, v85
  v_max3_f32 v209, v88, v89, v90
  v_max3_f32 v211, v91, v92, v93
  v_max3_f32 v208, v208, v86, v87
  v_max3_f32 v209, v209, v94, v95
  v_max_f32 v208, v208, v210
  v_max_f32 v209, v209, v211
  v_mov_b32 v210, v208
  v_mov_b32 v211, v209
  s_nop 0
  v_permlane16_swap_b32 v208, v210
  v_permlane16_swap_b32 v209, v211
  s_nop 0
  v_max_f32 v208, v208, v210
  v_max_f32 v209, v209, v211
  v_mov_b32 v210, v208
  v_mov_b32 v211, v209
  s_nop 0
  v_permlane32_swap_b32 v208, v210
  v_permlane32_swap_b32 v209, v211
  s_nop 0
  v_max_f32 v208, v208, v210
  v_max_f32 v209, v209, v211
  v_sub_f32 v80, v80, v208
  v_sub_f32 v81, v81, v208
  v_sub_f32 v82, v82, v208
  v_sub_f32 v83, v83, v208
  v_sub_f32 v84, v84, v208
  v_sub_f32 v85, v85, v208
  v_sub_f32 v86, v86, v208
  v_sub_f32 v87, v87, v208
  v_sub_f32 v88, v88, v209
  v_sub_f32 v89, v89, v209
  v_sub_f32 v90, v90, v209
  v_sub_f32 v91, v91, v209
  v_sub_f32 v92, v92, v209
  v_sub_f32 v93, v93, v209
  v_sub_f32 v94, v94, v209
  v_sub_f32 v95, v95, v209
  v_sub_f32 v96, 0, v208
  v_sub_f32 v97, 0, v208
  v_sub_f32 v98, 0, v208
  v_sub_f32 v99, 0, v208
  v_sub_f32 v100, 0, v209
  v_sub_f32 v101, 0, v209
  v_sub_f32 v102, 0, v209
  v_sub_f32 v103, 0, v209
  v_exp_f32 v160, v80
  v_exp_f32 v161, v81
  s_nop 0
  v_cvt_pk_bf16_f32 v120, v160, v161
  v_exp_f32 v162, v82
  v_exp_f32 v163, v83
  v_exp_f32 v160, v88
  s_nop 0
  v_cvt_pk_bf16_f32 v121, v162, v163
  v_exp_f32 v161, v89
  v_exp_f32 v162, v90
  s_nop 0
  v_cvt_pk_bf16_f32 v124, v160, v161
  v_exp_f32 v163, v91
  v_exp_f32 v160, v84
  s_nop 0
  v_cvt_pk_bf16_f32 v125, v162, v163
  v_exp_f32 v161, v85
  v_exp_f32 v162, v86
  s_nop 0
  v_cvt_pk_bf16_f32 v122, v160, v161
  v_exp_f32 v163, v87
  s_cmp_eq_u32 s77, s78
  s_cbranch_scc1 L_pro3L
  v_xor_b32 v169, 0x8000, v169
  v_xor_b32 v170, 0x38000, v170
  s_waitcnt vmcnt(0) lgkmcnt(0)
  s_barrier
  s_add_u32 s77, s77, 1
  s_cmp_eq_u32 s84, 0
  s_cbranch_scc1 L_nohook_58
  s_call_b64 s[88:89], L_hook
L_nohook_58:
  ds_read_b128 v[128:131], v169 offset:0
  ds_read_b128 v[132:135], v169 offset:1024
  ds_read_b128 v[136:139], v169 offset:4096
  ds_read_b128 v[140:143], v169 offset:5120
  ds_read_b128 v[144:147], v169 offset:2048
  ds_read_b128 v[148:151], v169 offset:3072
  s_waitcnt lgkmcnt(4)
  s_branch L_it0
L_pro3L:
  v_xor_b32 v169, 0x8000, v169
  v_xor_b32 v170, 0x38000, v170
  s_waitcnt vmcnt(0) lgkmcnt(0)
  s_barrier
  s_add_u32 s77, s77, 1
  s_cmp_eq_u32 s84, 0
  s_cbranch_scc1 L_nohook_59
  s_call_b64 s[88:89], L_hook
L_nohook_59:
  ds_read_b128 v[128:131], v170 offset:0
  ds_read_b128 v[132:135], v170 offset:1024
  ds_read_b128 v[136:139], v170 offset:2048
  ds_read_b128 v[140:143], v170 offset:3072
  ds_read_b128 v[144:147], v170 offset:4096
  ds_read_b128 v[148:151], v170 offset:5120
  s_branch L_tail
L_it0:
  v_mfma_f32_16x16x32_bf16 v[64:67], v[128:131], v[176:179], v[96:99]
  v_exp_f32 v160, v92
  v_mfma_f32_16x16x32_bf16 v[64:67], v[132:135], v[180:183], v[64:67]
  ds_read_b128 v[152:155], v169 offset:6144
  v_cvt_pk_bf16_f32 v123, v162, v163
  v_mfma_f32_16x16x32_bf16 v[72:75], v[128:131], v[192:195], v[100:103]
  v_exp_f32 v161, v93
  v_mfma_f32_16x16x32_bf16 v[72:75], v[132:135], v[196:199], v[72:75]
  ds_read_b128 v[156:159], v169 offset:7168
  s_waitcnt lgkmcnt(4)
  v_mfma_f32_16x16x32_bf16 v[64:67], v[136:139], v[184:187], v[64:67]
  v_exp_f32 v162, v94
  v_mfma_f32_16x16x32_bf16 v[64:67], v[140:143], v[188:191], v[64:67]
  ds_read_b128 v[128:131], v170 offset:0
  v_cvt_pk_bf16_f32 v126, v160, v161
  v_mfma_f32_16x16x32_bf16 v[104:107], v[164:167], v[120:123], v[104:107]
  v_exp_f32 v163, v95
  v_mfma_f32_16x16x32_bf16 v[72:75], v[136:139], v[200:203], v[72:75]
  ds_read_b128 v[132:135], v170 offset:1024
  v_cvt_pk_bf16_f32 v127, v162, v163
  v_mfma_f32_16x16x32_bf16 v[72:75], v[140:143], v[204:207], v[72:75]
  ds_read_b128 v[136:139], v170 offset:2048
  s_waitcnt lgkmcnt(5)
  v_mfma_f32_16x16x32_bf16 v[108:111], v[164:167], v[124:127], v[108:111]
  v_exp_f32 v160, v64
  v_mfma_f32_16x16x32_bf16 v[68:71], v[144:147], v[176:179], v[96:99]
  ds_read_b128 v[140:143], v170 offset:3072
  v_mfma_f32_16x16x32_bf16 v[68:71], v[148:151], v[180:183], v[68:71]
  v_exp_f32 v161, v65
  v_mfma_f32_16x16x32_bf16 v[76:79], v[144:147], v[192:195], v[100:103]
  ds_read_b128 v[144:147], v170 offset:4096
  v_cvt_pk_bf16_f32 v112, v160, v161
  v_mfma_f32_16x16x32_bf16 v[76:79], v[148:151], v[196:199], v[76:79]
  v_max_f32 v172, v104, v108
  s_waitcnt lgkmcnt(5)
  v_mfma_f32_16x16x32_bf16 v[68:71], v[152:155], v[184:187], v[68:71]
  v_exp_f32 v162, v66
  v_mfma_f32_16x16x32_bf16 v[68:71], v[156:159], v[188:191], v[68:71]
  ds_read_b128 v[148:151], v170 offset:5120
  v_cmp_nge_f32 vcc, s83, v172
  v_mfma_f32_16x16x32_bf16 v[76:79], v[152:155], v[200:203], v[76:79]
  v_exp_f32 v163, v67
  v_mfma_f32_16x16x32_bf16 v[76:79], v[156:159], v[204:207], v[76:79]
  s_cbranch_vccnz L_tr0
L_bk0:
  s_waitcnt lgkmcnt(4)
  v_mfma_f32_16x16x32_bf16 v[0:3], v[128:131], v[120:123], v[0:3]
  v_exp_f32 v160, v72
  v_mfma_f32_16x16x32_bf16 v[32:35], v[128:131], v[124:127], v[32:35]
  ds_read_b128 v[152:155], v170 offset:6144
  v_cvt_pk_bf16_f32 v113, v162, v163
  v_mfma_f32_16x16x32_bf16 v[4:7], v[132:135], v[120:123], v[4:7]
  v_exp_f32 v161, v73
  v_mfma_f32_16x16x32_bf16 v[36:39], v[132:135], v[124:127], v[36:39]
  ds_read_b128 v[156:159], v170 offset:7168
  s_waitcnt lgkmcnt(4)
  v_mfma_f32_16x16x32_bf16 v[8:11], v[136:139], v[120:123], v[8:11]
  v_exp_f32 v162, v74
  v_mfma_f32_16x16x32_bf16 v[40:43], v[136:139], v[124:127], v[40:43]
  ds_read_b128 v[128:131], v169 offset:8192
  v_cvt_pk_bf16_f32 v116, v160, v161
  v_mfma_f32_16x16x32_bf16 v[12:15], v[140:143], v[120:123], v[12:15]
  v_exp_f32 v163, v75
  v_mfma_f32_16x16x32_bf16 v[44:47], v[140:143], v[124:127], v[44:47]
  ds_read_b128 v[132:135], v169 offset:9216
  s_waitcnt lgkmcnt(4)
  v_mfma_f32_16x16x32_bf16 v[16:19], v[144:147], v[120:123], v[16:19]
  v_exp_f32 v160, v68
  v_mfma_f32_16x16x32_bf16 v[48:51], v[144:147], v[124:127], v[48:51]
  ds_read_b128 v[136:139], v169 offset:12288
  v_cvt_pk_bf16_f32 v117, v162, v163
  v_mfma_f32_16x16x32_bf16 v[20:23], v[148:151], v[120:123], v[20:23]
  v_exp_f32 v161, v69
  v_mfma_f32_16x16x32_bf16 v[52:55], v[148:151], v[124:127], v[52:55]
  ds_read_b128 v[140:143], v169 offset:13312
  s_waitcnt lgkmcnt(4)
  v_mfma_f32_16x16x32_bf16 v[24:27], v[152:155], v[120:123], v[24:27]
  v_exp_f32 v162, v70
  v_mfma_f32_16x16x32_bf16 v[56:59], v[152:155], v[124:127], v[56:59]
  ds_read_b128 v[144:147], v169 offset:10240
  v_cvt_pk_bf16_f32 v114, v160, v161
  v_mfma_f32_16x16x32_bf16 v[28:31], v[156:159], v[120:123], v[28:31]
  v_exp_f32 v163, v71
  v_mfma_f32_16x16x32_bf16 v[60:63], v[156:159], v[124:127], v[60:63]
  ds_read_b128 v[148:151], v169 offset:11264
  s_waitcnt lgkmcnt(4)
L_it1:
  s_cmp_lg_u32 s3, 0
  s_cbranch_scc1 L_h2c1
L_h2b1:
  v_mfma_f32_16x16x32_bf16 v[80:83], v[128:131], v[176:179], v[96:99]
  v_exp_f32 v160, v76
  v_mfma_f32_16x16x32_bf16 v[80:83], v[132:135], v[180:183], v[80:83]
  ds_read_b128 v[152:155], v169 offset:14336
  v_cvt_pk_bf16_f32 v115, v162, v163
  v_mfma_f32_16x16x32_bf16 v[88:91], v[128:131], v[192:195], v[100:103]
  v_exp_f32 v161, v77
  v_mfma_f32_16x16x32_bf16 v[88:91], v[132:135], v[196:199], v[88:91]
  ds_read_b128 v[156:159], v169 offset:15360
  s_waitcnt lgkmcnt(4)
  v_mfma_f32_16x16x32_bf16 v[80:83], v[136:139], v[184:187], v[80:83]
  v_exp_f32 v162, v78
  v_mfma_f32_16x16x32_bf16 v[80:83], v[140:143], v[188:191], v[80:83]
  ds_read_b128 v[128:131], v170 offset:8192
  v_cvt_pk_bf16_f32 v118, v160, v161
  v_mfma_f32_16x16x32_bf16 v[104:107], v[164:167], v[112:115], v[104:107]
  v_exp_f32 v163, v79
  v_mfma_f32_16x16x32_bf16 v[88:91], v[136:139], v[200:203], v[88:91]
  ds_read_b128 v[132:135], v170 offset:9216
  v_cvt_pk_bf16_f32 v119, v162, v163
  v_mfma_f32_16x16x32_bf16 v[88:91], v[140:143], v[204:207], v[88:91]
  ds_read_b128 v[136:139], v170 offset:10240
  s_waitcnt lgkmcnt(5)
  v_mfma_f32_16x16x32_bf16 v[108:111], v[164:167], v[116:119], v[108:111]
  v_exp_f32 v160, v80
  v_mfma_f32_16x16x32_bf16 v[84:87], v[144:147], v[176:179], v[96:99]
  ds_read_b128 v[140:143], v170 offset:11264
  v_mfma_f32_16x16x32_bf16 v[84:87], v[148:151], v[180:183], v[84:87]
  v_exp_f32 v161, v81
  v_mfma_f32_16x16x32_bf16 v[92:95], v[144:147], v[192:195], v[100:103]
  ds_read_b128 v[144:147], v170 offset:12288
  v_cvt_pk_bf16_f32 v120, v160, v161
  v_mfma_f32_16x16x32_bf16 v[92:95], v[148:151], v[196:199], v[92:95]
  v_max_f32 v172, v104, v108
  s_waitcnt lgkmcnt(5)
  v_mfma_f32_16x16x32_bf16 v[84:87], v[152:155], v[184:187], v[84:87]
  v_exp_f32 v162, v82
  v_mfma_f32_16x16x32_bf16 v[84:87], v[156:159], v[188:191], v[84:87]
  ds_read_b128 v[148:151], v170 offset:13312
  v_cmp_nge_f32 vcc, s83, v172
  v_mfma_f32_16x16x32_bf16 v[92:95], v[152:155], v[200:203], v[92:95]
  v_exp_f32 v163, v83
  v_mfma_f32_16x16x32_bf16 v[92:95], v[156:159], v[204:207], v[92:95]
  s_cbranch_vccnz L_tr1
L_bk1:
  s_waitcnt lgkmcnt(4)
  v_mfma_f32_16x16x32_bf16 v[0:3], v[128:131], v[112:115], v[0:3]
  v_exp_f32 v160, v88
  v_mfma_f32_16x16x32_bf16 v[32:35], v[128:131], v[116:119], v[32:35]
  ds_read_b128 v[152:155], v170 offset:14336
  v_cvt_pk_bf16_f32 v121, v162, v163
  v_mfma_f32_16x16x32_bf16 v[4:7], v[132:135], v[112:115], v[4:7]
  v_exp_f32 v161, v89
  v_mfma_f32_16x16x32_bf16 v[36:39], v[132:135], v[116:119], v[36:39]
  ds_read_b128 v[156:159], v170 offset:15360
  s_waitcnt lgkmcnt(4)
  v_mfma_f32_16x16x32_bf16 v[8:11], v[136:139], v[112:115], v[8:11]
  v_exp_f32 v162, v90
  v_mfma_f32_16x16x32_bf16 v[40:43], v[136:139], v[116:119], v[40:43]
  ds_read_b128 v[128:131], v169 offset:16384
  v_cvt_pk_bf16_f32 v124, v160, v161
  v_mfma_f32_16x16x32_bf16 v[12:15], v[140:143], v[112:115], v[12:15]
  v_exp_f32 v163, v91
  v_mfma_f32_16x16x32_bf16 v[44:47], v[140:143], v[116:119], v[44:47]
  ds_read_b128 v[132:135], v169 offset:17408
  s_waitcnt lgkmcnt(4)
  v_mfma_f32_16x16x32_bf16 v[16:19], v[144:147], v[112:115], v[16:19]
  v_exp_f32 v160, v84
  v_mfma_f32_16x16x32_bf16 v[48:51], v[144:147], v[116:119], v[48:51]
  ds_read_b128 v[136:139], v169 offset:20480
  v_cvt_pk_bf16_f32 v125, v162, v163
  v_mfma_f32_16x16x32_bf16 v[20:23], v[148:151], v[112:115], v[20:23]
  v_exp_f32 v161, v85
  v_mfma_f32_16x16x32_bf16 v[52:55], v[148:151], v[116:119], v[52:55]
  ds_read_b128 v[140:143], v169 offset:21504
  s_waitcnt lgkmcnt(4)
  v_mfma_f32_16x16x32_bf16 v[24:27], v[152:155], v[112:115], v[24:27]
  v_exp_f32 v162, v86
  v_mfma_f32_16x16x32_bf16 v[56:59], v[152:155], v[116:119], v[56:59]
  ds_read_b128 v[144:147], v169 offset:18432
  v_cvt_pk_bf16_f32 v122, v160, v161
  v_mfma_f32_16x16x32_bf16 v[28:31], v[156:159], v[112:115], v[28:31]
  v_exp_f32 v163, v87
  v_mfma_f32_16x16x32_bf16 v[60:63], v[156:159], v[116:119], v[60:63]
  ds_read_b128 v[148:151], v169 offset:19456
  s_waitcnt lgkmcnt(4)
L_it2:
  s_cmp_lg_u32 s3, 0
  s_cbranch_scc1 L_h2c2
L_h2b2:
  v_mfma_f32_16x16x32_bf16 v[64:67], v[128:131], v[176:179], v[96:99]
  v_exp_f32 v160, v92
  v_mfma_f32_16x16x32_bf16 v[64:67], v[132:135], v[180:183], v[64:67]
  ds_read_b128 v[152:155], v169 offset:22528
  v_cvt_pk_bf16_f32 v123, v162, v163
  v_mfma_f32_16x16x32_bf16 v[72:75], v[128:131], v[192:195], v[100:103]
  v_exp_f32 v161, v93
  v_mfma_f32_16x16x32_bf16 v[72:75], v[132:135], v[196:199], v[72:75]
  ds_read_b128 v[156:159], v169 offset:23552
  s_waitcnt lgkmcnt(4)
  v_mfma_f32_16x16x32_bf16 v[64:67], v[136:139], v[184:187], v[64:67]
  v_exp_f32 v162, v94
  v_mfma_f32_16x16x32_bf16 v[64:67], v[140:143], v[188:191], v[64:67]
  ds_read_b128 v[128:131], v170 offset:16384
  v_cvt_pk_bf16_f32 v126, v160, v161
  v_mfma_f32_16x16x32_bf16 v[104:107], v[164:167], v[120:123], v[104:107]
  v_exp_f32 v163, v95
  v_mfma_f32_16x16x32_bf16 v[72:75], v[136:139], v[200:203], v[72:75]
  ds_read_b128 v[132:135], v170 offset:17408
  v_cvt_pk_bf16_f32 v127, v162, v163
  v_mfma_f32_16x16x32_bf16 v[72:75], v[140:143], v[204:207], v[72:75]
  ds_read_b128 v[136:139], v170 offset:18432
  s_waitcnt lgkmcnt(5)
  v_mfma_f32_16x16x32_bf16 v[108:111], v[164:167], v[124:127], v[108:111]
  v_exp_f32 v160, v64
  v_mfma_f32_16x16x32_bf16 v[68:71], v[144:147], v[176:179], v[96:99]
  ds_read_b128 v[140:143], v170 offset:19456
  v_mfma_f32_16x16x32_bf16 v[68:71], v[148:151], v[180:183], v[68:71]
  v_exp_f32 v161, v65
  v_mfma_f32_16x16x32_bf16 v[76:79], v[144:147], v[192:195], v[100:103]
  ds_read_b128 v[144:147], v170 offset:20480
  v_cvt_pk_bf16_f32 v112, v160, v161
  v_mfma_f32_16x16x32_bf16 v[76:79], v[148:151], v[196:199], v[76:79]
  v_max_f32 v172, v104, v108
  s_waitcnt lgkmcnt(5)
  v_mfma_f32_16x16x32_bf16 v[68:71], v[152:155], v[184:187], v[68:71]
  v_exp_f32 v162, v66
  v_mfma_f32_16x16x32_bf16 v[68:71], v[156:159], v[188:191], v[68:71]
  ds_read_b128 v[148:151], v170 offset:21504
  v_cmp_nge_f32 vcc, s83, v172
  v_mfma_f32_16x16x32_bf16 v[76:79], v[152:155], v[200:203], v[76:79]
  v_exp_f32 v163, v67
  v_mfma_f32_16x16x32_bf16 v[76:79], v[156:159], v[204:207], v[76:79]
  s_cbranch_vccnz L_tr2
L_bk2:
  s_waitcnt lgkmcnt(4)
  v_mfma_f32_16x16x32_bf16 v[0:3], v[128:131], v[120:123], v[0:3]
  v_exp_f32 v160, v72
  v_mfma_f32_16x16x32_bf16 v[32:35], v[128:131], v[124:127], v[32:35]
  ds_read_b128 v[152:155], v170 offset:22528
  v_cvt_pk_bf16_f32 v113, v162, v163
  v_mfma_f32_16x16x32_bf16 v[4:7], v[132:135], v[120:123], v[4:7]
  v_exp_f32 v161, v73
  v_mfma_f32_16x16x32_bf16 v[36:39], v[132:135], v[124:127], v[36:39]
  ds_read_b128 v[156:159], v170 offset:23552
  s_waitcnt lgkmcnt(4)
  v_mfma_f32_16x16x32_bf16 v[8:11], v[136:139], v[120:123], v[8:11]
  v_exp_f32 v162, v74
  v_mfma_f32_16x16x32_bf16 v[40:43], v[136:139], v[124:127], v[40:43]
  ds_read_b128 v[128:131], v169 offset:24576
  v_cvt_pk_bf16_f32 v116, v160, v161
  v_mfma_f32_16x16x32_bf16 v[12:15], v[140:143], v[120:123], v[12:15]
  v_exp_f32 v163, v75
  v_mfma_f32_16x16x32_bf16 v[44:47], v[140:143], v[124:127], v[44:47]
  ds_read_b128 v[132:135], v169 offset:25600
  s_waitcnt lgkmcnt(4)
  v_mfma_f32_16x16x32_bf16 v[16:19], v[144:147], v[120:123], v[16:19]
  v_exp_f32 v160, v68
  v_mfma_f32_16x16x32_bf16 v[48:51], v[144:147], v[124:127], v[48:51]
  ds_read_b128 v[136:139], v169 offset:28672
  v_cvt_pk_bf16_f32 v117, v162, v163
  v_mfma_f32_16x16x32_bf16 v[20:23], v[148:151], v[120:123], v[20:23]
  v_exp_f32 v161, v69
  v_mfma_f32_16x16x32_bf16 v[52:55], v[148:151], v[124:127], v[52:55]
  ds_read_b128 v[140:143], v169 offset:29696
  s_waitcnt lgkmcnt(4)
  v_mfma_f32_16x16x32_bf16 v[24:27], v[152:155], v[120:123], v[24:27]
  v_exp_f32 v162, v70
  v_mfma_f32_16x16x32_bf16 v[56:59], v[152:155], v[124:127], v[56:59]
  ds_read_b128 v[144:147], v169 offset:26624
  v_cvt_pk_bf16_f32 v114, v160, v161
  v_mfma_f32_16x16x32_bf16 v[28:31], v[156:159], v[120:123], v[28:31]
  v_exp_f32 v163, v71
  v_mfma_f32_16x16x32_bf16 v[60:63], v[156:159], v[124:127], v[60:63]
  ds_read_b128 v[148:151], v169 offset:27648
  s_waitcnt lgkmcnt(4)
L_it3:
  s_cmp_eq_u32 s77, s78
  s_cbranch_scc1 L_it3L
  v_mfma_f32_16x16x32_bf16 v[80:83], v[128:131], v[176:179], v[96:99]
  v_exp_f32 v160, v76
  v_mfma_f32_16x16x32_bf16 v[80:83], v[132:135], v[180:183], v[80:83]
  ds_read_b128 v[152:155], v169 offset:30720
  v_cvt_pk_bf16_f32 v115, v162, v163
  v_mfma_f32_16x16x32_bf16 v[88:91], v[128:131], v[192:195], v[100:103]
  v_exp_f32 v161, v77
  v_mfma_f32_16x16x32_bf16 v[88:91], v[132:135], v[196:199], v[88:91]
  ds_read_b128 v[156:159], v169 offset:31744
  s_waitcnt lgkmcnt(4)
  v_mfma_f32_16x16x32_bf16 v[80:83], v[136:139], v[184:187], v[80:83]
  v_exp_f32 v162, v78
  v_mfma_f32_16x16x32_bf16 v[80:83], v[140:143], v[188:191], v[80:83]
  ds_read_b128 v[128:131], v170 offset:24576
  v_cvt_pk_bf16_f32 v118, v160, v161
  v_mfma_f32_16x16x32_bf16 v[104:107], v[164:167], v[112:115], v[104:107]
  v_exp_f32 v163, v79
  v_mfma_f32_16x16x32_bf16 v[88:91], v[136:139], v[200:203], v[88:91]
  ds_read_b128 v[132:135], v170 offset:25600
  v_cvt_pk_bf16_f32 v119, v162, v163
  v_mfma_f32_16x16x32_bf16 v[88:91], v[140:143], v[204:207], v[88:91]
  ds_read_b128 v[136:139], v170 offset:26624
  s_waitcnt lgkmcnt(5)
  v_mfma_f32_16x16x32_bf16 v[108:111], v[164:167], v[116:119], v[108:111]
  v_exp_f32 v160, v80
  v_mfma_f32_16x16x32_bf16 v[84:87], v[144:147], v[176:179], v[96:99]
  ds_read_b128 v[140:143], v170 offset:27648
  v_mfma_f32_16x16x32_bf16 v[84:87], v[148:151], v[180:183], v[84:87]
  v_exp_f32 v161, v81
  v_mfma_f32_16x16x32_bf16 v[92:95], v[144:147], v[192:195], v[100:103]
  ds_read_b128 v[144:147], v170 offset:28672
  v_cvt_pk_bf16_f32 v120, v160, v161
  v_mfma_f32_16x16x32_bf16 v[92:95], v[148:151], v[196:199], v[92:95]
  v_max_f32 v172, v104, v108
  s_waitcnt lgkmcnt(5)
  v_mfma_f32_16x16x32_bf16 v[84:87], v[152:155], v[184:187], v[84:87]
  v_exp_f32 v162, v82
  v_mfma_f32_16x16x32_bf16 v[84:87], v[156:159], v[188:191], v[84:87]
  ds_read_b128 v[148:151], v170 offset:29696
  v_cmp_nge_f32 vcc, s83, v172
  v_mfma_f32_16x16x32_bf16 v[92:95], v[152:155], v[200:203], v[92:95]
  v_exp_f32 v163, v83
  v_mfma_f32_16x16x32_bf16 v[92:95], v[156:159], v[204:207], v[92:95]
  s_cbranch_vccnz L_tr3
L_bk3:
  s_waitcnt lgkmcnt(4)
  v_mfma_f32_16x16x32_bf16 v[0:3], v[128:131], v[112:115], v[0:3]
  v_exp_f32 v160, v88
  v_mfma_f32_16x16x32_bf16 v[32:35], v[128:131], v[116:119], v[32:35]
  ds_read_b128 v[152:155], v170 offset:30720
  v_cvt_pk_bf16_f32 v121, v162, v163
  v_mfma_f32_16x16x32_bf16 v[4:7], v[132:135], v[112:115], v[4:7]
  v_exp_f32 v161, v89
  v_mfma_f32_16x16x32_bf16 v[36:39], v[132:135], v[116:119], v[36:39]
  ds_read_b128 v[156:159], v170 offset:31744
  s_waitcnt lgkmcnt(4)
  v_mfma_f32_16x16x32_bf16 v[8:11], v[136:139], v[112:115], v[8:11]
  v_exp_f32 v162, v90
  v_mfma_f32_16x16x32_bf16 v[40:43], v[136:139], v[116:119], v[40:43]
  v_cvt_pk_bf16_f32 v124, v160, v161
  v_mfma_f32_16x16x32_bf16 v[12:15], v[140:143], v[112:115], v[12:15]
  v_exp_f32 v163, v91
  v_mfma_f32_16x16x32_bf16 v[44:47], v[140:143], v[116:119], v[44:47]
  v_xor_b32 v169, 0x8000, v169
  v_xor_b32 v170, 0x38000, v170
  s_waitcnt vmcnt(0) lgkmcnt(0)
  s_barrier
  s_add_u32 s77, s77, 1
  s_cmp_eq_u32 s84, 0
  s_cbranch_scc1 L_nohook_60
  s_call_b64 s[88:89], L_hook
L_nohook_60:
  ds_read_b128 v[128:131], v169 offset:0
  ds_read_b128 v[132:135], v169 offset:1024
  v_mfma_f32_16x16x32_bf16 v[16:19], v[144:147], v[112:115], v[16:19]
  v_exp_f32 v160, v84
  v_mfma_f32_16x16x32_bf16 v[48:51], v[144:147], v[116:119], v[48:51]
  ds_read_b128 v[136:139], v169 offset:4096
  v_cvt_pk_bf16_f32 v125, v162, v163
  v_mfma_f32_16x16x32_bf16 v[20:23], v[148:151], v[112:115], v[20:23]
  s_cmp_eq_u32 s77, s48
  s_cselect_b32 s3, 16, s3
  v_exp_f32 v161, v85
  v_mfma_f32_16x16x32_bf16 v[52:55], v[148:151], v[116:119], v[52:55]
  ds_read_b128 v[140:143], v169 offset:5120
  s_waitcnt lgkmcnt(4)
  v_mfma_f32_16x16x32_bf16 v[24:27], v[152:155], v[112:115], v[24:27]
  v_exp_f32 v162, v86
  v_mfma_f32_16x16x32_bf16 v[56:59], v[152:155], v[116:119], v[56:59]
  ds_read_b128 v[144:147], v169 offset:2048
  v_cvt_pk_bf16_f32 v122, v160, v161
  v_mfma_f32_16x16x32_bf16 v[28:31], v[156:159], v[112:115], v[28:31]
  v_exp_f32 v163, v87
  v_mfma_f32_16x16x32_bf16 v[60:63], v[156:159], v[116:119], v[60:63]
  ds_read_b128 v[148:151], v169 offset:3072
  s_waitcnt lgkmcnt(4)
  s_branch L_it0
L_it3L:
  s_add_u32 s60, s77, 1
  s_cmp_ge_u32 s60, s97
  s_cbranch_scc1 L_it3F
  v_mfma_f32_16x16x32_bf16 v[80:83], v[128:131], v[176:179], v[96:99]
  v_exp_f32 v160, v76
  v_mfma_f32_16x16x32_bf16 v[80:83], v[132:135], v[180:183], v[80:83]
  ds_read_b128 v[152:155], v169 offset:30720
  v_cvt_pk_bf16_f32 v115, v162, v163
  v_mfma_f32_16x16x32_bf16 v[88:91], v[128:131], v[192:195], v[100:103]
  v_exp_f32 v161, v77
  v_mfma_f32_16x16x32_bf16 v[88:91], v[132:135], v[196:199], v[88:91]
  ds_read_b128 v[156:159], v169 offset:31744
  s_waitcnt lgkmcnt(4)
  v_mfma_f32_16x16x32_bf16 v[80:83], v[136:139], v[184:187], v[80:83]
  v_exp_f32 v162, v78
  v_mfma_f32_16x16x32_bf16 v[80:83], v[140:143], v[188:191], v[80:83]
  ds_read_b128 v[128:131], v170 offset:24576
  v_cvt_pk_bf16_f32 v118, v160, v161
  v_mfma_f32_16x16x32_bf16 v[104:107], v[164:167], v[112:115], v[104:107]
  v_exp_f32 v163, v79
  v_mfma_f32_16x16x32_bf16 v[88:91], v[136:139], v[200:203], v[88:91]
  ds_read_b128 v[132:135], v170 offset:25600
  v_cvt_pk_bf16_f32 v119, v162, v163
  v_mfma_f32_16x16x32_bf16 v[88:91], v[140:143], v[204:207], v[88:91]
  ds_read_b128 v[136:139], v170 offset:26624
  s_waitcnt lgkmcnt(5)
  v_mfma_f32_16x16x32_bf16 v[108:111], v[164:167], v[116:119], v[108:111]
  v_exp_f32 v160, v80
  v_mfma_f32_16x16x32_bf16 v[84:87], v[144:147], v[176:179], v[96:99]
  ds_read_b128 v[140:143], v170 offset:27648
  v_mfma_f32_16x16x32_bf16 v[84:87], v[148:151], v[180:183], v[84:87]
  v_exp_f32 v161, v81
  v_mfma_f32_16x16x32_bf16 v[92:95], v[144:147], v[192:195], v[100:103]
  ds_read_b128 v[144:147], v170 offset:28672
  v_cvt_pk_bf16_f32 v120, v160, v161
  v_mfma_f32_16x16x32_bf16 v[92:95], v[148:151], v[196:199], v[92:95]
  v_max_f32 v172, v104, v108
  s_waitcnt lgkmcnt(5)
  v_mfma_f32_16x16x32_bf16 v[84:87], v[152:155], v[184:187], v[84:87]
  v_exp_f32 v162, v82
  v_mfma_f32_16x16x32_bf16 v[84:87], v[156:159], v[188:191], v[84:87]
  ds_read_b128 v[148:151], v170 offset:29696
  v_cmp_nge_f32 vcc, s83, v172
  v_mfma_f32_16x16x32_bf16 v[92:95], v[152:155], v[200:203], v[92:95]
  v_exp_f32 v163, v83
  v_mfma_f32_16x16x32_bf16 v[92:95], v[156:159], v[204:207], v[92:95]
  s_cbranch_vccnz L_tr4
L_bk4:
  s_waitcnt lgkmcnt(4)
  v_mfma_f32_16x16x32_bf16 v[0:3], v[128:131], v[112:115], v[0:3]
  v_exp_f32 v160, v88
  v_mfma_f32_16x16x32_bf16 v[32:35], v[128:131], v[116:119], v[32:35]
  ds_read_b128 v[152:155], v170 offset:30720
  v_cvt_pk_bf16_f32 v121, v162, v163
  v_mfma_f32_16x16x32_bf16 v[4:7], v[132:135], v[112:115], v[4:7]
  v_exp_f32 v161, v89
  v_mfma_f32_16x16x32_bf16 v[36:39], v[132:135], v[116:119], v[36:39]
  ds_read_b128 v[156:159], v170 offset:31744
  s_waitcnt lgkmcnt(4)
  v_mfma_f32_16x16x32_bf16 v[8:11], v[136:139], v[112:115], v[8:11]
  v_exp_f32 v162, v90
  v_mfma_f32_16x16x32_bf16 v[40:43], v[136:139], v[116:119], v[40:43]
  v_cvt_pk_bf16_f32 v124, v160, v161
  v_mfma_f32_16x16x32_bf16 v[12:15], v[140:143], v[112:115], v[12:15]
  v_exp_f32 v163, v91
  v_mfma_f32_16x16x32_bf16 v[44:47], v[140:143], v[116:119], v[44:47]
  v_xor_b32 v169, 0x8000, v169
  v_xor_b32 v170, 0x38000, v170
  s_waitcnt vmcnt(0) lgkmcnt(0)
  s_barrier
  s_add_u32 s77, s77, 1
  s_cmp_eq_u32 s84, 0
  s_cbranch_scc1 L_nohook_61
  s_call_b64 s[88:89], L_hook
L_nohook_61:
  ds_read_b128 v[128:131], v170 offset:0
  ds_read_b128 v[132:135], v170 offset:1024
  v_mfma_f32_16x16x32_bf16 v[16:19], v[144:147], v[112:115], v[16:19]
  v_exp_f32 v160, v84
  v_mfma_f32_16x16x32_bf16 v[48:51], v[144:147], v[116:119], v[48:51]
  ds_read_b128 v[136:139], v170 offset:2048
  v_cvt_pk_bf16_f32 v125, v162, v163
  v_mfma_f32_16x16x32_bf16 v[20:23], v[148:151], v[112:115], v[20:23]
  v_exp_f32 v161, v85
  v_mfma_f32_16x16x32_bf16 v[52:55], v[148:151], v[116:119], v[52:55]
  ds_read_b128 v[140:143], v170 offset:3072
  s_waitcnt lgkmcnt(4)
  v_mfma_f32_16x16x32_bf16 v[24:27], v[152:155], v[112:115], v[24:27]
  v_exp_f32 v162, v86
  v_mfma_f32_16x16x32_bf16 v[56:59], v[152:155], v[116:119], v[56:59]
  ds_read_b128 v[144:147], v170 offset:4096
  v_cvt_pk_bf16_f32 v122, v160, v161
  v_mfma_f32_16x16x32_bf16 v[28:31], v[156:159], v[112:115], v[28:31]
  v_exp_f32 v163, v87
  v_mfma_f32_16x16x32_bf16 v[60:63], v[156:159], v[116:119], v[60:63]
  ds_read_b128 v[148:151], v170 offset:5120
  s_waitcnt lgkmcnt(4)
L_tail:
  ds_read_b128 v[152:155], v170 offset:6144
  ds_read_b128 v[156:159], v170 offset:7168
  v_exp_f32 v160, v92
  s_nop 0
  v_cvt_pk_bf16_f32 v123, v162, v163
  v_exp_f32 v161, v93
  v_exp_f32 v162, v94
  s_nop 0
  v_cvt_pk_bf16_f32 v126, v160, v161
  s_nop 1
  v_mfma_f32_16x16x32_bf16 v[104:107], v[164:167], v[120:123], v[104:107]
  v_exp_f32 v163, v95
  s_nop 0
  v_cvt_pk_bf16_f32 v127, v162, v163
  s_nop 1
  v_mfma_f32_16x16x32_bf16 v[108:111], v[164:167], v[124:127], v[108:111]
  s_nop 7
  v_max_f32 v172, v104, v108
  v_cmp_nge_f32 vcc, s83, v172
  s_nop 1
  s_cbranch_vccnz L_tr5
L_bk5:
  s_waitcnt lgkmcnt(7)
  v_mfma_f32_16x16x32_bf16 v[0:3], v[128:131], v[120:123], v[0:3]
  v_mfma_f32_16x16x32_bf16 v[32:35], v[128:131], v[124:127], v[32:35]
  s_waitcnt lgkmcnt(6)
  v_mfma_f32_16x16x32_bf16 v[4:7], v[132:135], v[120:123], v[4:7]
  v_mfma_f32_16x16x32_bf16 v[36:39], v[132:135], v[124:127], v[36:39]
  s_waitcnt lgkmcnt(5)
  v_mfma_f32_16x16x32_bf16 v[8:11], v[136:139], v[120:123], v[8:11]
  v_mfma_f32_16x16x32_bf16 v[40:43], v[136:139], v[124:127], v[40:43]
  s_waitcnt lgkmcnt(4)
  v_mfma_f32_16x16x32_bf16 v[12:15], v[140:143], v[120:123], v[12:15]
  v_mfma_f32_16x16x32_bf16 v[44:47], v[140:143], v[124:127], v[44:47]
  s_waitcnt lgkmcnt(3)
  v_mfma_f32_16x16x32_bf16 v[16:19], v[144:147], v[120:123], v[16:19]
  v_mfma_f32_16x16x32_bf16 v[48:51], v[144:147], v[124:127], v[48:51]
  s_waitcnt lgkmcnt(2)
  v_mfma_f32_16x16x32_bf16 v[20:23], v[148:151], v[120:123], v[20:23]
  v_mfma_f32_16x16x32_bf16 v[52:55], v[148:151], v[124:127], v[52:55]
  s_waitcnt lgkmcnt(1)
  v_mfma_f32_16x16x32_bf16 v[24:27], v[152:155], v[120:123], v[24:27]
  v_mfma_f32_16x16x32_bf16 v[56:59], v[152:155], v[124:127], v[56:59]
  s_waitcnt lgkmcnt(0)
  v_mfma_f32_16x16x32_bf16 v[28:31], v[156:159], v[120:123], v[28:31]
  v_mfma_f32_16x16x32_bf16 v[60:63], v[156:159], v[124:127], v[60:63]
  s_branch L_epi2
L_it3F:
  v_mfma_f32_16x16x32_bf16 v[80:83], v[128:131], v[176:179], v[96:99]
  v_exp_f32 v160, v76
  v_mfma_f32_16x16x32_bf16 v[80:83], v[132:135], v[180:183], v[80:83]
  ds_read_b128 v[152:155], v169 offset:30720
  v_cvt_pk_bf16_f32 v115, v162, v163
  v_mfma_f32_16x16x32_bf16 v[88:91], v[128:131], v[192:195], v[100:103]
  v_exp_f32 v161, v77
  v_mfma_f32_16x16x32_bf16 v[88:91], v[132:135], v[196:199], v[88:91]
  ds_read_b128 v[156:159], v169 offset:31744
  s_waitcnt lgkmcnt(4)
  v_mfma_f32_16x16x32_bf16 v[80:83], v[136:139], v[184:187], v[80:83]
  v_exp_f32 v162, v78
  v_mfma_f32_16x16x32_bf16 v[80:83], v[140:143], v[188:191], v[80:83]
  ds_read_b128 v[128:131], v170 offset:24576
  v_cvt_pk_bf16_f32 v118, v160, v161
  v_mfma_f32_16x16x32_bf16 v[104:107], v[164:167], v[112:115], v[104:107]
  v_exp_f32 v163, v79
  v_mfma_f32_16x16x32_bf16 v[88:91], v[136:139], v[200:203], v[88:91]
  ds_read_b128 v[132:135], v170 offset:25600
  v_cvt_pk_bf16_f32 v119, v162, v163
  v_mfma_f32_16x16x32_bf16 v[88:91], v[140:143], v[204:207], v[88:91]
  ds_read_b128 v[136:139], v170 offset:26624
  s_waitcnt lgkmcnt(5)
  v_mfma_f32_16x16x32_bf16 v[108:111], v[164:167], v[116:119], v[108:111]
  v_exp_f32 v160, v80
  v_mfma_f32_16x16x32_bf16 v[84:87], v[144:147], v[176:179], v[96:99]
  ds_read_b128 v[140:143], v170 offset:27648
  v_mfma_f32_16x16x32_bf16 v[84:87], v[148:151], v[180:183], v[84:87]
  v_exp_f32 v161, v81
  v_mfma_f32_16x16x32_bf16 v[92:95], v[144:147], v[192:195], v[100:103]
  ds_read_b128 v[144:147], v170 offset:28672
  v_cvt_pk_bf16_f32 v120, v160, v161
  v_mfma_f32_16x16x32_bf16 v[92:95], v[148:151], v[196:199], v[92:95]
  v_max_f32 v172, v104, v108
  s_waitcnt lgkmcnt(5)
  v_mfma_f32_16x16x32_bf16 v[84:87], v[152:155], v[184:187], v[84:87]
  v_exp_f32 v162, v82
  v_mfma_f32_16x16x32_bf16 v[84:87], v[156:159], v[188:191], v[84:87]
  ds_read_b128 v[148:151], v170 offset:29696
  v_cmp_nge_f32 vcc, s83, v172
  v_mfma_f32_16x16x32_bf16 v[92:95], v[152:155], v[200:203], v[92:95]
  v_exp_f32 v163, v83
  v_mfma_f32_16x16x32_bf16 v[92:95], v[156:159], v[204:207], v[92:95]
  s_cbranch_vccnz L_tr6
L_bk6:
  s_waitcnt lgkmcnt(4)
  v_mfma_f32_16x16x32_bf16 v[0:3], v[128:131], v[112:115], v[0:3]
  v_exp_f32 v160, v88
  v_mfma_f32_16x16x32_bf16 v[32:35], v[128:131], v[116:119], v[32:35]
  ds_read_b128 v[152:155], v170 offset:30720
  v_cvt_pk_bf16_f32 v121, v162, v163
  v_mfma_f32_16x16x32_bf16 v[4:7], v[132:135], v[112:115], v[4:7]
  v_exp_f32 v161, v89
  v_mfma_f32_16x16x32_bf16 v[36:39], v[132:135], v[116:119], v[36:39]
  ds_read_b128 v[156:159], v170 offset:31744
  s_waitcnt lgkmcnt(4)
  v_mfma_f32_16x16x32_bf16 v[8:11], v[136:139], v[112:115], v[8:11]
  v_exp_f32 v162, v90
  v_mfma_f32_16x16x32_bf16 v[40:43], v[136:139], v[116:119], v[40:43]
  v_cvt_pk_bf16_f32 v124, v160, v161
  v_mfma_f32_16x16x32_bf16 v[12:15], v[140:143], v[112:115], v[12:15]
  v_exp_f32 v163, v91
  v_mfma_f32_16x16x32_bf16 v[44:47], v[140:143], v[116:119], v[44:47]
  v_xor_b32 v169, 0x8000, v169
  v_xor_b32 v170, 0x38000, v170
  s_waitcnt vmcnt(0) lgkmcnt(0)
  s_barrier
  s_add_u32 s77, s77, 1
  s_cmp_eq_u32 s84, 0
  s_cbranch_scc1 L_nohook_62
  s_call_b64 s[88:89], L_hook
L_nohook_62:
  ds_read_b128 v[128:131], v170 offset:0
  ds_read_b128 v[132:135], v170 offset:1024
  v_mfma_f32_16x16x32_bf16 v[16:19], v[144:147], v[112:115], v[16:19]
  s_add_u32 s60, s2, 8192
  buffer_load_dwordx4 v[176:179], v253, s[28:31], s60 offen offset:0 sc1
  v_exp_f32 v160, v84
  v_mfma_f32_16x16x32_bf16 v[48:51], v[144:147], v[116:119], v[48:51]
  buffer_load_dwordx4 v[180:183], v253, s[28:31], s60 offen offset:1024 sc1
  ds_read_b128 v[136:139], v170 offset:2048
  v_cvt_pk_bf16_f32 v125, v162, v163
  v_mfma_f32_16x16x32_bf16 v[20:23], v[148:151], v[112:115], v[20:23]
  buffer_load_dwordx4 v[184:187], v253, s[28:31], s60 offen offset:2048 sc1
  v_exp_f32 v161, v85
  v_mfma_f32_16x16x32_bf16 v[52:55], v[148:151], v[116:119], v[52:55]
  buffer_load_dwordx4 v[188:191], v253, s[28:31], s60 offen offset:3072 sc1
  ds_read_b128 v[140:143], v170 offset:3072
  s_waitcnt lgkmcnt(4)
  v_mfma_f32_16x16x32_bf16 v[24:27], v[152:155], v[112:115], v[24:27]
  s_add_u32 s60, s2, 12288
  buffer_load_dwordx4 v[192:195], v253, s[28:31], s60 offen offset:0 sc1
  v_exp_f32 v162, v86
  v_mfma_f32_16x16x32_bf16 v[56:59], v[152:155], v[116:119], v[56:59]
  buffer_load_dwordx4 v[196:199], v253, s[28:31], s60 offen offset:1024 sc1
  ds_read_b128 v[144:147], v170 offset:4096
  v_cvt_pk_bf16_f32 v122, v160, v161
  v_mfma_f32_16x16x32_bf16 v[28:31], v[156:159], v[112:115], v[28:31]
  buffer_load_dwordx4 v[200:203], v253, s[28:31], s60 offen offset:2048 sc1
  v_exp_f32 v163, v87
  v_mfma_f32_16x16x32_bf16 v[60:63], v[156:159], v[116:119], v[60:63]
  buffer_load_dwordx4 v[204:207], v253, s[28:31], s60 offen offset:3072 sc1
  ds_read_b128 v[148:151], v170 offset:5120
  s_waitcnt lgkmcnt(4)
  ds_read_b128 v[152:155], v170 offset:6144
  ds_read_b128 v[156:159], v170 offset:7168
  v_exp_f32 v160, v92
  s_nop 0
  v_cvt_pk_bf16_f32 v123, v162, v163
  v_exp_f32 v161, v93
  v_exp_f32 v162, v94
  s_nop 0
  v_cvt_pk_bf16_f32 v126, v160, v161
  s_nop 1
  v_mfma_f32_16x16x32_bf16 v[104:107], v[164:167], v[120:123], v[104:107]
  v_exp_f32 v163, v95
  s_nop 0
  v_cvt_pk_bf16_f32 v127, v162, v163
  s_nop 1
  v_mfma_f32_16x16x32_bf16 v[108:111], v[164:167], v[124:127], v[108:111]
  s_nop 7
  v_max_f32 v172, v104, v108
  v_cmp_nge_f32 vcc, s83, v172
  s_nop 1
  s_cbranch_vccnz L_tr7
L_bk7:
  s_waitcnt lgkmcnt(7)
  v_mfma_f32_16x16x32_bf16 v[0:3], v[128:131], v[120:123], v[0:3]
  v_mfma_f32_16x16x32_bf16 v[32:35], v[128:131], v[124:127], v[32:35]
  s_waitcnt lgkmcnt(6)
  v_mfma_f32_16x16x32_bf16 v[4:7], v[132:135], v[120:123], v[4:7]
  v_mfma_f32_16x16x32_bf16 v[36:39], v[132:135], v[124:127], v[36:39]
  s_waitcnt lgkmcnt(5)
  v_mfma_f32_16x16x32_bf16 v[8:11], v[136:139], v[120:123], v[8:11]
  v_cmp_eq_u32 vcc, 0, v168
  s_nop 1
  s_cbranch_vccz L_gokeF_63
  v_bfe_u32 v208, v254, 3, 1
  v_lshlrev_b32 v208, 10, v208
  v_and_b32 v209, 7, v254
  v_lshl_add_u32 v208, v209, 2, v208
  s_lshl_b32 s52, s93, 2
  s_add_u32 s52, s52, s80
  s_lshl_b32 s52, s52, 12
  s_lshl_b32 s53, s91, 7
  s_add_u32 s52, s52, s53
  s_add_u32 s52, s52, 60817504
L_gtopeF_64:
  buffer_load_dword v168, v208, s[28:31], s52 offen offset:0 sc1
  s_waitcnt vmcnt(0)
  v_cmp_eq_u32 vcc, 0, v168
  s_nop 1
  s_cbranch_vccz L_gokeF_63
  s_sleep 4
  s_sub_u32 s99, s99, 1
  s_cbranch_scc0 L_gtopeF_64
  s_mov_b32 s99, 0
L_gokeF_63:
  v_cmp_eq_u32 vcc, 0, v171
  s_nop 1
  s_cbranch_vccz L_gokfF_65
  v_bfe_u32 v208, v254, 3, 1
  v_lshlrev_b32 v208, 10, v208
  v_and_b32 v209, 7, v254
  v_lshl_add_u32 v208, v209, 2, v208
  s_lshl_b32 s52, s93, 2
  s_add_u32 s52, s52, s80
  s_lshl_b32 s52, s52, 12
  s_lshl_b32 s53, s91, 7
  s_add_u32 s52, s52, s53
  s_add_u32 s52, s52, 60817504
L_gtopfF_66:
  buffer_load_dword v171, v208, s[28:31], s52 offen offset:2048 sc1
  s_waitcnt vmcnt(0)
  v_cmp_eq_u32 vcc, 0, v171
  s_nop 1
  s_cbranch_vccz L_gokfF_65
  s_sleep 4
  s_sub_u32 s99, s99, 1
  s_cbranch_scc0 L_gtopfF_66
  s_mov_b32 s99, 0
L_gokfF_65:
  v_rcp_f32 v208, v104
  v_rcp_f32 v209, v108
  v_add_f32 v168, -1.0, v168
  v_add_f32 v171, -1.0, v171
  v_mul_f32 v162, v208, v168
  v_mul_f32 v163, v209, v171
  v_lshrrev_b32 v168, 4, v254
  v_lshl_add_u32 v168, v168, 8, v253
  v_mfma_f32_16x16x32_bf16 v[40:43], v[136:139], v[124:127], v[40:43]
  v_mul_f32 v0, v0, v162
  v_mul_f32 v1, v1, v162
  v_mul_f32 v2, v2, v162
  v_mul_f32 v3, v3, v162
  v_mul_f32 v4, v4, v162
  v_mul_f32 v5, v5, v162
  v_mul_f32 v6, v6, v162
  s_waitcnt lgkmcnt(4)
  v_mfma_f32_16x16x32_bf16 v[12:15], v[140:143], v[120:123], v[12:15]
  v_mul_f32 v7, v7, v162
  v_mul_f32 v32, v32, v163
  v_mul_f32 v33, v33, v163
  v_mul_f32 v34, v34, v163
  v_mul_f32 v35, v35, v163
  v_mul_f32 v36, v36, v163
  v_mul_f32 v37, v37, v163
  v_mfma_f32_16x16x32_bf16 v[44:47], v[140:143], v[124:127], v[44:47]
  v_mul_f32 v38, v38, v163
  v_mul_f32 v39, v39, v163
  v_cvt_pk_bf16_f32 v80, v0, v1
  v_cvt_pk_bf16_f32 v81, v2, v3
  v_cvt_pk_bf16_f32 v82, v4, v5
  v_cvt_pk_bf16_f32 v83, v6, v7
  v_cvt_pk_bf16_f32 v84, v32, v33
  s_waitcnt lgkmcnt(3)
  v_mfma_f32_16x16x32_bf16 v[16:19], v[144:147], v[120:123], v[16:19]
  v_cvt_pk_bf16_f32 v85, v34, v35
  v_cvt_pk_bf16_f32 v86, v36, v37
  v_cvt_pk_bf16_f32 v87, v38, v39
  buffer_store_dwordx4 v[80:83], v168, s[28:31], s65 offen offset:0 sc1
  buffer_store_dwordx4 v[84:87], v168, s[28:31], s65 offen offset:256 sc1
  v_mfma_f32_16x16x32_bf16 v[48:51], v[144:147], v[124:127], v[48:51]
  v_mul_f32 v8, v8, v162
  v_mul_f32 v9, v9, v162
  v_mul_f32 v10, v10, v162
  v_mul_f32 v11, v11, v162
  v_mul_f32 v12, v12, v162
  v_mul_f32 v13, v13, v162
  v_mul_f32 v14, v14, v162
  s_waitcnt lgkmcnt(2)
  v_mfma_f32_16x16x32_bf16 v[20:23], v[148:151], v[120:123], v[20:23]
  v_mul_f32 v15, v15, v162
  v_mul_f32 v40, v40, v163
  v_mul_f32 v41, v41, v163
  v_mul_f32 v42, v42, v163
  v_mul_f32 v43, v43, v163
  v_mul_f32 v44, v44, v163
  v_mul_f32 v45, v45, v163
  v_mfma_f32_16x16x32_bf16 v[52:55], v[148:151], v[124:127], v[52:55]
  v_mul_f32 v46, v46, v163
  v_mul_f32 v47, v47, v163
  v_cvt_pk_bf16_f32 v88, v8, v9
  v_cvt_pk_bf16_f32 v89, v10, v11
  v_cvt_pk_bf16_f32 v90, v12, v13
  v_cvt_pk_bf16_f32 v91, v14, v15
  v_cvt_pk_bf16_f32 v92, v40, v41
  s_waitcnt lgkmcnt(1)
  v_mfma_f32_16x16x32_bf16 v[24:27], v[152:155], v[120:123], v[24:27]
  v_cvt_pk_bf16_f32 v93, v42, v43
  v_cvt_pk_bf16_f32 v94, v44, v45
  v_cvt_pk_bf16_f32 v95, v46, v47
  buffer_store_dwordx4 v[88:91], v168, s[28:31], s65 offen offset:2048 sc1
  buffer_store_dwordx4 v[92:95], v168, s[28:31], s65 offen offset:2304 sc1
  v_mfma_f32_16x16x32_bf16 v[56:59], v[152:155], v[124:127], v[56:59]
  s_add_u32 s61, s65, 4096
  v_mul_f32 v16, v16, v162
  v_mul_f32 v17, v17, v162
  v_mul_f32 v18, v18, v162
  v_mul_f32 v19, v19, v162
  v_mul_f32 v20, v20, v162
  v_mul_f32 v21, v21, v162
  s_waitcnt lgkmcnt(0)
  v_mfma_f32_16x16x32_bf16 v[28:31], v[156:159], v[120:123], v[28:31]
  v_mul_f32 v22, v22, v162
  v_mul_f32 v23, v23, v162
  v_mul_f32 v48, v48, v163
  v_mul_f32 v49, v49, v163
  v_mul_f32 v50, v50, v163
  v_mul_f32 v51, v51, v163
  v_mul_f32 v52, v52, v163
  v_mfma_f32_16x16x32_bf16 v[60:63], v[156:159], v[124:127], v[60:63]
  v_mul_f32 v53, v53, v163
  v_mul_f32 v54, v54, v163
  v_mul_f32 v55, v55, v163
  v_cvt_pk_bf16_f32 v96, v16, v17
  v_cvt_pk_bf16_f32 v97, v18, v19
  v_cvt_pk_bf16_f32 v98, v20, v21
  v_cvt_pk_bf16_f32 v99, v22, v23
  s_lshl_b32 s52, s96, 3
  s_add_u32 s52, s52, s92
  s_lshl_b32 s52, s52, 7
  s_add_u32 s52, s52, 61079552
  v_and_b32 v249, 7, v254
  v_lshl_add_u32 v249, v249, 2, s52
  v_cvt_pk_bf16_f32 v100, v48, v49
  v_cvt_pk_bf16_f32 v101, v50, v51
  v_cvt_pk_bf16_f32 v102, v52, v53
  v_cvt_pk_bf16_f32 v103, v54, v55
  buffer_store_dwordx4 v[96:99], v168, s[28:31], s61 offen offset:0 sc1
  buffer_store_dwordx4 v[100:103], v168, s[28:31], s61 offen offset:256 sc1
  v_mul_f32 v24, v24, v162
  v_mul_f32 v25, v25, v162
  v_mul_f32 v26, v26, v162
  v_mul_f32 v27, v27, v162
  v_mul_f32 v28, v28, v162
  v_mul_f32 v29, v29, v162
  v_mul_f32 v30, v30, v162
  v_mul_f32 v31, v31, v162
  v_mul_f32 v56, v56, v163
  v_mul_f32 v57, v57, v163
  v_mul_f32 v58, v58, v163
  v_mul_f32 v59, v59, v163
  v_mul_f32 v60, v60, v163
  v_mul_f32 v61, v61, v163
  v_mul_f32 v62, v62, v163
  v_mul_f32 v63, v63, v163
  v_cvt_pk_bf16_f32 v104, v24, v25
  v_cvt_pk_bf16_f32 v105, v26, v27
  v_cvt_pk_bf16_f32 v106, v28, v29
  v_cvt_pk_bf16_f32 v107, v30, v31
  v_cvt_pk_bf16_f32 v108, v56, v57
  v_cvt_pk_bf16_f32 v109, v58, v59
  v_cvt_pk_bf16_f32 v110, v60, v61
  v_cvt_pk_bf16_f32 v111, v62, v63
  buffer_store_dwordx4 v[104:107], v168, s[28:31], s61 offen offset:2048 sc1
  buffer_store_dwordx4 v[108:111], v168, s[28:31], s61 offen offset:2304 sc1
  s_mov_b32 s69, 2
  s_mov_b32 s81, 1
  s_cmp_eq_u32 s91, 7
  s_cbranch_scc1 L_cB
  s_waitcnt vmcnt(12)
  s_branch L_cq
L_cB:
  s_add_u32 s60, s2, 16384
  buffer_load_dwordx4 v[112:115], v253, s[28:31], s60 offen offset:0 sc1
  buffer_load_dwordx4 v[116:119], v253, s[28:31], s60 offen offset:1024 sc1
  buffer_load_dwordx4 v[120:123], v253, s[28:31], s60 offen offset:2048 sc1
  buffer_load_dwordx4 v[124:127], v253, s[28:31], s60 offen offset:3072 sc1
  s_add_u32 s60, s2, 20480
  buffer_load_dwordx4 v[0:3], v253, s[28:31], s60 offen offset:0 sc1
  buffer_load_dwordx4 v[4:7], v253, s[28:31], s60 offen offset:1024 sc1
  buffer_load_dwordx4 v[8:11], v253, s[28:31], s60 offen offset:2048 sc1
  buffer_load_dwordx4 v[12:15], v253, s[28:31], s60 offen offset:3072 sc1
  v_xor_b32 v213, 512, v249
  s_waitcnt vmcnt(8)
  v_and_b32 v173, 3, v254
  v_lshlrev_b32 v173, 13, v173
  v_mov_b32 v174, 1
  s_mov_b64 exec, 15
  buffer_store_dword v174, v173, s[28:31], s18 offen sc1
  s_mov_b64 exec, -1
  s_mov_b32 s81, 0
  s_cmp_eq_u32 s93, 0
  s_cbranch_scc1 L_cq
  s_add_u32 s60, s2, 24576
  buffer_load_dwordx4 v[16:19], v253, s[28:31], s60 offen offset:0 sc1
  buffer_load_dwordx4 v[20:23], v253, s[28:31], s60 offen offset:1024 sc1
  buffer_load_dwordx4 v[24:27], v253, s[28:31], s60 offen offset:2048 sc1
  buffer_load_dwordx4 v[28:31], v253, s[28:31], s60 offen offset:3072 sc1
  s_add_u32 s60, s2, 28672
  buffer_load_dwordx4 v[32:35], v253, s[28:31], s60 offen offset:0 sc1
  buffer_load_dwordx4 v[36:39], v253, s[28:31], s60 offen offset:1024 sc1
  buffer_load_dwordx4 v[40:43], v253, s[28:31], s60 offen offset:2048 sc1
  buffer_load_dwordx4 v[44:47], v253, s[28:31], s60 offen offset:3072 sc1
  s_add_u32 s60, s2, 32768
  buffer_load_dwordx4 v[48:51], v253, s[28:31], s60 offen offset:0 sc1
  buffer_load_dwordx4 v[52:55], v253, s[28:31], s60 offen offset:1024 sc1
  buffer_load_dwordx4 v[56:59], v253, s[28:31], s60 offen offset:2048 sc1
  buffer_load_dwordx4 v[60:63], v253, s[28:31], s60 offen offset:3072 sc1
  s_mov_b32 s69, 3
  buffer_load_dword v251, v249, s[28:31], 0 offen sc1
  buffer_load_dword v252, v213, s[28:31], 0 offen sc1
  s_waitcnt vmcnt(0)
L_fcb_67:
  v_cmp_ne_u32 vcc, 1, v251
  s_nop 1
  s_and_b32 s61, vcc_lo, 204
  s_cbranch_scc0 L_fcokb_68
  s_sleep 3
  buffer_load_dword v251, v249, s[28:31], 0 offen sc1
  s_waitcnt vmcnt(0)
  s_sub_u32 s99, s99, 1
  s_cbranch_scc0 L_fcb_67
  s_mov_b32 s99, 0
L_fcokb_68:
  s_add_u32 m0, s25, 0
  s_add_u32 s58, s19, 0
  buffer_load_dwordx4 v253, s[28:31], s58 offen offset:0 sc1 lds
  buffer_load_dwordx4 v253, s[28:31], s58 offen offset:1024 sc1 lds
  buffer_load_dwordx4 v253, s[28:31], s58 offen offset:2048 sc1 lds
  s_add_u32 m0, s25, 12288
  s_add_u32 s58, s19, 0
  s_add_u32 s58, s58, s23
  buffer_load_dwordx4 v253, s[28:31], s58 offen offset:0 sc1 lds
  buffer_load_dwordx4 v253, s[28:31], s58 offen offset:1024 sc1 lds
  buffer_load_dwordx4 v253, s[28:31], s58 offen offset:2048 sc1 lds
L_fcc_69:
  v_cmp_ne_u32 vcc, 1, v252
  s_nop 1
  s_and_b32 s61, vcc_lo, 204
  s_cbranch_scc0 L_fcokc_70
  s_sleep 3
  buffer_load_dword v252, v213, s[28:31], 0 offen sc1
  s_waitcnt vmcnt(0)
  s_sub_u32 s99, s99, 1
  s_cbranch_scc0 L_fcc_69
  s_mov_b32 s99, 0
L_fcokc_70:
  s_add_u32 m0, s44, 0
  s_add_u32 s58, s68, 0
  buffer_load_dwordx4 v253, s[28:31], s58 offen offset:0 sc1 lds
  buffer_load_dwordx4 v253, s[28:31], s58 offen offset:1024 sc1 lds
  buffer_load_dwordx4 v253, s[28:31], s58 offen offset:2048 sc1 lds
  s_add_u32 m0, s44, 12288
  s_add_u32 s58, s68, 0
  s_sub_u32 s58, s58, s23
  buffer_load_dwordx4 v253, s[28:31], s58 offen offset:0 sc1 lds
  buffer_load_dwordx4 v253, s[28:31], s58 offen offset:1024 sc1 lds
  buffer_load_dwordx4 v253, s[28:31], s58 offen offset:2048 sc1 lds
  s_waitcnt vmcnt(0)
  s_branch L_cq
L_epi2:
  v_cmp_eq_u32 vcc, 0, v168
  s_nop 1
  s_cbranch_vccz L_goke_71
  v_bfe_u32 v208, v254, 3, 1
  v_lshlrev_b32 v208, 10, v208
  v_and_b32 v209, 7, v254
  v_lshl_add_u32 v208, v209, 2, v208
  s_lshl_b32 s52, s93, 2
  s_add_u32 s52, s52, s80
  s_lshl_b32 s52, s52, 12
  s_lshl_b32 s53, s91, 7
  s_add_u32 s52, s52, s53
  s_add_u32 s52, s52, 60817504
L_gtope_72:
  buffer_load_dword v168, v208, s[28:31], s52 offen offset:0 sc1
  s_waitcnt vmcnt(0)
  v_cmp_eq_u32 vcc, 0, v168
  s_nop 1
  s_cbranch_vccz L_goke_71
  s_sleep 4
  s_sub_u32 s99, s99, 1
  s_cbranch_scc0 L_gtope_72
  s_mov_b32 s99, 0
L_goke_71:
  v_cmp_eq_u32 vcc, 0, v171
  s_nop 1
  s_cbranch_vccz L_gokf_73
  v_bfe_u32 v208, v254, 3, 1
  v_lshlrev_b32 v208, 10, v208
  v_and_b32 v209, 7, v254
  v_lshl_add_u32 v208, v209, 2, v208
  s_lshl_b32 s52, s93, 2
  s_add_u32 s52, s52, s80
  s_lshl_b32 s52, s52, 12
  s_lshl_b32 s53, s91, 7
  s_add_u32 s52, s52, s53
  s_add_u32 s52, s52, 60817504
L_gtopf_74:
  buffer_load_dword v171, v208, s[28:31], s52 offen offset:2048 sc1
  s_waitcnt vmcnt(0)
  v_cmp_eq_u32 vcc, 0, v171
  s_nop 1
  s_cbranch_vccz L_gokf_73
  s_sleep 4
  s_sub_u32 s99, s99, 1
  s_cbranch_scc0 L_gtopf_74
  s_mov_b32 s99, 0
L_gokf_73:
  v_rcp_f32 v208, v104
  v_rcp_f32 v209, v108
  v_add_f32 v168, -1.0, v168
  v_add_f32 v171, -1.0, v171
  v_mul_f32 v162, v208, v168
  v_mul_f32 v163, v209, v171
  v_lshrrev_b32 v168, 4, v254
  v_lshl_add_u32 v168, v168, 8, v253
  s_mov_b32 s81, 3
  s_lshl_b32 s52, s3, 4
  s_add_u32 s52, s52, s77
  s_add_u32 s52, s52, 4
  s_cmp_lt_u32 s52, s97
  s_cbranch_scc1 L_help
L_help0:
  s_add_u32 s52, s77, 1
  s_cmp_eq_u32 s52, s97
  s_cbranch_scc1 L_early
L_help1:
  s_cmp_eq_u32 s3, 0
  s_cbranch_scc1 L_hs1
  s_add_u32 s64, s64, 4
  s_sub_u32 s3, s3, 2
  s_cmp_eq_u32 s3, 0
  s_cbranch_scc1 L_hs0
  s_add_u32 s61, s70, 8192
  buffer_store_dwordx4 v[216:219], v253, s[28:31], s70 offen offset:0 sc1
  buffer_store_dwordx4 v[220:223], v253, s[28:31], s70 offen offset:1024 sc1
  buffer_store_dwordx4 v[224:227], v253, s[28:31], s70 offen offset:2048 sc1
  buffer_store_dwordx4 v[228:231], v253, s[28:31], s70 offen offset:3072 sc1
  s_branch L_help
L_hs0:
  s_add_u32 s61, s70, 8192
  buffer_store_dwordx4 v[232:235], v253, s[28:31], s61 offen offset:0 sc1
  buffer_store_dwordx4 v[236:239], v253, s[28:31], s61 offen offset:1024 sc1
  buffer_store_dwordx4 v[240:243], v253, s[28:31], s61 offen offset:2048 sc1
  buffer_store_dwordx4 v[244:247], v253, s[28:31], s61 offen offset:3072 sc1
  s_branch L_help
L_hs1:
  s_cmp_lt_u32 s81, 2
  s_cbranch_scc1 L_hw
  s_add_u32 s64, s64, 4
  s_sub_u32 s81, s81, 1
  s_cmp_eq_u32 s81, 1
  s_cbranch_scc1 L_hs2
  v_mul_f32 v0, v0, v162
  v_mul_f32 v1, v1, v162
  v_mul_f32 v2, v2, v162
  v_mul_f32 v3, v3, v162
  v_mul_f32 v4, v4, v162
  v_mul_f32 v5, v5, v162
  v_mul_f32 v6, v6, v162
  v_mul_f32 v7, v7, v162
  v_mul_f32 v32, v32, v163
  v_mul_f32 v33, v33, v163
  v_mul_f32 v34, v34, v163
  v_mul_f32 v35, v35, v163
  v_mul_f32 v36, v36, v163
  v_mul_f32 v37, v37, v163
  v_mul_f32 v38, v38, v163
  v_mul_f32 v39, v39, v163
  v_cvt_pk_bf16_f32 v80, v0, v1
  v_cvt_pk_bf16_f32 v81, v2, v3
  v_cvt_pk_bf16_f32 v82, v4, v5
  v_cvt_pk_bf16_f32 v83, v6, v7
  v_cvt_pk_bf16_f32 v84, v32, v33
  v_cvt_pk_bf16_f32 v85, v34, v35
  v_cvt_pk_bf16_f32 v86, v36, v37
  v_cvt_pk_bf16_f32 v87, v38, v39
  buffer_store_dwordx4 v[80:83], v168, s[28:31], s65 offen offset:0 sc1
  buffer_store_dwordx4 v[84:87], v168, s[28:31], s65 offen offset:256 sc1
  v_mul_f32 v8, v8, v162
  v_mul_f32 v9, v9, v162
  v_mul_f32 v10, v10, v162
  v_mul_f32 v11, v11, v162
  v_mul_f32 v12, v12, v162
  v_mul_f32 v13, v13, v162
  v_mul_f32 v14, v14, v162
  v_mul_f32 v15, v15, v162
  v_mul_f32 v40, v40, v163
  v_mul_f32 v41, v41, v163
  v_mul_f32 v42, v42, v163
  v_mul_f32 v43, v43, v163
  v_mul_f32 v44, v44, v163
  v_mul_f32 v45, v45, v163
  v_mul_f32 v46, v46, v163
  v_mul_f32 v47, v47, v163
  v_cvt_pk_bf16_f32 v88, v8, v9
  v_cvt_pk_bf16_f32 v89, v10, v11
  v_cvt_pk_bf16_f32 v90, v12, v13
  v_cvt_pk_bf16_f32 v91, v14, v15
  v_cvt_pk_bf16_f32 v92, v40, v41
  v_cvt_pk_bf16_f32 v93, v42, v43
  v_cvt_pk_bf16_f32 v94, v44, v45
  v_cvt_pk_bf16_f32 v95, v46, v47
  buffer_store_dwordx4 v[88:91], v168, s[28:31], s65 offen offset:2048 sc1
  buffer_store_dwordx4 v[92:95], v168, s[28:31], s65 offen offset:2304 sc1
  s_add_u32 s52, s77, 2
  s_cmp_ge_u32 s52, s97
  s_cbranch_scc1 L_hs1
  s_branch L_help
L_hs2:
  s_add_u32 s61, s65, 4096
  v_mul_f32 v16, v16, v162
  v_mul_f32 v17, v17, v162
  v_mul_f32 v18, v18, v162
  v_mul_f32 v19, v19, v162
  v_mul_f32 v20, v20, v162
  v_mul_f32 v21, v21, v162
  v_mul_f32 v22, v22, v162
  v_mul_f32 v23, v23, v162
  v_mul_f32 v48, v48, v163
  v_mul_f32 v49, v49, v163
  v_mul_f32 v50, v50, v163
  v_mul_f32 v51, v51, v163
  v_mul_f32 v52, v52, v163
  v_mul_f32 v53, v53, v163
  v_mul_f32 v54, v54, v163
  v_mul_f32 v55, v55, v163
  v_cvt_pk_bf16_f32 v96, v16, v17
  v_cvt_pk_bf16_f32 v97, v18, v19
  v_cvt_pk_bf16_f32 v98, v20, v21
  v_cvt_pk_bf16_f32 v99, v22, v23
  v_cvt_pk_bf16_f32 v100, v48, v49
  v_cvt_pk_bf16_f32 v101, v50, v51
  v_cvt_pk_bf16_f32 v102, v52, v53
  v_cvt_pk_bf16_f32 v103, v54, v55
  buffer_store_dwordx4 v[96:99], v168, s[28:31], s61 offen offset:0 sc1
  buffer_store_dwordx4 v[100:103], v168, s[28:31], s61 offen offset:256 sc1
  v_mul_f32 v24, v24, v162
  v_mul_f32 v25, v25, v162
  v_mul_f32 v26, v26, v162
  v_mul_f32 v27, v27, v162
  v_mul_f32 v28, v28, v162
  v_mul_f32 v29, v29, v162
  v_mul_f32 v30, v30, v162
  v_mul_f32 v31, v31, v162
  v_mul_f32 v56, v56, v163
  v_mul_f32 v57, v57, v163
  v_mul_f32 v58, v58, v163
  v_mul_f32 v59, v59, v163
  v_mul_f32 v60, v60, v163
  v_mul_f32 v61, v61, v163
  v_mul_f32 v62, v62, v163
  v_mul_f32 v63, v63, v163
  v_cvt_pk_bf16_f32 v104, v24, v25
  v_cvt_pk_bf16_f32 v105, v26, v27
  v_cvt_pk_bf16_f32 v106, v28, v29
  v_cvt_pk_bf16_f32 v107, v30, v31
  v_cvt_pk_bf16_f32 v108, v56, v57
  v_cvt_pk_bf16_f32 v109, v58, v59
  v_cvt_pk_bf16_f32 v110, v60, v61
  v_cvt_pk_bf16_f32 v111, v62, v63
  buffer_store_dwordx4 v[104:107], v168, s[28:31], s61 offen offset:2048 sc1
  buffer_store_dwordx4 v[108:111], v168, s[28:31], s61 offen offset:2304 sc1
  s_branch L_help
L_hw:
  s_cmp_lg_u32 s81, 0
  s_cbranch_scc1 L_help
  s_cmp_eq_u32 s0, 0
  s_cbranch_scc1 L_help
  s_add_u32 s52, s77, 3
  s_cmp_lt_u32 s52, s97
  s_cbranch_scc1 L_help
  s_cmp_ge_u32 s69, 3
  s_cbranch_scc1 L_help
  s_add_u32 s64, s64, 12
  s_add_u32 s69, s69, 1
  s_cmp_eq_u32 s69, 2
  s_cbranch_scc1 L_hwb
  s_cmp_eq_u32 s69, 3
  s_cbranch_scc1 L_hwc
  s_add_u32 s60, s2, 0
  buffer_load_dwordx4 v[216:219], v253, s[28:31], s60 offen offset:0 sc1
  buffer_load_dwordx4 v[220:223], v253, s[28:31], s60 offen offset:1024 sc1
  buffer_load_dwordx4 v[224:227], v253, s[28:31], s60 offen offset:2048 sc1
  buffer_load_dwordx4 v[228:231], v253, s[28:31], s60 offen offset:3072 sc1
  s_add_u32 s60, s2, 4096
  buffer_load_dwordx4 v[232:235], v253, s[28:31], s60 offen offset:0 sc1
  buffer_load_dwordx4 v[236:239], v253, s[28:31], s60 offen offset:1024 sc1
  buffer_load_dwordx4 v[240:243], v253, s[28:31], s60 offen offset:2048 sc1
  buffer_load_dwordx4 v[244:247], v253, s[28:31], s60 offen offset:3072 sc1
  s_add_u32 s60, s2, 8192
  buffer_load_dwordx4 v[176:179], v253, s[28:31], s60 offen offset:0 sc1
  buffer_load_dwordx4 v[180:183], v253, s[28:31], s60 offen offset:1024 sc1
  buffer_load_dwordx4 v[184:187], v253, s[28:31], s60 offen offset:2048 sc1
  buffer_load_dwordx4 v[188:191], v253, s[28:31], s60 offen offset:3072 sc1
  s_branch L_help
L_hwb:
  s_add_u32 s60, s2, 12288
  buffer_load_dwordx4 v[192:195], v253, s[28:31], s60 offen offset:0 sc1
  buffer_load_dwordx4 v[196:199], v253, s[28:31], s60 offen offset:1024 sc1
  buffer_load_dwordx4 v[200:203], v253, s[28:31], s60 offen offset:2048 sc1
  buffer_load_dwordx4 v[204:207], v253, s[28:31], s60 offen offset:3072 sc1
  s_add_u32 s60, s2, 16384
  buffer_load_dwordx4 v[112:115], v253, s[28:31], s60 offen offset:0 sc1
  buffer_load_dwordx4 v[116:119], v253, s[28:31], s60 offen offset:1024 sc1
  buffer_load_dwordx4 v[120:123], v253, s[28:31], s60 offen offset:2048 sc1
  buffer_load_dwordx4 v[124:127], v253, s[28:31], s60 offen offset:3072 sc1
  s_add_u32 s60, s2, 20480
  buffer_load_dwordx4 v[0:3], v253, s[28:31], s60 offen offset:0 sc1
  buffer_load_dwordx4 v[4:7], v253, s[28:31], s60 offen offset:1024 sc1
  buffer_load_dwordx4 v[8:11], v253, s[28:31], s60 offen offset:2048 sc1
  buffer_load_dwordx4 v[12:15], v253, s[28:31], s60 offen offset:3072 sc1
  s_branch L_help
L_hwc:
  s_add_u32 s60, s2, 24576
  buffer_load_dwordx4 v[16:19], v253, s[28:31], s60 offen offset:0 sc1
  buffer_load_dwordx4 v[20:23], v253, s[28:31], s60 offen offset:1024 sc1
  buffer_load_dwordx4 v[24:27], v253, s[28:31], s60 offen offset:2048 sc1
  buffer_load_dwordx4 v[28:31], v253, s[28:31], s60 offen offset:3072 sc1
  s_add_u32 s60, s2, 28672
  buffer_load_dwordx4 v[32:35], v253, s[28:31], s60 offen offset:0 sc1
  buffer_load_dwordx4 v[36:39], v253, s[28:31], s60 offen offset:1024 sc1
  buffer_load_dwordx4 v[40:43], v253, s[28:31], s60 offen offset:2048 sc1
  buffer_load_dwordx4 v[44:47], v253, s[28:31], s60 offen offset:3072 sc1
  s_add_u32 s60, s2, 32768
  buffer_load_dwordx4 v[48:51], v253, s[28:31], s60 offen offset:0 sc1
  buffer_load_dwordx4 v[52:55], v253, s[28:31], s60 offen offset:1024 sc1
  buffer_load_dwordx4 v[56:59], v253, s[28:31], s60 offen offset:2048 sc1
  buffer_load_dwordx4 v[60:63], v253, s[28:31], s60 offen offset:3072 sc1
L_help:
  s_cmp_ge_u32 s77, s97
  s_cbranch_scc1 L_hy
  s_cmp_ge_u32 s64, 64
  s_cbranch_scc1 L_hnf
  s_cmp_lt_u32 s64, 8
  s_cbranch_scc1 L_tr_75
  s_cmp_lt_u32 s64, 12
  s_cbranch_scc1 L_tr_76
  s_cmp_lt_u32 s64, 14
  s_cbranch_scc1 L_tr_77
  s_cmp_lt_u32 s64, 15
  s_cbranch_scc1 L_tr_78
  s_waitcnt vmcnt(15)
  s_branch L_hnf
L_tr_78:
  s_waitcnt vmcnt(14)
  s_branch L_hnf
L_tr_77:
  s_cmp_lt_u32 s64, 13
  s_cbranch_scc1 L_tr_79
  s_waitcnt vmcnt(13)
  s_branch L_hnf
L_tr_79:
  s_waitcnt vmcnt(12)
  s_branch L_hnf
L_tr_76:
  s_cmp_lt_u32 s64, 10
  s_cbranch_scc1 L_tr_80
  s_cmp_lt_u32 s64, 11
  s_cbranch_scc1 L_tr_81
  s_waitcnt vmcnt(11)
  s_branch L_hnf
L_tr_81:
  s_waitcnt vmcnt(10)
  s_branch L_hnf
L_tr_80:
  s_cmp_lt_u32 s64, 9
  s_cbranch_scc1 L_tr_82
  s_waitcnt vmcnt(9)
  s_branch L_hnf
L_tr_82:
  s_waitcnt vmcnt(8)
  s_branch L_hnf
L_tr_75:
  s_cmp_lt_u32 s64, 4
  s_cbranch_scc1 L_tr_83
  s_cmp_lt_u32 s64, 6
  s_cbranch_scc1 L_tr_84
  s_cmp_lt_u32 s64, 7
  s_cbranch_scc1 L_tr_85
  s_waitcnt vmcnt(7)
  s_branch L_hnf
L_tr_85:
  s_waitcnt vmcnt(6)
  s_branch L_hnf
L_tr_84:
  s_cmp_lt_u32 s64, 5
  s_cbranch_scc1 L_tr_86
  s_waitcnt vmcnt(5)
  s_branch L_hnf
L_tr_86:
  s_waitcnt vmcnt(4)
  s_branch L_hnf
L_tr_83:
  s_cmp_lt_u32 s64, 2
  s_cbranch_scc1 L_tr_87
  s_cmp_lt_u32 s64, 3
  s_cbranch_scc1 L_tr_88
  s_waitcnt vmcnt(3)
  s_branch L_hnf
L_tr_88:
  s_waitcnt vmcnt(2)
  s_branch L_hnf
L_tr_87:
  s_cmp_lt_u32 s64, 1
  s_cbranch_scc1 L_tr_89
  s_waitcnt vmcnt(1)
  s_branch L_hnf
L_tr_89:
  s_waitcnt vmcnt(0)
L_hnf:
  s_barrier
  s_add_u32 s77, s77, 1
  s_call_b64 s[88:89], L_hook
  s_branch L_help0
L_hy:
  s_cmp_ge_u32 s81, 2
  s_cbranch_scc1 L_help0
  s_cmp_eq_u32 s81, 0
  s_cbranch_scc1 L_hx
  s_waitcnt vmcnt(0)
  v_and_b32 v173, 3, v254
  v_lshlrev_b32 v173, 13, v173
  v_mov_b32 v174, 1
  s_mov_b64 exec, 15
  buffer_store_dword v174, v173, s[28:31], s18 offen sc1
  s_mov_b64 exec, -1
L_hx:
  s_cmp_lg_u32 s46, 0
  s_cbranch_scc1 L_ce
  v_xor_b32 v213, 512, v249
  buffer_load_dword v251, v249, s[28:31], 0 offen sc1
  buffer_load_dword v252, v213, s[28:31], 0 offen sc1
  s_cmp_gt_u32 s69, 0
  s_cbranch_scc1 L_wsk_90
  s_add_u32 s60, s2, 0
  buffer_load_dwordx4 v[216:219], v253, s[28:31], s60 offen offset:0 sc1
  buffer_load_dwordx4 v[220:223], v253, s[28:31], s60 offen offset:1024 sc1
  buffer_load_dwordx4 v[224:227], v253, s[28:31], s60 offen offset:2048 sc1
  buffer_load_dwordx4 v[228:231], v253, s[28:31], s60 offen offset:3072 sc1
  s_add_u32 s60, s2, 4096
  buffer_load_dwordx4 v[232:235], v253, s[28:31], s60 offen offset:0 sc1
  buffer_load_dwordx4 v[236:239], v253, s[28:31], s60 offen offset:1024 sc1
  buffer_load_dwordx4 v[240:243], v253, s[28:31], s60 offen offset:2048 sc1
  buffer_load_dwordx4 v[244:247], v253, s[28:31], s60 offen offset:3072 sc1
  s_add_u32 s60, s2, 8192
  buffer_load_dwordx4 v[176:179], v253, s[28:31], s60 offen offset:0 sc1
  buffer_load_dwordx4 v[180:183], v253, s[28:31], s60 offen offset:1024 sc1
  buffer_load_dwordx4 v[184:187], v253, s[28:31], s60 offen offset:2048 sc1
  buffer_load_dwordx4 v[188:191], v253, s[28:31], s60 offen offset:3072 sc1
L_wsk_90:
  s_waitcnt vmcnt(12)
  s_cmp_lt_u32 s69, 1
  s_cbranch_scc1 L_cwd_91
  s_waitcnt vmcnt(0)
L_cwd_91:
L_fcs_92:
  v_cmp_ne_u32 vcc, 1, v251
  s_nop 1
  s_and_b32 s61, vcc_lo, 51
  s_cbranch_scc0 L_fcoks_93
  s_sleep 3
  buffer_load_dword v251, v249, s[28:31], 0 offen sc1
  s_waitcnt vmcnt(0)
  s_sub_u32 s99, s99, 1
  s_cbranch_scc0 L_fcs_92
  s_mov_b32 s99, 0
L_fcoks_93:
L_fct_94:
  v_cmp_ne_u32 vcc, 1, v252
  s_nop 1
  s_and_b32 s61, vcc_lo, 51
  s_cbranch_scc0 L_fcokt_95
  s_sleep 3
  buffer_load_dword v252, v213, s[28:31], 0 offen sc1
  s_waitcnt vmcnt(0)
  s_sub_u32 s99, s99, 1
  s_cbranch_scc0 L_fct_94
  s_mov_b32 s99, 0
L_fcokt_95:
  s_add_u32 m0, s25, 0
  s_add_u32 s58, s19, 0
  buffer_load_dwordx4 v253, s[28:31], s58 offen offset:0 sc1 lds
  buffer_load_dwordx4 v253, s[28:31], s58 offen offset:1024 sc1 lds
  buffer_load_dwordx4 v253, s[28:31], s58 offen offset:2048 sc1 lds
  s_add_u32 m0, s25, 12288
  s_add_u32 s58, s19, 0
  s_add_u32 s58, s58, s23
  buffer_load_dwordx4 v253, s[28:31], s58 offen offset:0 sc1 lds
  buffer_load_dwordx4 v253, s[28:31], s58 offen offset:1024 sc1 lds
  buffer_load_dwordx4 v253, s[28:31], s58 offen offset:2048 sc1 lds
  s_add_u32 m0, s44, 0
  s_add_u32 s58, s68, 0
  buffer_load_dwordx4 v253, s[28:31], s58 offen offset:0 sc1 lds
  buffer_load_dwordx4 v253, s[28:31], s58 offen offset:1024 sc1 lds
  buffer_load_dwordx4 v253, s[28:31], s58 offen offset:2048 sc1 lds
  s_add_u32 m0, s44, 12288
  s_add_u32 s58, s68, 0
  s_sub_u32 s58, s58, s23
  buffer_load_dwordx4 v253, s[28:31], s58 offen offset:0 sc1 lds
  buffer_load_dwordx4 v253, s[28:31], s58 offen offset:1024 sc1 lds
  buffer_load_dwordx4 v253, s[28:31], s58 offen offset:2048 sc1 lds
  s_branch L_cf
L_ce:
  s_cmp_gt_u32 s69, 0
  s_cbranch_scc1 L_wsk_96
  s_add_u32 s60, s2, 0
  buffer_load_dwordx4 v[216:219], v253, s[28:31], s60 offen offset:0 sc1
  buffer_load_dwordx4 v[220:223], v253, s[28:31], s60 offen offset:1024 sc1
  buffer_load_dwordx4 v[224:227], v253, s[28:31], s60 offen offset:2048 sc1
  buffer_load_dwordx4 v[228:231], v253, s[28:31], s60 offen offset:3072 sc1
  s_add_u32 s60, s2, 4096
  buffer_load_dwordx4 v[232:235], v253, s[28:31], s60 offen offset:0 sc1
  buffer_load_dwordx4 v[236:239], v253, s[28:31], s60 offen offset:1024 sc1
  buffer_load_dwordx4 v[240:243], v253, s[28:31], s60 offen offset:2048 sc1
  buffer_load_dwordx4 v[244:247], v253, s[28:31], s60 offen offset:3072 sc1
  s_add_u32 s60, s2, 8192
  buffer_load_dwordx4 v[176:179], v253, s[28:31], s60 offen offset:0 sc1
  buffer_load_dwordx4 v[180:183], v253, s[28:31], s60 offen offset:1024 sc1
  buffer_load_dwordx4 v[184:187], v253, s[28:31], s60 offen offset:2048 sc1
  buffer_load_dwordx4 v[188:191], v253, s[28:31], s60 offen offset:3072 sc1
L_wsk_96:
L_cf:
  s_cmp_gt_u32 s69, 1
  s_cbranch_scc1 L_wsk_97
  s_add_u32 s60, s2, 12288
  buffer_load_dwordx4 v[192:195], v253, s[28:31], s60 offen offset:0 sc1
  buffer_load_dwordx4 v[196:199], v253, s[28:31], s60 offen offset:1024 sc1
  buffer_load_dwordx4 v[200:203], v253, s[28:31], s60 offen offset:2048 sc1
  buffer_load_dwordx4 v[204:207], v253, s[28:31], s60 offen offset:3072 sc1
  s_add_u32 s60, s2, 16384
  buffer_load_dwordx4 v[112:115], v253, s[28:31], s60 offen offset:0 sc1
  buffer_load_dwordx4 v[116:119], v253, s[28:31], s60 offen offset:1024 sc1
  buffer_load_dwordx4 v[120:123], v253, s[28:31], s60 offen offset:2048 sc1
  buffer_load_dwordx4 v[124:127], v253, s[28:31], s60 offen offset:3072 sc1
  s_add_u32 s60, s2, 20480
  buffer_load_dwordx4 v[0:3], v253, s[28:31], s60 offen offset:0 sc1
  buffer_load_dwordx4 v[4:7], v253, s[28:31], s60 offen offset:1024 sc1
  buffer_load_dwordx4 v[8:11], v253, s[28:31], s60 offen offset:2048 sc1
  buffer_load_dwordx4 v[12:15], v253, s[28:31], s60 offen offset:3072 sc1
L_wsk_97:
  s_add_u32 m0, s26, 0
  s_add_u32 s58, s19, 3072
  buffer_load_dwordx4 v253, s[28:31], s58 offen offset:0 sc1 lds
  buffer_load_dwordx4 v253, s[28:31], s58 offen offset:1024 sc1 lds
  buffer_load_dwordx4 v253, s[28:31], s58 offen offset:2048 sc1 lds
  s_add_u32 m0, s26, 12288
  s_add_u32 s58, s19, 3072
  s_add_u32 s58, s58, s23
  buffer_load_dwordx4 v253, s[28:31], s58 offen offset:0 sc1 lds
  buffer_load_dwordx4 v253, s[28:31], s58 offen offset:1024 sc1 lds
  buffer_load_dwordx4 v253, s[28:31], s58 offen offset:2048 sc1 lds
  s_add_u32 m0, s45, 0
  s_add_u32 s58, s68, 3072
  buffer_load_dwordx4 v253, s[28:31], s58 offen offset:0 sc1 lds
  buffer_load_dwordx4 v253, s[28:31], s58 offen offset:1024 sc1 lds
  buffer_load_dwordx4 v253, s[28:31], s58 offen offset:2048 sc1 lds
  s_add_u32 m0, s45, 12288
  s_add_u32 s58, s68, 3072
  s_sub_u32 s58, s58, s23
  buffer_load_dwordx4 v253, s[28:31], s58 offen offset:0 sc1 lds
  buffer_load_dwordx4 v253, s[28:31], s58 offen offset:1024 sc1 lds
  buffer_load_dwordx4 v253, s[28:31], s58 offen offset:2048 sc1 lds
  s_waitcnt vmcnt(24)
  s_cmp_lt_u32 s69, 2
  s_cbranch_scc1 L_cwd_98
  s_waitcnt vmcnt(12)
L_cwd_98:
L_cq:
  s_mul_i32 s52, s94, 3072
  v_lshrrev_b32 v210, 4, v254
  v_lshl_add_u32 v210, v210, 8, v253
  s_sub_u32 s53, s25, s52
  s_sub_u32 s54, s26, s52
  s_sub_u32 s55, s27, s52
  v_add_u32 v208, s53, v210
  v_add_u32 v209, s54, v210
  v_add_u32 v210, s55, v210
  s_barrier
  ds_read_b128 v[144:147], v208 offset:12288
  ds_read_b128 v[148:151], v208 offset:14336
  ds_read_b128 v[152:155], v208 offset:16384
  ds_read_b128 v[156:159], v208 offset:18432
  ds_read_b128 v[160:163], v208 offset:20480
  ds_read_b128 v[164:167], v208 offset:22528
  s_waitcnt lgkmcnt(4)
  v_mfma_f32_16x16x32_bf16 v[128:131], v[216:219], v[144:147], 0
  ds_read_b128 v[168:171], v208 offset:12544
  v_mfma_f32_16x16x32_bf16 v[128:131], v[224:227], v[148:151], v[128:131]
  s_cmp_lg_u32 s91, 7
  s_cbranch_scc1 L_a7_99
  s_add_u32 m0, s26, 0
  s_add_u32 s58, s19, 3072
  buffer_load_dwordx4 v253, s[28:31], s58 offen offset:0 sc1 lds
  buffer_load_dwordx4 v253, s[28:31], s58 offen offset:1024 sc1 lds
  buffer_load_dwordx4 v253, s[28:31], s58 offen offset:2048 sc1 lds
L_a7_99:
  s_cmp_eq_u32 s81, 0
  s_cbranch_scc1 L_l45_100
  s_add_u32 s60, s2, 16384
  buffer_load_dwordx4 v[112:115], v253, s[28:31], s60 offen offset:0 sc1
  buffer_load_dwordx4 v[116:119], v253, s[28:31], s60 offen offset:1024 sc1
  buffer_load_dwordx4 v[120:123], v253, s[28:31], s60 offen offset:2048 sc1
  buffer_load_dwordx4 v[124:127], v253, s[28:31], s60 offen offset:3072 sc1
L_l45_100:
  v_mfma_f32_16x16x32_bf16 v[132:135], v[220:223], v[144:147], 0
  ds_read_b128 v[172:175], v208 offset:14592
  v_mfma_f32_16x16x32_bf16 v[132:135], v[228:231], v[148:151], v[132:135]
  s_waitcnt lgkmcnt(4)
  v_mfma_f32_16x16x32_bf16 v[132:135], v[236:239], v[152:155], v[132:135]
  ds_read_b128 v[144:147], v208 offset:16640
  v_mfma_f32_16x16x32_bf16 v[132:135], v[244:247], v[156:159], v[132:135]
  v_mfma_f32_16x16x32_bf16 v[128:131], v[232:235], v[152:155], v[128:131]
  ds_read_b128 v[148:151], v208 offset:18688
  v_mfma_f32_16x16x32_bf16 v[128:131], v[240:243], v[156:159], v[128:131]
  s_cmp_lg_u32 s91, 7
  s_cbranch_scc1 L_a7_101
  s_add_u32 m0, s26, 12288
  s_add_u32 s58, s19, 3072
  s_add_u32 s58, s58, s23
  buffer_load_dwordx4 v253, s[28:31], s58 offen offset:0 sc1 lds
  buffer_load_dwordx4 v253, s[28:31], s58 offen offset:1024 sc1 lds
  buffer_load_dwordx4 v253, s[28:31], s58 offen offset:2048 sc1 lds
L_a7_101:
  s_cmp_eq_u32 s81, 0
  s_cbranch_scc1 L_l45_102
  s_add_u32 s60, s2, 20480
  buffer_load_dwordx4 v[0:3], v253, s[28:31], s60 offen offset:0 sc1
  buffer_load_dwordx4 v[4:7], v253, s[28:31], s60 offen offset:1024 sc1
  buffer_load_dwordx4 v[8:11], v253, s[28:31], s60 offen offset:2048 sc1
  buffer_load_dwordx4 v[12:15], v253, s[28:31], s60 offen offset:3072 sc1
L_l45_102:
  s_waitcnt lgkmcnt(4)
  v_mfma_f32_16x16x32_bf16 v[128:131], v[176:179], v[160:163], v[128:131]
  ds_read_b128 v[152:155], v208 offset:20736
  v_mfma_f32_16x16x32_bf16 v[128:131], v[184:187], v[164:167], v[128:131]
  v_mfma_f32_16x16x32_bf16 v[132:135], v[180:183], v[160:163], v[132:135]
  ds_read_b128 v[156:159], v208 offset:22784
  v_mfma_f32_16x16x32_bf16 v[132:135], v[188:191], v[164:167], v[132:135]
  s_waitcnt lgkmcnt(4)
  v_mfma_f32_16x16x32_bf16 v[136:139], v[216:219], v[168:171], 0
  ds_read_b128 v[160:163], v208 offset:0
  v_mfma_f32_16x16x32_bf16 v[136:139], v[224:227], v[172:175], v[136:139]
  s_cmp_eq_u32 s81, 0
  s_cbranch_scc1 L_nof_103
  s_waitcnt vmcnt(8)
  v_and_b32 v211, 3, v254
  v_lshlrev_b32 v211, 13, v211
  v_mov_b32 v212, 1
  s_mov_b64 exec, 15
  buffer_store_dword v212, v211, s[28:31], s18 offen sc1
  s_mov_b64 exec, -1
L_nof_103:
  v_mfma_f32_16x16x32_bf16 v[140:143], v[220:223], v[168:171], 0
  ds_read_b128 v[164:167], v208 offset:2048
  v_mfma_f32_16x16x32_bf16 v[140:143], v[228:231], v[172:175], v[140:143]
  s_waitcnt lgkmcnt(4)
  v_mfma_f32_16x16x32_bf16 v[140:143], v[236:239], v[144:147], v[140:143]
  ds_read_b128 v[168:171], v208 offset:4096
  v_mfma_f32_16x16x32_bf16 v[140:143], v[244:247], v[148:151], v[140:143]
  v_mfma_f32_16x16x32_bf16 v[136:139], v[232:235], v[144:147], v[136:139]
  ds_read_b128 v[172:175], v208 offset:6144
  v_mfma_f32_16x16x32_bf16 v[136:139], v[240:243], v[148:151], v[136:139]
  s_cmp_gt_u32 s69, 2
  s_cbranch_scc1 L_wsk_104
  s_add_u32 s60, s2, 24576
  buffer_load_dwordx4 v[16:19], v253, s[28:31], s60 offen offset:0 sc1
  buffer_load_dwordx4 v[20:23], v253, s[28:31], s60 offen offset:1024 sc1
  buffer_load_dwordx4 v[24:27], v253, s[28:31], s60 offen offset:2048 sc1
  buffer_load_dwordx4 v[28:31], v253, s[28:31], s60 offen offset:3072 sc1
L_wsk_104:
  s_waitcnt lgkmcnt(4)
  v_mfma_f32_16x16x32_bf16 v[136:139], v[176:179], v[152:155], v[136:139]
  ds_read_b128 v[144:147], v208 offset:8192
  v_mfma_f32_16x16x32_bf16 v[136:139], v[184:187], v[156:159], v[136:139]
  v_mfma_f32_16x16x32_bf16 v[140:143], v[180:183], v[152:155], v[140:143]
  ds_read_b128 v[148:151], v208 offset:10240
  v_mfma_f32_16x16x32_bf16 v[140:143], v[188:191], v[156:159], v[140:143]
  s_waitcnt lgkmcnt(4)
  v_mfma_f32_16x16x32_bf16 v[64:67], v[216:219], v[160:163], 0
  ds_read_b128 v[152:155], v208 offset:256
  v_mfma_f32_16x16x32_bf16 v[64:67], v[224:227], v[164:167], v[64:67]
  s_add_u32 m0, s27, 0
  s_add_u32 s58, s19, 6144
  buffer_load_dwordx4 v253, s[28:31], s58 offen offset:0 sc1 lds
  v_mfma_f32_16x16x32_bf16 v[68:71], v[220:223], v[160:163], 0
  ds_read_b128 v[156:159], v208 offset:2304
  v_mfma_f32_16x16x32_bf16 v[68:71], v[228:231], v[164:167], v[68:71]
  s_waitcnt lgkmcnt(4)
  v_mfma_f32_16x16x32_bf16 v[68:71], v[236:239], v[168:171], v[68:71]
  ds_read_b128 v[160:163], v208 offset:4352
  v_mfma_f32_16x16x32_bf16 v[68:71], v[244:247], v[172:175], v[68:71]
  v_mfma_f32_16x16x32_bf16 v[64:67], v[232:235], v[168:171], v[64:67]
  ds_read_b128 v[164:167], v208 offset:6400
  v_mfma_f32_16x16x32_bf16 v[64:67], v[240:243], v[172:175], v[64:67]
  buffer_load_dwordx4 v253, s[28:31], s58 offen offset:1024 sc1 lds
  s_waitcnt lgkmcnt(4)
  v_mfma_f32_16x16x32_bf16 v[64:67], v[176:179], v[144:147], v[64:67]
  ds_read_b128 v[168:171], v208 offset:8448
  v_mfma_f32_16x16x32_bf16 v[64:67], v[184:187], v[148:151], v[64:67]
  v_mfma_f32_16x16x32_bf16 v[68:71], v[180:183], v[144:147], v[68:71]
  ds_read_b128 v[172:175], v208 offset:10496
  v_mfma_f32_16x16x32_bf16 v[68:71], v[188:191], v[148:151], v[68:71]
  s_waitcnt lgkmcnt(4)
  v_mfma_f32_16x16x32_bf16 v[72:75], v[216:219], v[152:155], 0
  v_mfma_f32_16x16x32_bf16 v[72:75], v[224:227], v[156:159], v[72:75]
  s_add_u32 s58, s58, s24
  buffer_load_dwordx4 v253, s[28:31], s58 offen offset:2048 sc1 lds
  v_mfma_f32_16x16x32_bf16 v[76:79], v[220:223], v[152:155], 0
  v_mfma_f32_16x16x32_bf16 v[76:79], v[228:231], v[156:159], v[76:79]
  s_waitcnt lgkmcnt(2)
  v_mfma_f32_16x16x32_bf16 v[76:79], v[236:239], v[160:163], v[76:79]
  v_mfma_f32_16x16x32_bf16 v[76:79], v[244:247], v[164:167], v[76:79]
  v_mfma_f32_16x16x32_bf16 v[72:75], v[232:235], v[160:163], v[72:75]
  v_mfma_f32_16x16x32_bf16 v[72:75], v[240:243], v[164:167], v[72:75]
  s_waitcnt vmcnt(7)
  s_cmp_lt_u32 s69, 3
  s_cbranch_scc1 L_cwd_105
  s_waitcnt vmcnt(3)
L_cwd_105:
  s_waitcnt lgkmcnt(0)
  s_barrier
  ds_read_b128 v[144:147], v209 offset:12288
  ds_read_b128 v[148:151], v209 offset:14336
  ds_read_b128 v[152:155], v209 offset:16384
  ds_read_b128 v[156:159], v209 offset:18432
  v_mfma_f32_16x16x32_bf16 v[72:75], v[176:179], v[168:171], v[72:75]
  ds_read_b128 v[160:163], v209 offset:20480
  v_mfma_f32_16x16x32_bf16 v[72:75], v[184:187], v[172:175], v[72:75]
  v_mfma_f32_16x16x32_bf16 v[76:79], v[180:183], v[168:171], v[76:79]
  ds_read_b128 v[164:167], v209 offset:22528
  v_mfma_f32_16x16x32_bf16 v[76:79], v[188:191], v[172:175], v[76:79]
  s_waitcnt lgkmcnt(4)
  v_mfma_f32_16x16x32_bf16 v[128:131], v[192:195], v[144:147], v[128:131]
  ds_read_b128 v[168:171], v209 offset:12544
  v_mfma_f32_16x16x32_bf16 v[128:131], v[200:203], v[148:151], v[128:131]
  s_cmp_gt_u32 s69, 2
  s_cbranch_scc1 L_wsk_106
  s_add_u32 s60, s2, 28672
  buffer_load_dwordx4 v[32:35], v253, s[28:31], s60 offen offset:0 sc1
  buffer_load_dwordx4 v[36:39], v253, s[28:31], s60 offen offset:1024 sc1
  buffer_load_dwordx4 v[40:43], v253, s[28:31], s60 offen offset:2048 sc1
  buffer_load_dwordx4 v[44:47], v253, s[28:31], s60 offen offset:3072 sc1
L_wsk_106:
  v_mfma_f32_16x16x32_bf16 v[132:135], v[196:199], v[144:147], v[132:135]
  ds_read_b128 v[172:175], v209 offset:14592
  v_mfma_f32_16x16x32_bf16 v[132:135], v[204:207], v[148:151], v[132:135]
  s_cmp_gt_u32 s69, 2
  s_cbranch_scc1 L_wsk_107
  s_add_u32 s60, s2, 32768
  buffer_load_dwordx4 v[48:51], v253, s[28:31], s60 offen offset:0 sc1
  buffer_load_dwordx4 v[52:55], v253, s[28:31], s60 offen offset:1024 sc1
  buffer_load_dwordx4 v[56:59], v253, s[28:31], s60 offen offset:2048 sc1
  buffer_load_dwordx4 v[60:63], v253, s[28:31], s60 offen offset:3072 sc1
L_wsk_107:
  s_waitcnt lgkmcnt(4)
  v_mfma_f32_16x16x32_bf16 v[132:135], v[116:119], v[152:155], v[132:135]
  ds_read_b128 v[144:147], v209 offset:16640
  v_mfma_f32_16x16x32_bf16 v[132:135], v[124:127], v[156:159], v[132:135]
  v_mfma_f32_16x16x32_bf16 v[128:131], v[112:115], v[152:155], v[128:131]
  ds_read_b128 v[148:151], v209 offset:18688
  v_mfma_f32_16x16x32_bf16 v[128:131], v[120:123], v[156:159], v[128:131]
  s_add_u32 m0, s27, 12288
  s_add_u32 s58, s19, 6144
  s_add_u32 s58, s58, s23
  buffer_load_dwordx4 v253, s[28:31], s58 offen offset:0 sc1 lds
  s_waitcnt lgkmcnt(4)
  v_mfma_f32_16x16x32_bf16 v[128:131], v[0:3], v[160:163], v[128:131]
  ds_read_b128 v[152:155], v209 offset:20736
  v_mfma_f32_16x16x32_bf16 v[128:131], v[8:11], v[164:167], v[128:131]
  buffer_load_dwordx4 v253, s[28:31], s58 offen offset:1024 sc1 lds
  v_mfma_f32_16x16x32_bf16 v[132:135], v[4:7], v[160:163], v[132:135]
  ds_read_b128 v[156:159], v209 offset:22784
  v_mfma_f32_16x16x32_bf16 v[132:135], v[12:15], v[164:167], v[132:135]
  s_waitcnt lgkmcnt(4)
  v_mfma_f32_16x16x32_bf16 v[136:139], v[192:195], v[168:171], v[136:139]
  ds_read_b128 v[160:163], v209 offset:0
  v_mfma_f32_16x16x32_bf16 v[136:139], v[200:203], v[172:175], v[136:139]
  s_add_u32 s58, s58, s24
  buffer_load_dwordx4 v253, s[28:31], s58 offen offset:2048 sc1 lds
  v_mfma_f32_16x16x32_bf16 v[140:143], v[196:199], v[168:171], v[140:143]
  ds_read_b128 v[164:167], v209 offset:2048
  v_mfma_f32_16x16x32_bf16 v[140:143], v[204:207], v[172:175], v[140:143]
  s_waitcnt lgkmcnt(4)
  v_mfma_f32_16x16x32_bf16 v[140:143], v[116:119], v[144:147], v[140:143]
  ds_read_b128 v[168:171], v209 offset:4096
  v_mfma_f32_16x16x32_bf16 v[140:143], v[124:127], v[148:151], v[140:143]
  buffer_load_dword v251, v249, s[28:31], 0 offen sc1
  v_mfma_f32_16x16x32_bf16 v[136:139], v[112:115], v[144:147], v[136:139]
  ds_read_b128 v[172:175], v209 offset:6144
  v_mfma_f32_16x16x32_bf16 v[136:139], v[120:123], v[148:151], v[136:139]
  s_waitcnt lgkmcnt(4)
  v_mfma_f32_16x16x32_bf16 v[136:139], v[0:3], v[152:155], v[136:139]
  ds_read_b128 v[144:147], v209 offset:8192
  v_mfma_f32_16x16x32_bf16 v[136:139], v[8:11], v[156:159], v[136:139]
  v_mfma_f32_16x16x32_bf16 v[140:143], v[4:7], v[152:155], v[140:143]
  ds_read_b128 v[148:151], v209 offset:10240
  v_mfma_f32_16x16x32_bf16 v[140:143], v[12:15], v[156:159], v[140:143]
  s_waitcnt lgkmcnt(4)
  v_mfma_f32_16x16x32_bf16 v[64:67], v[192:195], v[160:163], v[64:67]
  ds_read_b128 v[152:155], v209 offset:256
  v_mfma_f32_16x16x32_bf16 v[64:67], v[200:203], v[164:167], v[64:67]
  v_mfma_f32_16x16x32_bf16 v[68:71], v[196:199], v[160:163], v[68:71]
  ds_read_b128 v[156:159], v209 offset:2304
  v_mfma_f32_16x16x32_bf16 v[68:71], v[204:207], v[164:167], v[68:71]
  s_waitcnt lgkmcnt(4)
  v_mfma_f32_16x16x32_bf16 v[68:71], v[116:119], v[168:171], v[68:71]
  ds_read_b128 v[160:163], v209 offset:4352
  v_mfma_f32_16x16x32_bf16 v[68:71], v[124:127], v[172:175], v[68:71]
  s_waitcnt vmcnt(0)
L_fcl_108:
  v_cmp_ne_u32 vcc, 1, v251
  s_nop 1
  s_and_b32 s61, vcc_lo, s47
  s_cbranch_scc0 L_fcokl_109
  s_sleep 3
  buffer_load_dword v251, v249, s[28:31], 0 offen sc1
  s_waitcnt vmcnt(0)
  s_sub_u32 s99, s99, 1
  s_cbranch_scc0 L_fcl_108
  s_mov_b32 s99, 0
L_fcokl_109:
  v_mfma_f32_16x16x32_bf16 v[64:67], v[112:115], v[168:171], v[64:67]
  ds_read_b128 v[164:167], v209 offset:6400
  v_mfma_f32_16x16x32_bf16 v[64:67], v[120:123], v[172:175], v[64:67]
  s_add_u32 m0, s25, 0
  s_add_u32 s58, s21, 0
  buffer_load_dwordx4 v253, s[28:31], s58 offen offset:0 sc1 lds
  s_waitcnt lgkmcnt(4)
  v_mfma_f32_16x16x32_bf16 v[64:67], v[0:3], v[144:147], v[64:67]
  ds_read_b128 v[168:171], v209 offset:8448
  v_mfma_f32_16x16x32_bf16 v[64:67], v[8:11], v[148:151], v[64:67]
  buffer_load_dwordx4 v253, s[28:31], s58 offen offset:1024 sc1 lds
  v_mfma_f32_16x16x32_bf16 v[68:71], v[4:7], v[144:147], v[68:71]
  ds_read_b128 v[172:175], v209 offset:10496
  v_mfma_f32_16x16x32_bf16 v[68:71], v[12:15], v[148:151], v[68:71]
  buffer_load_dwordx4 v253, s[28:31], s58 offen offset:2048 sc1 lds
  s_waitcnt lgkmcnt(4)
  v_mfma_f32_16x16x32_bf16 v[72:75], v[192:195], v[152:155], v[72:75]
  v_mfma_f32_16x16x32_bf16 v[72:75], v[200:203], v[156:159], v[72:75]
  v_mfma_f32_16x16x32_bf16 v[76:79], v[196:199], v[152:155], v[76:79]
  v_mfma_f32_16x16x32_bf16 v[76:79], v[204:207], v[156:159], v[76:79]
  s_add_u32 m0, s25, 12288
  s_add_u32 s58, s21, 0
  s_add_u32 s58, s58, s23
  buffer_load_dwordx4 v253, s[28:31], s58 offen offset:0 sc1 lds
  s_waitcnt lgkmcnt(2)
  v_mfma_f32_16x16x32_bf16 v[76:79], v[116:119], v[160:163], v[76:79]
  v_mfma_f32_16x16x32_bf16 v[76:79], v[124:127], v[164:167], v[76:79]
  buffer_load_dwordx4 v253, s[28:31], s58 offen offset:1024 sc1 lds
  v_mfma_f32_16x16x32_bf16 v[72:75], v[112:115], v[160:163], v[72:75]
  v_mfma_f32_16x16x32_bf16 v[72:75], v[120:123], v[164:167], v[72:75]
  buffer_load_dwordx4 v253, s[28:31], s58 offen offset:2048 sc1 lds
  s_waitcnt vmcnt(6) lgkmcnt(0)
  s_barrier
  ds_read_b128 v[144:147], v210 offset:12288
  ds_read_b128 v[148:151], v210 offset:14336
  ds_read_b128 v[152:155], v210 offset:16384
  ds_read_b128 v[156:159], v210 offset:18432
  v_mfma_f32_16x16x32_bf16 v[72:75], v[0:3], v[168:171], v[72:75]
  ds_read_b128 v[160:163], v210 offset:20480
  v_mfma_f32_16x16x32_bf16 v[72:75], v[8:11], v[172:175], v[72:75]
  v_mfma_f32_16x16x32_bf16 v[76:79], v[4:7], v[168:171], v[76:79]
  ds_read_b128 v[164:167], v210 offset:22528
  v_mfma_f32_16x16x32_bf16 v[76:79], v[12:15], v[172:175], v[76:79]
  s_waitcnt lgkmcnt(4)
  v_mfma_f32_16x16x32_bf16 v[128:131], v[16:19], v[144:147], v[128:131]
  ds_read_b128 v[168:171], v210 offset:12544
  v_mfma_f32_16x16x32_bf16 v[128:131], v[24:27], v[148:151], v[128:131]
  s_add_u32 m0, s26, 0
  s_add_u32 s58, s21, 3072
  buffer_load_dwordx4 v253, s[28:31], s58 offen offset:0 sc1 lds
  v_mfma_f32_16x16x32_bf16 v[132:135], v[20:23], v[144:147], v[132:135]
  ds_read_b128 v[172:175], v210 offset:14592
  v_mfma_f32_16x16x32_bf16 v[132:135], v[28:31], v[148:151], v[132:135]
  s_waitcnt lgkmcnt(4)
  v_mfma_f32_16x16x32_bf16 v[132:135], v[36:39], v[152:155], v[132:135]
  ds_read_b128 v[144:147], v210 offset:16640
  v_mfma_f32_16x16x32_bf16 v[132:135], v[44:47], v[156:159], v[132:135]
  v_mfma_f32_16x16x32_bf16 v[128:131], v[32:35], v[152:155], v[128:131]
  ds_read_b128 v[148:151], v210 offset:18688
  v_mfma_f32_16x16x32_bf16 v[128:131], v[40:43], v[156:159], v[128:131]
  buffer_load_dwordx4 v253, s[28:31], s58 offen offset:1024 sc1 lds
  s_waitcnt lgkmcnt(4)
  v_mfma_f32_16x16x32_bf16 v[128:131], v[48:51], v[160:163], v[128:131]
  ds_read_b128 v[152:155], v210 offset:20736
  v_mfma_f32_16x16x32_bf16 v[128:131], v[56:59], v[164:167], v[128:131]
  v_mfma_f32_16x16x32_bf16 v[132:135], v[52:55], v[160:163], v[132:135]
  ds_read_b128 v[156:159], v210 offset:22784
  v_mfma_f32_16x16x32_bf16 v[132:135], v[60:63], v[164:167], v[132:135]
  s_waitcnt lgkmcnt(4)
  v_mfma_f32_16x16x32_bf16 v[136:139], v[16:19], v[168:171], v[136:139]
  ds_read_b128 v[160:163], v210 offset:0
  v_mfma_f32_16x16x32_bf16 v[136:139], v[24:27], v[172:175], v[136:139]
  buffer_load_dwordx4 v253, s[28:31], s58 offen offset:2048 sc1 lds
  v_mfma_f32_16x16x32_bf16 v[140:143], v[20:23], v[168:171], v[140:143]
  ds_read_b128 v[164:167], v210 offset:2048
  v_mfma_f32_16x16x32_bf16 v[140:143], v[28:31], v[172:175], v[140:143]
  s_waitcnt lgkmcnt(4)
  v_mfma_f32_16x16x32_bf16 v[140:143], v[36:39], v[144:147], v[140:143]
  ds_read_b128 v[168:171], v210 offset:4096
  v_mfma_f32_16x16x32_bf16 v[140:143], v[44:47], v[148:151], v[140:143]
  v_mfma_f32_16x16x32_bf16 v[136:139], v[32:35], v[144:147], v[136:139]
  ds_read_b128 v[172:175], v210 offset:6144
  v_mfma_f32_16x16x32_bf16 v[136:139], v[40:43], v[148:151], v[136:139]
  s_waitcnt lgkmcnt(4)
  v_mfma_f32_16x16x32_bf16 v[136:139], v[48:51], v[152:155], v[136:139]
  ds_read_b128 v[144:147], v210 offset:8192
  v_mfma_f32_16x16x32_bf16 v[136:139], v[56:59], v[156:159], v[136:139]
  s_add_u32 m0, s26, 12288
  s_add_u32 s58, s21, 3072
  s_add_u32 s58, s58, s23
  buffer_load_dwordx4 v253, s[28:31], s58 offen offset:0 sc1 lds
  v_mfma_f32_16x16x32_bf16 v[140:143], v[52:55], v[152:155], v[140:143]
  ds_read_b128 v[148:151], v210 offset:10240
  v_mfma_f32_16x16x32_bf16 v[140:143], v[60:63], v[156:159], v[140:143]
  s_waitcnt lgkmcnt(4)
  v_mfma_f32_16x16x32_bf16 v[64:67], v[16:19], v[160:163], v[64:67]
  ds_read_b128 v[152:155], v210 offset:256
  v_mfma_f32_16x16x32_bf16 v[64:67], v[24:27], v[164:167], v[64:67]
  v_mfma_f32_16x16x32_bf16 v[68:71], v[20:23], v[160:163], v[68:71]
  ds_read_b128 v[156:159], v210 offset:2304
  v_mfma_f32_16x16x32_bf16 v[68:71], v[28:31], v[164:167], v[68:71]
  buffer_load_dwordx4 v253, s[28:31], s58 offen offset:1024 sc1 lds
  s_waitcnt lgkmcnt(4)
  v_mfma_f32_16x16x32_bf16 v[68:71], v[36:39], v[168:171], v[68:71]
  ds_read_b128 v[160:163], v210 offset:4352
  v_mfma_f32_16x16x32_bf16 v[68:71], v[44:47], v[172:175], v[68:71]
  v_mfma_f32_16x16x32_bf16 v[64:67], v[32:35], v[168:171], v[64:67]
  ds_read_b128 v[164:167], v210 offset:6400
  v_mfma_f32_16x16x32_bf16 v[64:67], v[40:43], v[172:175], v[64:67]
  s_waitcnt lgkmcnt(4)
  v_mfma_f32_16x16x32_bf16 v[64:67], v[48:51], v[144:147], v[64:67]
  ds_read_b128 v[168:171], v210 offset:8448
  v_mfma_f32_16x16x32_bf16 v[64:67], v[56:59], v[148:151], v[64:67]
  buffer_load_dwordx4 v253, s[28:31], s58 offen offset:2048 sc1 lds
  v_mfma_f32_16x16x32_bf16 v[68:71], v[52:55], v[144:147], v[68:71]
  ds_read_b128 v[172:175], v210 offset:10496
  v_mfma_f32_16x16x32_bf16 v[68:71], v[60:63], v[148:151], v[68:71]
  s_waitcnt lgkmcnt(4)
  v_mfma_f32_16x16x32_bf16 v[72:75], v[16:19], v[152:155], v[72:75]
  v_mfma_f32_16x16x32_bf16 v[72:75], v[24:27], v[156:159], v[72:75]
  v_mfma_f32_16x16x32_bf16 v[76:79], v[20:23], v[152:155], v[76:79]
  v_mfma_f32_16x16x32_bf16 v[76:79], v[28:31], v[156:159], v[76:79]
  s_waitcnt vmcnt(6) lgkmcnt(0)
  s_barrier
  ds_read_b128 v[144:147], v208 offset:12288
  ds_read_b128 v[148:151], v208 offset:14336
  v_mfma_f32_16x16x32_bf16 v[76:79], v[36:39], v[160:163], v[76:79]
  ds_read_b128 v[152:155], v208 offset:16384
  v_mfma_f32_16x16x32_bf16 v[76:79], v[44:47], v[164:167], v[76:79]
  v_mfma_f32_16x16x32_bf16 v[72:75], v[32:35], v[160:163], v[72:75]
  ds_read_b128 v[156:159], v208 offset:18432
  v_mfma_f32_16x16x32_bf16 v[72:75], v[40:43], v[164:167], v[72:75]
  v_mfma_f32_16x16x32_bf16 v[72:75], v[48:51], v[168:171], v[72:75]
  ds_read_b128 v[160:163], v208 offset:20480
  v_mfma_f32_16x16x32_bf16 v[72:75], v[56:59], v[172:175], v[72:75]
  v_mfma_f32_16x16x32_bf16 v[76:79], v[52:55], v[168:171], v[76:79]
  ds_read_b128 v[164:167], v208 offset:22528
  v_mfma_f32_16x16x32_bf16 v[76:79], v[60:63], v[172:175], v[76:79]
  s_waitcnt lgkmcnt(4)
  v_mfma_f32_16x16x32_bf16 v[96:99], v[216:219], v[144:147], 0
  ds_read_b128 v[168:171], v208 offset:12544
  v_mfma_f32_16x16x32_bf16 v[96:99], v[224:227], v[148:151], v[96:99]
  s_add_u32 m0, s27, 0
  s_add_u32 s58, s21, 6144
  buffer_load_dwordx4 v253, s[28:31], s58 offen offset:0 sc1 lds
  v_mfma_f32_16x16x32_bf16 v[100:103], v[220:223], v[144:147], 0
  ds_read_b128 v[172:175], v208 offset:14592
  v_mfma_f32_16x16x32_bf16 v[100:103], v[228:231], v[148:151], v[100:103]
  buffer_load_dwordx4 v253, s[28:31], s58 offen offset:1024 sc1 lds
  s_waitcnt lgkmcnt(4)
  v_mfma_f32_16x16x32_bf16 v[100:103], v[236:239], v[152:155], v[100:103]
  ds_read_b128 v[144:147], v208 offset:16640
  v_mfma_f32_16x16x32_bf16 v[100:103], v[244:247], v[156:159], v[100:103]
  s_add_u32 s58, s58, s24
  buffer_load_dwordx4 v253, s[28:31], s58 offen offset:2048 sc1 lds
  v_mfma_f32_16x16x32_bf16 v[96:99], v[232:235], v[152:155], v[96:99]
  ds_read_b128 v[148:151], v208 offset:18688
  v_mfma_f32_16x16x32_bf16 v[96:99], v[240:243], v[156:159], v[96:99]
  s_add_u32 m0, s27, 12288
  s_add_u32 s58, s21, 6144
  s_add_u32 s58, s58, s23
  buffer_load_dwordx4 v253, s[28:31], s58 offen offset:0 sc1 lds
  s_waitcnt lgkmcnt(4)
  v_mfma_f32_16x16x32_bf16 v[96:99], v[176:179], v[160:163], v[96:99]
  ds_read_b128 v[152:155], v208 offset:20736
  v_mfma_f32_16x16x32_bf16 v[96:99], v[184:187], v[164:167], v[96:99]
  buffer_load_dwordx4 v253, s[28:31], s58 offen offset:1024 sc1 lds
  v_mfma_f32_16x16x32_bf16 v[100:103], v[180:183], v[160:163], v[100:103]
  ds_read_b128 v[156:159], v208 offset:22784
  v_mfma_f32_16x16x32_bf16 v[100:103], v[188:191], v[164:167], v[100:103]
  s_add_u32 s58, s58, s24
  buffer_load_dwordx4 v253, s[28:31], s58 offen offset:2048 sc1 lds
  s_waitcnt lgkmcnt(4)
  v_mfma_f32_16x16x32_bf16 v[104:107], v[216:219], v[168:171], 0
  ds_read_b128 v[160:163], v208 offset:0
  v_mfma_f32_16x16x32_bf16 v[104:107], v[224:227], v[172:175], v[104:107]
  s_lshl_b32 s52, s94, 12
  s_mul_i32 s53, s93, 73728
  s_add_u32 s54, s52, s53
  s_sub_u32 s55, s52, s53
  v_mfma_f32_16x16x32_bf16 v[108:111], v[220:223], v[168:171], 0
  ds_read_b128 v[164:167], v208 offset:2048
  v_mfma_f32_16x16x32_bf16 v[108:111], v[228:231], v[172:175], v[108:111]
  s_add_u32 s54, s54, 73728
  s_add_u32 s55, s55, 147456
  v_add_u32 v211, s54, v253
  v_add_u32 v212, s55, v253
  s_waitcnt lgkmcnt(4)
  v_mfma_f32_16x16x32_bf16 v[108:111], v[236:239], v[144:147], v[108:111]
  ds_read_b128 v[168:171], v208 offset:4096
  v_mfma_f32_16x16x32_bf16 v[108:111], v[244:247], v[148:151], v[108:111]
  v_bfe_u32 v213, v254, 3, 1
  v_lshlrev_b32 v213, 12, v213
  v_and_b32 v214, 7, v254
  v_lshl_add_u32 v213, v214, 4, v213
  v_mfma_f32_16x16x32_bf16 v[104:107], v[232:235], v[144:147], v[104:107]
  ds_read_b128 v[172:175], v208 offset:6144
  v_mfma_f32_16x16x32_bf16 v[104:107], v[240:243], v[148:151], v[104:107]
  v_lshrrev_b32 v215, 4, v254
  v_lshl_add_u32 v213, v215, 7, v213
  v_lshlrev_b32 v214, 10, v214
  v_lshrrev_b32 v215, 3, v254
  s_waitcnt lgkmcnt(4)
  v_mfma_f32_16x16x32_bf16 v[104:107], v[176:179], v[152:155], v[104:107]
  ds_read_b128 v[144:147], v208 offset:8192
  v_mfma_f32_16x16x32_bf16 v[104:107], v[184:187], v[156:159], v[104:107]
  v_lshl_add_u32 v214, v215, 3, v214
  s_and_b32 s52, s96, 63
  s_lshl_b32 s52, s52, 3
  s_add_u32 s52, s52, s92
  v_mfma_f32_16x16x32_bf16 v[108:111], v[180:183], v[152:155], v[108:111]
  ds_read_b128 v[148:151], v208 offset:10240
  v_mfma_f32_16x16x32_bf16 v[108:111], v[188:191], v[156:159], v[108:111]
  s_lshl_b32 s4, s52, 5
  s_add_u32 s4, s4, s71
  s_lshl_b32 s4, s4, 2
  s_add_u32 s4, s4, 61079584
  s_waitcnt lgkmcnt(4)
  v_mfma_f32_16x16x32_bf16 v[80:83], v[216:219], v[160:163], 0
  ds_read_b128 v[152:155], v208 offset:256
  v_mfma_f32_16x16x32_bf16 v[80:83], v[224:227], v[164:167], v[80:83]
  s_lshl_b32 s52, s52, 15
  s_add_u32 s52, s52, 75497472
  s_lshl_b32 s5, s71, 10
  s_add_u32 s5, s5, s52
  v_mfma_f32_16x16x32_bf16 v[84:87], v[220:223], v[160:163], 0
  ds_read_b128 v[156:159], v208 offset:2304
  v_mfma_f32_16x16x32_bf16 v[84:87], v[228:231], v[164:167], v[84:87]
  s_lshl_b32 s6, s71, 12
  s_add_u32 s6, s6, s52
  s_lshl_b32 s52, s94, 6
  s_add_u32 s66, s66, s52
  s_waitcnt lgkmcnt(4)
  v_mfma_f32_16x16x32_bf16 v[84:87], v[236:239], v[168:171], v[84:87]
  ds_read_b128 v[160:163], v208 offset:4352
  v_mfma_f32_16x16x32_bf16 v[84:87], v[244:247], v[172:175], v[84:87]
  s_add_u32 s67, s67, s52
  s_and_b32 s52, s71, 1
  s_lshl_b32 s52, s52, 3
  s_lshl_b32 s52, 0x00ff00ff, s52
  v_mfma_f32_16x16x32_bf16 v[80:83], v[232:235], v[168:171], v[80:83]
  ds_read_b128 v[164:167], v208 offset:6400
  v_mfma_f32_16x16x32_bf16 v[80:83], v[240:243], v[172:175], v[80:83]
  s_lshr_b32 s12, s71, 1
  s_mul_i32 s12, s12, s52
  s_xor_b32 s8, s12, s52
  s_mov_b32 s13, s12
  s_waitcnt lgkmcnt(4)
  v_mfma_f32_16x16x32_bf16 v[80:83], v[176:179], v[144:147], v[80:83]
  ds_read_b128 v[168:171], v208 offset:8448
  v_mfma_f32_16x16x32_bf16 v[80:83], v[184:187], v[148:151], v[80:83]
  s_mov_b32 s9, s8
  s_lshl_b32 s52, s92, 10
  s_add_u32 s52, s52, 32768
  v_and_b32 v248, 0xfff, v213
  v_mfma_f32_16x16x32_bf16 v[84:87], v[180:183], v[144:147], v[84:87]
  ds_read_b128 v[172:175], v208 offset:10496
  v_mfma_f32_16x16x32_bf16 v[84:87], v[188:191], v[148:151], v[84:87]
  v_add_u32 v248, s52, v248
  v_add_u32 v250, s52, v253
  s_mov_b32 s10, 0
  s_lshl_b32 s57, 1, s71
  s_waitcnt lgkmcnt(4)
  v_mfma_f32_16x16x32_bf16 v[88:91], v[216:219], v[152:155], 0
  v_mfma_f32_16x16x32_bf16 v[88:91], v[224:227], v[156:159], v[88:91]
  s_xor_b32 s57, s57, 15
  s_xor_b32 s53, s71, 1
  s_lshl_b32 s53, s53, 10
  s_add_u32 s53, s53, s6
  v_mfma_f32_16x16x32_bf16 v[92:95], v[220:223], v[152:155], 0
  v_mfma_f32_16x16x32_bf16 v[92:95], v[228:231], v[156:159], v[92:95]
  s_xor_b32 s54, s71, 2
  s_lshl_b32 s54, s54, 10
  s_add_u32 s54, s54, s6
  s_xor_b32 s55, s71, 3
  s_waitcnt vmcnt(6) lgkmcnt(0)
  s_barrier
  ds_read_b128 v[144:147], v209 offset:12288
  ds_read_b128 v[148:151], v209 offset:14336
  v_mfma_f32_16x16x32_bf16 v[92:95], v[236:239], v[160:163], v[92:95]
  ds_read_b128 v[152:155], v209 offset:16384
  v_mfma_f32_16x16x32_bf16 v[92:95], v[244:247], v[164:167], v[92:95]
  s_lshl_b32 s55, s55, 10
  s_add_u32 s55, s55, s6
  v_and_b32 v215, 0x1f0, v253
  v_lshrrev_b32 v252, 5, v254
  v_mfma_f32_16x16x32_bf16 v[88:91], v[232:235], v[160:163], v[88:91]
  ds_read_b128 v[156:159], v209 offset:18432
  v_mfma_f32_16x16x32_bf16 v[88:91], v[240:243], v[164:167], v[88:91]
  v_lshl_add_u32 v215, v252, 3, v215
  v_mfma_f32_16x16x32_bf16 v[88:91], v[176:179], v[168:171], v[88:91]
  ds_read_b128 v[160:163], v209 offset:20480
  v_mfma_f32_16x16x32_bf16 v[88:91], v[184:187], v[172:175], v[88:91]
  v_mfma_f32_16x16x32_bf16 v[92:95], v[180:183], v[168:171], v[92:95]
  ds_read_b128 v[164:167], v209 offset:22528
  v_mfma_f32_16x16x32_bf16 v[92:95], v[188:191], v[172:175], v[92:95]
  s_waitcnt lgkmcnt(4)
  v_mfma_f32_16x16x32_bf16 v[96:99], v[192:195], v[144:147], v[96:99]
  ds_read_b128 v[168:171], v209 offset:12544
  v_mfma_f32_16x16x32_bf16 v[96:99], v[200:203], v[148:151], v[96:99]
  v_mfma_f32_16x16x32_bf16 v[100:103], v[196:199], v[144:147], v[100:103]
  ds_read_b128 v[172:175], v209 offset:14592
  v_mfma_f32_16x16x32_bf16 v[100:103], v[204:207], v[148:151], v[100:103]
  s_waitcnt lgkmcnt(4)
  v_mfma_f32_16x16x32_bf16 v[100:103], v[116:119], v[152:155], v[100:103]
  ds_read_b128 v[144:147], v209 offset:16640
  v_mfma_f32_16x16x32_bf16 v[100:103], v[124:127], v[156:159], v[100:103]
  ds_write_b128 v211, v[128:131] offset:0
  v_mfma_f32_16x16x32_bf16 v[96:99], v[112:115], v[152:155], v[96:99]
  ds_read_b128 v[148:151], v209 offset:18688
  v_mfma_f32_16x16x32_bf16 v[96:99], v[120:123], v[156:159], v[96:99]
  s_waitcnt lgkmcnt(5)
  v_mfma_f32_16x16x32_bf16 v[96:99], v[0:3], v[160:163], v[96:99]
  ds_read_b128 v[152:155], v209 offset:20736
  v_mfma_f32_16x16x32_bf16 v[96:99], v[8:11], v[164:167], v[96:99]
  v_mfma_f32_16x16x32_bf16 v[100:103], v[4:7], v[160:163], v[100:103]
  ds_read_b128 v[156:159], v209 offset:22784
  v_mfma_f32_16x16x32_bf16 v[100:103], v[12:15], v[164:167], v[100:103]
  s_waitcnt lgkmcnt(5)
  v_mfma_f32_16x16x32_bf16 v[104:107], v[192:195], v[168:171], v[104:107]
  ds_read_b128 v[160:163], v209 offset:0
  v_mfma_f32_16x16x32_bf16 v[104:107], v[200:203], v[172:175], v[104:107]
  v_mfma_f32_16x16x32_bf16 v[108:111], v[196:199], v[168:171], v[108:111]
  ds_read_b128 v[164:167], v209 offset:2048
  v_mfma_f32_16x16x32_bf16 v[108:111], v[204:207], v[172:175], v[108:111]
  ds_write_b128 v211, v[132:135] offset:1024
  s_waitcnt lgkmcnt(5)
  v_mfma_f32_16x16x32_bf16 v[108:111], v[116:119], v[144:147], v[108:111]
  ds_read_b128 v[168:171], v209 offset:4096
  v_mfma_f32_16x16x32_bf16 v[108:111], v[124:127], v[148:151], v[108:111]
  v_mfma_f32_16x16x32_bf16 v[104:107], v[112:115], v[144:147], v[104:107]
  ds_read_b128 v[172:175], v209 offset:6144
  v_mfma_f32_16x16x32_bf16 v[104:107], v[120:123], v[148:151], v[104:107]
  buffer_load_dword v251, v249, s[28:31], 0 offen offset:32 sc1
  s_waitcnt lgkmcnt(5)
  v_mfma_f32_16x16x32_bf16 v[104:107], v[0:3], v[152:155], v[104:107]
  ds_read_b128 v[144:147], v209 offset:8192
  v_mfma_f32_16x16x32_bf16 v[104:107], v[8:11], v[156:159], v[104:107]
  v_mfma_f32_16x16x32_bf16 v[108:111], v[4:7], v[152:155], v[108:111]
  ds_read_b128 v[148:151], v209 offset:10240
  v_mfma_f32_16x16x32_bf16 v[108:111], v[12:15], v[156:159], v[108:111]
  s_waitcnt lgkmcnt(5)
  v_mfma_f32_16x16x32_bf16 v[80:83], v[192:195], v[160:163], v[80:83]
  ds_read_b128 v[152:155], v209 offset:256
  v_mfma_f32_16x16x32_bf16 v[80:83], v[200:203], v[164:167], v[80:83]
  ds_write_b128 v211, v[136:139] offset:2048
  v_mfma_f32_16x16x32_bf16 v[84:87], v[196:199], v[160:163], v[84:87]
  ds_read_b128 v[156:159], v209 offset:2304
  v_mfma_f32_16x16x32_bf16 v[84:87], v[204:207], v[164:167], v[84:87]
  s_waitcnt lgkmcnt(5)
  v_mfma_f32_16x16x32_bf16 v[84:87], v[116:119], v[168:171], v[84:87]
  ds_read_b128 v[160:163], v209 offset:4352
  v_mfma_f32_16x16x32_bf16 v[84:87], v[124:127], v[172:175], v[84:87]
  v_mfma_f32_16x16x32_bf16 v[80:83], v[112:115], v[168:171], v[80:83]
  ds_read_b128 v[164:167], v209 offset:6400
  v_mfma_f32_16x16x32_bf16 v[80:83], v[120:123], v[172:175], v[80:83]
  s_waitcnt lgkmcnt(5)
  v_mfma_f32_16x16x32_bf16 v[80:83], v[0:3], v[144:147], v[80:83]
  ds_read_b128 v[168:171], v209 offset:8448
  v_mfma_f32_16x16x32_bf16 v[80:83], v[8:11], v[148:151], v[80:83]
  v_mfma_f32_16x16x32_bf16 v[84:87], v[4:7], v[144:147], v[84:87]
  ds_read_b128 v[172:175], v209 offset:10496
  v_mfma_f32_16x16x32_bf16 v[84:87], v[12:15], v[148:151], v[84:87]
  ds_write_b128 v211, v[140:143] offset:3072
  s_waitcnt lgkmcnt(5)
  v_mfma_f32_16x16x32_bf16 v[88:91], v[192:195], v[152:155], v[88:91]
  v_mfma_f32_16x16x32_bf16 v[88:91], v[200:203], v[156:159], v[88:91]
  v_mfma_f32_16x16x32_bf16 v[92:95], v[196:199], v[152:155], v[92:95]
  v_mfma_f32_16x16x32_bf16 v[92:95], v[204:207], v[156:159], v[92:95]
  s_waitcnt vmcnt(0) lgkmcnt(0)
  s_barrier
  ds_read_b128 v[216:219], v212 offset:0
  ds_read_b128 v[220:223], v212 offset:1024
  ds_read_b128 v[224:227], v212 offset:2048
  ds_read_b128 v[228:231], v212 offset:3072
  ds_read_b128 v[144:147], v210 offset:12288
  ds_read_b128 v[148:151], v210 offset:14336
  v_mfma_f32_16x16x32_bf16 v[92:95], v[116:119], v[160:163], v[92:95]
  ds_read_b128 v[152:155], v210 offset:16384
  v_mfma_f32_16x16x32_bf16 v[92:95], v[124:127], v[164:167], v[92:95]
  v_mfma_f32_16x16x32_bf16 v[88:91], v[112:115], v[160:163], v[88:91]
  ds_read_b128 v[156:159], v210 offset:18432
  v_mfma_f32_16x16x32_bf16 v[88:91], v[120:123], v[164:167], v[88:91]
  v_mfma_f32_16x16x32_bf16 v[88:91], v[0:3], v[168:171], v[88:91]
  ds_read_b128 v[160:163], v210 offset:20480
  v_mfma_f32_16x16x32_bf16 v[88:91], v[8:11], v[172:175], v[88:91]
  v_mfma_f32_16x16x32_bf16 v[92:95], v[4:7], v[168:171], v[92:95]
  ds_read_b128 v[164:167], v210 offset:22528
  v_mfma_f32_16x16x32_bf16 v[92:95], v[12:15], v[172:175], v[92:95]
  s_waitcnt lgkmcnt(4)
  v_mfma_f32_16x16x32_bf16 v[96:99], v[16:19], v[144:147], v[96:99]
  ds_read_b128 v[168:171], v210 offset:12544
  v_mfma_f32_16x16x32_bf16 v[96:99], v[24:27], v[148:151], v[96:99]
  v_mfma_f32_16x16x32_bf16 v[100:103], v[20:23], v[144:147], v[100:103]
  ds_read_b128 v[172:175], v210 offset:14592
  v_mfma_f32_16x16x32_bf16 v[100:103], v[28:31], v[148:151], v[100:103]
  v_add_f32 v64, v64, v216
  v_add_f32 v65, v65, v217
  v_add_f32 v66, v66, v218
  v_add_f32 v67, v67, v219
  s_waitcnt lgkmcnt(4)
  v_mfma_f32_16x16x32_bf16 v[100:103], v[36:39], v[152:155], v[100:103]
  ds_read_b128 v[144:147], v210 offset:16640
  v_mfma_f32_16x16x32_bf16 v[100:103], v[44:47], v[156:159], v[100:103]
  v_add_f32 v68, v68, v220
  v_add_f32 v69, v69, v221
  v_add_f32 v70, v70, v222
  v_add_f32 v71, v71, v223
  v_mfma_f32_16x16x32_bf16 v[96:99], v[32:35], v[152:155], v[96:99]
  ds_read_b128 v[148:151], v210 offset:18688
  v_mfma_f32_16x16x32_bf16 v[96:99], v[40:43], v[156:159], v[96:99]
  v_add_f32 v72, v72, v224
  v_add_f32 v73, v73, v225
  v_add_f32 v74, v74, v226
  v_add_f32 v75, v75, v227
  s_waitcnt lgkmcnt(4)
  v_mfma_f32_16x16x32_bf16 v[96:99], v[48:51], v[160:163], v[96:99]
  ds_read_b128 v[152:155], v210 offset:20736
  v_mfma_f32_16x16x32_bf16 v[96:99], v[56:59], v[164:167], v[96:99]
  v_add_f32 v76, v76, v228
  v_add_f32 v77, v77, v229
  v_add_f32 v78, v78, v230
  v_add_f32 v79, v79, v231
  v_mfma_f32_16x16x32_bf16 v[100:103], v[52:55], v[160:163], v[100:103]
  ds_read_b128 v[156:159], v210 offset:22784
  v_mfma_f32_16x16x32_bf16 v[100:103], v[60:63], v[164:167], v[100:103]
  v_cvt_pk_bf16_f32 v216, v64, v65
  v_cvt_pk_bf16_f32 v217, v66, v67
  v_cvt_pk_bf16_f32 v218, v68, v69
  v_cvt_pk_bf16_f32 v219, v70, v71
  s_not_b64 exec, s[8:9]
  buffer_store_dwordx4 v[216:219], v213, s[28:31], s5 offen sc1
  s_mov_b64 exec, -1
  v_cvt_pk_bf16_f32 v224, v72, v73
  v_cvt_pk_bf16_f32 v225, v74, v75
  v_cvt_pk_bf16_f32 v226, v76, v77
  v_cvt_pk_bf16_f32 v227, v78, v79
  s_add_u32 s60, s5, 8192
  s_not_b64 exec, s[12:13]
  buffer_store_dwordx4 v[224:227], v213, s[28:31], s60 offen sc1
  s_mov_b64 exec, -1
  s_waitcnt lgkmcnt(4)
  v_mfma_f32_16x16x32_bf16 v[104:107], v[16:19], v[168:171], v[104:107]
  ds_read_b128 v[160:163], v210 offset:0
  v_mfma_f32_16x16x32_bf16 v[104:107], v[24:27], v[172:175], v[104:107]
  v_cmp_ne_u32 vcc, 1, v251
  s_nop 1
  s_and_b32 s61, vcc_lo, s57
  s_or_b32 s61, s61, s10
  s_cbranch_scc1 L_tga_110
  s_mov_b32 s10, 1
  s_add_u32 s56, s53, 16384
  buffer_load_dwordx2 v[238:239], v215, s[28:31], s53 offen sc1
  buffer_load_dwordx2 v[182:183], v215, s[28:31], s56 offen sc1
  s_add_u32 s56, s54, 16384
  buffer_load_dwordx2 v[242:243], v215, s[28:31], s54 offen sc1
  buffer_load_dwordx2 v[186:187], v215, s[28:31], s56 offen sc1
  s_add_u32 s56, s55, 16384
  buffer_load_dwordx2 v[246:247], v215, s[28:31], s55 offen sc1
  buffer_load_dwordx2 v[190:191], v215, s[28:31], s56 offen sc1
L_tga_110:
  v_mfma_f32_16x16x32_bf16 v[108:111], v[20:23], v[168:171], v[108:111]
  ds_read_b128 v[164:167], v210 offset:2048
  v_mfma_f32_16x16x32_bf16 v[108:111], v[28:31], v[172:175], v[108:111]
  s_lshl_b32 s58, s92, 12
  s_xor_b32 s59, s58, 0x4000
  v_add_u32 v211, s58, v253
  v_add_u32 v212, s59, v253
  s_add_u32 s5, s5, 16384
  s_waitcnt lgkmcnt(4)
  v_mfma_f32_16x16x32_bf16 v[108:111], v[36:39], v[144:147], v[108:111]
  ds_read_b128 v[168:171], v210 offset:4096
  v_mfma_f32_16x16x32_bf16 v[108:111], v[44:47], v[148:151], v[108:111]
  ds_write_b128 v211, v[96:99] offset:0
  v_mfma_f32_16x16x32_bf16 v[104:107], v[32:35], v[144:147], v[104:107]
  ds_read_b128 v[172:175], v210 offset:6144
  v_mfma_f32_16x16x32_bf16 v[104:107], v[40:43], v[148:151], v[104:107]
  s_waitcnt lgkmcnt(5)
  v_mfma_f32_16x16x32_bf16 v[104:107], v[48:51], v[152:155], v[104:107]
  ds_read_b128 v[144:147], v210 offset:8192
  v_mfma_f32_16x16x32_bf16 v[104:107], v[56:59], v[156:159], v[104:107]
  ds_write_b128 v211, v[100:103] offset:1024
  v_mfma_f32_16x16x32_bf16 v[108:111], v[52:55], v[152:155], v[108:111]
  ds_read_b128 v[148:151], v210 offset:10240
  v_mfma_f32_16x16x32_bf16 v[108:111], v[60:63], v[156:159], v[108:111]
  s_waitcnt lgkmcnt(6)
  v_mfma_f32_16x16x32_bf16 v[80:83], v[16:19], v[160:163], v[80:83]
  ds_read_b128 v[152:155], v210 offset:256
  v_mfma_f32_16x16x32_bf16 v[80:83], v[24:27], v[164:167], v[80:83]
  v_mfma_f32_16x16x32_bf16 v[84:87], v[20:23], v[160:163], v[84:87]
  ds_read_b128 v[156:159], v210 offset:2304
  v_mfma_f32_16x16x32_bf16 v[84:87], v[28:31], v[164:167], v[84:87]
  ds_write_b128 v211, v[104:107] offset:2048
  s_waitcnt lgkmcnt(6)
  v_mfma_f32_16x16x32_bf16 v[84:87], v[36:39], v[168:171], v[84:87]
  ds_read_b128 v[160:163], v210 offset:4352
  v_mfma_f32_16x16x32_bf16 v[84:87], v[44:47], v[172:175], v[84:87]
  ds_write_b128 v211, v[108:111] offset:3072
  v_mfma_f32_16x16x32_bf16 v[80:83], v[32:35], v[168:171], v[80:83]
  ds_read_b128 v[164:167], v210 offset:6400
  v_mfma_f32_16x16x32_bf16 v[80:83], v[40:43], v[172:175], v[80:83]
  s_waitcnt lgkmcnt(6)
  v_mfma_f32_16x16x32_bf16 v[80:83], v[48:51], v[144:147], v[80:83]
  ds_read_b128 v[168:171], v210 offset:8448
  v_mfma_f32_16x16x32_bf16 v[80:83], v[56:59], v[148:151], v[80:83]
  s_waitcnt lgkmcnt(0)
  s_barrier
  ds_read_b128 v[216:219], v212 offset:0
  ds_read_b128 v[220:223], v212 offset:1024
  ds_read_b128 v[224:227], v212 offset:2048
  ds_read_b128 v[228:231], v212 offset:3072
  v_mfma_f32_16x16x32_bf16 v[84:87], v[52:55], v[144:147], v[84:87]
  ds_read_b128 v[172:175], v210 offset:10496
  v_mfma_f32_16x16x32_bf16 v[84:87], v[60:63], v[148:151], v[84:87]
  v_mfma_f32_16x16x32_bf16 v[88:91], v[16:19], v[152:155], v[88:91]
  v_mfma_f32_16x16x32_bf16 v[88:91], v[24:27], v[156:159], v[88:91]
  v_mfma_f32_16x16x32_bf16 v[92:95], v[20:23], v[152:155], v[92:95]
  v_mfma_f32_16x16x32_bf16 v[92:95], v[28:31], v[156:159], v[92:95]
  v_mfma_f32_16x16x32_bf16 v[92:95], v[36:39], v[160:163], v[92:95]
  v_mfma_f32_16x16x32_bf16 v[92:95], v[44:47], v[164:167], v[92:95]
  s_waitcnt lgkmcnt(0)
  v_add_f32 v80, v80, v216
  v_add_f32 v81, v81, v217
  v_add_f32 v82, v82, v218
  v_add_f32 v83, v83, v219
  v_add_f32 v84, v84, v220
  v_add_f32 v85, v85, v221
  v_add_f32 v86, v86, v222
  v_add_f32 v87, v87, v223
  v_mfma_f32_16x16x32_bf16 v[88:91], v[32:35], v[160:163], v[88:91]
  v_mfma_f32_16x16x32_bf16 v[88:91], v[40:43], v[164:167], v[88:91]
  v_cvt_pk_bf16_f32 v216, v80, v81
  v_cvt_pk_bf16_f32 v217, v82, v83
  v_cvt_pk_bf16_f32 v218, v84, v85
  v_cvt_pk_bf16_f32 v219, v86, v87
  s_not_b64 exec, s[8:9]
  buffer_store_dwordx4 v[216:219], v213, s[28:31], s5 offen sc1
  s_mov_b64 exec, -1
  v_mfma_f32_16x16x32_bf16 v[88:91], v[48:51], v[168:171], v[88:91]
  v_mfma_f32_16x16x32_bf16 v[88:91], v[56:59], v[172:175], v[88:91]
  v_mfma_f32_16x16x32_bf16 v[92:95], v[52:55], v[168:171], v[92:95]
  v_mfma_f32_16x16x32_bf16 v[92:95], v[60:63], v[172:175], v[92:95]
  s_nop 6
  s_waitcnt lgkmcnt(0)
  v_add_f32 v88, v88, v224
  v_add_f32 v89, v89, v225
  v_add_f32 v90, v90, v226
  v_add_f32 v91, v91, v227
  v_add_f32 v92, v92, v228
  v_add_f32 v93, v93, v229
  v_add_f32 v94, v94, v230
  v_add_f32 v95, v95, v231
  v_cvt_pk_bf16_f32 v224, v88, v89
  v_cvt_pk_bf16_f32 v225, v90, v91
  v_cvt_pk_bf16_f32 v226, v92, v93
  v_cvt_pk_bf16_f32 v227, v94, v95
  s_add_u32 s60, s5, 8192
  s_not_b64 exec, s[12:13]
  buffer_store_dwordx4 v[224:227], v213, s[28:31], s60 offen sc1
  s_mov_b64 exec, -1
  buffer_load_dword v251, v249, s[28:31], 0 offen offset:32 sc1
  s_mov_b64 exec, s[8:9]
  ds_write_b128 v248, v[80:83] offset:0
  ds_write_b128 v248, v[84:87] offset:512
  s_mov_b64 exec, s[12:13]
  ds_write_b128 v248, v[88:91] offset:0
  ds_write_b128 v248, v[92:95] offset:512
  s_mov_b64 exec, -1
  ds_read_b128 v[176:179], v250 offset:0
  s_mov_b64 exec, s[8:9]
  ds_write_b128 v248, v[64:67] offset:57344
  ds_write_b128 v248, v[68:71] offset:57856
  s_mov_b64 exec, s[12:13]
  ds_write_b128 v248, v[72:75] offset:57344
  ds_write_b128 v248, v[76:79] offset:57856
  s_mov_b64 exec, -1
  ds_read_b128 v[232:235], v250 offset:57344
  s_waitcnt vmcnt(0)
  v_cmp_ne_u32 vcc, 1, v251
  s_nop 1
  s_and_b32 s61, vcc_lo, s57
  s_or_b32 s61, s61, s10
  s_cbranch_scc1 L_tgb_111
  s_mov_b32 s10, 1
  s_add_u32 s56, s53, 16384
  buffer_load_dwordx2 v[238:239], v215, s[28:31], s53 offen sc1
  buffer_load_dwordx2 v[182:183], v215, s[28:31], s56 offen sc1
  s_add_u32 s56, s54, 16384
  buffer_load_dwordx2 v[242:243], v215, s[28:31], s54 offen sc1
  buffer_load_dwordx2 v[186:187], v215, s[28:31], s56 offen sc1
  s_add_u32 s56, s55, 16384
  buffer_load_dwordx2 v[246:247], v215, s[28:31], s55 offen sc1
  buffer_load_dwordx2 v[190:191], v215, s[28:31], s56 offen sc1
L_tgb_111:
  v_lshlrev_b32 v216, 16, v254
  v_mov_b32 v217, 1
  s_mov_b64 exec, 15
  buffer_store_dword v217, v216, s[28:31], s4 offen offset:0 sc1
  s_mov_b64 exec, -1
  s_cmp_lg_u32 s10, 0
  s_cbranch_scc1 L_xf
L_fcx_112:
  v_cmp_ne_u32 vcc, 1, v251
  s_nop 1
  s_and_b32 s61, vcc_lo, s57
  s_cbranch_scc0 L_fcokx_113
  s_sleep 8
  buffer_load_dword v251, v249, s[28:31], 0 offen offset:32 sc1
  s_waitcnt vmcnt(0)
  s_sub_u32 s99, s99, 1
  s_cbranch_scc0 L_fcx_112
  s_mov_b32 s99, 0
L_fcokx_113:
  s_add_u32 s56, s53, 16384
  buffer_load_dwordx2 v[238:239], v215, s[28:31], s53 offen sc1
  buffer_load_dwordx2 v[182:183], v215, s[28:31], s56 offen sc1
  s_add_u32 s56, s54, 16384
  buffer_load_dwordx2 v[242:243], v215, s[28:31], s54 offen sc1
  buffer_load_dwordx2 v[186:187], v215, s[28:31], s56 offen sc1
  s_add_u32 s56, s55, 16384
  buffer_load_dwordx2 v[246:247], v215, s[28:31], s55 offen sc1
  buffer_load_dwordx2 v[190:191], v215, s[28:31], s56 offen sc1
  s_waitcnt vmcnt(0)
L_xf:
  s_waitcnt vmcnt(1) lgkmcnt(0)
  v_lshlrev_b32 v180, 16, v182
  v_and_b32 v181, 0xffff0000, v182
  v_lshlrev_b32 v182, 16, v183
  v_and_b32 v183, 0xffff0000, v183
  v_lshlrev_b32 v184, 16, v186
  v_and_b32 v185, 0xffff0000, v186
  v_lshlrev_b32 v186, 16, v187
  v_and_b32 v187, 0xffff0000, v187
  v_lshlrev_b32 v188, 16, v190
  v_and_b32 v189, 0xffff0000, v190
  v_lshlrev_b32 v190, 16, v191
  v_and_b32 v191, 0xffff0000, v191
  v_add_f32 v176, v176, v180
  v_add_f32 v184, v184, v188
  v_add_f32 v177, v177, v181
  v_add_f32 v185, v185, v189
  v_add_f32 v178, v178, v182
  v_add_f32 v186, v186, v190
  v_add_f32 v179, v179, v183
  v_add_f32 v187, v187, v191
  v_add_f32 v176, v176, v184
  v_add_f32 v177, v177, v185
  v_add_f32 v178, v178, v186
  v_add_f32 v179, v179, v187
  v_cvt_pk_bf16_f32 v176, v176, v177
  v_cvt_pk_bf16_f32 v177, v178, v179
  buffer_store_dwordx2 v[176:177], v214, s[40:43], s67 offen
  v_lshlrev_b32 v236, 16, v238
  v_and_b32 v237, 0xffff0000, v238
  v_lshlrev_b32 v238, 16, v239
  v_and_b32 v239, 0xffff0000, v239
  v_lshlrev_b32 v240, 16, v242
  v_and_b32 v241, 0xffff0000, v242
  v_lshlrev_b32 v242, 16, v243
  v_and_b32 v243, 0xffff0000, v243
  v_lshlrev_b32 v244, 16, v246
  v_and_b32 v245, 0xffff0000, v246
  v_lshlrev_b32 v246, 16, v247
  v_and_b32 v247, 0xffff0000, v247
  v_add_f32 v232, v232, v236
  v_add_f32 v240, v240, v244
  v_add_f32 v233, v233, v237
  v_add_f32 v241, v241, v245
  v_add_f32 v234, v234, v238
  v_add_f32 v242, v242, v246
  v_add_f32 v235, v235, v239
  v_add_f32 v243, v243, v247
  v_add_f32 v232, v232, v240
  v_add_f32 v233, v233, v241
  v_add_f32 v234, v234, v242
  v_add_f32 v235, v235, v243
  v_cvt_pk_bf16_f32 v232, v232, v233
  v_cvt_pk_bf16_f32 v233, v234, v235
  buffer_store_dwordx2 v[232:233], v214, s[40:43], s66 offen
L_end:
  s_endpgm
L_early:
  s_lshl_b32 s52, s96, 3
  s_add_u32 s52, s52, s92
  s_lshl_b32 s52, s52, 7
  s_add_u32 s52, s52, 61079552
  v_and_b32 v249, 7, v254
  v_lshl_add_u32 v249, v249, 2, s52
  v_xor_b32 v213, 512, v249
  buffer_load_dword v251, v249, s[28:31], 0 offen sc1
  buffer_load_dword v252, v213, s[28:31], 0 offen sc1
  s_mov_b32 s64, 64
  s_waitcnt vmcnt(0)
  v_and_b32 v251, v251, v252
  v_cmp_ne_u32 vcc, 1, v251
  s_nop 1
  s_and_b32 s61, vcc_lo, 0x33
  s_cbranch_scc1 L_help1
  s_mov_b32 s46, 1
  s_add_u32 m0, s25, 0
  s_add_u32 s58, s19, 0
  buffer_load_dwordx4 v253, s[28:31], s58 offen offset:0 sc1 lds
  buffer_load_dwordx4 v253, s[28:31], s58 offen offset:1024 sc1 lds
  buffer_load_dwordx4 v253, s[28:31], s58 offen offset:2048 sc1 lds
  s_add_u32 m0, s25, 12288
  s_add_u32 s58, s19, 0
  s_add_u32 s58, s58, s23
  buffer_load_dwordx4 v253, s[28:31], s58 offen offset:0 sc1 lds
  buffer_load_dwordx4 v253, s[28:31], s58 offen offset:1024 sc1 lds
  buffer_load_dwordx4 v253, s[28:31], s58 offen offset:2048 sc1 lds
  s_add_u32 m0, s44, 0
  s_add_u32 s58, s68, 0
  buffer_load_dwordx4 v253, s[28:31], s58 offen offset:0 sc1 lds
  buffer_load_dwordx4 v253, s[28:31], s58 offen offset:1024 sc1 lds
  buffer_load_dwordx4 v253, s[28:31], s58 offen offset:2048 sc1 lds
  s_add_u32 m0, s44, 12288
  s_add_u32 s58, s68, 0
  s_sub_u32 s58, s58, s23
  buffer_load_dwordx4 v253, s[28:31], s58 offen offset:0 sc1 lds
  buffer_load_dwordx4 v253, s[28:31], s58 offen offset:1024 sc1 lds
  buffer_load_dwordx4 v253, s[28:31], s58 offen offset:2048 sc1 lds
  s_branch L_help1
L_hook:
  s_cmp_eq_u32 s85, 0
  s_cbranch_scc0 L_hookd
L_nda_114:
  v_cmp_ne_u32 vcc, 1, v250
  s_mov_b32 m0, s75
  s_nop 0
  s_and_b64 s[62:63], vcc, s[8:9]
  s_cbranch_scc0 L_ndoka_115
  s_sleep 1
  buffer_load_dword v250, v248, s[28:31], s6 offen sc1
  s_waitcnt vmcnt(0)
  s_sub_u32 s99, s99, 1
  s_cbranch_scc0 L_nda_114
  s_mov_b32 s99, 0
L_ndoka_115:
  buffer_load_dwordx4 v253, s[28:31], s4 offen offset:0 sc1 lds
  buffer_load_dwordx4 v253, s[28:31], s4 offen offset:1024 sc1 lds
  s_mov_b32 s7, s82
  s_cmp_ge_u32 s77, s91
  s_addc_u32 s82, s77, 0
  buffer_load_dwordx4 v253, s[28:31], s4 offen offset:2048 sc1 lds
  s_cmp_lg_u32 s94, 0
  s_cselect_b32 s15, s82, s7
  s_lshl_b32 s15, s15, 15
  buffer_load_dwordx4 v253, s[28:31], s4 offen offset:3072 sc1 lds
  s_sub_u32 s14, 15, s82
  s_min_u32 s14, s14, s82
  s_add_u32 m0, m0, 4096
  s_add_u32 s4, s4, 4096
  buffer_load_dwordx4 v253, s[28:31], s4 offen offset:0 sc1 lds
  buffer_load_dwordx4 v253, s[28:31], s4 offen offset:1024 sc1 lds
  s_lshl_b32 s14, s14, 3
  s_lshl_b64 s[8:9], 0xff, s14
  buffer_load_dwordx4 v253, s[28:31], s4 offen offset:2048 sc1 lds
  s_lshr_b32 s14, s82, 3
  s_lshl_b32 s6, s14, 5
  buffer_load_dwordx4 v253, s[28:31], s4 offen offset:3072 sc1 lds
  s_lshl_b32 s14, s82, 15
  s_add_u32 s4, s73, s14
  s_mov_b32 m0, s76
  s_xor_b32 s75, s75, 0x8000
  buffer_load_dwordx4 v253, s[28:31], s5 offen offset:0 sc1 lds
  buffer_load_dwordx4 v253, s[28:31], s5 offen offset:1024 sc1 lds
  s_xor_b32 s76, s76, 0x38000
  buffer_load_dwordx4 v253, s[28:31], s5 offen offset:2048 sc1 lds
  s_and_b32 s17, s12, 15
  s_and_b32 s14, s10, 8
  s_lshl_b32 s14, s14, 1
  s_or_b32 s17, s17, s14
  buffer_load_dwordx4 v253, s[28:31], s5 offen offset:3072 sc1 lds
  s_lshr_b64 s[10:11], s[10:11], 4
  s_lshr_b64 s[12:13], s[12:13], 4
  s_and_b32 s85, s10, 7
  s_add_u32 m0, m0, 4096
  s_add_u32 s5, s5, 4096
  buffer_load_dwordx4 v253, s[28:31], s5 offen offset:0 sc1 lds
  buffer_load_dwordx4 v253, s[28:31], s5 offen offset:1024 sc1 lds
  buffer_load_dwordx4 v253, s[28:31], s5 offen offset:2048 sc1 lds
  buffer_load_dwordx4 v253, s[28:31], s5 offen offset:3072 sc1 lds
  s_add_u32 s5, s74, s15
  buffer_load_dword v250, v248, s[28:31], s6 offen sc1
  s_mov_b32 s64, 0
  s_waitcnt vmcnt(17)
L_post:
  s_setprio 0
  s_cmp_eq_u32 s81, 1
  s_cselect_b32 s52, 32, 0
  s_or_b32 s17, s17, s52
  s_cbranch_scc1 L_post1
  s_setpc_b64 s[88:89]
L_post1:
  s_bitcmp1_b32 s17, 0
  s_cbranch_scc0 L_due_116
  s_add_u32 s64, s64, 1
  v_mov_b32 v173, 1
  v_mov_b32 v174, 0
  s_lshl_b32 s52, s96, 7
  s_lshl_b32 s53, s94, 2
  s_add_u32 s52, s52, s53
  s_add_u32 s52, s52, 60817408
  s_mov_b64 exec, 1
  buffer_store_dword v173, v174, s[28:31], s52 offen offset:80 sc1
  s_mov_b64 exec, -1
L_due_116:
  s_bitcmp1_b32 s17, 1
  s_cbranch_scc0 L_due_117
  s_add_u32 s64, s64, 1
  s_andn2_b32 s52, s18, 128
  s_and_b32 s53, s90, 1
  s_lshl_b32 s53, s53, 3
  s_add_u32 s52, s52, s53
  s_add_u32 s52, s52, 16
  v_and_b32 v173, 3, v254
  v_lshlrev_b32 v173, 13, v173
  v_lshrrev_b32 v174, 2, v254
  v_lshl_add_u32 v173, v174, 7, v173
  v_mov_b32 v174, 1
  s_mov_b64 exec, 255
  buffer_store_dword v174, v173, s[28:31], s52 offen sc1
  s_mov_b64 exec, -1
L_due_117:
  s_bitcmp1_b32 s17, 5
  s_cbranch_scc0 L_due_118
  s_add_u32 s64, s64, 1
  v_and_b32 v173, 3, v254
  v_lshlrev_b32 v173, 13, v173
  v_mov_b32 v174, 1
  s_mov_b64 exec, 15
  buffer_store_dword v174, v173, s[28:31], s18 offen sc1
  s_mov_b64 exec, -1
  s_mov_b32 s81, 0
L_due_118:
  s_bitcmp1_b32 s17, 3
  s_cbranch_scc0 L_due_119
  s_add_u32 s64, s64, 1
  v_cmp_ne_u32 vcc, 1, v251
  s_mov_b32 s0, 1
  s_nop 0
  s_cbranch_vccz L_wtok
  v_and_b32 v173, 15, v254
  v_lshlrev_b32 v173, 2, v173
  s_lshl_b32 s52, s96, 7
  s_add_u32 s52, s52, 60882944
L_pollwt_120:
  buffer_load_dword v251, v173, s[28:31], s52 offen sc1
  s_waitcnt vmcnt(0)
  v_cmp_ne_u32 vcc, 1, v251
  s_nop 1
  s_cbranch_vccz L_pdonewt_121
  s_sleep 4
  s_sub_u32 s99, s99, 1
  s_cbranch_scc0 L_pollwt_120
  s_mov_b32 s99, 0
L_pdonewt_121:
L_wtok:
  v_min_u32 v175, 35, v254
  v_lshlrev_b32 v175, 7, v175
  s_lshl_b32 s52, s91, 2
  s_add_u32 s52, s52, s94
  s_mul_i32 s52, s52, 4608
  s_add_u32 s52, s52, s1
  s_add_u32 s52, s52, 147456
  buffer_load_dword v251, v175, s[28:31], s52 offen sc1
L_due_119:
  s_bitcmp1_b32 s17, 2
  s_cbranch_scc0 L_due_122
  s_add_u32 s64, s64, 1
  v_and_b32 v173, 15, v254
  v_lshlrev_b32 v173, 2, v173
  s_lshl_b32 s52, s96, 7
  s_add_u32 s52, s52, 60882944
  buffer_load_dword v251, v173, s[28:31], s52 offen sc1
L_due_122:
  s_cmp_lg_u32 s92, 0
  s_cbranch_scc1 L_postx
  s_bitcmp1_b32 s17, 4
  s_cbranch_scc0 L_due_123
  s_add_u32 s64, s64, 2
  v_mov_b32 v173, 1
  v_lshlrev_b32 v174, 2, v254
  s_lshl_b32 s52, s96, 7
  s_add_u32 s52, s52, 60850176
  s_mov_b64 exec, 255
  buffer_store_dword v173, v174, s[28:31], s52 offen offset:32 sc1
  s_mov_b64 exec, -1
  v_bfe_u32 v173, v254, 3, 1
  v_lshlrev_b32 v173, 12, v173
  v_and_b32 v174, 7, v254
  v_lshl_add_u32 v173, v174, 7, v173
  v_mov_b32 v174, 1
  s_lshl_b32 s52, s71, 13
  s_lshl_b32 s53, s72, 10
  s_add_u32 s52, s52, s53
  s_bfe_u32 s53, s90, 0x10002
  s_lshl_b32 s53, s53, 3
  s_add_u32 s53, s53, s91
  s_lshl_b32 s53, s53, 2
  s_add_u32 s52, s52, s53
  s_add_u32 s52, s52, 60882944
  s_mov_b64 exec, 0xffff
  buffer_store_dword v174, v173, s[28:31], s52 offen sc1
  s_mov_b64 exec, -1
L_due_123:
L_postx:
  s_setpc_b64 s[88:89]
L_hookd:
  s_cmp_eq_u32 s85, 9
  s_cbranch_scc1 L_hook1
  s_cmp_eq_u32 s85, 8
  s_cbranch_scc1 L_j8
  s_cmp_eq_u32 s85, 1
  s_cbranch_scc1 L_j1
  s_cmp_eq_u32 s85, 2
  s_cbranch_scc1 L_j2
  s_cmp_eq_u32 s85, 3
  s_cbranch_scc1 L_j3
  s_cmp_eq_u32 s85, 4
  s_cbranch_scc1 L_j4
  s_cmp_eq_u32 s85, 5
  s_cbranch_scc1 L_j5
  s_waitcnt vmcnt(0)
  s_mov_b32 s59, s85
  s_add_u32 s60, s77, 1
  s_cmp_ge_u32 s60, s97
  s_cbranch_scc1 L_skipk_124
L_ndg_126:
  v_cmp_ne_u32 vcc, 1, v250
  s_mov_b32 m0, s75
  s_nop 0
  s_and_b64 s[62:63], vcc, s[8:9]
  s_cbranch_scc0 L_ndokg_127
  s_sleep 1
  buffer_load_dword v250, v248, s[28:31], s6 offen sc1
  s_waitcnt vmcnt(0)
  s_sub_u32 s99, s99, 1
  s_cbranch_scc0 L_ndg_126
  s_mov_b32 s99, 0
L_ndokg_127:
  buffer_load_dwordx4 v253, s[28:31], s4 offen offset:0 sc1 lds
  buffer_load_dwordx4 v253, s[28:31], s4 offen offset:1024 sc1 lds
  buffer_load_dwordx4 v253, s[28:31], s4 offen offset:2048 sc1 lds
  buffer_load_dwordx4 v253, s[28:31], s4 offen offset:3072 sc1 lds
  s_add_u32 m0, m0, 4096
  s_add_u32 s4, s4, 4096
  buffer_load_dwordx4 v253, s[28:31], s4 offen offset:0 sc1 lds
  buffer_load_dwordx4 v253, s[28:31], s4 offen offset:1024 sc1 lds
  buffer_load_dwordx4 v253, s[28:31], s4 offen offset:2048 sc1 lds
  buffer_load_dwordx4 v253, s[28:31], s4 offen offset:3072 sc1 lds
L_skipk_124:
  s_xor_b32 s75, s75, 0x8000
  s_cmp_lg_u32 s94, 0
  s_cselect_b32 s14, 1, 0
  s_cselect_b32 s16, 99, s77
  s_add_u32 s14, s77, s14
  s_cmp_ge_u32 s14, s97
  s_cbranch_scc1 L_skipv_125
  s_cmp_lt_u32 s16, 2
  s_cbranch_scc1 L_skipv_125
  s_mov_b32 m0, s76
  s_nop 0
  buffer_load_dwordx4 v253, s[28:31], s5 offen offset:0 sc1 lds
  buffer_load_dwordx4 v253, s[28:31], s5 offen offset:1024 sc1 lds
  buffer_load_dwordx4 v253, s[28:31], s5 offen offset:2048 sc1 lds
  buffer_load_dwordx4 v253, s[28:31], s5 offen offset:3072 sc1 lds
  s_add_u32 m0, m0, 4096
  s_add_u32 s5, s5, 4096
  buffer_load_dwordx4 v253, s[28:31], s5 offen offset:0 sc1 lds
  buffer_load_dwordx4 v253, s[28:31], s5 offen offset:1024 sc1 lds
  buffer_load_dwordx4 v253, s[28:31], s5 offen offset:2048 sc1 lds
  buffer_load_dwordx4 v253, s[28:31], s5 offen offset:3072 sc1 lds
L_skipv_125:
  s_mov_b32 s7, s82
  s_cmp_ge_u32 s77, s91
  s_addc_u32 s82, s77, 0
  s_cmp_lg_u32 s94, 0
  s_cselect_b32 s15, s82, s7
  s_lshl_b32 s15, s15, 15
  s_sub_u32 s14, 15, s82
  s_min_u32 s14, s14, s82
  s_lshl_b32 s14, s14, 3
  s_lshl_b64 s[8:9], 0xff, s14
  s_lshr_b32 s14, s82, 3
  s_lshl_b32 s6, s14, 5
  s_lshl_b32 s14, s82, 15
  s_add_u32 s4, s73, s14
  s_add_u32 s5, s74, s15
  s_and_b32 s17, s12, 15
  s_and_b32 s14, s10, 8
  s_lshl_b32 s14, s14, 1
  s_or_b32 s17, s17, s14
  s_lshr_b64 s[10:11], s[10:11], 4
  s_lshr_b64 s[12:13], s[12:13], 4
  s_and_b32 s85, s10, 7
  s_xor_b32 s76, s76, 0x38000
  buffer_load_dword v250, v248, s[28:31], s6 offen sc1
  s_mov_b32 s64, 0
  s_cmp_eq_u32 s59, 7
  s_cbranch_scc1 L_post
  s_lshl_b32 s53, s94, 11
  s_add_u32 s53, s53, 65536
  v_add_u32 v175, s53, v253
  v_add_u32 v173, 65536, v253
  ds_read_b128 v[128:131], v173 offset:8192
  ds_read_b128 v[132:135], v173 offset:9216
  ds_read_b128 v[136:139], v173 offset:10240
  ds_read_b128 v[140:143], v173 offset:11264
  ds_read_b128 v[208:211], v175 offset:0
  ds_read_b128 v[212:215], v175 offset:1024
  v_cmp_eq_u32 vcc, 0, v249
  s_nop 1
  s_cbranch_vccz L_goko_128
  v_bfe_u32 v173, v254, 3, 2
  v_lshlrev_b32 v173, 10, v173
  v_and_b32 v174, 7, v254
  v_lshl_add_u32 v173, v174, 2, v173
  s_and_b32 s52, s90, 1
  s_lshl_b32 s52, s52, 2
  s_add_u32 s52, s52, s94
  s_lshl_b32 s52, s52, 12
  s_lshl_b32 s53, s91, 7
  s_add_u32 s52, s52, s53
  s_add_u32 s52, s52, 60817504
L_gtopo_129:
  buffer_load_dword v249, v173, s[28:31], s52 offen offset:0 sc1
  s_waitcnt vmcnt(0)
  v_cmp_eq_u32 vcc, 0, v249
  s_nop 1
  s_cbranch_vccz L_goko_128
  s_sleep 4
  s_sub_u32 s99, s99, 1
  s_cbranch_scc0 L_gtopo_129
  s_mov_b32 s99, 0
L_goko_128:
  v_and_b32 v173, 16, v254
  v_cmp_ne_u32 vcc, 0, v173
  s_waitcnt lgkmcnt(0)
  v_cvt_pk_bf16_f32 v64, v128, v129
  v_cvt_pk_bf16_f32 v65, v130, v131
  v_cvt_pk_bf16_f32 v66, v132, v133
  v_cvt_pk_bf16_f32 v67, v134, v135
  v_cvt_pk_bf16_f32 v68, v136, v137
  v_cvt_pk_bf16_f32 v69, v138, v139
  v_cvt_pk_bf16_f32 v70, v140, v141
  v_cvt_pk_bf16_f32 v71, v142, v143
  v_cndmask_b32 v128, v64, 0, vcc
  v_cndmask_b32 v129, v65, 0, vcc
  v_cndmask_b32 v130, v66, 0, vcc
  v_cndmask_b32 v131, v67, 0, vcc
  v_cndmask_b32 v132, v68, 0, vcc
  v_cndmask_b32 v133, v69, 0, vcc
  v_cndmask_b32 v134, v70, 0, vcc
  v_cndmask_b32 v135, v71, 0, vcc
  v_cndmask_b32 v136, 0, v64, vcc
  v_cndmask_b32 v137, 0, v65, vcc
  v_cndmask_b32 v138, 0, v66, vcc
  v_cndmask_b32 v139, 0, v67, vcc
  v_cndmask_b32 v140, 0, v68, vcc
  v_cndmask_b32 v141, 0, v69, vcc
  v_cndmask_b32 v142, 0, v70, vcc
  v_cndmask_b32 v143, 0, v71, vcc
  s_nop 1
  v_mfma_f32_32x32x16_bf16 v[64:79], v[132:135], v[208:211], 0
  v_mfma_f32_32x32x16_bf16 v[64:79], v[140:143], v[212:215], v[64:79]
  s_lshl_b32 s52, s98, 2
  s_add_u32 s52, s52, s94
  s_mul_i32 s52, s52, 288
  s_lshl_b32 s53, s95, 1
  s_add_u32 s52, s52, s53
  s_add_u32 s52, s52, 256
  s_lshl_b32 s52, s52, 10
  s_add_u32 s52, s52, 33554432
  s_nop 7
  v_add_f32 v173, 0x358637bd, v64
  v_add_f32 v174, 0x358637bd, v72
  v_mfma_f32_32x32x16_bf16 v[64:79], v[128:131], v[208:211], 0
  v_mfma_f32_32x32x16_bf16 v[64:79], v[136:139], v[212:215], v[64:79]
  v_rcp_f32 v173, v173
  v_rcp_f32 v174, v174
  v_sub_f32 v249, 2.0, v249
  v_mul_f32 v173, v173, v249
  v_mul_f32 v174, v174, v249
  s_nop 8
  v_mul_f32 v64, v64, v173
  v_mul_f32 v65, v65, v173
  v_mul_f32 v66, v66, v173
  v_mul_f32 v67, v67, v173
  v_mul_f32 v68, v68, v173
  v_mul_f32 v69, v69, v173
  v_mul_f32 v70, v70, v173
  v_mul_f32 v71, v71, v173
  v_mul_f32 v72, v72, v174
  v_mul_f32 v73, v73, v174
  v_mul_f32 v74, v74, v174
  v_mul_f32 v75, v75, v174
  v_mul_f32 v76, v76, v174
  v_mul_f32 v77, v77, v174
  v_mul_f32 v78, v78, v174
  v_mul_f32 v79, v79, v174
  v_cvt_pk_bf16_f32 v128, v64, v65
  v_cvt_pk_bf16_f32 v129, v66, v67
  v_cvt_pk_bf16_f32 v130, v68, v69
  v_cvt_pk_bf16_f32 v131, v70, v71
  v_cvt_pk_bf16_f32 v132, v72, v73
  v_cvt_pk_bf16_f32 v133, v74, v75
  v_cvt_pk_bf16_f32 v134, v76, v77
  v_cvt_pk_bf16_f32 v135, v78, v79
  buffer_store_dwordx4 v[128:131], v253, s[28:31], s52 offen offset:0 sc1
  buffer_store_dwordx4 v[132:135], v253, s[28:31], s52 offen offset:1024 sc1
  s_mov_b32 s64, 2
  s_branch L_post
L_j4:
L_ndd_132:
  v_cmp_ne_u32 vcc, 1, v250
  s_mov_b32 m0, s75
  s_nop 0
  s_and_b64 s[62:63], vcc, s[8:9]
  s_cbranch_scc0 L_ndokd_133
  s_sleep 1
  buffer_load_dword v250, v248, s[28:31], s6 offen sc1
  s_waitcnt vmcnt(0)
  s_sub_u32 s99, s99, 1
  s_cbranch_scc0 L_ndd_132
  s_mov_b32 s99, 0
L_ndokd_133:
  buffer_load_dwordx4 v253, s[28:31], s4 offen offset:0 sc1 lds
  s_lshl_b32 s53, s94, 11
  s_add_u32 s53, s53, 65536
  v_add_u32 v175, s53, v253
  v_add_u32 v173, 65536, v253
  ds_read_b128 v[128:131], v173 offset:8192
  ds_read_b128 v[132:135], v173 offset:9216
  ds_read_b128 v[136:139], v173 offset:10240
  buffer_load_dwordx4 v253, s[28:31], s4 offen offset:1024 sc1 lds
  s_mov_b32 s7, s82
  s_cmp_ge_u32 s77, s91
  s_addc_u32 s82, s77, 0
  ds_read_b128 v[140:143], v173 offset:11264
  ds_read_b128 v[208:211], v175 offset:0
  ds_read_b128 v[212:215], v175 offset:1024
  v_cmp_eq_u32 vcc, 0, v249
  s_nop 1
  s_cbranch_vccz L_goko_130
  v_bfe_u32 v173, v254, 3, 2
  v_lshlrev_b32 v173, 10, v173
  v_and_b32 v174, 7, v254
  v_lshl_add_u32 v173, v174, 2, v173
  s_and_b32 s52, s90, 1
  s_lshl_b32 s52, s52, 2
  s_add_u32 s52, s52, s94
  s_lshl_b32 s52, s52, 12
  s_lshl_b32 s53, s91, 7
  s_add_u32 s52, s52, s53
  s_add_u32 s52, s52, 60817504
L_gtopo_131:
  buffer_load_dword v249, v173, s[28:31], s52 offen offset:0 sc1
  s_waitcnt vmcnt(0)
  v_cmp_eq_u32 vcc, 0, v249
  s_nop 1
  s_cbranch_vccz L_goko_130
  s_sleep 4
  s_sub_u32 s99, s99, 1
  s_cbranch_scc0 L_gtopo_131
  s_mov_b32 s99, 0
L_goko_130:
  buffer_load_dwordx4 v253, s[28:31], s4 offen offset:2048 sc1 lds
  s_cmp_lg_u32 s94, 0
  s_cselect_b32 s15, s82, s7
  s_lshl_b32 s15, s15, 15
  buffer_load_dwordx4 v253, s[28:31], s4 offen offset:3072 sc1 lds
  s_sub_u32 s14, 15, s82
  s_min_u32 s14, s14, s82
  s_add_u32 m0, m0, 4096
  s_add_u32 s4, s4, 4096
  buffer_load_dwordx4 v253, s[28:31], s4 offen offset:0 sc1 lds
  buffer_load_dwordx4 v253, s[28:31], s4 offen offset:1024 sc1 lds
  s_lshl_b32 s14, s14, 3
  s_lshl_b64 s[8:9], 0xff, s14
  v_and_b32 v173, 16, v254
  v_cmp_ne_u32 vcc, 0, v173
  s_waitcnt lgkmcnt(0)
  v_cvt_pk_bf16_f32 v64, v128, v129
  buffer_load_dwordx4 v253, s[28:31], s4 offen offset:2048 sc1 lds
  s_lshr_b32 s14, s82, 3
  s_lshl_b32 s6, s14, 5
  v_cvt_pk_bf16_f32 v65, v130, v131
  v_cvt_pk_bf16_f32 v66, v132, v133
  v_cvt_pk_bf16_f32 v67, v134, v135
  v_cvt_pk_bf16_f32 v68, v136, v137
  v_cvt_pk_bf16_f32 v69, v138, v139
  v_cvt_pk_bf16_f32 v70, v140, v141
  buffer_load_dwordx4 v253, s[28:31], s4 offen offset:3072 sc1 lds
  s_lshl_b32 s14, s82, 15
  s_add_u32 s4, s73, s14
  v_cvt_pk_bf16_f32 v71, v142, v143
  v_cndmask_b32 v128, v64, 0, vcc
  v_cndmask_b32 v129, v65, 0, vcc
  v_cndmask_b32 v130, v66, 0, vcc
  v_cndmask_b32 v131, v67, 0, vcc
  v_cndmask_b32 v132, v68, 0, vcc
  s_setprio 2
  s_mov_b32 m0, s76
  s_xor_b32 s75, s75, 0x8000
  buffer_load_dwordx4 v253, s[28:31], s5 offen offset:0 sc1 lds
  v_cndmask_b32 v133, v69, 0, vcc
  v_cndmask_b32 v134, v70, 0, vcc
  v_cndmask_b32 v135, v71, 0, vcc
  v_cndmask_b32 v136, 0, v64, vcc
  v_cndmask_b32 v137, 0, v65, vcc
  v_cndmask_b32 v138, 0, v66, vcc
  v_cndmask_b32 v139, 0, v67, vcc
  buffer_load_dwordx4 v253, s[28:31], s5 offen offset:1024 sc1 lds
  s_xor_b32 s76, s76, 0x38000
  v_cndmask_b32 v140, 0, v68, vcc
  v_cndmask_b32 v141, 0, v69, vcc
  v_cndmask_b32 v142, 0, v70, vcc
  v_cndmask_b32 v143, 0, v71, vcc
  s_nop 1
  v_mfma_f32_32x32x16_bf16 v[64:79], v[132:135], v[208:211], 0
  buffer_load_dwordx4 v253, s[28:31], s5 offen offset:2048 sc1 lds
  s_and_b32 s17, s12, 15
  s_and_b32 s14, s10, 8
  s_lshl_b32 s14, s14, 1
  s_or_b32 s17, s17, s14
  v_mfma_f32_32x32x16_bf16 v[64:79], v[140:143], v[212:215], v[64:79]
  s_lshl_b32 s52, s98, 2
  s_add_u32 s52, s52, s94
  s_mul_i32 s52, s52, 288
  s_lshl_b32 s53, s95, 1
  s_add_u32 s52, s52, s53
  buffer_load_dwordx4 v253, s[28:31], s5 offen offset:3072 sc1 lds
  s_lshr_b64 s[10:11], s[10:11], 4
  s_lshr_b64 s[12:13], s[12:13], 4
  s_and_b32 s85, s10, 7
  s_add_u32 s52, s52, 256
  s_lshl_b32 s52, s52, 10
  s_add_u32 s52, s52, 33554432
  s_nop 7
  v_add_f32 v173, 0x358637bd, v64
  v_add_f32 v174, 0x358637bd, v72
  v_mfma_f32_32x32x16_bf16 v[64:79], v[128:131], v[208:211], 0
  s_add_u32 m0, m0, 4096
  s_add_u32 s5, s5, 4096
  buffer_load_dwordx4 v253, s[28:31], s5 offen offset:0 sc1 lds
  v_mfma_f32_32x32x16_bf16 v[64:79], v[136:139], v[212:215], v[64:79]
  v_rcp_f32 v173, v173
  v_rcp_f32 v174, v174
  v_sub_f32 v249, 2.0, v249
  v_mul_f32 v173, v173, v249
  v_mul_f32 v174, v174, v249
  buffer_load_dwordx4 v253, s[28:31], s5 offen offset:1024 sc1 lds
  s_nop 8
  v_mul_f32 v64, v64, v173
  v_mul_f32 v65, v65, v173
  v_mul_f32 v66, v66, v173
  v_mul_f32 v67, v67, v173
  v_mul_f32 v68, v68, v173
  buffer_load_dwordx4 v253, s[28:31], s5 offen offset:2048 sc1 lds
  v_mul_f32 v69, v69, v173
  v_mul_f32 v70, v70, v173
  v_mul_f32 v71, v71, v173
  v_mul_f32 v72, v72, v174
  v_mul_f32 v73, v73, v174
  v_mul_f32 v74, v74, v174
  v_mul_f32 v75, v75, v174
  buffer_load_dwordx4 v253, s[28:31], s5 offen offset:3072 sc1 lds
  s_add_u32 s5, s74, s15
  v_mul_f32 v76, v76, v174
  v_mul_f32 v77, v77, v174
  v_mul_f32 v78, v78, v174
  v_mul_f32 v79, v79, v174
  v_cvt_pk_bf16_f32 v128, v64, v65
  v_cvt_pk_bf16_f32 v129, v66, v67
  buffer_load_dword v250, v248, s[28:31], s6 offen sc1
  v_cvt_pk_bf16_f32 v130, v68, v69
  v_cvt_pk_bf16_f32 v131, v70, v71
  v_cvt_pk_bf16_f32 v132, v72, v73
  v_cvt_pk_bf16_f32 v133, v74, v75
  v_cvt_pk_bf16_f32 v134, v76, v77
  v_cvt_pk_bf16_f32 v135, v78, v79
  buffer_store_dwordx4 v[128:131], v253, s[28:31], s52 offen offset:0 sc1
  buffer_store_dwordx4 v[132:135], v253, s[28:31], s52 offen offset:1024 sc1
  s_mov_b32 s64, 2
  s_waitcnt vmcnt(19)
  s_branch L_post
L_j1:
  v_lshrrev_b32 v173, 2, v254
  v_lshlrev_b32 v174, 12, v173
  v_lshlrev_b32 v173, 7, v173
  v_and_b32 v175, 3, v254
  v_lshl_add_u32 v173, v175, 2, v173
  s_lshl_b32 s61, s95, 11
  s_add_u32 s61, s61, 60817424
  buffer_load_dword v252, v173, s[28:31], s61 offen sc1
L_ndb_134:
  v_cmp_ne_u32 vcc, 1, v250
  s_mov_b32 m0, s75
  s_nop 0
  s_and_b64 s[62:63], vcc, s[8:9]
  s_cbranch_scc0 L_ndokb_135
  s_sleep 1
  buffer_load_dword v250, v248, s[28:31], s6 offen sc1
  s_waitcnt vmcnt(0)
  s_sub_u32 s99, s99, 1
  s_cbranch_scc0 L_ndb_134
  s_mov_b32 s99, 0
L_ndokb_135:
  buffer_load_dwordx4 v253, s[28:31], s4 offen offset:0 sc1 lds
  v_lshl_add_u32 v174, v175, 4, v174
  s_and_b32 s52, s96, 15
  s_lshl_b32 s52, s52, 2
  s_add_u32 s52, s52, s94
  buffer_load_dwordx4 v253, s[28:31], s4 offen offset:1024 sc1 lds
  s_mov_b32 s7, s82
  s_cmp_ge_u32 s77, s91
  s_addc_u32 s82, s77, 0
  s_lshl_b32 s52, s52, 6
  s_add_u32 s52, s52, 54525952
  s_lshl_b32 s53, s95, 18
  s_add_u32 s52, s52, s53
  buffer_load_dwordx4 v253, s[28:31], s4 offen offset:2048 sc1 lds
  s_cmp_lg_u32 s94, 0
  s_cselect_b32 s15, s82, s7
  s_lshl_b32 s15, s15, 15
  s_lshl_b32 s54, s94, 12
  s_lshl_b32 s55, s94, 11
  s_add_u32 s55, s55, 65536
  v_add_u32 v175, s55, v253
  buffer_load_dwordx4 v253, s[28:31], s4 offen offset:3072 sc1 lds
  s_sub_u32 s14, 15, s82
  s_min_u32 s14, s14, s82
  ds_read_b128 v[208:211], v175 offset:0
  s_waitcnt lgkmcnt(0)
  v_lshlrev_b32 v64, 16, v208
  v_and_b32 v65, 0xffff0000, v208
  s_add_u32 m0, m0, 4096
  s_add_u32 s4, s4, 4096
  buffer_load_dwordx4 v253, s[28:31], s4 offen offset:0 sc1 lds
  v_lshlrev_b32 v66, 16, v209
  v_and_b32 v67, 0xffff0000, v209
  v_lshlrev_b32 v68, 16, v210
  v_and_b32 v69, 0xffff0000, v210
  buffer_load_dwordx4 v253, s[28:31], s4 offen offset:1024 sc1 lds
  s_lshl_b32 s14, s14, 3
  s_lshl_b64 s[8:9], 0xff, s14
  v_lshlrev_b32 v70, 16, v211
  v_and_b32 v71, 0xffff0000, v211
  v_mul_f32 v72, s20, v64
  v_mul_f32 v73, s20, v65
  buffer_load_dwordx4 v253, s[28:31], s4 offen offset:2048 sc1 lds
  s_lshr_b32 s14, s82, 3
  s_lshl_b32 s6, s14, 5
  v_mul_f32 v74, s20, v66
  v_mul_f32 v75, s20, v67
  v_mul_f32 v76, s20, v68
  v_mul_f32 v77, s20, v69
  buffer_load_dwordx4 v253, s[28:31], s4 offen offset:3072 sc1 lds
  s_lshl_b32 s14, s82, 15
  s_add_u32 s4, s73, s14
  v_mul_f32 v78, s20, v70
  v_mul_f32 v79, s20, v71
  v_exp_f32_e64 v72, v72 clamp
  v_max_f32 v64, 0, v64
  s_mov_b32 m0, s76
  s_xor_b32 s75, s75, 0x8000
  buffer_load_dwordx4 v253, s[28:31], s5 offen offset:0 sc1 lds
  v_exp_f32_e64 v73, v73 clamp
  v_max_f32 v65, 0, v65
  v_exp_f32_e64 v74, v74 clamp
  v_max_f32 v66, 0, v66
  buffer_load_dwordx4 v253, s[28:31], s5 offen offset:1024 sc1 lds
  s_xor_b32 s76, s76, 0x38000
  v_exp_f32_e64 v75, v75 clamp
  v_max_f32 v67, 0, v67
  v_exp_f32_e64 v76, v76 clamp
  v_max_f32 v68, 0, v68
  buffer_load_dwordx4 v253, s[28:31], s5 offen offset:2048 sc1 lds
  s_and_b32 s17, s12, 15
  s_and_b32 s14, s10, 8
  s_lshl_b32 s14, s14, 1
  s_or_b32 s17, s17, s14
  v_exp_f32_e64 v77, v77 clamp
  v_max_f32 v69, 0, v69
  v_exp_f32_e64 v78, v78 clamp
  v_max_f32 v70, 0, v70
  buffer_load_dwordx4 v253, s[28:31], s5 offen offset:3072 sc1 lds
  s_lshr_b64 s[10:11], s[10:11], 4
  s_lshr_b64 s[12:13], s[12:13], 4
  s_and_b32 s85, s10, 7
  v_exp_f32_e64 v79, v79 clamp
  v_max_f32 v71, 0, v71
  v_add_f32 v64, s22, v64
  v_add_f32 v65, s22, v65
  s_add_u32 m0, m0, 4096
  s_add_u32 s5, s5, 4096
  buffer_load_dwordx4 v253, s[28:31], s5 offen offset:0 sc1 lds
  v_add_f32 v66, s22, v66
  v_add_f32 v67, s22, v67
  v_add_f32 v68, s22, v68
  v_add_f32 v69, s22, v69
  buffer_load_dwordx4 v253, s[28:31], s5 offen offset:1024 sc1 lds
  v_add_f32 v70, s22, v70
  v_add_f32 v71, s22, v71
  v_add_f32 v64, v64, v72
  v_add_f32 v65, v65, v73
  buffer_load_dwordx4 v253, s[28:31], s5 offen offset:2048 sc1 lds
  v_add_f32 v66, v66, v74
  v_add_f32 v67, v67, v75
  v_add_f32 v68, v68, v76
  v_add_f32 v69, v69, v77
  buffer_load_dwordx4 v253, s[28:31], s5 offen offset:3072 sc1 lds
  s_add_u32 s5, s74, s15
  v_add_f32 v70, v70, v78
  v_add_f32 v71, v71, v79
  v_cvt_pk_bf16_f32 v208, v64, v65
  v_cvt_pk_bf16_f32 v209, v66, v67
  buffer_load_dword v250, v248, s[28:31], s6 offen sc1
  v_cvt_pk_bf16_f32 v210, v68, v69
  v_cvt_pk_bf16_f32 v211, v70, v71
  ds_write_b128 v175, v[208:211] offset:0
  s_waitcnt vmcnt(17)
  v_cmp_ne_u32 vcc, 1, v252
  s_nop 1
  s_cbranch_vccz L_jok_136
L_pollfb_137:
  buffer_load_dword v252, v173, s[28:31], s61 offen sc1
  s_waitcnt vmcnt(0)
  v_cmp_ne_u32 vcc, 1, v252
  s_nop 1
  s_cbranch_vccz L_pdonefb_138
  s_sleep 4
  s_sub_u32 s99, s99, 1
  s_cbranch_scc0 L_pollfb_137
  s_mov_b32 s99, 0
L_pdonefb_138:
L_jok_136:
  s_add_u32 m0, s54, 73728
  s_mov_b32 s64, 4
  s_add_u32 s53, s52, 0
  buffer_load_dwordx4 v174, s[28:31], s53 offen offset:0 sc1 lds
  s_add_u32 s53, s52, 64512
  buffer_load_dwordx4 v174, s[28:31], s53 offen offset:1024 sc1 lds
  s_add_u32 s53, s52, 129024
  buffer_load_dwordx4 v174, s[28:31], s53 offen offset:2048 sc1 lds
  s_add_u32 s53, s52, 193536
  buffer_load_dwordx4 v174, s[28:31], s53 offen offset:3072 sc1 lds
  s_waitcnt lgkmcnt(0)
  s_branch L_post
L_j3:
  v_lshrrev_b32 v173, 2, v254
  v_lshlrev_b32 v174, 12, v173
  v_lshlrev_b32 v173, 7, v173
  v_and_b32 v175, 3, v254
  v_lshl_add_u32 v173, v175, 2, v173
  s_lshl_b32 s61, s95, 11
  s_add_u32 s61, s61, 60817488
  buffer_load_dword v252, v173, s[28:31], s61 offen sc1
L_ndc_139:
  v_cmp_ne_u32 vcc, 1, v250
  s_mov_b32 m0, s75
  s_nop 0
  s_and_b64 s[62:63], vcc, s[8:9]
  s_cbranch_scc0 L_ndokc_140
  s_sleep 1
  buffer_load_dword v250, v248, s[28:31], s6 offen sc1
  s_waitcnt vmcnt(0)
  s_sub_u32 s99, s99, 1
  s_cbranch_scc0 L_ndc_139
  s_mov_b32 s99, 0
L_ndokc_140:
  buffer_load_dwordx4 v253, s[28:31], s4 offen offset:0 sc1 lds
  s_lshl_b32 s55, s94, 11
  s_add_u32 s55, s55, 65536
  v_add_u32 v175, s55, v253
  ds_read_b128 v[208:211], v175 offset:1024
  buffer_load_dwordx4 v253, s[28:31], s4 offen offset:1024 sc1 lds
  s_mov_b32 s7, s82
  s_cmp_ge_u32 s77, s91
  s_addc_u32 s82, s77, 0
  s_waitcnt lgkmcnt(0)
  v_lshlrev_b32 v64, 16, v208
  v_and_b32 v65, 0xffff0000, v208
  v_lshlrev_b32 v66, 16, v209
  buffer_load_dwordx4 v253, s[28:31], s4 offen offset:2048 sc1 lds
  s_cmp_lg_u32 s94, 0
  s_cselect_b32 s15, s82, s7
  s_lshl_b32 s15, s15, 15
  v_and_b32 v67, 0xffff0000, v209
  v_lshlrev_b32 v68, 16, v210
  v_and_b32 v69, 0xffff0000, v210
  buffer_load_dwordx4 v253, s[28:31], s4 offen offset:3072 sc1 lds
  s_sub_u32 s14, 15, s82
  s_min_u32 s14, s14, s82
  v_lshlrev_b32 v70, 16, v211
  v_and_b32 v71, 0xffff0000, v211
  v_mul_f32 v72, s20, v64
  v_mul_f32 v73, s20, v65
  s_add_u32 m0, m0, 4096
  s_add_u32 s4, s4, 4096
  buffer_load_dwordx4 v253, s[28:31], s4 offen offset:0 sc1 lds
  v_mul_f32 v74, s20, v66
  v_mul_f32 v75, s20, v67
  v_mul_f32 v76, s20, v68
  v_mul_f32 v77, s20, v69
  buffer_load_dwordx4 v253, s[28:31], s4 offen offset:1024 sc1 lds
  s_lshl_b32 s14, s14, 3
  s_lshl_b64 s[8:9], 0xff, s14
  v_mul_f32 v78, s20, v70
  v_mul_f32 v79, s20, v71
  v_exp_f32_e64 v72, v72 clamp
  buffer_load_dwordx4 v253, s[28:31], s4 offen offset:2048 sc1 lds
  s_lshr_b32 s14, s82, 3
  s_lshl_b32 s6, s14, 5
  v_max_f32 v64, 0, v64
  v_exp_f32_e64 v73, v73 clamp
  v_max_f32 v65, 0, v65
  v_exp_f32_e64 v74, v74 clamp
  buffer_load_dwordx4 v253, s[28:31], s4 offen offset:3072 sc1 lds
  s_lshl_b32 s14, s82, 15
  s_add_u32 s4, s73, s14
  v_max_f32 v66, 0, v66
  v_exp_f32_e64 v75, v75 clamp
  v_max_f32 v67, 0, v67
  v_exp_f32_e64 v76, v76 clamp
  s_mov_b32 m0, s76
  s_xor_b32 s75, s75, 0x8000
  buffer_load_dwordx4 v253, s[28:31], s5 offen offset:0 sc1 lds
  v_max_f32 v68, 0, v68
  v_exp_f32_e64 v77, v77 clamp
  v_max_f32 v69, 0, v69
  buffer_load_dwordx4 v253, s[28:31], s5 offen offset:1024 sc1 lds
  s_xor_b32 s76, s76, 0x38000
  v_exp_f32_e64 v78, v78 clamp
  v_max_f32 v70, 0, v70
  v_exp_f32_e64 v79, v79 clamp
  v_max_f32 v71, 0, v71
  buffer_load_dwordx4 v253, s[28:31], s5 offen offset:2048 sc1 lds
  s_and_b32 s17, s12, 15
  s_and_b32 s14, s10, 8
  s_lshl_b32 s14, s14, 1
  s_or_b32 s17, s17, s14
  v_add_f32 v64, s22, v64
  v_add_f32 v65, s22, v65
  v_add_f32 v66, s22, v66
  v_add_f32 v67, s22, v67
  buffer_load_dwordx4 v253, s[28:31], s5 offen offset:3072 sc1 lds
  s_lshr_b64 s[10:11], s[10:11], 4
  s_lshr_b64 s[12:13], s[12:13], 4
  s_and_b32 s85, s10, 7
  v_add_f32 v68, s22, v68
  v_add_f32 v69, s22, v69
  v_add_f32 v70, s22, v70
  s_add_u32 m0, m0, 4096
  s_add_u32 s5, s5, 4096
  buffer_load_dwordx4 v253, s[28:31], s5 offen offset:0 sc1 lds
  v_add_f32 v71, s22, v71
  v_add_f32 v64, v64, v72
  v_add_f32 v65, v65, v73
  v_add_f32 v66, v66, v74
  buffer_load_dwordx4 v253, s[28:31], s5 offen offset:1024 sc1 lds
  v_add_f32 v67, v67, v75
  v_add_f32 v68, v68, v76
  v_add_f32 v69, v69, v77
  v_add_f32 v70, v70, v78
  buffer_load_dwordx4 v253, s[28:31], s5 offen offset:2048 sc1 lds
  v_add_f32 v71, v71, v79
  v_cvt_pk_bf16_f32 v208, v64, v65
  v_cvt_pk_bf16_f32 v209, v66, v67
  buffer_load_dwordx4 v253, s[28:31], s5 offen offset:3072 sc1 lds
  s_add_u32 s5, s74, s15
  v_cvt_pk_bf16_f32 v210, v68, v69
  v_cvt_pk_bf16_f32 v211, v70, v71
  ds_write_b128 v175, v[208:211] offset:1024
  s_lshl_b32 s53, s94, 10
  buffer_load_dword v250, v248, s[28:31], s6 offen sc1
  s_lshl_b32 s52, s95, 12
  s_add_u32 s52, s52, s53
  s_add_u32 s52, s52, 58720256
  s_waitcnt vmcnt(17)
  v_cmp_ne_u32 vcc, 1, v252
  s_nop 1
  s_cbranch_vccz L_jok_141
L_pollfk_142:
  buffer_load_dword v252, v173, s[28:31], s61 offen sc1
  s_waitcnt vmcnt(0)
  v_cmp_ne_u32 vcc, 1, v252
  s_nop 1
  s_cbranch_vccz L_pdonefk_143
  s_sleep 4
  s_sub_u32 s99, s99, 1
  s_cbranch_scc0 L_pollfk_142
  s_mov_b32 s99, 0
L_pdonefk_143:
L_jok_141:
  s_add_u32 m0, s53, 73728
  s_mov_b32 s64, 0
  buffer_load_dwordx4 v253, s[28:31], s52 offen sc1 lds
  s_waitcnt lgkmcnt(0)
  s_branch L_post
L_j2:
L_nde_144:
  v_cmp_ne_u32 vcc, 1, v250
  s_mov_b32 m0, s75
  s_nop 0
  s_and_b64 s[62:63], vcc, s[8:9]
  s_cbranch_scc0 L_ndoke_145
  s_sleep 1
  buffer_load_dword v250, v248, s[28:31], s6 offen sc1
  s_waitcnt vmcnt(0)
  s_sub_u32 s99, s99, 1
  s_cbranch_scc0 L_nde_144
  s_mov_b32 s99, 0
L_ndoke_145:
  buffer_load_dwordx4 v253, s[28:31], s4 offen offset:0 sc1 lds
  s_lshl_b32 s52, s94, 12
  s_add_u32 s52, s52, 73728
  v_add_u32 v174, s52, v253
  v_and_b32 v175, 3, v254
  buffer_load_dwordx4 v253, s[28:31], s4 offen offset:1024 sc1 lds
  s_mov_b32 s7, s82
  s_cmp_ge_u32 s77, s91
  s_addc_u32 s82, s77, 0
  v_lshlrev_b32 v175, 4, v175
  s_and_b32 s52, s96, 15
  s_lshl_b32 s52, s52, 2
  s_add_u32 s52, s52, s94
  buffer_load_dwordx4 v253, s[28:31], s4 offen offset:2048 sc1 lds
  s_cmp_lg_u32 s94, 0
  s_cselect_b32 s15, s82, s7
  s_lshl_b32 s15, s15, 15
  s_lshl_b32 s52, s52, 6
  s_add_u32 s52, s52, 58720256
  s_lshl_b32 s53, s95, 12
  buffer_load_dwordx4 v253, s[28:31], s4 offen offset:3072 sc1 lds
  s_sub_u32 s14, 15, s82
  s_min_u32 s14, s14, s82
  s_add_u32 s52, s52, s53
  s_waitcnt vmcnt(4)
  ds_read_b128 v[128:131], v174 offset:0
  ds_read_b128 v[132:135], v174 offset:1024
  ds_read_b128 v[136:139], v174 offset:2048
  s_add_u32 m0, m0, 4096
  s_add_u32 s4, s4, 4096
  buffer_load_dwordx4 v253, s[28:31], s4 offen offset:0 sc1 lds
  ds_read_b128 v[140:143], v174 offset:3072
  s_waitcnt lgkmcnt(0)
  v_add_f32 v128, v128, v132
  buffer_load_dwordx4 v253, s[28:31], s4 offen offset:1024 sc1 lds
  s_lshl_b32 s14, s14, 3
  s_lshl_b64 s[8:9], 0xff, s14
  v_add_f32 v136, v136, v140
  v_add_f32 v129, v129, v133
  v_add_f32 v137, v137, v141
  v_add_f32 v130, v130, v134
  buffer_load_dwordx4 v253, s[28:31], s4 offen offset:2048 sc1 lds
  s_lshr_b32 s14, s82, 3
  s_lshl_b32 s6, s14, 5
  v_add_f32 v138, v138, v142
  v_add_f32 v131, v131, v135
  v_add_f32 v139, v139, v143
  v_add_f32 v128, v128, v136
  buffer_load_dwordx4 v253, s[28:31], s4 offen offset:3072 sc1 lds
  s_lshl_b32 s14, s82, 15
  s_add_u32 s4, s73, s14
  v_add_f32 v129, v129, v137
  v_add_f32 v130, v130, v138
  v_add_f32 v131, v131, v139
  s_mov_b32 m0, s76
  s_xor_b32 s75, s75, 0x8000
  buffer_load_dwordx4 v253, s[28:31], s5 offen offset:0 sc1 lds
  v_add_f32_dpp v128, v128, v128 row_shr:4 row_mask:0xf bank_mask:0xf bound_ctrl:0
  v_add_f32_dpp v129, v129, v129 row_shr:4 row_mask:0xf bank_mask:0xf bound_ctrl:0
  v_add_f32_dpp v130, v130, v130 row_shr:4 row_mask:0xf bank_mask:0xf bound_ctrl:0
  v_add_f32_dpp v131, v131, v131 row_shr:4 row_mask:0xf bank_mask:0xf bound_ctrl:0
  buffer_load_dwordx4 v253, s[28:31], s5 offen offset:1024 sc1 lds
  s_xor_b32 s76, s76, 0x38000
  v_add_f32_dpp v128, v128, v128 row_shr:8 row_mask:0xf bank_mask:0xf bound_ctrl:0
  v_add_f32_dpp v129, v129, v129 row_shr:8 row_mask:0xf bank_mask:0xf bound_ctrl:0
  v_add_f32_dpp v130, v130, v130 row_shr:8 row_mask:0xf bank_mask:0xf bound_ctrl:0
  buffer_load_dwordx4 v253, s[28:31], s5 offen offset:2048 sc1 lds
  s_and_b32 s17, s12, 15
  s_and_b32 s14, s10, 8
  s_lshl_b32 s14, s14, 1
  s_or_b32 s17, s17, s14
  v_add_f32_dpp v131, v131, v131 row_shr:8 row_mask:0xf bank_mask:0xf bound_ctrl:0
  v_mov_b32 v132, v128
  v_mov_b32 v133, v129
  v_mov_b32 v134, v130
  buffer_load_dwordx4 v253, s[28:31], s5 offen offset:3072 sc1 lds
  s_lshr_b64 s[10:11], s[10:11], 4
  s_lshr_b64 s[12:13], s[12:13], 4
  s_and_b32 s85, s10, 7
  v_mov_b32 v135, v131
  v_permlane16_swap_b32 v128, v132
  v_permlane16_swap_b32 v129, v133
  v_permlane16_swap_b32 v130, v134
  s_add_u32 m0, m0, 4096
  s_add_u32 s5, s5, 4096
  buffer_load_dwordx4 v253, s[28:31], s5 offen offset:0 sc1 lds
  v_permlane16_swap_b32 v131, v135
  v_add_f32 v128, v128, v132
  v_add_f32 v129, v129, v133
  buffer_load_dwordx4 v253, s[28:31], s5 offen offset:1024 sc1 lds
  v_add_f32 v130, v130, v134
  v_add_f32 v131, v131, v135
  v_mov_b32 v132, v128
  v_mov_b32 v133, v129
  buffer_load_dwordx4 v253, s[28:31], s5 offen offset:2048 sc1 lds
  v_mov_b32 v134, v130
  v_mov_b32 v135, v131
  v_permlane32_swap_b32 v128, v132
  buffer_load_dwordx4 v253, s[28:31], s5 offen offset:3072 sc1 lds
  s_add_u32 s5, s74, s15
  v_permlane32_swap_b32 v129, v133
  v_permlane32_swap_b32 v130, v134
  v_permlane32_swap_b32 v131, v135
  v_add_f32 v128, v128, v132
  buffer_load_dword v250, v248, s[28:31], s6 offen sc1
  v_add_f32 v129, v129, v133
  v_add_f32 v130, v130, v134
  v_add_f32 v131, v131, v135
  s_mov_b64 exec, 0xf000
  buffer_store_dwordx4 v[128:131], v175, s[28:31], s52 offen sc1
  s_mov_b64 exec, -1
  s_mov_b32 s64, 1
  s_branch L_post
L_j5:
L_ndf_146:
  v_cmp_ne_u32 vcc, 1, v250
  s_mov_b32 m0, s75
  s_nop 0
  s_and_b64 s[62:63], vcc, s[8:9]
  s_cbranch_scc0 L_ndokf_147
  s_sleep 1
  buffer_load_dword v250, v248, s[28:31], s6 offen sc1
  s_waitcnt vmcnt(0)
  s_sub_u32 s99, s99, 1
  s_cbranch_scc0 L_ndf_146
  s_mov_b32 s99, 0
L_ndokf_147:
  buffer_load_dwordx4 v253, s[28:31], s4 offen offset:0 sc1 lds
  v_lshrrev_b32 v173, 5, v254
  v_bfe_u32 v174, v254, 2, 2
  v_lshl_add_u32 v173, v173, 2, v174
  v_lshlrev_b32 v173, 7, v173
  buffer_load_dwordx4 v253, s[28:31], s4 offen offset:1024 sc1 lds
  s_mov_b32 s7, s82
  s_cmp_ge_u32 s77, s91
  s_addc_u32 s82, s77, 0
  v_bfe_u32 v175, v254, 4, 1
  v_lshl_add_u32 v173, v175, 5, v173
  v_and_b32 v175, 3, v254
  v_lshl_add_u32 v173, v175, 3, v173
  buffer_load_dwordx4 v253, s[28:31], s4 offen offset:2048 sc1 lds
  s_cmp_lg_u32 s94, 0
  s_cselect_b32 s15, s82, s7
  s_lshl_b32 s15, s15, 15
  v_lshrrev_b32 v174, 1, v174
  v_lshl_add_u32 v173, v174, 6, v173
  s_lshl_b32 s52, s94, 12
  buffer_load_dwordx4 v253, s[28:31], s4 offen offset:3072 sc1 lds
  s_sub_u32 s14, 15, s82
  s_min_u32 s14, s14, s82
  s_add_u32 s52, s52, 73728
  v_add_u32 v173, s52, v173
  v_xor_b32 v174, 64, v173
  s_bfe_u32 s52, s90, 0x10002
  s_add_u32 m0, m0, 4096
  s_add_u32 s4, s4, 4096
  buffer_load_dwordx4 v253, s[28:31], s4 offen offset:0 sc1 lds
  s_lshl_b32 s52, s52, 1
  s_and_b32 s53, s91, 1
  s_add_u32 s52, s52, s53
  buffer_load_dwordx4 v253, s[28:31], s4 offen offset:1024 sc1 lds
  s_lshl_b32 s14, s14, 3
  s_lshl_b64 s[8:9], 0xff, s14
  s_mul_i32 s52, s52, 72
  s_lshr_b32 s53, s91, 1
  s_mul_i32 s53, s53, 3
  s_add_u32 s52, s52, s53
  buffer_load_dwordx4 v253, s[28:31], s4 offen offset:2048 sc1 lds
  s_lshr_b32 s14, s82, 3
  s_lshl_b32 s6, s14, 5
  s_lshl_b32 s52, s52, 10
  s_add_u32 s52, s52, s1
  s_lshl_b32 s55, s94, 3
  s_lshr_b32 s53, 0xc020100, s55
  buffer_load_dwordx4 v253, s[28:31], s4 offen offset:3072 sc1 lds
  s_lshl_b32 s14, s82, 15
  s_add_u32 s4, s73, s14
  s_lshr_b32 s54, 0x19180e0d, s55
  s_and_b32 s53, s53, 0xff
  s_lshl_b32 s53, s53, 10
  s_mov_b32 m0, s76
  s_xor_b32 s75, s75, 0x8000
  buffer_load_dwordx4 v253, s[28:31], s5 offen offset:0 sc1 lds
  s_add_u32 s53, s53, s52
  s_and_b32 s54, s54, 0xff
  s_lshl_b32 s54, s54, 10
  s_add_u32 s54, s54, s52
  buffer_load_dwordx4 v253, s[28:31], s5 offen offset:1024 sc1 lds
  s_xor_b32 s76, s76, 0x38000
  s_add_u32 s55, s52, 26624
  s_lshr_b32 s56, s53, 1
  s_and_b32 s56, s56, 512
  buffer_load_dwordx4 v253, s[28:31], s5 offen offset:2048 sc1 lds
  s_and_b32 s17, s12, 15
  s_and_b32 s14, s10, 8
  s_lshl_b32 s14, s14, 1
  s_or_b32 s17, s17, s14
  s_sub_u32 s53, s53, s56
  s_lshr_b32 s56, s54, 1
  s_and_b32 s56, s56, 512
  s_sub_u32 s54, s54, s56
  buffer_load_dwordx4 v253, s[28:31], s5 offen offset:3072 sc1 lds
  s_lshr_b64 s[10:11], s[10:11], 4
  s_lshr_b64 s[12:13], s[12:13], 4
  s_and_b32 s85, s10, 7
  s_lshr_b32 s56, s55, 1
  s_and_b32 s56, s56, 512
  s_sub_u32 s55, s55, s56
  v_and_b32 v175, 15, v254
  s_add_u32 m0, m0, 4096
  s_add_u32 s5, s5, 4096
  buffer_load_dwordx4 v253, s[28:31], s5 offen offset:0 sc1 lds
  v_lshlrev_b32 v175, 4, v175
  v_lshrrev_b32 v136, 5, v254
  v_lshl_add_u32 v175, v136, 8, v175
  buffer_load_dwordx4 v253, s[28:31], s5 offen offset:1024 sc1 lds
  v_bfe_u32 v136, v254, 4, 1
  v_lshl_add_u32 v175, v136, 10, v175
  s_waitcnt vmcnt(14)
  ds_read_b64_tr_b16 v[64:65], v173 offset:0
  ds_read_b64_tr_b16 v[66:67], v173 offset:1024
  buffer_load_dwordx4 v253, s[28:31], s5 offen offset:2048 sc1 lds
  ds_read_b64_tr_b16 v[68:69], v174 offset:0
  ds_read_b64_tr_b16 v[70:71], v174 offset:1024
  ds_read_b64_tr_b16 v[72:73], v173 offset:2048
  buffer_load_dwordx4 v253, s[28:31], s5 offen offset:3072 sc1 lds
  s_add_u32 s5, s74, s15
  ds_read_b64_tr_b16 v[74:75], v173 offset:3072
  ds_read_b64_tr_b16 v[76:77], v174 offset:2048
  ds_read_b64_tr_b16 v[78:79], v174 offset:3072
  ds_read_b64_tr_b16 v[128:129], v173 offset:16384
  buffer_load_dword v250, v248, s[28:31], s6 offen sc1
  ds_read_b64_tr_b16 v[130:131], v173 offset:17408
  ds_read_b64_tr_b16 v[132:133], v174 offset:16384
  ds_read_b64_tr_b16 v[134:135], v174 offset:17408
  s_mov_b32 s64, 4
  s_waitcnt lgkmcnt(0)
  buffer_store_dwordx4 v[64:67], v175, s[28:31], s53 offen sc1
  s_add_u32 s53, s53, 36864
  buffer_store_dwordx4 v[68:71], v175, s[28:31], s53 offen sc1
  buffer_store_dwordx4 v[72:75], v175, s[28:31], s54 offen sc1
  s_add_u32 s54, s54, 36864
  buffer_store_dwordx4 v[76:79], v175, s[28:31], s54 offen sc1
  s_cmp_lg_u32 s94, 0
  s_cbranch_scc1 L_post
  s_mov_b32 s64, 6
  buffer_store_dwordx4 v[128:131], v175, s[28:31], s55 offen sc1
  s_add_u32 s55, s55, 36864
  buffer_store_dwordx4 v[132:135], v175, s[28:31], s55 offen sc1
  s_branch L_post
L_j8:
L_ndi_148:
  v_cmp_ne_u32 vcc, 1, v250
  s_mov_b32 m0, s75
  s_nop 0
  s_and_b64 s[62:63], vcc, s[8:9]
  s_cbranch_scc0 L_ndoki_149
  s_sleep 1
  buffer_load_dword v250, v248, s[28:31], s6 offen sc1
  s_waitcnt vmcnt(0)
  s_sub_u32 s99, s99, 1
  s_cbranch_scc0 L_ndi_148
  s_mov_b32 s99, 0
L_ndoki_149:
  s_cmp_eq_u32 s94, 0
  s_cbranch_scc1 L_idle0
  buffer_load_dwordx4 v253, s[28:31], s4 offen offset:0 sc1 lds
  s_lshl_b32 s52, s94, 12
  s_add_u32 s52, s52, 73728
  v_add_u32 v175, s52, v253
  ds_read_b128 v[208:211], v175 offset:0
  ds_read_b128 v[212:215], v175 offset:1024
  ds_read_b128 v[128:131], v175 offset:2048
  ds_read_b128 v[132:135], v175 offset:3072
  v_mov_b32 v136, 0x3f803f80
  buffer_load_dwordx4 v253, s[28:31], s4 offen offset:1024 sc1 lds
  s_mov_b32 s7, s82
  s_cmp_ge_u32 s77, s91
  s_addc_u32 s82, s77, 0
  v_mov_b32 v137, 0x3f803f80
  v_mov_b32 v138, 0x3f803f80
  v_mov_b32 v139, 0x3f803f80
  s_lshl_b32 s52, s96, 2
  s_add_u32 s52, s52, s94
  s_lshl_b32 s52, s52, 12
  s_add_u32 s52, s52, 54525952
  buffer_load_dwordx4 v253, s[28:31], s4 offen offset:2048 sc1 lds
  s_cmp_lg_u32 s94, 0
  s_cselect_b32 s15, s82, s7
  s_lshl_b32 s15, s15, 15
  s_waitcnt lgkmcnt(0)
  v_lshlrev_b32 v64, 16, v208
  v_and_b32 v65, 0xffff0000, v208
  v_lshlrev_b32 v66, 16, v209
  v_and_b32 v67, 0xffff0000, v209
  v_lshlrev_b32 v68, 16, v210
  v_and_b32 v69, 0xffff0000, v210
  buffer_load_dwordx4 v253, s[28:31], s4 offen offset:3072 sc1 lds
  s_sub_u32 s14, 15, s82
  s_min_u32 s14, s14, s82
  v_lshlrev_b32 v70, 16, v211
  v_and_b32 v71, 0xffff0000, v211
  v_mul_f32 v72, s20, v64
  v_mul_f32 v73, s20, v65
  v_mul_f32 v74, s20, v66
  v_mul_f32 v75, s20, v67
  v_mul_f32 v76, s20, v68
  v_mul_f32 v77, s20, v69
  s_add_u32 m0, m0, 4096
  s_add_u32 s4, s4, 4096
  buffer_load_dwordx4 v253, s[28:31], s4 offen offset:0 sc1 lds
  v_mul_f32 v78, s20, v70
  v_mul_f32 v79, s20, v71
  v_exp_f32_e64 v72, v72 clamp
  v_max_f32 v64, 0, v64
  v_exp_f32_e64 v73, v73 clamp
  v_max_f32 v65, 0, v65
  v_exp_f32_e64 v74, v74 clamp
  buffer_load_dwordx4 v253, s[28:31], s4 offen offset:1024 sc1 lds
  s_lshl_b32 s14, s14, 3
  s_lshl_b64 s[8:9], 0xff, s14
  v_max_f32 v66, 0, v66
  v_exp_f32_e64 v75, v75 clamp
  v_max_f32 v67, 0, v67
  v_exp_f32_e64 v76, v76 clamp
  v_max_f32 v68, 0, v68
  v_exp_f32_e64 v77, v77 clamp
  v_max_f32 v69, 0, v69
  buffer_load_dwordx4 v253, s[28:31], s4 offen offset:2048 sc1 lds
  s_lshr_b32 s14, s82, 3
  s_lshl_b32 s6, s14, 5
  v_exp_f32_e64 v78, v78 clamp
  v_max_f32 v70, 0, v70
  v_exp_f32_e64 v79, v79 clamp
  v_max_f32 v71, 0, v71
  v_add_f32 v64, s22, v64
  v_add_f32 v65, s22, v65
  v_add_f32 v66, s22, v66
  v_add_f32 v67, s22, v67
  buffer_load_dwordx4 v253, s[28:31], s4 offen offset:3072 sc1 lds
  s_lshl_b32 s14, s82, 15
  s_add_u32 s4, s73, s14
  v_add_f32 v68, s22, v68
  v_add_f32 v69, s22, v69
  v_add_f32 v70, s22, v70
  v_add_f32 v71, s22, v71
  v_add_f32 v64, v64, v72
  v_add_f32 v65, v65, v73
  v_add_f32 v66, v66, v74
  s_mov_b32 m0, s76
  s_xor_b32 s75, s75, 0x8000
  buffer_load_dwordx4 v253, s[28:31], s5 offen offset:0 sc1 lds
  v_add_f32 v67, v67, v75
  v_add_f32 v68, v68, v76
  v_add_f32 v69, v69, v77
  v_add_f32 v70, v70, v78
  v_add_f32 v71, v71, v79
  v_cvt_pk_bf16_f32 v208, v64, v65
  v_cvt_pk_bf16_f32 v209, v66, v67
  buffer_load_dwordx4 v253, s[28:31], s5 offen offset:1024 sc1 lds
  s_xor_b32 s76, s76, 0x38000
  v_cvt_pk_bf16_f32 v210, v68, v69
  v_cvt_pk_bf16_f32 v211, v70, v71
  v_lshlrev_b32 v64, 16, v212
  v_and_b32 v65, 0xffff0000, v212
  v_lshlrev_b32 v66, 16, v213
  v_and_b32 v67, 0xffff0000, v213
  v_lshlrev_b32 v68, 16, v214
  buffer_load_dwordx4 v253, s[28:31], s5 offen offset:2048 sc1 lds
  v_and_b32 v69, 0xffff0000, v214
  v_lshlrev_b32 v70, 16, v215
  v_and_b32 v71, 0xffff0000, v215
  v_mul_f32 v72, s20, v64
  v_mul_f32 v73, s20, v65
  v_mul_f32 v74, s20, v66
  v_mul_f32 v75, s20, v67
  v_mul_f32 v76, s20, v68
  buffer_load_dwordx4 v253, s[28:31], s5 offen offset:3072 sc1 lds
  v_mul_f32 v77, s20, v69
  v_mul_f32 v78, s20, v70
  v_mul_f32 v79, s20, v71
  v_exp_f32_e64 v72, v72 clamp
  v_max_f32 v64, 0, v64
  v_exp_f32_e64 v73, v73 clamp
  v_max_f32 v65, 0, v65
  s_add_u32 m0, m0, 4096
  s_add_u32 s5, s5, 4096
  buffer_load_dwordx4 v253, s[28:31], s5 offen offset:0 sc1 lds
  v_exp_f32_e64 v74, v74 clamp
  v_max_f32 v66, 0, v66
  v_exp_f32_e64 v75, v75 clamp
  v_max_f32 v67, 0, v67
  v_exp_f32_e64 v76, v76 clamp
  v_max_f32 v68, 0, v68
  v_exp_f32_e64 v77, v77 clamp
  buffer_load_dwordx4 v253, s[28:31], s5 offen offset:1024 sc1 lds
  v_max_f32 v69, 0, v69
  v_exp_f32_e64 v78, v78 clamp
  v_max_f32 v70, 0, v70
  v_exp_f32_e64 v79, v79 clamp
  v_max_f32 v71, 0, v71
  v_add_f32 v64, s22, v64
  v_add_f32 v65, s22, v65
  v_add_f32 v66, s22, v66
  buffer_load_dwordx4 v253, s[28:31], s5 offen offset:2048 sc1 lds
  v_add_f32 v67, s22, v67
  v_add_f32 v68, s22, v68
  v_add_f32 v69, s22, v69
  v_add_f32 v70, s22, v70
  v_add_f32 v71, s22, v71
  v_add_f32 v64, v64, v72
  v_add_f32 v65, v65, v73
  buffer_load_dwordx4 v253, s[28:31], s5 offen offset:3072 sc1 lds
  s_add_u32 s5, s74, s15
  v_add_f32 v66, v66, v74
  v_add_f32 v67, v67, v75
  v_add_f32 v68, v68, v76
  v_add_f32 v69, v69, v77
  v_add_f32 v70, v70, v78
  v_add_f32 v71, v71, v79
  v_cvt_pk_bf16_f32 v212, v64, v65
  buffer_load_dword v250, v248, s[28:31], s6 offen sc1
  v_cvt_pk_bf16_f32 v213, v66, v67
  v_cvt_pk_bf16_f32 v214, v68, v69
  v_cvt_pk_bf16_f32 v215, v70, v71
  v_and_b32 v173, 16, v254
  v_cmp_ne_u32 vcc, 0, v173
  v_mfma_f32_32x32x16_bf16 v[64:79], v[208:211], v[128:131], 0
  v_mfma_f32_32x32x16_bf16 v[64:79], v[212:215], v[132:135], v[64:79]
  s_branch L_idle1
L_idle0:
  buffer_load_dwordx4 v253, s[28:31], s4 offen offset:0 sc1 lds
  s_lshl_b32 s52, s94, 12
  s_add_u32 s52, s52, 73728
  v_add_u32 v175, s52, v253
  ds_read_b128 v[208:211], v175 offset:0
  ds_read_b128 v[212:215], v175 offset:1024
  ds_read_b128 v[128:131], v175 offset:2048
  ds_read_b128 v[132:135], v175 offset:3072
  v_mov_b32 v136, 0x3f803f80
  v_mov_b32 v137, 0x3f803f80
  v_mov_b32 v138, 0x3f803f80
  v_mov_b32 v139, 0x3f803f80
  s_lshl_b32 s52, s96, 2
  s_add_u32 s52, s52, s94
  s_lshl_b32 s52, s52, 12
  buffer_load_dwordx4 v253, s[28:31], s4 offen offset:1024 sc1 lds
  s_mov_b32 s7, s82
  s_cmp_ge_u32 s77, s91
  s_addc_u32 s82, s77, 0
  s_add_u32 s52, s52, 54525952
  s_waitcnt lgkmcnt(0)
  v_lshlrev_b32 v64, 16, v208
  v_and_b32 v65, 0xffff0000, v208
  v_lshlrev_b32 v66, 16, v209
  v_and_b32 v67, 0xffff0000, v209
  v_lshlrev_b32 v68, 16, v210
  v_and_b32 v69, 0xffff0000, v210
  v_lshlrev_b32 v70, 16, v211
  v_and_b32 v71, 0xffff0000, v211
  v_mul_f32 v72, s20, v64
  v_mul_f32 v73, s20, v65
  v_mul_f32 v74, s20, v66
  v_mul_f32 v75, s20, v67
  buffer_load_dwordx4 v253, s[28:31], s4 offen offset:2048 sc1 lds
  s_cmp_lg_u32 s94, 0
  s_cselect_b32 s15, s82, s7
  s_lshl_b32 s15, s15, 15
  v_mul_f32 v76, s20, v68
  v_mul_f32 v77, s20, v69
  v_mul_f32 v78, s20, v70
  v_mul_f32 v79, s20, v71
  v_exp_f32_e64 v72, v72 clamp
  v_max_f32 v64, 0, v64
  v_exp_f32_e64 v73, v73 clamp
  v_max_f32 v65, 0, v65
  v_exp_f32_e64 v74, v74 clamp
  v_max_f32 v66, 0, v66
  v_exp_f32_e64 v75, v75 clamp
  v_max_f32 v67, 0, v67
  v_exp_f32_e64 v76, v76 clamp
  v_max_f32 v68, 0, v68
  buffer_load_dwordx4 v253, s[28:31], s4 offen offset:3072 sc1 lds
  s_sub_u32 s14, 15, s82
  s_min_u32 s14, s14, s82
  v_exp_f32_e64 v77, v77 clamp
  v_max_f32 v69, 0, v69
  v_exp_f32_e64 v78, v78 clamp
  v_max_f32 v70, 0, v70
  v_exp_f32_e64 v79, v79 clamp
  v_max_f32 v71, 0, v71
  v_add_f32 v64, s22, v64
  v_add_f32 v65, s22, v65
  v_add_f32 v66, s22, v66
  v_add_f32 v67, s22, v67
  v_add_f32 v68, s22, v68
  v_add_f32 v69, s22, v69
  v_add_f32 v70, s22, v70
  v_add_f32 v71, s22, v71
  s_add_u32 m0, m0, 4096
  s_add_u32 s4, s4, 4096
  buffer_load_dwordx4 v253, s[28:31], s4 offen offset:0 sc1 lds
  v_add_f32 v64, v64, v72
  v_add_f32 v65, v65, v73
  v_add_f32 v66, v66, v74
  v_add_f32 v67, v67, v75
  v_add_f32 v68, v68, v76
  v_add_f32 v69, v69, v77
  v_add_f32 v70, v70, v78
  v_add_f32 v71, v71, v79
  v_cvt_pk_bf16_f32 v208, v64, v65
  v_cvt_pk_bf16_f32 v209, v66, v67
  v_cvt_pk_bf16_f32 v210, v68, v69
  v_cvt_pk_bf16_f32 v211, v70, v71
  v_lshlrev_b32 v64, 16, v212
  buffer_load_dwordx4 v253, s[28:31], s4 offen offset:1024 sc1 lds
  s_lshl_b32 s14, s14, 3
  s_lshl_b64 s[8:9], 0xff, s14
  v_and_b32 v65, 0xffff0000, v212
  v_lshlrev_b32 v66, 16, v213
  v_and_b32 v67, 0xffff0000, v213
  v_lshlrev_b32 v68, 16, v214
  v_and_b32 v69, 0xffff0000, v214
  v_lshlrev_b32 v70, 16, v215
  v_and_b32 v71, 0xffff0000, v215
  v_mul_f32 v72, s20, v64
  v_mul_f32 v73, s20, v65
  v_mul_f32 v74, s20, v66
  v_mul_f32 v75, s20, v67
  v_mul_f32 v76, s20, v68
  v_mul_f32 v77, s20, v69
  v_mul_f32 v78, s20, v70
  buffer_load_dwordx4 v253, s[28:31], s4 offen offset:2048 sc1 lds
  s_lshr_b32 s14, s82, 3
  s_lshl_b32 s6, s14, 5
  v_mul_f32 v79, s20, v71
  v_exp_f32_e64 v72, v72 clamp
  v_max_f32 v64, 0, v64
  v_exp_f32_e64 v73, v73 clamp
  v_max_f32 v65, 0, v65
  v_exp_f32_e64 v74, v74 clamp
  v_max_f32 v66, 0, v66
  v_exp_f32_e64 v75, v75 clamp
  v_max_f32 v67, 0, v67
  v_exp_f32_e64 v76, v76 clamp
  v_max_f32 v68, 0, v68
  v_exp_f32_e64 v77, v77 clamp
  v_max_f32 v69, 0, v69
  v_exp_f32_e64 v78, v78 clamp
  buffer_load_dwordx4 v253, s[28:31], s4 offen offset:3072 sc1 lds
  s_lshl_b32 s14, s82, 15
  s_add_u32 s4, s73, s14
  v_max_f32 v70, 0, v70
  v_exp_f32_e64 v79, v79 clamp
  v_max_f32 v71, 0, v71
  v_add_f32 v64, s22, v64
  v_add_f32 v65, s22, v65
  v_add_f32 v66, s22, v66
  v_add_f32 v67, s22, v67
  v_add_f32 v68, s22, v68
  v_add_f32 v69, s22, v69
  v_add_f32 v70, s22, v70
  v_add_f32 v71, s22, v71
  v_add_f32 v64, v64, v72
  v_add_f32 v65, v65, v73
  v_add_f32 v66, v66, v74
  s_xor_b32 s75, s75, 0x8000
  s_xor_b32 s76, s76, 0x38000
  s_add_u32 s5, s74, s15
  buffer_load_dword v250, v248, s[28:31], s6 offen sc1
  v_add_f32 v67, v67, v75
  v_add_f32 v68, v68, v76
  v_add_f32 v69, v69, v77
  v_add_f32 v70, v70, v78
  v_add_f32 v71, v71, v79
  v_cvt_pk_bf16_f32 v212, v64, v65
  v_cvt_pk_bf16_f32 v213, v66, v67
  v_cvt_pk_bf16_f32 v214, v68, v69
  v_cvt_pk_bf16_f32 v215, v70, v71
  v_and_b32 v173, 16, v254
  v_cmp_ne_u32 vcc, 0, v173
  v_mfma_f32_32x32x16_bf16 v[64:79], v[208:211], v[128:131], 0
  v_mfma_f32_32x32x16_bf16 v[64:79], v[212:215], v[132:135], v[64:79]
L_idle1:
  s_nop 11
  v_cndmask_b32 v128, v64, v72, vcc
  v_cndmask_b32 v129, v65, v73, vcc
  v_cndmask_b32 v130, v66, v74, vcc
  v_cndmask_b32 v131, v67, v75, vcc
  v_cndmask_b32 v132, v68, v76, vcc
  v_cndmask_b32 v133, v69, v77, vcc
  v_cndmask_b32 v134, v70, v78, vcc
  v_cndmask_b32 v135, v71, v79, vcc
  v_mfma_f32_32x32x16_bf16 v[64:79], v[208:211], v[136:139], 0
  v_mfma_f32_32x32x16_bf16 v[64:79], v[212:215], v[136:139], v[64:79]
  buffer_store_dwordx4 v[128:131], v253, s[28:31], s52 offen offset:0 sc1
  buffer_store_dwordx4 v[132:135], v253, s[28:31], s52 offen offset:1024 sc1
  s_nop 9
  v_cndmask_b32 v136, v64, v72, vcc
  v_cndmask_b32 v137, v65, v73, vcc
  v_cndmask_b32 v138, v66, v74, vcc
  v_cndmask_b32 v139, v67, v75, vcc
  v_cndmask_b32 v140, v68, v76, vcc
  v_cndmask_b32 v141, v69, v77, vcc
  v_cndmask_b32 v142, v70, v78, vcc
  v_cndmask_b32 v143, v71, v79, vcc
  buffer_store_dwordx4 v[136:139], v253, s[28:31], s52 offen offset:2048 sc1
  buffer_store_dwordx4 v[140:143], v253, s[28:31], s52 offen offset:3072 sc1
  s_waitcnt vmcnt(4)
  s_barrier
  s_mov_b32 s77, 2
L_ndj_150:
  v_cmp_ne_u32 vcc, 1, v250
  s_mov_b32 m0, s75
  s_nop 0
  s_and_b64 s[62:63], vcc, s[8:9]
  s_cbranch_scc0 L_ndokj_151
  s_sleep 1
  buffer_load_dword v250, v248, s[28:31], s6 offen sc1
  s_waitcnt vmcnt(0)
  s_sub_u32 s99, s99, 1
  s_cbranch_scc0 L_ndj_150
  s_mov_b32 s99, 0
L_ndokj_151:
  buffer_load_dwordx4 v253, s[28:31], s4 offen offset:0 sc1 lds
  v_lshrrev_b32 v173, 3, v254
  v_lshlrev_b32 v173, 10, v173
  v_bfe_u32 v174, v254, 4, 1
  v_lshlrev_b32 v174, 2, v174
  v_and_b32 v175, 7, v254
  v_xor_b32 v175, v175, v174
  v_lshl_add_u32 v173, v175, 4, v173
  s_lshl_b32 s52, s72, 1
  s_and_b32 s53, s91, 1
  buffer_load_dwordx4 v253, s[28:31], s4 offen offset:1024 sc1 lds
  s_mov_b32 s7, s82
  s_cmp_ge_u32 s77, s91
  s_addc_u32 s82, s77, 0
  s_add_u32 s52, s52, s53
  s_lshl_b32 s52, s52, 7
  v_add_u32 v173, s52, v173
  s_lshr_b32 s54, s90, 2
  s_lshl_b32 s54, s54, 2
  s_lshr_b32 s53, s91, 1
  s_add_u32 s54, s54, s53
  s_lshl_b32 s52, s54, 17
  buffer_load_dwordx4 v253, s[28:31], s4 offen offset:2048 sc1 lds
  s_cmp_lg_u32 s94, 0
  s_cselect_b32 s15, s82, s7
  s_lshl_b32 s15, s15, 15
  s_lshr_b32 s53, s94, 1
  s_lshl_b32 s53, s53, 15
  s_add_u32 s52, s52, s53
  s_and_b32 s53, s94, 1
  s_lshl_b32 s53, s53, 13
  s_add_u32 s52, s52, s53
  s_lshl_b32 s55, s94, 12
  s_andn2_b32 s18, s90, 7
  buffer_load_dwordx4 v253, s[28:31], s4 offen offset:3072 sc1 lds
  s_sub_u32 s14, 15, s82
  s_min_u32 s14, s14, s82
  s_lshr_b32 s56, s80, 1
  s_lshl_b32 s56, s56, 2
  s_add_u32 s18, s18, s56
  s_lshl_b32 s18, s18, 3
  s_add_u32 s18, s18, s91
  s_lshl_b32 s18, s18, 3
  s_and_b32 s56, s90, 7
  s_add_u32 s18, s18, s56
  s_add_u32 m0, m0, 4096
  s_add_u32 s4, s4, 4096
  buffer_load_dwordx4 v253, s[28:31], s4 offen offset:0 sc1 lds
  s_lshl_b32 s18, s18, 4
  s_add_u32 s18, s18, s93
  s_lshl_b32 s18, s18, 1
  s_and_b32 s56, s80, 1
  s_add_u32 s18, s18, s56
  s_lshl_b32 s18, s18, 2
  s_add_u32 s18, s18, 61079552
  s_lshl_b32 s56, s79, 2
  buffer_load_dwordx4 v253, s[28:31], s4 offen offset:1024 sc1 lds
  s_lshl_b32 s14, s14, 3
  s_lshl_b64 s[8:9], 0xff, s14
  s_add_u32 s56, s56, s80
  s_mul_i32 s56, s56, 288
  s_lshl_b32 s57, s90, 3
  s_add_u32 s56, s56, s57
  s_lshl_b32 s56, s56, 10
  s_add_u32 s65, s56, 33554432
  s_mul_i32 s56, s92, 36864
  s_add_u32 s2, s1, s56
  s_bfe_u32 s56, s90, 0x10002
  buffer_load_dwordx4 v253, s[28:31], s4 offen offset:2048 sc1 lds
  s_lshr_b32 s14, s82, 3
  s_lshl_b32 s6, s14, 5
  s_lshl_b32 s56, s56, 1
  s_add_u32 s56, s56, s93
  s_lshl_b32 s57, s91, 2
  s_sub_u32 s58, 60, s57
  s_add_u32 s57, s57, s56
  s_add_u32 s58, s58, s56
  s_cmp_eq_u32 s91, 7
  s_cselect_b32 s19, s58, s57
  s_cselect_b32 s21, s57, s58
  s_cselect_b32 s47, 0x33, 0xcc
  buffer_load_dwordx4 v253, s[28:31], s4 offen offset:3072 sc1 lds
  s_lshl_b32 s14, s82, 15
  s_add_u32 s4, s73, s14
  s_lshl_b32 s56, s71, 13
  s_lshl_b32 s57, s72, 8
  s_add_u32 s56, s56, s57
  s_lshl_b32 s66, s19, 15
  s_add_u32 s66, s66, s56
  s_lshl_b32 s67, s21, 15
  s_mov_b32 m0, s76
  s_xor_b32 s75, s75, 0x8000
  buffer_load_dwordx4 v253, s[28:31], s5 offen offset:0 sc1 lds
  s_add_u32 s67, s67, s56
  s_lshl_b32 s56, s71, 3
  s_add_u32 s56, s56, s92
  s_lshl_b32 s57, s56, 13
  s_add_u32 s57, s57, 33554432
  s_mul_i32 s19, s19, 294912
  s_add_u32 s19, s19, s57
  s_mul_i32 s21, s21, 294912
  buffer_load_dwordx4 v253, s[28:31], s5 offen offset:1024 sc1 lds
  s_xor_b32 s76, s76, 0x38000
  s_add_u32 s21, s21, s57
  s_mul_i32 s24, s56, 7168
  s_sub_u32 s24, 253952, s24
  s_mul_i32 s56, s94, 3072
  s_bitcmp1_b32 s97, 0
  s_cselect_b32 s57, 49152, 0
  s_cselect_b32 s58, 0, 49152
  s_cmp_eq_u32 s93, 0
  s_cselect_b32 s25, 73728, s57
  s_cselect_b32 s26, 24576, s58
  s_cselect_b32 s44, s57, 73728
  s_cselect_b32 s45, s58, 24576
  s_cselect_b32 s27, 0, 24
  s_cselect_b32 s23, 1, -1
  buffer_load_dwordx4 v253, s[28:31], s5 offen offset:2048 sc1 lds
  s_mul_i32 s68, s23, 327680
  s_add_u32 s68, s68, s19
  buffer_load_dwordx4 v253, s[28:31], s5 offen offset:3072 sc1 lds
  s_mul_i32 s23, s23, 294912
  s_lshl_b32 s27, s27, 10
  s_add_u32 s27, s27, 98304
  s_add_u32 s25, s25, s56
  s_add_u32 s26, s26, s56
  s_add_u32 s27, s27, s56
  s_add_u32 s44, s44, s56
  s_add_u32 s45, s45, s56
  s_mov_b32 s46, 0
  s_add_u32 m0, m0, 4096
  s_add_u32 s5, s5, 4096
  buffer_load_dwordx4 v253, s[28:31], s5 offen offset:0 sc1 lds
  s_mov_b32 s10, 0x2905
  s_mov_b32 s11, 0x770043
  s_mov_b32 s12, 0x84010000
  s_mov_b32 s13, 0x200
  s_cmp_eq_u32 s91, 1
  s_cselect_b32 s10, 0x30002905, s10
  s_cselect_b32 s11, 0x77004, s11
  s_cselect_b32 s12, 0x8410000, s12
  s_cselect_b32 s13, 0x20, s13
  buffer_load_dwordx4 v253, s[28:31], s5 offen offset:1024 sc1 lds
  s_cmp_eq_u32 s91, 2
  s_cselect_b32 s10, 0x43000295, s10
  s_cselect_b32 s11, 0x7700, s11
  s_cselect_b32 s12, 0x841000, s12
  s_cselect_b32 s13, 0x2, s13
  s_cmp_eq_u32 s91, 3
  s_cselect_b32 s10, 0x4300295, s10
  s_cselect_b32 s11, 0x770, s11
  s_cselect_b32 s12, 0x20085000, s12
  s_cselect_b32 s13, 0x0, s13
  buffer_load_dwordx4 v253, s[28:31], s5 offen offset:2048 sc1 lds
  s_cmp_eq_u32 s91, 4
  s_cselect_b32 s10, 0x430295, s10
  s_cselect_b32 s11, 0x77, s11
  s_cselect_b32 s12, 0x2085000, s12
  s_cselect_b32 s13, 0x0, s13
  buffer_load_dwordx4 v253, s[28:31], s5 offen offset:3072 sc1 lds
  s_add_u32 s5, s74, s15
  s_cmp_eq_u32 s91, 5
  s_cselect_b32 s10, 0x70430295, s10
  s_cselect_b32 s11, 0x7, s11
  s_cselect_b32 s12, 0x2085000, s12
  s_cselect_b32 s13, 0x0, s13
  s_cmp_eq_u32 s91, 6
  s_cselect_b32 s10, 0x77430295, s10
  s_cselect_b32 s11, 0x0, s11
  s_cselect_b32 s12, 0x2085000, s12
  s_cselect_b32 s13, 0x0, s13
  buffer_load_dword v250, v248, s[28:31], s6 offen sc1
  s_cmp_eq_u32 s91, 7
  s_cselect_b32 s10, 0x7630295, s10
  s_cselect_b32 s11, 0x0, s11
  s_cselect_b32 s12, 0x2085000, s12
  s_cselect_b32 s13, 0x0, s13
  s_mov_b32 s85, 5
  s_add_u32 m0, s55, 73728
  s_add_u32 s53, s52, 0
  buffer_load_dwordx4 v173, s[32:35], s53 offen offset:0 lds
  s_add_u32 s53, s52, 15360
  buffer_load_dwordx4 v173, s[32:35], s53 offen offset:1024 lds
  s_add_u32 s53, s52, 63488
  buffer_load_dwordx4 v173, s[32:35], s53 offen offset:2048 lds
  s_add_u32 s53, s52, 78848
  buffer_load_dwordx4 v173, s[32:35], s53 offen offset:3072 lds
  s_waitcnt vmcnt(21)
  v_mov_b32 v174, 1
  v_mov_b32 v175, 0
  s_lshl_b32 s52, s96, 7
  s_lshl_b32 s53, s94, 2
  s_add_u32 s52, s52, s53
  s_add_u32 s52, s52, 60817408
  s_mov_b64 exec, 1
  buffer_store_dword v174, v175, s[28:31], s52 offen offset:16 sc1
  s_mov_b64 exec, -1
  s_mov_b32 s64, 5
  s_cmp_lg_u32 s94, 0
  s_cbranch_scc1 L_wt1
  s_mov_b32 s64, 7
  s_lshl_b32 s52, s54, 14
  s_mov_b32 m0, 90112
  s_add_u32 s53, s52, 7168
  buffer_load_dwordx4 v173, s[36:39], s52 offen lds
  buffer_load_dwordx4 v173, s[36:39], s53 offen offset:1024 lds
L_wt1:
  s_min_u32 s3, s91, 1
  s_lshl_b32 s3, s3, 2
  s_setpc_b64 s[88:89]
L_hook1:
  s_min_u32 s3, s91, 1
  s_lshl_b32 s3, s3, 2
  s_mov_b32 s84, 0
L_hook1x:
  s_setpc_b64 s[88:89]
L_h2c1:
  s_cmp_lt_u32 s3, 16
  s_cbranch_scc1 L_h2e1
  s_add_u32 s60, s2, 0
  buffer_load_dwordx4 v[216:219], v253, s[28:31], s60 offen offset:0 sc1
  buffer_load_dwordx4 v[220:223], v253, s[28:31], s60 offen offset:1024 sc1
  buffer_load_dwordx4 v[224:227], v253, s[28:31], s60 offen offset:2048 sc1
  buffer_load_dwordx4 v[228:231], v253, s[28:31], s60 offen offset:3072 sc1
  s_branch L_h2b1
L_h2e1:
  s_sub_u32 s3, s3, 1
  s_cmp_lt_u32 s3, 2
  s_cbranch_scc1 L_h2d1
  s_add_u32 s61, s70, 8192
  buffer_store_dwordx4 v[216:219], v253, s[28:31], s70 offen offset:0 sc1
  buffer_store_dwordx4 v[220:223], v253, s[28:31], s70 offen offset:1024 sc1
  s_branch L_h2b1
L_h2d1:
  s_add_u32 s61, s70, 8192
  buffer_store_dwordx4 v[232:235], v253, s[28:31], s61 offen offset:0 sc1
  buffer_store_dwordx4 v[236:239], v253, s[28:31], s61 offen offset:1024 sc1
  s_branch L_h2b1
L_h2c2:
  s_cmp_lt_u32 s3, 16
  s_cbranch_scc1 L_h2e2
  s_add_u32 s60, s2, 4096
  buffer_load_dwordx4 v[232:235], v253, s[28:31], s60 offen offset:0 sc1
  buffer_load_dwordx4 v[236:239], v253, s[28:31], s60 offen offset:1024 sc1
  buffer_load_dwordx4 v[240:243], v253, s[28:31], s60 offen offset:2048 sc1
  buffer_load_dwordx4 v[244:247], v253, s[28:31], s60 offen offset:3072 sc1
  s_mov_b32 s3, 0
  s_branch L_h2b2
L_h2e2:
  s_sub_u32 s3, s3, 1
  s_cmp_lt_u32 s3, 2
  s_cbranch_scc1 L_h2d2
  s_add_u32 s61, s70, 8192
  buffer_store_dwordx4 v[224:227], v253, s[28:31], s70 offen offset:2048 sc1
  buffer_store_dwordx4 v[228:231], v253, s[28:31], s70 offen offset:3072 sc1
  s_branch L_h2b2
L_h2d2:
  s_add_u32 s61, s70, 8192
  buffer_store_dwordx4 v[240:243], v253, s[28:31], s61 offen offset:2048 sc1
  buffer_store_dwordx4 v[244:247], v253, s[28:31], s61 offen offset:3072 sc1
  s_branch L_h2b2
L_tr0:
  s_call_b64 s[86:87], L_rare1
  s_branch L_bk0
L_tr1:
  s_call_b64 s[86:87], L_rare0
  s_branch L_bk1
L_tr2:
  s_call_b64 s[86:87], L_rare1
  s_branch L_bk2
L_tr3:
  s_call_b64 s[86:87], L_rare0
  s_branch L_bk3
L_tr4:
  s_call_b64 s[86:87], L_rare0
  s_branch L_bk4
L_tr5:
  s_call_b64 s[86:87], L_rare1
  s_branch L_bk5
L_tr6:
  s_call_b64 s[86:87], L_rare0
  s_branch L_bk6
L_tr7:
  s_call_b64 s[86:87], L_rare1
  s_branch L_bk7
L_rare0:
  v_log_f32 v212, v104
  v_log_f32 v213, v108
  s_mov_b32 s56, 0x5f800000
  s_nop 15
  v_max3_f32 v208, v64, v65, v66
  v_max3_f32 v210, v67, v68, v69
  v_max3_f32 v209, v72, v73, v74
  v_max3_f32 v211, v75, v76, v77
  v_max3_f32 v208, v208, v70, v71
  v_max3_f32 v209, v209, v78, v79
  v_max_f32 v208, v208, v210
  v_max_f32 v209, v209, v211
  v_mov_b32 v210, v208
  v_mov_b32 v211, v209
  s_nop 0
  v_permlane16_swap_b32 v208, v210
  v_permlane16_swap_b32 v209, v211
  s_nop 0
  v_max_f32 v208, v208, v210
  v_max_f32 v209, v209, v211
  v_mov_b32 v210, v208
  v_mov_b32 v211, v209
  s_nop 0
  v_permlane32_swap_b32 v208, v210
  v_permlane32_swap_b32 v209, v211
  s_nop 0
  v_max_f32 v208, v208, v210
  v_max_f32 v209, v209, v211
  v_cmp_gt_f32 s[52:53], s56, v104
  v_cmp_gt_f32 s[54:55], s56, v108
  s_nop 0
  v_cndmask_b32 v208, v208, v212, s[52:53]
  v_cndmask_b32 v209, v209, v213, s[54:55]
  v_ceil_f32 v208, v208
  v_ceil_f32 v209, v209
  v_max_f32 v208, 0, v208
  v_max_f32 v209, 0, v209
  v_exp_f32 v210, -v208
  v_exp_f32 v211, -v209
  v_sub_f32 v64, v64, v208
  v_sub_f32 v65, v65, v208
  v_sub_f32 v66, v66, v208
  v_sub_f32 v67, v67, v208
  v_sub_f32 v68, v68, v208
  v_sub_f32 v69, v69, v208
  v_sub_f32 v70, v70, v208
  v_sub_f32 v71, v71, v208
  v_sub_f32 v72, v72, v209
  v_sub_f32 v73, v73, v209
  v_sub_f32 v74, v74, v209
  v_sub_f32 v75, v75, v209
  v_sub_f32 v76, v76, v209
  v_sub_f32 v77, v77, v209
  v_sub_f32 v78, v78, v209
  v_sub_f32 v79, v79, v209
  v_sub_f32 v80, v80, v208
  v_sub_f32 v81, v81, v208
  v_sub_f32 v82, v82, v208
  v_sub_f32 v83, v83, v208
  v_sub_f32 v84, v84, v208
  v_sub_f32 v85, v85, v208
  v_sub_f32 v86, v86, v208
  v_sub_f32 v87, v87, v208
  v_sub_f32 v88, v88, v209
  v_sub_f32 v89, v89, v209
  v_sub_f32 v90, v90, v209
  v_sub_f32 v91, v91, v209
  v_sub_f32 v92, v92, v209
  v_sub_f32 v93, v93, v209
  v_sub_f32 v94, v94, v209
  v_sub_f32 v95, v95, v209
  v_sub_f32 v96, v96, v208
  v_sub_f32 v97, v97, v208
  v_sub_f32 v98, v98, v208
  v_sub_f32 v99, v99, v208
  v_sub_f32 v100, v100, v209
  v_sub_f32 v101, v101, v209
  v_sub_f32 v102, v102, v209
  v_sub_f32 v103, v103, v209
  v_mul_f32 v0, v0, v210
  v_mul_f32 v1, v1, v210
  v_mul_f32 v2, v2, v210
  v_mul_f32 v3, v3, v210
  v_mul_f32 v4, v4, v210
  v_mul_f32 v5, v5, v210
  v_mul_f32 v6, v6, v210
  v_mul_f32 v7, v7, v210
  v_mul_f32 v8, v8, v210
  v_mul_f32 v9, v9, v210
  v_mul_f32 v10, v10, v210
  v_mul_f32 v11, v11, v210
  v_mul_f32 v12, v12, v210
  v_mul_f32 v13, v13, v210
  v_mul_f32 v14, v14, v210
  v_mul_f32 v15, v15, v210
  v_mul_f32 v16, v16, v210
  v_mul_f32 v17, v17, v210
  v_mul_f32 v18, v18, v210
  v_mul_f32 v19, v19, v210
  v_mul_f32 v20, v20, v210
  v_mul_f32 v21, v21, v210
  v_mul_f32 v22, v22, v210
  v_mul_f32 v23, v23, v210
  v_mul_f32 v24, v24, v210
  v_mul_f32 v25, v25, v210
  v_mul_f32 v26, v26, v210
  v_mul_f32 v27, v27, v210
  v_mul_f32 v28, v28, v210
  v_mul_f32 v29, v29, v210
  v_mul_f32 v30, v30, v210
  v_mul_f32 v31, v31, v210
  v_mul_f32 v32, v32, v211
  v_mul_f32 v33, v33, v211
  v_mul_f32 v34, v34, v211
  v_mul_f32 v35, v35, v211
  v_mul_f32 v36, v36, v211
  v_mul_f32 v37, v37, v211
  v_mul_f32 v38, v38, v211
  v_mul_f32 v39, v39, v211
  v_mul_f32 v40, v40, v211
  v_mul_f32 v41, v41, v211
  v_mul_f32 v42, v42, v211
  v_mul_f32 v43, v43, v211
  v_mul_f32 v44, v44, v211
  v_mul_f32 v45, v45, v211
  v_mul_f32 v46, v46, v211
  v_mul_f32 v47, v47, v211
  v_mul_f32 v48, v48, v211
  v_mul_f32 v49, v49, v211
  v_mul_f32 v50, v50, v211
  v_mul_f32 v51, v51, v211
  v_mul_f32 v52, v52, v211
  v_mul_f32 v53, v53, v211
  v_mul_f32 v54, v54, v211
  v_mul_f32 v55, v55, v211
  v_mul_f32 v56, v56, v211
  v_mul_f32 v57, v57, v211
  v_mul_f32 v58, v58, v211
  v_mul_f32 v59, v59, v211
  v_mul_f32 v60, v60, v211
  v_mul_f32 v61, v61, v211
  v_mul_f32 v62, v62, v211
  v_mul_f32 v63, v63, v211
  v_mul_f32 v104, v104, v210
  v_mul_f32 v108, v108, v211
  v_exp_f32 v160, v64
  s_nop 0
  v_exp_f32 v161, v65
  s_nop 0
  v_cvt_pk_bf16_f32 v112, v160, v161
  s_nop 0
  v_exp_f32 v162, v66
  s_nop 0
  v_exp_f32 v163, v67
  s_nop 0
  v_exp_f32 v160, v72
  s_nop 0
  v_cvt_pk_bf16_f32 v113, v162, v163
  s_nop 0
  v_exp_f32 v161, v73
  s_nop 0
  v_exp_f32 v162, v74
  s_nop 0
  v_cvt_pk_bf16_f32 v116, v160, v161
  s_nop 0
  v_exp_f32 v163, v75
  s_nop 0
  v_exp_f32 v160, v68
  s_nop 0
  v_cvt_pk_bf16_f32 v117, v162, v163
  s_nop 0
  v_exp_f32 v161, v69
  s_nop 0
  v_exp_f32 v162, v70
  s_nop 0
  v_cvt_pk_bf16_f32 v114, v160, v161
  s_nop 0
  v_exp_f32 v163, v71
  s_nop 0
  v_exp_f32 v160, v76
  s_nop 0
  v_cvt_pk_bf16_f32 v115, v162, v163
  s_nop 0
  v_exp_f32 v161, v77
  s_nop 0
  v_exp_f32 v162, v78
  s_nop 0
  v_cvt_pk_bf16_f32 v118, v160, v161
  s_nop 0
  v_exp_f32 v163, v79
  s_nop 0
  v_cvt_pk_bf16_f32 v119, v162, v163
  s_nop 0
  v_exp_f32 v160, v80
  s_nop 0
  v_exp_f32 v161, v81
  s_nop 0
  v_cvt_pk_bf16_f32 v120, v160, v161
  s_nop 0
  v_exp_f32 v162, v82
  s_nop 0
  v_exp_f32 v163, v83
  s_nop 0
  s_nop 1
  v_mfma_f32_16x16x32_bf16 v[208:211], v[164:167], v[112:115], 0
  v_mfma_f32_16x16x32_bf16 v[212:215], v[164:167], v[116:119], 0
  s_nop 7
  v_cndmask_b32 v104, v208, v104, s[52:53]
  v_cndmask_b32 v108, v212, v108, s[54:55]
  s_nop 1
  s_setpc_b64 s[86:87]
L_rare1:
  v_log_f32 v212, v104
  v_log_f32 v213, v108
  s_mov_b32 s56, 0x5f800000
  s_nop 15
  v_max3_f32 v208, v80, v81, v82
  v_max3_f32 v210, v83, v84, v85
  v_max3_f32 v209, v88, v89, v90
  v_max3_f32 v211, v91, v92, v93
  v_max3_f32 v208, v208, v86, v87
  v_max3_f32 v209, v209, v94, v95
  v_max_f32 v208, v208, v210
  v_max_f32 v209, v209, v211
  v_mov_b32 v210, v208
  v_mov_b32 v211, v209
  s_nop 0
  v_permlane16_swap_b32 v208, v210
  v_permlane16_swap_b32 v209, v211
  s_nop 0
  v_max_f32 v208, v208, v210
  v_max_f32 v209, v209, v211
  v_mov_b32 v210, v208
  v_mov_b32 v211, v209
  s_nop 0
  v_permlane32_swap_b32 v208, v210
  v_permlane32_swap_b32 v209, v211
  s_nop 0
  v_max_f32 v208, v208, v210
  v_max_f32 v209, v209, v211
  v_cmp_gt_f32 s[52:53], s56, v104
  v_cmp_gt_f32 s[54:55], s56, v108
  s_nop 0
  v_cndmask_b32 v208, v208, v212, s[52:53]
  v_cndmask_b32 v209, v209, v213, s[54:55]
  v_ceil_f32 v208, v208
  v_ceil_f32 v209, v209
  v_max_f32 v208, 0, v208
  v_max_f32 v209, 0, v209
  v_exp_f32 v210, -v208
  v_exp_f32 v211, -v209
  v_sub_f32 v64, v64, v208
  v_sub_f32 v65, v65, v208
  v_sub_f32 v66, v66, v208
  v_sub_f32 v67, v67, v208
  v_sub_f32 v68, v68, v208
  v_sub_f32 v69, v69, v208
  v_sub_f32 v70, v70, v208
  v_sub_f32 v71, v71, v208
  v_sub_f32 v72, v72, v209
  v_sub_f32 v73, v73, v209
  v_sub_f32 v74, v74, v209
  v_sub_f32 v75, v75, v209
  v_sub_f32 v76, v76, v209
  v_sub_f32 v77, v77, v209
  v_sub_f32 v78, v78, v209
  v_sub_f32 v79, v79, v209
  v_sub_f32 v80, v80, v208
  v_sub_f32 v81, v81, v208
  v_sub_f32 v82, v82, v208
  v_sub_f32 v83, v83, v208
  v_sub_f32 v84, v84, v208
  v_sub_f32 v85, v85, v208
  v_sub_f32 v86, v86, v208
  v_sub_f32 v87, v87, v208
  v_sub_f32 v88, v88, v209
  v_sub_f32 v89, v89, v209
  v_sub_f32 v90, v90, v209
  v_sub_f32 v91, v91, v209
  v_sub_f32 v92, v92, v209
  v_sub_f32 v93, v93, v209
  v_sub_f32 v94, v94, v209
  v_sub_f32 v95, v95, v209
  v_sub_f32 v96, v96, v208
  v_sub_f32 v97, v97, v208
  v_sub_f32 v98, v98, v208
  v_sub_f32 v99, v99, v208
  v_sub_f32 v100, v100, v209
  v_sub_f32 v101, v101, v209
  v_sub_f32 v102, v102, v209
  v_sub_f32 v103, v103, v209
  v_mul_f32 v0, v0, v210
  v_mul_f32 v1, v1, v210
  v_mul_f32 v2, v2, v210
  v_mul_f32 v3, v3, v210
  v_mul_f32 v4, v4, v210
  v_mul_f32 v5, v5, v210
  v_mul_f32 v6, v6, v210
  v_mul_f32 v7, v7, v210
  v_mul_f32 v8, v8, v210
  v_mul_f32 v9, v9, v210
  v_mul_f32 v10, v10, v210
  v_mul_f32 v11, v11, v210
  v_mul_f32 v12, v12, v210
  v_mul_f32 v13, v13, v210
  v_mul_f32 v14, v14, v210
  v_mul_f32 v15, v15, v210
  v_mul_f32 v16, v16, v210
  v_mul_f32 v17, v17, v210
  v_mul_f32 v18, v18, v210
  v_mul_f32 v19, v19, v210
  v_mul_f32 v20, v20, v210
  v_mul_f32 v21, v21, v210
  v_mul_f32 v22, v22, v210
  v_mul_f32 v23, v23, v210
  v_mul_f32 v24, v24, v210
  v_mul_f32 v25, v25, v210
  v_mul_f32 v26, v26, v210
  v_mul_f32 v27, v27, v210
  v_mul_f32 v28, v28, v210
  v_mul_f32 v29, v29, v210
  v_mul_f32 v30, v30, v210
  v_mul_f32 v31, v31, v210
  v_mul_f32 v32, v32, v211
  v_mul_f32 v33, v33, v211
  v_mul_f32 v34, v34, v211
  v_mul_f32 v35, v35, v211
  v_mul_f32 v36, v36, v211
  v_mul_f32 v37, v37, v211
  v_mul_f32 v38, v38, v211
  v_mul_f32 v39, v39, v211
  v_mul_f32 v40, v40, v211
  v_mul_f32 v41, v41, v211
  v_mul_f32 v42, v42, v211
  v_mul_f32 v43, v43, v211
  v_mul_f32 v44, v44, v211
  v_mul_f32 v45, v45, v211
  v_mul_f32 v46, v46, v211
  v_mul_f32 v47, v47, v211
  v_mul_f32 v48, v48, v211
  v_mul_f32 v49, v49, v211
  v_mul_f32 v50, v50, v211
  v_mul_f32 v51, v51, v211
  v_mul_f32 v52, v52, v211
  v_mul_f32 v53, v53, v211
  v_mul_f32 v54, v54, v211
  v_mul_f32 v55, v55, v211
  v_mul_f32 v56, v56, v211
  v_mul_f32 v57, v57, v211
  v_mul_f32 v58, v58, v211
  v_mul_f32 v59, v59, v211
  v_mul_f32 v60, v60, v211
  v_mul_f32 v61, v61, v211
  v_mul_f32 v62, v62, v211
  v_mul_f32 v63, v63, v211
  v_mul_f32 v104, v104, v210
  v_mul_f32 v108, v108, v211
  v_exp_f32 v160, v80
  s_nop 0
  v_exp_f32 v161, v81
  s_nop 0
  v_cvt_pk_bf16_f32 v120, v160, v161
  s_nop 0
  v_exp_f32 v162, v82
  s_nop 0
  v_exp_f32 v163, v83
  s_nop 0
  v_exp_f32 v160, v88
  s_nop 0
  v_cvt_pk_bf16_f32 v121, v162, v163
  s_nop 0
  v_exp_f32 v161, v89
  s_nop 0
  v_exp_f32 v162, v90
  s_nop 0
  v_cvt_pk_bf16_f32 v124, v160, v161
  s_nop 0
  v_exp_f32 v163, v91
  s_nop 0
  v_exp_f32 v160, v84
  s_nop 0
  v_cvt_pk_bf16_f32 v125, v162, v163
  s_nop 0
  v_exp_f32 v161, v85
  s_nop 0
  v_exp_f32 v162, v86
  s_nop 0
  v_cvt_pk_bf16_f32 v122, v160, v161
  s_nop 0
  v_exp_f32 v163, v87
  s_nop 0
  v_exp_f32 v160, v92
  s_nop 0
  v_cvt_pk_bf16_f32 v123, v162, v163
  s_nop 0
  v_exp_f32 v161, v93
  s_nop 0
  v_exp_f32 v162, v94
  s_nop 0
  v_cvt_pk_bf16_f32 v126, v160, v161
  s_nop 0
  v_exp_f32 v163, v95
  s_nop 0
  v_cvt_pk_bf16_f32 v127, v162, v163
  s_nop 0
  v_exp_f32 v160, v64
  s_nop 0
  v_exp_f32 v161, v65
  s_nop 0
  v_cvt_pk_bf16_f32 v112, v160, v161
  s_nop 0
  v_exp_f32 v162, v66
  s_nop 0
  v_exp_f32 v163, v67
  s_nop 0
  s_nop 1
  v_mfma_f32_16x16x32_bf16 v[208:211], v[164:167], v[120:123], 0
  v_mfma_f32_16x16x32_bf16 v[212:215], v[164:167], v[124:127], 0
  s_nop 7
  v_cndmask_b32 v104, v208, v104, s[52:53]
  v_cndmask_b32 v108, v212, v108, s[54:55]
  s_nop 1
  s_setpc_b64 s[86:87]
.section .rodata,"a"
.p2align 6
.amdhsa_kernel fused_kernel
  .amdhsa_next_free_vgpr 256
  .amdhsa_next_free_sgpr 102
  .amdhsa_accum_offset 256
  .amdhsa_group_segment_fixed_size 0
  .amdhsa_kernarg_size 104
  .amdhsa_user_sgpr_count 2
  .amdhsa_user_sgpr_kernarg_segment_ptr 1
  .amdhsa_system_sgpr_workgroup_id_x 1
.end_amdhsa_kernel
```
